```python
import torch

def _softmax(x, axis=-1):
    return torch.softmax(x, dim=axis)
def _gelu(x):
    return torch.nn.functional.gelu(x, approximate="tanh")
def _silu(x):
    return torch.nn.functional.silu(x)
def _sigmoid(x):
    return torch.sigmoid(x)
def _layernorm(x, axis=-1, eps=1e-5):
    m = x.mean(dim=axis, keepdim=True)
    v = x.var(dim=axis, keepdim=True, unbiased=False)
    return (x - m) / torch.sqrt(v + eps)
def _scatter_add(tgt, idx, src, axis=0):
    return tgt.clone().index_add_(axis, idx, src)
def _segment_sum(src, seg, n):
    out = torch.zeros((n,) + src.shape[1:], dtype=src.dtype)
    return out.index_add_(0, seg, src)
def _pad(x, pw):
    flat = tuple(v for pair in reversed(pw) for v in pair)
    return torch.nn.functional.pad(x, flat)

kernel_name = 'gated_mix__sliding_block__mixer_channel_mlp__prompt'

def setup_inputs():

    _w = (lambda a: (lambda t: t.to(torch.bfloat16) if t.is_floating_point() else t)(torch.as_tensor(a)))
    def _A_setup():
        B, S, D = 1, 2048, 576
        return {
            "x": _w((lambda *s: torch.randn(*s, dtype=torch.bfloat16) * 0.05)(B, S, D)),
            "wqkv": _w((lambda *s: torch.randn(*s, dtype=torch.bfloat16) * 0.8)(D, 3 * D)),
            "wo": _w((lambda *s: torch.randn(*s, dtype=torch.bfloat16) * 0.05)(D, D)),
        }
    _A_in = _A_setup()

    def _B_setup():
        B, S, D, F = 1, 2048, 576, 4608
        return {
            "x": _w((lambda *s: torch.randn(*s, dtype=torch.bfloat16) * 0.05)(B, S, D)),
            "w1": _w((lambda *s: torch.randn(*s, dtype=torch.bfloat16) * 3.2)(D, F) * (D ** -0.5)),
            "b1": _w((lambda *s: torch.randn(*s, dtype=torch.bfloat16) * 1.6)(F)),
            "w2": _w((lambda *s: torch.randn(*s, dtype=torch.bfloat16) * 0.1)(F, D) * (F ** -0.5)),
            "b2": _w((lambda *s: torch.randn(*s, dtype=torch.bfloat16) * 0.2)(D)),
        }
    _B_in = _B_setup()

    return {
        "A_x": _A_in["x"],
        "A_wqkv": _A_in["wqkv"],
        "A_wo": _A_in["wo"],
        "B_x": _B_in["x"],
        "B_w1": _B_in["w1"],
        "B_b1": _B_in["b1"],
        "B_w2": _B_in["w2"],
        "B_b2": _B_in["b2"],
        "gate_w": _w((lambda *s: torch.randn(*s, dtype=torch.bfloat16) * 0.05)(576) * 16.0),
    }

def reference(A_x, A_wqkv, A_wo, B_x, B_w1, B_b1, B_w2, B_b2, gate_w):
    def _A_ref(x, wqkv, wo):
        B, S, D = x.shape
        H = 32; Dh = D // H; W = 256
        qkv = (lambda x, *d: x.permute(*d))((x @ wqkv).reshape(B, S, 3, H, Dh), 2, 0, 3, 1, 4)
        q, k, v = qkv[0], qkv[1], qkv[2]
        scores = torch.einsum("bhqd,bhkd->bhqk", q, k) * (Dh ** -0.5)
        idx = torch.arange(S)
        mask = (idx[:, None] - idx[None, :] >= 0) & (idx[:, None] - idx[None, :] < W)
        scores = torch.where(mask[None, None], scores, -1e9)
        p = _softmax(scores, axis=-1)
        o = torch.einsum("bhqk,bhkd->bhqd", p, v)
        return (lambda x, *d: x.permute(*d))(o, 0, 2, 1, 3).reshape(B, S, D) @ wo

    def _B_ref(x, w1, b1, w2, b2):
        y = _layernorm(x, axis=-1)
        h = _gelu(torch.einsum("bsd,df->bsf", y, w1) + b1)
        return torch.einsum("bsf,fd->bsd", h, w2) + b2

    x = A_x
    g = _sigmoid((x * gate_w).sum(-1, keepdims=True))
    a = _A_ref(x, A_wqkv, A_wo)
    b = _B_ref(x, B_w1, B_b1, B_w2, B_b2)
    return g * a + (1 - g) * b
```

```asm
; @launch grid=(256,1,1) block=(256,1,1) lds=160000
.amdgcn_target "amdgcn-amd-amdhsa--gfx950"
.text
.globl gated_mix__sliding_block__mixer_channel_mlp__prompt_kernel
.p2align 8
.type gated_mix__sliding_block__mixer_channel_mlp__prompt_kernel,@function
gated_mix__sliding_block__mixer_channel_mlp__prompt_kernel:
    s_cmp_ge_u32 s2, 256
    s_cbranch_scc1 F_DONE
    s_load_dwordx16 s[64:79], s[0:1], 0
    s_load_dwordx8 s[4:11], s[0:1], 64
    s_getpc_b64 s[46:47]
    s_and_b32 s46, s46, 0xffffff00
    s_lshr_b32 s48, s2, 3
    s_lshl_b32 s48, s48, 12
    v_lshrrev_b32 v5, 3, v0
    v_lshl_add_u32 v5, v5, 7, s48
    v_min_u32 v5, CODE_SPAN, v5
    global_load_dword v255, v5, s[46:47]
    s_memrealtime s[44:45]
    s_getreg_b32 s37, hwreg(HW_REG_XCC_ID)
    s_and_b32 s37, s37, 15
    v_lshrrev_b32 v1, 6, v0
    v_and_b32 v0, 63, v0
    v_readfirstlane_b32 s32, v1
    s_and_b32 s46, s2, 7
    s_lshr_b32 s38, s2, 3
    s_and_b32 s35, s46, 3
    s_lshr_b32 s46, s46, 2
    s_lshl_b32 s46, s46, 3
    s_and_b32 s33, s38, 7
    s_add_u32 s33, s33, s46
    s_lshr_b32 s34, s38, 3
    s_lshl_b32 s38, s33, 2
    s_add_u32 s38, s38, s35
    s_and_b32 s46, s2, 63
    s_cmp_eq_u32 s34, 3
    s_cselect_b32 s38, s46, s38
    s_lshl_b32 s38, s38, 9
    s_add_u32 s3, s38, 28393472
    s_lshl_b32 s38, s34, 7
    s_add_u32 s38, s38, s3
    v_lshrrev_b32 v2, 3, v0
    v_and_b32 v3, 7, v0
    s_lshl_b32 s39, s33, 2
    s_add_u32 s39, s39, s32
    s_mul_i32 s40, s39, 36864
    s_waitcnt lgkmcnt(0)
    s_mov_b32 s16, s64
    s_and_b32 s17, s65, 0xffff
    s_mov_b32 s18, 0x240000
    s_mov_b32 s19, 0x00020000
    s_mov_b32 s24, s10
    s_and_b32 s25, s11, 0xffff
    s_mov_b32 s26, 0x2d1c000
    s_mov_b32 s27, 0x00020000
    s_mov_b32 s12, s8
    s_and_b32 s13, s9, 0xffff
    s_mov_b32 s14, 0x100
    s_mov_b32 s15, 0x00020000
    s_or_b32 s46, s2, s32
    s_cmp_eq_u32 s46, 0
    s_cbranch_scc0 F_NOTAG
    s_lshl_b32 s44, s44, 8
    s_max_u32 s44, s44, 0x100
    v_mov_b32 v5, s44
    v_mov_b32 v6, 0
    buffer_store_dword v5, v6, s[12:15], 0 offen sc0 sc1
F_NOTAG:
    s_cmp_eq_u32 s34, 3
    s_cbranch_scc1 K1_QKV
    s_mov_b32 s60, s4
    s_and_b32 s61, s5, 0xffff
    s_mov_b32 s62, 0x480
    s_mov_b32 s63, 0x00020000
    v_lshlrev_b32 v223, 4, v0
    s_mul_i32 s55, s32, 1280
    s_add_u32 m0, s55, 151552
    v_lshrrev_b32 v7, 1, v2
    v_xor_b32 v7, v7, v3
    v_mul_u32_u24 v12, 1152, v2
    buffer_load_dwordx4 v223, s[60:63], 0 offen lds
    buffer_load_dwordx4 v223, s[60:63], 0 offen offset:128 lds
    v_lshl_add_u32 v4, v7, 4, v12
    v_xor_b32 v5, 64, v4
    v_add_u32 v5, 8192, v5
    v_add_u32 v6, 16384, v4
    v_add_u32 v7, 16384, v5
    s_mul_i32 s49, s32, 36864
    s_add_u32 m0, s49, 0
    s_nop 0
    buffer_load_dwordx4 v4, s[16:19], s40 offen offset:0  lds
    buffer_load_dwordx4 v5, s[16:19], s40 offen offset:1024  lds
    buffer_load_dwordx4 v6, s[16:19], s40 offen offset:2048  lds
    buffer_load_dwordx4 v7, s[16:19], s40 offen offset:3072  lds
    s_add_u32 m0, s49, 4096
    s_add_u32 s40, s40, 128
    buffer_load_dwordx4 v4, s[16:19], s40 offen offset:0  lds
    buffer_load_dwordx4 v5, s[16:19], s40 offen offset:1024  lds
    buffer_load_dwordx4 v6, s[16:19], s40 offen offset:2048  lds
    buffer_load_dwordx4 v7, s[16:19], s40 offen offset:3072  lds
    s_add_u32 m0, s49, 8192
    s_add_u32 s40, s40, 128
    buffer_load_dwordx4 v4, s[16:19], s40 offen offset:0  lds
    buffer_load_dwordx4 v5, s[16:19], s40 offen offset:1024  lds
    buffer_load_dwordx4 v6, s[16:19], s40 offen offset:2048  lds
    buffer_load_dwordx4 v7, s[16:19], s40 offen offset:3072  lds
    s_add_u32 m0, s49, 12288
    s_add_u32 s40, s40, 128
    buffer_load_dwordx4 v4, s[16:19], s40 offen offset:0  lds
    buffer_load_dwordx4 v5, s[16:19], s40 offen offset:1024  lds
    buffer_load_dwordx4 v6, s[16:19], s40 offen offset:2048  lds
    buffer_load_dwordx4 v7, s[16:19], s40 offen offset:3072  lds
    s_add_u32 m0, s49, 16384
    s_add_u32 s40, s40, 128
    buffer_load_dwordx4 v4, s[16:19], s40 offen offset:0  lds
    buffer_load_dwordx4 v5, s[16:19], s40 offen offset:1024  lds
    buffer_load_dwordx4 v6, s[16:19], s40 offen offset:2048  lds
    buffer_load_dwordx4 v7, s[16:19], s40 offen offset:3072  lds
    s_mul_i32 s36, s35, 3
    s_add_u32 s36, s36, s34
    s_mov_b32 s20, s72
    s_and_b32 s21, s73, 0xffff
    s_mov_b32 s22, 0x510000
    s_mov_b32 s23, 0x00020000
    s_and_b32 s45, s39, 31
    s_mul_i32 s45, s45, 36
    v_min_u32 v253, 35, v0
    v_add_u32 v253, s45, v253
    v_lshrrev_b32 v13, 1, v253
    v_mul_u32_u24 v13, 9216, v13
    v_and_b32 v14, 1, v253
    v_lshl_add_u32 v252, v14, 7, v13
    s_mul_i32 s47, s36, 768
    s_mov_b32 s42, s47
    s_mul_i32 s45, s39, 54
    v_min_u32 v251, 53, v0
    v_add_u32 v12, s45, v251
    s_mov_b32 s45, 43691
    v_mul_lo_u32 v13, v12, s45
    v_lshrrev_b32 v13, 18, v13
    v_mul_u32_u24 v14, 6, v13
    v_sub_u32 v14, v12, v14
    v_mul_u32_u24 v13, 9216, v13
    v_lshl_add_u32 v250, v14, 7, v13
    v_lshlrev_b32 v198, 7, v251
    s_mul_i32 s45, s39, 3
    s_add_u32 s45, s45, s34
    s_mul_i32 s46, s45, 6912
    v_add_u32 v198, s46, v198
    s_mul_i32 s46, s35, 1327104
    v_add_u32 v198, s46, v198
    s_lshl_b32 s45, s45, 2
    s_add_u32 s45, s45, s35
    s_mul_i32 s45, s45, 864
    v_min_u32 v199, 7, v0
    v_lshlrev_b32 v199, 7, v199
    v_add_u32 v199, s45, v199
    s_mov_b32 s28, s74
    s_and_b32 s29, s75, 0xffff
    s_mov_b32 s30, 0x2400
    s_mov_b32 s31, 0x00020000
    s_lshl_b32 s45, s32, 8
    v_lshl_add_u32 v14, v0, 2, s45
    s_mov_b32 s60, s78
    s_and_b32 s61, s79, 0xffff
    s_mov_b32 s62, 0x480
    s_mov_b32 s63, 0x00020000
    s_cmp_eq_u32 s35, 0
    s_cselect_b32 s62, 1152, 0
    s_mul_i32 s45, s34, 384
    s_lshl_b32 s46, s32, 7
    s_add_u32 s45, s45, s46
    v_lshl_add_u32 v229, v0, 1, s45
    v_and_b32 v12, 31, v0
    v_lshrrev_b32 v13, 5, v0
    s_add_u32 s55, s55, 151552
    v_lshl_add_u32 v233, v13, 4, s55
    v_bfe_u32 v8, v0, 1, 3
    v_xor_b32 v8, v8, v13
    v_lshlrev_b32 v8, 4, v8
    v_lshl_add_u32 v8, v12, 7, v8
    v_add_u32 v8, s49, v8
    v_xor_b32 v9, 32, v8
    v_xor_b32 v10, 64, v8
    v_xor_b32 v11, 0x60, v8
    v_mov_b32 v230, 0x3f803f80
    v_mov_b32 v231, 0x00003f80
    v_mov_b32 v232, 0x3f800000
    v_mov_b32 v234, 0
    v_mov_b32 v235, 0
    v_mov_b32 v236, 0
    v_mov_b32 v237, 0
    v_mov_b32 v238, 0
    v_mov_b32 v239, 0
    v_mov_b32 v240, 0
    v_mov_b32 v241, 0
    v_mov_b32 v242, 0
    v_mov_b32 v243, 0
    v_mov_b32 v244, 0
    v_mov_b32 v245, 0
    v_bfe_u32 v12, v0, 4, 1
    v_lshlrev_b32 v13, 2, v12
    v_xor_b32 v13, v13, v3
    v_mul_u32_u24 v1, 9216, v2
    v_lshl_add_u32 v220, v13, 4, v1
    v_add_u32 v221, 72704, v220
    v_add_u32 v222, 145408, v220
    v_lshrrev_b32 v1, 5, v0
    v_lshlrev_b32 v1, 10, v1
    v_lshl_add_u32 v1, v12, 5, v1
    v_bfe_u32 v12, v0, 2, 2
    v_lshl_add_u32 v1, v12, 7, v1
    v_and_b32 v12, 1, v0
    v_lshl_add_u32 v1, v12, 4, v1
    v_bfe_u32 v12, v0, 1, 1
    v_lshl_add_u32 v1, v12, 3, v1
    v_bfe_u32 v12, v0, 3, 1
    v_lshl_add_u32 v216, v12, 6, v1
    v_and_b32 v1, 0x13, v0
    v_lshl_add_u32 v1, v12, 2, v1
    v_bfe_u32 v12, v0, 2, 1
    v_lshl_add_u32 v1, v12, 3, v1
    v_lshlrev_b32 v1, 2, v1
    v_add_u32 v224, 147456, v1
    v_accvgpr_write_b32 a49, 0
    v_accvgpr_write_b32 a50, 0
    v_accvgpr_write_b32 a51, 0
    v_mov_b32 v247, 0
    s_waitcnt vmcnt(16)
    ds_read_b128 v[16:19], v8 offset:0
    ds_read_b128 v[20:23], v9 offset:0
    ds_read_b128 v[24:27], v10 offset:0
    ds_read_b128 v[28:31], v11 offset:0
    s_add_u32 m0, s49, 20480
    s_add_u32 s40, s40, 128
    buffer_load_dwordx4 v4, s[16:19], s40 offen offset:0  lds
    buffer_load_dwordx4 v5, s[16:19], s40 offen offset:1024  lds
    buffer_load_dwordx4 v6, s[16:19], s40 offen offset:2048  lds
    buffer_load_dwordx4 v7, s[16:19], s40 offen offset:3072  lds
    ds_read_b128 v[200:203], v233 offset:0
    ds_read_b128 v[204:207], v233 offset:32
    ds_read_b128 v[208:211], v233 offset:64
    ds_read_b128 v[212:215], v233 offset:96
    s_waitcnt vmcnt(16)
    ds_read_b128 v[32:35], v8 offset:4096
    ds_read_b128 v[36:39], v9 offset:4096
    ds_read_b128 v[40:43], v10 offset:4096
    ds_read_b128 v[44:47], v11 offset:4096
    s_add_u32 m0, s49, 24576
    s_add_u32 s40, s40, 128
    buffer_load_dwordx4 v4, s[16:19], s40 offen offset:0  lds
    buffer_load_dwordx4 v5, s[16:19], s40 offen offset:1024  lds
    buffer_load_dwordx4 v6, s[16:19], s40 offen offset:2048  lds
    buffer_load_dwordx4 v7, s[16:19], s40 offen offset:3072  lds
    s_waitcnt lgkmcnt(8)
    v_dot2_f32_bf16 v234, v16, v230, v234
    v_dot2_f32_bf16 v238, v16, v16, v238
    v_dot2_f32_bf16 v235, v17, v230, v235
    v_dot2_f32_bf16 v239, v17, v17, v239
    v_dot2_f32_bf16 v236, v18, v230, v236
    v_dot2_f32_bf16 v240, v18, v18, v240
    v_dot2_f32_bf16 v237, v19, v230, v237
    v_dot2_f32_bf16 v241, v19, v19, v241
    v_dot2_f32_bf16 v234, v20, v230, v234
    v_dot2_f32_bf16 v238, v20, v20, v238
    v_dot2_f32_bf16 v235, v21, v230, v235
    v_dot2_f32_bf16 v239, v21, v21, v239
    v_dot2_f32_bf16 v236, v22, v230, v236
    v_dot2_f32_bf16 v240, v22, v22, v240
    v_dot2_f32_bf16 v237, v23, v230, v237
    v_dot2_f32_bf16 v241, v23, v23, v241
    v_dot2_f32_bf16 v234, v24, v230, v234
    v_dot2_f32_bf16 v238, v24, v24, v238
    v_dot2_f32_bf16 v235, v25, v230, v235
    v_dot2_f32_bf16 v239, v25, v25, v239
    v_dot2_f32_bf16 v236, v26, v230, v236
    v_dot2_f32_bf16 v240, v26, v26, v240
    v_dot2_f32_bf16 v237, v27, v230, v237
    v_dot2_f32_bf16 v241, v27, v27, v241
    v_dot2_f32_bf16 v234, v28, v230, v234
    v_dot2_f32_bf16 v238, v28, v28, v238
    v_dot2_f32_bf16 v235, v29, v230, v235
    v_dot2_f32_bf16 v239, v29, v29, v239
    v_dot2_f32_bf16 v236, v30, v230, v236
    v_dot2_f32_bf16 v240, v30, v30, v240
    v_dot2_f32_bf16 v237, v31, v230, v237
    v_dot2_f32_bf16 v241, v31, v31, v241
    s_waitcnt lgkmcnt(4)
    v_dot2_f32_bf16 v242, v16, v200, v242
    v_dot2_f32_bf16 v243, v17, v201, v243
    v_dot2_f32_bf16 v244, v18, v202, v244
    v_dot2_f32_bf16 v245, v19, v203, v245
    v_dot2_f32_bf16 v242, v20, v204, v242
    v_dot2_f32_bf16 v243, v21, v205, v243
    v_dot2_f32_bf16 v244, v22, v206, v244
    v_dot2_f32_bf16 v245, v23, v207, v245
    v_dot2_f32_bf16 v242, v24, v208, v242
    v_dot2_f32_bf16 v243, v25, v209, v243
    v_dot2_f32_bf16 v244, v26, v210, v244
    v_dot2_f32_bf16 v245, v27, v211, v245
    v_dot2_f32_bf16 v242, v28, v212, v242
    v_dot2_f32_bf16 v243, v29, v213, v243
    v_dot2_f32_bf16 v244, v30, v214, v244
    v_dot2_f32_bf16 v245, v31, v215, v245
    ds_read_b128 v[200:203], v233 offset:128
    ds_read_b128 v[204:207], v233 offset:160
    ds_read_b128 v[208:211], v233 offset:192
    ds_read_b128 v[212:215], v233 offset:224
    s_waitcnt vmcnt(16)
    ds_read_b128 v[48:51], v8 offset:8192
    ds_read_b128 v[52:55], v9 offset:8192
    ds_read_b128 v[56:59], v10 offset:8192
    ds_read_b128 v[60:63], v11 offset:8192
    s_add_u32 m0, s49, 28672
    s_add_u32 s40, s40, 128
    buffer_load_dwordx4 v4, s[16:19], s40 offen offset:0  lds
    buffer_load_dwordx4 v5, s[16:19], s40 offen offset:1024  lds
    buffer_load_dwordx4 v6, s[16:19], s40 offen offset:2048  lds
    buffer_load_dwordx4 v7, s[16:19], s40 offen offset:3072  lds
    s_waitcnt lgkmcnt(8)
    v_dot2_f32_bf16 v234, v32, v230, v234
    v_dot2_f32_bf16 v238, v32, v32, v238
    v_dot2_f32_bf16 v235, v33, v230, v235
    v_dot2_f32_bf16 v239, v33, v33, v239
    v_dot2_f32_bf16 v236, v34, v230, v236
    v_dot2_f32_bf16 v240, v34, v34, v240
    v_dot2_f32_bf16 v237, v35, v230, v237
    v_dot2_f32_bf16 v241, v35, v35, v241
    v_dot2_f32_bf16 v234, v36, v230, v234
    v_dot2_f32_bf16 v238, v36, v36, v238
    v_dot2_f32_bf16 v235, v37, v230, v235
    v_dot2_f32_bf16 v239, v37, v37, v239
    v_dot2_f32_bf16 v236, v38, v230, v236
    v_dot2_f32_bf16 v240, v38, v38, v240
    v_dot2_f32_bf16 v237, v39, v230, v237
    v_dot2_f32_bf16 v241, v39, v39, v241
    v_dot2_f32_bf16 v234, v40, v230, v234
    v_dot2_f32_bf16 v238, v40, v40, v238
    v_dot2_f32_bf16 v235, v41, v230, v235
    v_dot2_f32_bf16 v239, v41, v41, v239
    v_dot2_f32_bf16 v236, v42, v230, v236
    v_dot2_f32_bf16 v240, v42, v42, v240
    v_dot2_f32_bf16 v237, v43, v230, v237
    v_dot2_f32_bf16 v241, v43, v43, v241
    v_dot2_f32_bf16 v234, v44, v230, v234
    v_dot2_f32_bf16 v238, v44, v44, v238
    v_dot2_f32_bf16 v235, v45, v230, v235
    v_dot2_f32_bf16 v239, v45, v45, v239
    v_dot2_f32_bf16 v236, v46, v230, v236
    v_dot2_f32_bf16 v240, v46, v46, v240
    v_dot2_f32_bf16 v237, v47, v230, v237
    v_dot2_f32_bf16 v241, v47, v47, v241
    s_waitcnt lgkmcnt(4)
    v_dot2_f32_bf16 v242, v32, v200, v242
    v_dot2_f32_bf16 v243, v33, v201, v243
    v_dot2_f32_bf16 v244, v34, v202, v244
    v_dot2_f32_bf16 v245, v35, v203, v245
    v_dot2_f32_bf16 v242, v36, v204, v242
    v_dot2_f32_bf16 v243, v37, v205, v243
    v_dot2_f32_bf16 v244, v38, v206, v244
    v_dot2_f32_bf16 v245, v39, v207, v245
    v_dot2_f32_bf16 v242, v40, v208, v242
    v_dot2_f32_bf16 v243, v41, v209, v243
    v_dot2_f32_bf16 v244, v42, v210, v244
    v_dot2_f32_bf16 v245, v43, v211, v245
    v_dot2_f32_bf16 v242, v44, v212, v242
    v_dot2_f32_bf16 v243, v45, v213, v243
    v_dot2_f32_bf16 v244, v46, v214, v244
    v_dot2_f32_bf16 v245, v47, v215, v245
    ds_read_b128 v[200:203], v233 offset:256
    ds_read_b128 v[204:207], v233 offset:288
    ds_read_b128 v[208:211], v233 offset:320
    ds_read_b128 v[212:215], v233 offset:352
    s_waitcnt vmcnt(16)
    ds_read_b128 v[64:67], v8 offset:12288
    ds_read_b128 v[68:71], v9 offset:12288
    ds_read_b128 v[72:75], v10 offset:12288
    ds_read_b128 v[76:79], v11 offset:12288
    s_add_u32 m0, s49, 32768
    s_add_u32 s40, s40, 128
    buffer_load_dwordx4 v4, s[16:19], s40 offen offset:0  lds
    buffer_load_dwordx4 v5, s[16:19], s40 offen offset:1024  lds
    buffer_load_dwordx4 v6, s[16:19], s40 offen offset:2048  lds
    buffer_load_dwordx4 v7, s[16:19], s40 offen offset:3072  lds
    s_waitcnt lgkmcnt(8)
    v_dot2_f32_bf16 v234, v48, v230, v234
    v_dot2_f32_bf16 v238, v48, v48, v238
    v_dot2_f32_bf16 v235, v49, v230, v235
    v_dot2_f32_bf16 v239, v49, v49, v239
    v_dot2_f32_bf16 v236, v50, v230, v236
    v_dot2_f32_bf16 v240, v50, v50, v240
    v_dot2_f32_bf16 v237, v51, v230, v237
    v_dot2_f32_bf16 v241, v51, v51, v241
    v_dot2_f32_bf16 v234, v52, v230, v234
    v_dot2_f32_bf16 v238, v52, v52, v238
    v_dot2_f32_bf16 v235, v53, v230, v235
    v_dot2_f32_bf16 v239, v53, v53, v239
    v_dot2_f32_bf16 v236, v54, v230, v236
    v_dot2_f32_bf16 v240, v54, v54, v240
    v_dot2_f32_bf16 v237, v55, v230, v237
    v_dot2_f32_bf16 v241, v55, v55, v241
    v_dot2_f32_bf16 v234, v56, v230, v234
    v_dot2_f32_bf16 v238, v56, v56, v238
    v_dot2_f32_bf16 v235, v57, v230, v235
    v_dot2_f32_bf16 v239, v57, v57, v239
    v_dot2_f32_bf16 v236, v58, v230, v236
    v_dot2_f32_bf16 v240, v58, v58, v240
    v_dot2_f32_bf16 v237, v59, v230, v237
    v_dot2_f32_bf16 v241, v59, v59, v241
    v_dot2_f32_bf16 v234, v60, v230, v234
    v_dot2_f32_bf16 v238, v60, v60, v238
    v_dot2_f32_bf16 v235, v61, v230, v235
    v_dot2_f32_bf16 v239, v61, v61, v239
    v_dot2_f32_bf16 v236, v62, v230, v236
    v_dot2_f32_bf16 v240, v62, v62, v240
    v_dot2_f32_bf16 v237, v63, v230, v237
    v_dot2_f32_bf16 v241, v63, v63, v241
    s_waitcnt lgkmcnt(4)
    v_dot2_f32_bf16 v242, v48, v200, v242
    v_dot2_f32_bf16 v243, v49, v201, v243
    v_dot2_f32_bf16 v244, v50, v202, v244
    v_dot2_f32_bf16 v245, v51, v203, v245
    v_dot2_f32_bf16 v242, v52, v204, v242
    v_dot2_f32_bf16 v243, v53, v205, v243
    v_dot2_f32_bf16 v244, v54, v206, v244
    v_dot2_f32_bf16 v245, v55, v207, v245
    v_dot2_f32_bf16 v242, v56, v208, v242
    v_dot2_f32_bf16 v243, v57, v209, v243
    v_dot2_f32_bf16 v244, v58, v210, v244
    v_dot2_f32_bf16 v245, v59, v211, v245
    v_dot2_f32_bf16 v242, v60, v212, v242
    v_dot2_f32_bf16 v243, v61, v213, v243
    v_dot2_f32_bf16 v244, v62, v214, v244
    v_dot2_f32_bf16 v245, v63, v215, v245
    ds_read_b128 v[200:203], v233 offset:384
    ds_read_b128 v[204:207], v233 offset:416
    ds_read_b128 v[208:211], v233 offset:448
    ds_read_b128 v[212:215], v233 offset:480
    s_waitcnt vmcnt(16)
    ds_read_b128 v[80:83], v8 offset:16384
    ds_read_b128 v[84:87], v9 offset:16384
    ds_read_b128 v[88:91], v10 offset:16384
    ds_read_b128 v[92:95], v11 offset:16384
    buffer_load_dword v250, v250, s[20:23], s42 offen
    buffer_load_dword v15, v14, s[28:31], s47 offen
    buffer_load_ushort v229, v229, s[60:63], 0 offen
    v_lshlrev_b32 v14, 1, v14
    v_add_u32 v14, 147456, v14
    s_waitcnt lgkmcnt(8)
    v_dot2_f32_bf16 v234, v64, v230, v234
    v_dot2_f32_bf16 v238, v64, v64, v238
    v_dot2_f32_bf16 v235, v65, v230, v235
    v_dot2_f32_bf16 v239, v65, v65, v239
    v_dot2_f32_bf16 v236, v66, v230, v236
    v_dot2_f32_bf16 v240, v66, v66, v240
    v_dot2_f32_bf16 v237, v67, v230, v237
    v_dot2_f32_bf16 v241, v67, v67, v241
    v_dot2_f32_bf16 v234, v68, v230, v234
    v_dot2_f32_bf16 v238, v68, v68, v238
    v_dot2_f32_bf16 v235, v69, v230, v235
    v_dot2_f32_bf16 v239, v69, v69, v239
    v_dot2_f32_bf16 v236, v70, v230, v236
    v_dot2_f32_bf16 v240, v70, v70, v240
    v_dot2_f32_bf16 v237, v71, v230, v237
    v_dot2_f32_bf16 v241, v71, v71, v241
    v_dot2_f32_bf16 v234, v72, v230, v234
    v_dot2_f32_bf16 v238, v72, v72, v238
    v_dot2_f32_bf16 v235, v73, v230, v235
    v_dot2_f32_bf16 v239, v73, v73, v239
    v_dot2_f32_bf16 v236, v74, v230, v236
    v_dot2_f32_bf16 v240, v74, v74, v240
    v_dot2_f32_bf16 v237, v75, v230, v237
    v_dot2_f32_bf16 v241, v75, v75, v241
    v_dot2_f32_bf16 v234, v76, v230, v234
    v_dot2_f32_bf16 v238, v76, v76, v238
    v_dot2_f32_bf16 v235, v77, v230, v235
    v_dot2_f32_bf16 v239, v77, v77, v239
    v_dot2_f32_bf16 v236, v78, v230, v236
    v_dot2_f32_bf16 v240, v78, v78, v240
    v_dot2_f32_bf16 v237, v79, v230, v237
    v_dot2_f32_bf16 v241, v79, v79, v241
    s_waitcnt lgkmcnt(4)
    v_dot2_f32_bf16 v242, v64, v200, v242
    v_dot2_f32_bf16 v243, v65, v201, v243
    v_dot2_f32_bf16 v244, v66, v202, v244
    v_dot2_f32_bf16 v245, v67, v203, v245
    v_dot2_f32_bf16 v242, v68, v204, v242
    v_dot2_f32_bf16 v243, v69, v205, v243
    v_dot2_f32_bf16 v244, v70, v206, v244
    v_dot2_f32_bf16 v245, v71, v207, v245
    v_dot2_f32_bf16 v242, v72, v208, v242
    v_dot2_f32_bf16 v243, v73, v209, v243
    v_dot2_f32_bf16 v244, v74, v210, v244
    v_dot2_f32_bf16 v245, v75, v211, v245
    v_dot2_f32_bf16 v242, v76, v212, v242
    v_dot2_f32_bf16 v243, v77, v213, v243
    v_dot2_f32_bf16 v244, v78, v214, v244
    v_dot2_f32_bf16 v245, v79, v215, v245
    ds_read_b128 v[200:203], v233 offset:512
    ds_read_b128 v[204:207], v233 offset:544
    ds_read_b128 v[208:211], v233 offset:576
    ds_read_b128 v[212:215], v233 offset:608
    s_waitcnt vmcnt(15)
    ds_read_b128 v[96:99], v8 offset:20480
    ds_read_b128 v[100:103], v9 offset:20480
    ds_read_b128 v[104:107], v10 offset:20480
    ds_read_b128 v[108:111], v11 offset:20480
    s_waitcnt lgkmcnt(8)
    v_dot2_f32_bf16 v234, v80, v230, v234
    v_dot2_f32_bf16 v238, v80, v80, v238
    v_dot2_f32_bf16 v235, v81, v230, v235
    v_dot2_f32_bf16 v239, v81, v81, v239
    v_dot2_f32_bf16 v236, v82, v230, v236
    v_dot2_f32_bf16 v240, v82, v82, v240
    v_dot2_f32_bf16 v237, v83, v230, v237
    v_dot2_f32_bf16 v241, v83, v83, v241
    v_dot2_f32_bf16 v234, v84, v230, v234
    v_dot2_f32_bf16 v238, v84, v84, v238
    v_dot2_f32_bf16 v235, v85, v230, v235
    v_dot2_f32_bf16 v239, v85, v85, v239
    v_dot2_f32_bf16 v236, v86, v230, v236
    v_dot2_f32_bf16 v240, v86, v86, v240
    v_dot2_f32_bf16 v237, v87, v230, v237
    v_dot2_f32_bf16 v241, v87, v87, v241
    v_dot2_f32_bf16 v234, v88, v230, v234
    v_dot2_f32_bf16 v238, v88, v88, v238
    v_dot2_f32_bf16 v235, v89, v230, v235
    v_dot2_f32_bf16 v239, v89, v89, v239
    v_dot2_f32_bf16 v236, v90, v230, v236
    v_dot2_f32_bf16 v240, v90, v90, v240
    v_dot2_f32_bf16 v237, v91, v230, v237
    v_dot2_f32_bf16 v241, v91, v91, v241
    v_dot2_f32_bf16 v234, v92, v230, v234
    v_dot2_f32_bf16 v238, v92, v92, v238
    v_dot2_f32_bf16 v235, v93, v230, v235
    v_dot2_f32_bf16 v239, v93, v93, v239
    v_dot2_f32_bf16 v236, v94, v230, v236
    v_dot2_f32_bf16 v240, v94, v94, v240
    v_dot2_f32_bf16 v237, v95, v230, v237
    v_dot2_f32_bf16 v241, v95, v95, v241
    s_waitcnt lgkmcnt(4)
    v_dot2_f32_bf16 v242, v80, v200, v242
    v_dot2_f32_bf16 v243, v81, v201, v243
    v_dot2_f32_bf16 v244, v82, v202, v244
    v_dot2_f32_bf16 v245, v83, v203, v245
    v_dot2_f32_bf16 v242, v84, v204, v242
    v_dot2_f32_bf16 v243, v85, v205, v243
    v_dot2_f32_bf16 v244, v86, v206, v244
    v_dot2_f32_bf16 v245, v87, v207, v245
    v_dot2_f32_bf16 v242, v88, v208, v242
    v_dot2_f32_bf16 v243, v89, v209, v243
    v_dot2_f32_bf16 v244, v90, v210, v244
    v_dot2_f32_bf16 v245, v91, v211, v245
    v_dot2_f32_bf16 v242, v92, v212, v242
    v_dot2_f32_bf16 v243, v93, v213, v243
    v_dot2_f32_bf16 v244, v94, v214, v244
    v_dot2_f32_bf16 v245, v95, v215, v245
    ds_read_b128 v[200:203], v233 offset:640
    ds_read_b128 v[204:207], v233 offset:672
    ds_read_b128 v[208:211], v233 offset:704
    ds_read_b128 v[212:215], v233 offset:736
    s_waitcnt vmcnt(11)
    ds_read_b128 v[112:115], v8 offset:24576
    ds_read_b128 v[116:119], v9 offset:24576
    ds_read_b128 v[120:123], v10 offset:24576
    ds_read_b128 v[124:127], v11 offset:24576
    s_waitcnt lgkmcnt(8)
    v_dot2_f32_bf16 v234, v96, v230, v234
    v_dot2_f32_bf16 v238, v96, v96, v238
    v_dot2_f32_bf16 v235, v97, v230, v235
    v_dot2_f32_bf16 v239, v97, v97, v239
    v_dot2_f32_bf16 v236, v98, v230, v236
    v_dot2_f32_bf16 v240, v98, v98, v240
    v_dot2_f32_bf16 v237, v99, v230, v237
    v_dot2_f32_bf16 v241, v99, v99, v241
    v_dot2_f32_bf16 v234, v100, v230, v234
    v_dot2_f32_bf16 v238, v100, v100, v238
    v_dot2_f32_bf16 v235, v101, v230, v235
    v_dot2_f32_bf16 v239, v101, v101, v239
    v_dot2_f32_bf16 v236, v102, v230, v236
    v_dot2_f32_bf16 v240, v102, v102, v240
    v_dot2_f32_bf16 v237, v103, v230, v237
    v_dot2_f32_bf16 v241, v103, v103, v241
    v_dot2_f32_bf16 v234, v104, v230, v234
    v_dot2_f32_bf16 v238, v104, v104, v238
    v_dot2_f32_bf16 v235, v105, v230, v235
    v_dot2_f32_bf16 v239, v105, v105, v239
    v_dot2_f32_bf16 v236, v106, v230, v236
    v_dot2_f32_bf16 v240, v106, v106, v240
    v_dot2_f32_bf16 v237, v107, v230, v237
    v_dot2_f32_bf16 v241, v107, v107, v241
    v_dot2_f32_bf16 v234, v108, v230, v234
    v_dot2_f32_bf16 v238, v108, v108, v238
    v_dot2_f32_bf16 v235, v109, v230, v235
    v_dot2_f32_bf16 v239, v109, v109, v239
    v_dot2_f32_bf16 v236, v110, v230, v236
    v_dot2_f32_bf16 v240, v110, v110, v240
    v_dot2_f32_bf16 v237, v111, v230, v237
    v_dot2_f32_bf16 v241, v111, v111, v241
    s_waitcnt lgkmcnt(4)
    v_dot2_f32_bf16 v242, v96, v200, v242
    v_dot2_f32_bf16 v243, v97, v201, v243
    v_dot2_f32_bf16 v244, v98, v202, v244
    v_dot2_f32_bf16 v245, v99, v203, v245
    v_dot2_f32_bf16 v242, v100, v204, v242
    v_dot2_f32_bf16 v243, v101, v205, v243
    v_dot2_f32_bf16 v244, v102, v206, v244
    v_dot2_f32_bf16 v245, v103, v207, v245
    v_dot2_f32_bf16 v242, v104, v208, v242
    v_dot2_f32_bf16 v243, v105, v209, v243
    v_dot2_f32_bf16 v244, v106, v210, v244
    v_dot2_f32_bf16 v245, v107, v211, v245
    v_dot2_f32_bf16 v242, v108, v212, v242
    v_dot2_f32_bf16 v243, v109, v213, v243
    v_dot2_f32_bf16 v244, v110, v214, v244
    v_dot2_f32_bf16 v245, v111, v215, v245
    ds_read_b128 v[200:203], v233 offset:768
    ds_read_b128 v[204:207], v233 offset:800
    ds_read_b128 v[208:211], v233 offset:832
    ds_read_b128 v[212:215], v233 offset:864
    s_waitcnt vmcnt(7)
    ds_read_b128 v[128:131], v8 offset:28672
    ds_read_b128 v[132:135], v9 offset:28672
    ds_read_b128 v[136:139], v10 offset:28672
    ds_read_b128 v[140:143], v11 offset:28672
    s_waitcnt lgkmcnt(8)
    v_dot2_f32_bf16 v234, v112, v230, v234
    v_dot2_f32_bf16 v238, v112, v112, v238
    v_dot2_f32_bf16 v235, v113, v230, v235
    v_dot2_f32_bf16 v239, v113, v113, v239
    v_dot2_f32_bf16 v236, v114, v230, v236
    v_dot2_f32_bf16 v240, v114, v114, v240
    v_dot2_f32_bf16 v237, v115, v230, v237
    v_dot2_f32_bf16 v241, v115, v115, v241
    v_dot2_f32_bf16 v234, v116, v230, v234
    v_dot2_f32_bf16 v238, v116, v116, v238
    v_dot2_f32_bf16 v235, v117, v230, v235
    v_dot2_f32_bf16 v239, v117, v117, v239
    v_dot2_f32_bf16 v236, v118, v230, v236
    v_dot2_f32_bf16 v240, v118, v118, v240
    v_dot2_f32_bf16 v237, v119, v230, v237
    v_dot2_f32_bf16 v241, v119, v119, v241
    v_dot2_f32_bf16 v234, v120, v230, v234
    v_dot2_f32_bf16 v238, v120, v120, v238
    v_dot2_f32_bf16 v235, v121, v230, v235
    v_dot2_f32_bf16 v239, v121, v121, v239
    v_dot2_f32_bf16 v236, v122, v230, v236
    v_dot2_f32_bf16 v240, v122, v122, v240
    v_dot2_f32_bf16 v237, v123, v230, v237
    v_dot2_f32_bf16 v241, v123, v123, v241
    v_dot2_f32_bf16 v234, v124, v230, v234
    v_dot2_f32_bf16 v238, v124, v124, v238
    v_dot2_f32_bf16 v235, v125, v230, v235
    v_dot2_f32_bf16 v239, v125, v125, v239
    v_dot2_f32_bf16 v236, v126, v230, v236
    v_dot2_f32_bf16 v240, v126, v126, v240
    v_dot2_f32_bf16 v237, v127, v230, v237
    v_dot2_f32_bf16 v241, v127, v127, v241
    s_waitcnt lgkmcnt(4)
    v_dot2_f32_bf16 v242, v112, v200, v242
    v_dot2_f32_bf16 v243, v113, v201, v243
    v_dot2_f32_bf16 v244, v114, v202, v244
    v_dot2_f32_bf16 v245, v115, v203, v245
    v_dot2_f32_bf16 v242, v116, v204, v242
    v_dot2_f32_bf16 v243, v117, v205, v243
    v_dot2_f32_bf16 v244, v118, v206, v244
    v_dot2_f32_bf16 v245, v119, v207, v245
    v_dot2_f32_bf16 v242, v120, v208, v242
    v_dot2_f32_bf16 v243, v121, v209, v243
    v_dot2_f32_bf16 v244, v122, v210, v244
    v_dot2_f32_bf16 v245, v123, v211, v245
    v_dot2_f32_bf16 v242, v124, v212, v242
    v_dot2_f32_bf16 v243, v125, v213, v243
    v_dot2_f32_bf16 v244, v126, v214, v244
    v_dot2_f32_bf16 v245, v127, v215, v245
    ds_read_b128 v[200:203], v233 offset:896
    ds_read_b128 v[204:207], v233 offset:928
    ds_read_b128 v[208:211], v233 offset:960
    ds_read_b128 v[212:215], v233 offset:992
    s_waitcnt vmcnt(3)
    ds_read_b128 v[144:147], v8 offset:32768
    ds_read_b128 v[148:151], v9 offset:32768
    ds_read_b128 v[152:155], v10 offset:32768
    ds_read_b128 v[156:159], v11 offset:32768
    s_waitcnt lgkmcnt(8)
    v_dot2_f32_bf16 v234, v128, v230, v234
    v_dot2_f32_bf16 v238, v128, v128, v238
    v_dot2_f32_bf16 v235, v129, v230, v235
    v_dot2_f32_bf16 v239, v129, v129, v239
    v_dot2_f32_bf16 v236, v130, v230, v236
    v_dot2_f32_bf16 v240, v130, v130, v240
    v_dot2_f32_bf16 v237, v131, v230, v237
    v_dot2_f32_bf16 v241, v131, v131, v241
    v_dot2_f32_bf16 v234, v132, v230, v234
    v_dot2_f32_bf16 v238, v132, v132, v238
    v_dot2_f32_bf16 v235, v133, v230, v235
    v_dot2_f32_bf16 v239, v133, v133, v239
    v_dot2_f32_bf16 v236, v134, v230, v236
    v_dot2_f32_bf16 v240, v134, v134, v240
    v_dot2_f32_bf16 v237, v135, v230, v237
    v_dot2_f32_bf16 v241, v135, v135, v241
    v_dot2_f32_bf16 v234, v136, v230, v234
    v_dot2_f32_bf16 v238, v136, v136, v238
    v_dot2_f32_bf16 v235, v137, v230, v235
    v_dot2_f32_bf16 v239, v137, v137, v239
    v_dot2_f32_bf16 v236, v138, v230, v236
    v_dot2_f32_bf16 v240, v138, v138, v240
    v_dot2_f32_bf16 v237, v139, v230, v237
    v_dot2_f32_bf16 v241, v139, v139, v241
    v_dot2_f32_bf16 v234, v140, v230, v234
    v_dot2_f32_bf16 v238, v140, v140, v238
    v_dot2_f32_bf16 v235, v141, v230, v235
    v_dot2_f32_bf16 v239, v141, v141, v239
    v_dot2_f32_bf16 v236, v142, v230, v236
    v_dot2_f32_bf16 v240, v142, v142, v240
    v_dot2_f32_bf16 v237, v143, v230, v237
    v_dot2_f32_bf16 v241, v143, v143, v241
    s_waitcnt lgkmcnt(4)
    v_dot2_f32_bf16 v242, v128, v200, v242
    v_dot2_f32_bf16 v243, v129, v201, v243
    v_dot2_f32_bf16 v244, v130, v202, v244
    v_dot2_f32_bf16 v245, v131, v203, v245
    v_dot2_f32_bf16 v242, v132, v204, v242
    v_dot2_f32_bf16 v243, v133, v205, v243
    v_dot2_f32_bf16 v244, v134, v206, v244
    v_dot2_f32_bf16 v245, v135, v207, v245
    v_dot2_f32_bf16 v242, v136, v208, v242
    v_dot2_f32_bf16 v243, v137, v209, v243
    v_dot2_f32_bf16 v244, v138, v210, v244
    v_dot2_f32_bf16 v245, v139, v211, v245
    v_dot2_f32_bf16 v242, v140, v212, v242
    v_dot2_f32_bf16 v243, v141, v213, v243
    v_dot2_f32_bf16 v244, v142, v214, v244
    v_dot2_f32_bf16 v245, v143, v215, v245
    ds_read_b128 v[200:203], v233 offset:1024
    ds_read_b128 v[204:207], v233 offset:1056
    ds_read_b128 v[208:211], v233 offset:1088
    ds_read_b128 v[212:215], v233 offset:1120
    s_waitcnt lgkmcnt(4)
    v_dot2_f32_bf16 v234, v144, v230, v234
    v_dot2_f32_bf16 v238, v144, v144, v238
    v_dot2_f32_bf16 v235, v145, v230, v235
    v_dot2_f32_bf16 v239, v145, v145, v239
    v_dot2_f32_bf16 v236, v146, v230, v236
    v_dot2_f32_bf16 v240, v146, v146, v240
    v_dot2_f32_bf16 v237, v147, v230, v237
    v_dot2_f32_bf16 v241, v147, v147, v241
    v_dot2_f32_bf16 v234, v148, v230, v234
    v_dot2_f32_bf16 v238, v148, v148, v238
    v_dot2_f32_bf16 v235, v149, v230, v235
    v_dot2_f32_bf16 v239, v149, v149, v239
    v_dot2_f32_bf16 v236, v150, v230, v236
    v_dot2_f32_bf16 v240, v150, v150, v240
    v_dot2_f32_bf16 v237, v151, v230, v237
    v_dot2_f32_bf16 v241, v151, v151, v241
    v_dot2_f32_bf16 v234, v152, v230, v234
    v_dot2_f32_bf16 v238, v152, v152, v238
    v_dot2_f32_bf16 v235, v153, v230, v235
    v_dot2_f32_bf16 v239, v153, v153, v239
    v_dot2_f32_bf16 v236, v154, v230, v236
    v_dot2_f32_bf16 v240, v154, v154, v240
    v_dot2_f32_bf16 v237, v155, v230, v237
    v_dot2_f32_bf16 v241, v155, v155, v241
    v_dot2_f32_bf16 v234, v156, v230, v234
    v_dot2_f32_bf16 v238, v156, v156, v238
    v_dot2_f32_bf16 v235, v157, v230, v235
    v_dot2_f32_bf16 v239, v157, v157, v239
    v_dot2_f32_bf16 v236, v158, v230, v236
    v_dot2_f32_bf16 v240, v158, v158, v240
    v_dot2_f32_bf16 v237, v159, v230, v237
    v_dot2_f32_bf16 v241, v159, v159, v241
    s_waitcnt lgkmcnt(0)
    v_dot2_f32_bf16 v242, v144, v200, v242
    v_dot2_f32_bf16 v243, v145, v201, v243
    v_dot2_f32_bf16 v244, v146, v202, v244
    v_dot2_f32_bf16 v245, v147, v203, v245
    v_dot2_f32_bf16 v242, v148, v204, v242
    v_dot2_f32_bf16 v243, v149, v205, v243
    v_dot2_f32_bf16 v244, v150, v206, v244
    v_dot2_f32_bf16 v245, v151, v207, v245
    v_dot2_f32_bf16 v242, v152, v208, v242
    v_dot2_f32_bf16 v243, v153, v209, v243
    v_dot2_f32_bf16 v244, v154, v210, v244
    v_dot2_f32_bf16 v245, v155, v211, v245
    v_dot2_f32_bf16 v242, v156, v212, v242
    v_dot2_f32_bf16 v243, v157, v213, v243
    v_dot2_f32_bf16 v244, v158, v214, v244
    v_dot2_f32_bf16 v245, v159, v215, v245
    s_barrier
    s_mul_i32 s45, s32, 663552
    s_add_u32 s47, s47, s45
    s_mul_i32 s49, s32, 9216
    s_add_u32 m0, s49, 0
    s_add_u32 s46, s47, 0
    buffer_load_dwordx4 v220, s[20:23], s46 offen offset:0  lds
    buffer_load_dwordx4 v221, s[20:23], s46 offen offset:1024  lds
    buffer_load_dwordx4 v222, s[20:23], s46 offen offset:2048  lds
    s_add_u32 m0, s49, 3072
    s_add_u32 s46, s47, 221184
    buffer_load_dwordx4 v220, s[20:23], s46 offen offset:0  lds
    buffer_load_dwordx4 v221, s[20:23], s46 offen offset:1024  lds
    buffer_load_dwordx4 v222, s[20:23], s46 offen offset:2048  lds
    buffer_load_dword v246, v247, s[12:15], 0 offen
    v_add_f32 v234, v234, v235
    v_add_f32 v236, v236, v237
    v_add_f32 v238, v238, v239
    v_add_f32 v240, v240, v241
    v_add_f32 v234, v234, v236
    v_add_f32 v238, v238, v240
    v_mov_b32 v235, v234
    v_mov_b32 v239, v238
    s_nop 0
    v_permlane32_swap_b32 v234, v235
    v_permlane32_swap_b32 v238, v239
    v_add_f32 v234, v234, v235
    v_add_f32 v238, v238, v239
    v_mul_f32 v234, 0xbae38e39, v234
    v_mul_f32 v238, 0x3ae38e39, v238
    v_fma_f32 v238, -v234, v234, v238
    v_max_f32 v238, 0, v238
    v_add_f32 v238, 0x3727c5ac, v238
    v_rsq_f32 v239, v238
    v_cmp_gt_u32 vcc, 32, v0
    v_mul_f32 v240, v238, v239
    v_cvt_pk_bf16_f32 v241, v240, v240
    v_and_b32 v241, 0xffff0000, v241
    v_sub_f32 v240, v240, v241
    v_cvt_pk_bf16_f32 v192, v241, v240
    v_cndmask_b32 v192, 0, v192, vcc
    v_mov_b32 v193, 0
    v_mov_b32 v194, 0
    v_mov_b32 v195, 0
    v_dot2_f32_bf16 v160, v16, v231, v234
    v_dot2_f32_bf16 v161, v16, v232, v234
    v_dot2_f32_bf16 v162, v17, v231, v234
    v_dot2_f32_bf16 v163, v17, v232, v234
    v_dot2_f32_bf16 v164, v18, v231, v234
    v_dot2_f32_bf16 v165, v18, v232, v234
    v_dot2_f32_bf16 v166, v19, v231, v234
    v_dot2_f32_bf16 v167, v19, v232, v234
    v_dot2_f32_bf16 v168, v20, v231, v234
    v_dot2_f32_bf16 v169, v20, v232, v234
    v_dot2_f32_bf16 v170, v21, v231, v234
    v_dot2_f32_bf16 v171, v21, v232, v234
    v_dot2_f32_bf16 v172, v22, v231, v234
    v_dot2_f32_bf16 v173, v22, v232, v234
    v_dot2_f32_bf16 v174, v23, v231, v234
    v_dot2_f32_bf16 v175, v23, v232, v234
    v_dot2_f32_bf16 v176, v24, v231, v234
    v_dot2_f32_bf16 v177, v24, v232, v234
    v_dot2_f32_bf16 v178, v25, v231, v234
    v_dot2_f32_bf16 v179, v25, v232, v234
    v_dot2_f32_bf16 v180, v26, v231, v234
    v_dot2_f32_bf16 v181, v26, v232, v234
    v_dot2_f32_bf16 v182, v27, v231, v234
    v_dot2_f32_bf16 v183, v27, v232, v234
    v_dot2_f32_bf16 v184, v28, v231, v234
    v_dot2_f32_bf16 v185, v28, v232, v234
    v_dot2_f32_bf16 v186, v29, v231, v234
    v_dot2_f32_bf16 v187, v29, v232, v234
    v_dot2_f32_bf16 v188, v30, v231, v234
    v_dot2_f32_bf16 v189, v30, v232, v234
    v_dot2_f32_bf16 v190, v31, v231, v234
    v_dot2_f32_bf16 v191, v31, v232, v234
    v_cvt_pk_bf16_f32 v16, v160, v161
    v_cvt_pk_bf16_f32 v17, v162, v163
    v_cvt_pk_bf16_f32 v18, v164, v165
    v_cvt_pk_bf16_f32 v19, v166, v167
    v_cvt_pk_bf16_f32 v20, v168, v169
    v_cvt_pk_bf16_f32 v21, v170, v171
    v_cvt_pk_bf16_f32 v22, v172, v173
    v_cvt_pk_bf16_f32 v23, v174, v175
    v_cvt_pk_bf16_f32 v24, v176, v177
    v_cvt_pk_bf16_f32 v25, v178, v179
    v_cvt_pk_bf16_f32 v26, v180, v181
    v_cvt_pk_bf16_f32 v27, v182, v183
    v_cvt_pk_bf16_f32 v28, v184, v185
    v_cvt_pk_bf16_f32 v29, v186, v187
    v_cvt_pk_bf16_f32 v30, v188, v189
    v_cvt_pk_bf16_f32 v31, v190, v191
    s_add_u32 m0, s49, 6144
    s_add_u32 s46, s47, 442368
    buffer_load_dwordx4 v220, s[20:23], s46 offen offset:0  lds
    buffer_load_dwordx4 v221, s[20:23], s46 offen offset:1024  lds
    buffer_load_dwordx4 v222, s[20:23], s46 offen offset:2048  lds
    v_dot2_f32_bf16 v160, v32, v231, v234
    v_dot2_f32_bf16 v161, v32, v232, v234
    v_dot2_f32_bf16 v162, v33, v231, v234
    v_dot2_f32_bf16 v163, v33, v232, v234
    v_dot2_f32_bf16 v164, v34, v231, v234
    v_dot2_f32_bf16 v165, v34, v232, v234
    v_dot2_f32_bf16 v166, v35, v231, v234
    v_dot2_f32_bf16 v167, v35, v232, v234
    v_dot2_f32_bf16 v168, v36, v231, v234
    v_dot2_f32_bf16 v169, v36, v232, v234
    v_dot2_f32_bf16 v170, v37, v231, v234
    v_dot2_f32_bf16 v171, v37, v232, v234
    v_dot2_f32_bf16 v172, v38, v231, v234
    v_dot2_f32_bf16 v173, v38, v232, v234
    v_dot2_f32_bf16 v174, v39, v231, v234
    v_dot2_f32_bf16 v175, v39, v232, v234
    v_dot2_f32_bf16 v176, v40, v231, v234
    v_dot2_f32_bf16 v177, v40, v232, v234
    v_dot2_f32_bf16 v178, v41, v231, v234
    v_dot2_f32_bf16 v179, v41, v232, v234
    v_dot2_f32_bf16 v180, v42, v231, v234
    v_dot2_f32_bf16 v181, v42, v232, v234
    v_dot2_f32_bf16 v182, v43, v231, v234
    v_dot2_f32_bf16 v183, v43, v232, v234
    v_dot2_f32_bf16 v184, v44, v231, v234
    v_dot2_f32_bf16 v185, v44, v232, v234
    v_dot2_f32_bf16 v186, v45, v231, v234
    v_dot2_f32_bf16 v187, v45, v232, v234
    v_dot2_f32_bf16 v188, v46, v231, v234
    v_dot2_f32_bf16 v189, v46, v232, v234
    v_dot2_f32_bf16 v190, v47, v231, v234
    v_dot2_f32_bf16 v191, v47, v232, v234
    v_cvt_pk_bf16_f32 v32, v160, v161
    v_cvt_pk_bf16_f32 v33, v162, v163
    v_cvt_pk_bf16_f32 v34, v164, v165
    v_cvt_pk_bf16_f32 v35, v166, v167
    v_cvt_pk_bf16_f32 v36, v168, v169
    v_cvt_pk_bf16_f32 v37, v170, v171
    v_cvt_pk_bf16_f32 v38, v172, v173
    v_cvt_pk_bf16_f32 v39, v174, v175
    v_cvt_pk_bf16_f32 v40, v176, v177
    v_cvt_pk_bf16_f32 v41, v178, v179
    v_cvt_pk_bf16_f32 v42, v180, v181
    v_cvt_pk_bf16_f32 v43, v182, v183
    v_cvt_pk_bf16_f32 v44, v184, v185
    v_cvt_pk_bf16_f32 v45, v186, v187
    v_cvt_pk_bf16_f32 v46, v188, v189
    v_cvt_pk_bf16_f32 v47, v190, v191
    s_add_u32 m0, s49, 36864
    s_add_u32 s46, s47, 2654208
    buffer_load_dwordx4 v220, s[20:23], s46 offen offset:0  lds
    buffer_load_dwordx4 v221, s[20:23], s46 offen offset:1024  lds
    buffer_load_dwordx4 v222, s[20:23], s46 offen offset:2048  lds
    v_dot2_f32_bf16 v160, v48, v231, v234
    v_dot2_f32_bf16 v161, v48, v232, v234
    v_dot2_f32_bf16 v162, v49, v231, v234
    v_dot2_f32_bf16 v163, v49, v232, v234
    v_dot2_f32_bf16 v164, v50, v231, v234
    v_dot2_f32_bf16 v165, v50, v232, v234
    v_dot2_f32_bf16 v166, v51, v231, v234
    v_dot2_f32_bf16 v167, v51, v232, v234
    v_dot2_f32_bf16 v168, v52, v231, v234
    v_dot2_f32_bf16 v169, v52, v232, v234
    v_dot2_f32_bf16 v170, v53, v231, v234
    v_dot2_f32_bf16 v171, v53, v232, v234
    v_dot2_f32_bf16 v172, v54, v231, v234
    v_dot2_f32_bf16 v173, v54, v232, v234
    v_dot2_f32_bf16 v174, v55, v231, v234
    v_dot2_f32_bf16 v175, v55, v232, v234
    v_dot2_f32_bf16 v176, v56, v231, v234
    v_dot2_f32_bf16 v177, v56, v232, v234
    v_dot2_f32_bf16 v178, v57, v231, v234
    v_dot2_f32_bf16 v179, v57, v232, v234
    v_dot2_f32_bf16 v180, v58, v231, v234
    v_dot2_f32_bf16 v181, v58, v232, v234
    v_dot2_f32_bf16 v182, v59, v231, v234
    v_dot2_f32_bf16 v183, v59, v232, v234
    v_dot2_f32_bf16 v184, v60, v231, v234
    v_dot2_f32_bf16 v185, v60, v232, v234
    v_dot2_f32_bf16 v186, v61, v231, v234
    v_dot2_f32_bf16 v187, v61, v232, v234
    v_dot2_f32_bf16 v188, v62, v231, v234
    v_dot2_f32_bf16 v189, v62, v232, v234
    v_dot2_f32_bf16 v190, v63, v231, v234
    v_dot2_f32_bf16 v191, v63, v232, v234
    v_cvt_pk_bf16_f32 v48, v160, v161
    v_cvt_pk_bf16_f32 v49, v162, v163
    v_cvt_pk_bf16_f32 v50, v164, v165
    v_cvt_pk_bf16_f32 v51, v166, v167
    v_cvt_pk_bf16_f32 v52, v168, v169
    v_cvt_pk_bf16_f32 v53, v170, v171
    v_cvt_pk_bf16_f32 v54, v172, v173
    v_cvt_pk_bf16_f32 v55, v174, v175
    v_cvt_pk_bf16_f32 v56, v176, v177
    v_cvt_pk_bf16_f32 v57, v178, v179
    v_cvt_pk_bf16_f32 v58, v180, v181
    v_cvt_pk_bf16_f32 v59, v182, v183
    v_cvt_pk_bf16_f32 v60, v184, v185
    v_cvt_pk_bf16_f32 v61, v186, v187
    v_cvt_pk_bf16_f32 v62, v188, v189
    v_cvt_pk_bf16_f32 v63, v190, v191
    s_add_u32 m0, s49, 39936
    s_add_u32 s46, s47, 2875392
    buffer_load_dwordx4 v220, s[20:23], s46 offen offset:0  lds
    buffer_load_dwordx4 v221, s[20:23], s46 offen offset:1024  lds
    buffer_load_dwordx4 v222, s[20:23], s46 offen offset:2048  lds
    v_dot2_f32_bf16 v160, v64, v231, v234
    v_dot2_f32_bf16 v161, v64, v232, v234
    v_dot2_f32_bf16 v162, v65, v231, v234
    v_dot2_f32_bf16 v163, v65, v232, v234
    v_dot2_f32_bf16 v164, v66, v231, v234
    v_dot2_f32_bf16 v165, v66, v232, v234
    v_dot2_f32_bf16 v166, v67, v231, v234
    v_dot2_f32_bf16 v167, v67, v232, v234
    v_dot2_f32_bf16 v168, v68, v231, v234
    v_dot2_f32_bf16 v169, v68, v232, v234
    v_dot2_f32_bf16 v170, v69, v231, v234
    v_dot2_f32_bf16 v171, v69, v232, v234
    v_dot2_f32_bf16 v172, v70, v231, v234
    v_dot2_f32_bf16 v173, v70, v232, v234
    v_dot2_f32_bf16 v174, v71, v231, v234
    v_dot2_f32_bf16 v175, v71, v232, v234
    v_dot2_f32_bf16 v176, v72, v231, v234
    v_dot2_f32_bf16 v177, v72, v232, v234
    v_dot2_f32_bf16 v178, v73, v231, v234
    v_dot2_f32_bf16 v179, v73, v232, v234
    v_dot2_f32_bf16 v180, v74, v231, v234
    v_dot2_f32_bf16 v181, v74, v232, v234
    v_dot2_f32_bf16 v182, v75, v231, v234
    v_dot2_f32_bf16 v183, v75, v232, v234
    v_dot2_f32_bf16 v184, v76, v231, v234
    v_dot2_f32_bf16 v185, v76, v232, v234
    v_dot2_f32_bf16 v186, v77, v231, v234
    v_dot2_f32_bf16 v187, v77, v232, v234
    v_dot2_f32_bf16 v188, v78, v231, v234
    v_dot2_f32_bf16 v189, v78, v232, v234
    v_dot2_f32_bf16 v190, v79, v231, v234
    v_dot2_f32_bf16 v191, v79, v232, v234
    v_cvt_pk_bf16_f32 v64, v160, v161
    v_cvt_pk_bf16_f32 v65, v162, v163
    v_cvt_pk_bf16_f32 v66, v164, v165
    v_cvt_pk_bf16_f32 v67, v166, v167
    v_cvt_pk_bf16_f32 v68, v168, v169
    v_cvt_pk_bf16_f32 v69, v170, v171
    v_cvt_pk_bf16_f32 v70, v172, v173
    v_cvt_pk_bf16_f32 v71, v174, v175
    v_cvt_pk_bf16_f32 v72, v176, v177
    v_cvt_pk_bf16_f32 v73, v178, v179
    v_cvt_pk_bf16_f32 v74, v180, v181
    v_cvt_pk_bf16_f32 v75, v182, v183
    v_cvt_pk_bf16_f32 v76, v184, v185
    v_cvt_pk_bf16_f32 v77, v186, v187
    v_cvt_pk_bf16_f32 v78, v188, v189
    v_cvt_pk_bf16_f32 v79, v190, v191
    s_add_u32 m0, s49, 43008
    s_add_u32 s46, s47, 3096576
    buffer_load_dwordx4 v220, s[20:23], s46 offen offset:0  lds
    buffer_load_dwordx4 v221, s[20:23], s46 offen offset:1024  lds
    buffer_load_dwordx4 v222, s[20:23], s46 offen offset:2048  lds
    v_dot2_f32_bf16 v160, v80, v231, v234
    v_dot2_f32_bf16 v161, v80, v232, v234
    v_dot2_f32_bf16 v162, v81, v231, v234
    v_dot2_f32_bf16 v163, v81, v232, v234
    v_dot2_f32_bf16 v164, v82, v231, v234
    v_dot2_f32_bf16 v165, v82, v232, v234
    v_dot2_f32_bf16 v166, v83, v231, v234
    v_dot2_f32_bf16 v167, v83, v232, v234
    v_dot2_f32_bf16 v168, v84, v231, v234
    v_dot2_f32_bf16 v169, v84, v232, v234
    v_dot2_f32_bf16 v170, v85, v231, v234
    v_dot2_f32_bf16 v171, v85, v232, v234
    v_dot2_f32_bf16 v172, v86, v231, v234
    v_dot2_f32_bf16 v173, v86, v232, v234
    v_dot2_f32_bf16 v174, v87, v231, v234
    v_dot2_f32_bf16 v175, v87, v232, v234
    v_dot2_f32_bf16 v176, v88, v231, v234
    v_dot2_f32_bf16 v177, v88, v232, v234
    v_dot2_f32_bf16 v178, v89, v231, v234
    v_dot2_f32_bf16 v179, v89, v232, v234
    v_dot2_f32_bf16 v180, v90, v231, v234
    v_dot2_f32_bf16 v181, v90, v232, v234
    v_dot2_f32_bf16 v182, v91, v231, v234
    v_dot2_f32_bf16 v183, v91, v232, v234
    v_dot2_f32_bf16 v184, v92, v231, v234
    v_dot2_f32_bf16 v185, v92, v232, v234
    v_dot2_f32_bf16 v186, v93, v231, v234
    v_dot2_f32_bf16 v187, v93, v232, v234
    v_dot2_f32_bf16 v188, v94, v231, v234
    v_dot2_f32_bf16 v189, v94, v232, v234
    v_dot2_f32_bf16 v190, v95, v231, v234
    v_dot2_f32_bf16 v191, v95, v232, v234
    v_cvt_pk_bf16_f32 v80, v160, v161
    v_cvt_pk_bf16_f32 v81, v162, v163
    v_cvt_pk_bf16_f32 v82, v164, v165
    v_cvt_pk_bf16_f32 v83, v166, v167
    v_cvt_pk_bf16_f32 v84, v168, v169
    v_cvt_pk_bf16_f32 v85, v170, v171
    v_cvt_pk_bf16_f32 v86, v172, v173
    v_cvt_pk_bf16_f32 v87, v174, v175
    v_cvt_pk_bf16_f32 v88, v176, v177
    v_cvt_pk_bf16_f32 v89, v178, v179
    v_cvt_pk_bf16_f32 v90, v180, v181
    v_cvt_pk_bf16_f32 v91, v182, v183
    v_cvt_pk_bf16_f32 v92, v184, v185
    v_cvt_pk_bf16_f32 v93, v186, v187
    v_cvt_pk_bf16_f32 v94, v188, v189
    v_cvt_pk_bf16_f32 v95, v190, v191
    s_add_u32 m0, s49, 73728
    s_add_u32 s46, s47, 128
    buffer_load_dwordx4 v220, s[20:23], s46 offen offset:0  lds
    buffer_load_dwordx4 v221, s[20:23], s46 offen offset:1024  lds
    buffer_load_dwordx4 v222, s[20:23], s46 offen offset:2048  lds
    v_dot2_f32_bf16 v160, v96, v231, v234
    v_dot2_f32_bf16 v161, v96, v232, v234
    v_dot2_f32_bf16 v162, v97, v231, v234
    v_dot2_f32_bf16 v163, v97, v232, v234
    v_dot2_f32_bf16 v164, v98, v231, v234
    v_dot2_f32_bf16 v165, v98, v232, v234
    v_dot2_f32_bf16 v166, v99, v231, v234
    v_dot2_f32_bf16 v167, v99, v232, v234
    v_dot2_f32_bf16 v168, v100, v231, v234
    v_dot2_f32_bf16 v169, v100, v232, v234
    v_dot2_f32_bf16 v170, v101, v231, v234
    v_dot2_f32_bf16 v171, v101, v232, v234
    v_dot2_f32_bf16 v172, v102, v231, v234
    v_dot2_f32_bf16 v173, v102, v232, v234
    v_dot2_f32_bf16 v174, v103, v231, v234
    v_dot2_f32_bf16 v175, v103, v232, v234
    v_dot2_f32_bf16 v176, v104, v231, v234
    v_dot2_f32_bf16 v177, v104, v232, v234
    v_dot2_f32_bf16 v178, v105, v231, v234
    v_dot2_f32_bf16 v179, v105, v232, v234
    v_dot2_f32_bf16 v180, v106, v231, v234
    v_dot2_f32_bf16 v181, v106, v232, v234
    v_dot2_f32_bf16 v182, v107, v231, v234
    v_dot2_f32_bf16 v183, v107, v232, v234
    v_dot2_f32_bf16 v184, v108, v231, v234
    v_dot2_f32_bf16 v185, v108, v232, v234
    v_dot2_f32_bf16 v186, v109, v231, v234
    v_dot2_f32_bf16 v187, v109, v232, v234
    v_dot2_f32_bf16 v188, v110, v231, v234
    v_dot2_f32_bf16 v189, v110, v232, v234
    v_dot2_f32_bf16 v190, v111, v231, v234
    v_dot2_f32_bf16 v191, v111, v232, v234
    v_cvt_pk_bf16_f32 v96, v160, v161
    v_cvt_pk_bf16_f32 v97, v162, v163
    v_cvt_pk_bf16_f32 v98, v164, v165
    v_cvt_pk_bf16_f32 v99, v166, v167
    v_cvt_pk_bf16_f32 v100, v168, v169
    v_cvt_pk_bf16_f32 v101, v170, v171
    v_cvt_pk_bf16_f32 v102, v172, v173
    v_cvt_pk_bf16_f32 v103, v174, v175
    v_cvt_pk_bf16_f32 v104, v176, v177
    v_cvt_pk_bf16_f32 v105, v178, v179
    v_cvt_pk_bf16_f32 v106, v180, v181
    v_cvt_pk_bf16_f32 v107, v182, v183
    v_cvt_pk_bf16_f32 v108, v184, v185
    v_cvt_pk_bf16_f32 v109, v186, v187
    v_cvt_pk_bf16_f32 v110, v188, v189
    v_cvt_pk_bf16_f32 v111, v190, v191
    s_add_u32 m0, s49, 76800
    s_add_u32 s46, s47, 221312
    buffer_load_dwordx4 v220, s[20:23], s46 offen offset:0  lds
    buffer_load_dwordx4 v221, s[20:23], s46 offen offset:1024  lds
    buffer_load_dwordx4 v222, s[20:23], s46 offen offset:2048  lds
    s_waitcnt vmcnt(26)
    v_and_b32 v12, 0xffff, v15
    v_lshl_or_b32 v12, v15, 16, v12
    v_lshrrev_b32 v13, 16, v15
    v_and_b32 v15, 0xffff0000, v15
    v_or_b32 v13, v13, v15
    s_cmp_lt_u32 s32, 3
    s_cbranch_scc0 F_NOBT
    ds_write_b64 v14, v[12:13]
F_NOBT:
    v_dot2_f32_bf16 v160, v112, v231, v234
    v_dot2_f32_bf16 v161, v112, v232, v234
    v_dot2_f32_bf16 v162, v113, v231, v234
    v_dot2_f32_bf16 v163, v113, v232, v234
    v_dot2_f32_bf16 v164, v114, v231, v234
    v_dot2_f32_bf16 v165, v114, v232, v234
    v_dot2_f32_bf16 v166, v115, v231, v234
    v_dot2_f32_bf16 v167, v115, v232, v234
    v_dot2_f32_bf16 v168, v116, v231, v234
    v_dot2_f32_bf16 v169, v116, v232, v234
    v_dot2_f32_bf16 v170, v117, v231, v234
    v_dot2_f32_bf16 v171, v117, v232, v234
    v_dot2_f32_bf16 v172, v118, v231, v234
    v_dot2_f32_bf16 v173, v118, v232, v234
    v_dot2_f32_bf16 v174, v119, v231, v234
    v_dot2_f32_bf16 v175, v119, v232, v234
    v_dot2_f32_bf16 v176, v120, v231, v234
    v_dot2_f32_bf16 v177, v120, v232, v234
    v_dot2_f32_bf16 v178, v121, v231, v234
    v_dot2_f32_bf16 v179, v121, v232, v234
    v_dot2_f32_bf16 v180, v122, v231, v234
    v_dot2_f32_bf16 v181, v122, v232, v234
    v_dot2_f32_bf16 v182, v123, v231, v234
    v_dot2_f32_bf16 v183, v123, v232, v234
    v_dot2_f32_bf16 v184, v124, v231, v234
    v_dot2_f32_bf16 v185, v124, v232, v234
    v_dot2_f32_bf16 v186, v125, v231, v234
    v_dot2_f32_bf16 v187, v125, v232, v234
    v_dot2_f32_bf16 v188, v126, v231, v234
    v_dot2_f32_bf16 v189, v126, v232, v234
    v_dot2_f32_bf16 v190, v127, v231, v234
    v_dot2_f32_bf16 v191, v127, v232, v234
    v_cvt_pk_bf16_f32 v112, v160, v161
    v_cvt_pk_bf16_f32 v113, v162, v163
    v_cvt_pk_bf16_f32 v114, v164, v165
    v_cvt_pk_bf16_f32 v115, v166, v167
    v_cvt_pk_bf16_f32 v116, v168, v169
    v_cvt_pk_bf16_f32 v117, v170, v171
    v_cvt_pk_bf16_f32 v118, v172, v173
    v_cvt_pk_bf16_f32 v119, v174, v175
    v_cvt_pk_bf16_f32 v120, v176, v177
    v_cvt_pk_bf16_f32 v121, v178, v179
    v_cvt_pk_bf16_f32 v122, v180, v181
    v_cvt_pk_bf16_f32 v123, v182, v183
    v_cvt_pk_bf16_f32 v124, v184, v185
    v_cvt_pk_bf16_f32 v125, v186, v187
    v_cvt_pk_bf16_f32 v126, v188, v189
    v_cvt_pk_bf16_f32 v127, v190, v191
    v_dot2_f32_bf16 v160, v128, v231, v234
    v_dot2_f32_bf16 v161, v128, v232, v234
    v_dot2_f32_bf16 v162, v129, v231, v234
    v_dot2_f32_bf16 v163, v129, v232, v234
    v_dot2_f32_bf16 v164, v130, v231, v234
    v_dot2_f32_bf16 v165, v130, v232, v234
    v_dot2_f32_bf16 v166, v131, v231, v234
    v_dot2_f32_bf16 v167, v131, v232, v234
    v_dot2_f32_bf16 v168, v132, v231, v234
    v_dot2_f32_bf16 v169, v132, v232, v234
    v_dot2_f32_bf16 v170, v133, v231, v234
    v_dot2_f32_bf16 v171, v133, v232, v234
    v_dot2_f32_bf16 v172, v134, v231, v234
    v_dot2_f32_bf16 v173, v134, v232, v234
    v_dot2_f32_bf16 v174, v135, v231, v234
    v_dot2_f32_bf16 v175, v135, v232, v234
    v_dot2_f32_bf16 v176, v136, v231, v234
    v_dot2_f32_bf16 v177, v136, v232, v234
    v_dot2_f32_bf16 v178, v137, v231, v234
    v_dot2_f32_bf16 v179, v137, v232, v234
    v_dot2_f32_bf16 v180, v138, v231, v234
    v_dot2_f32_bf16 v181, v138, v232, v234
    v_dot2_f32_bf16 v182, v139, v231, v234
    v_dot2_f32_bf16 v183, v139, v232, v234
    v_dot2_f32_bf16 v184, v140, v231, v234
    v_dot2_f32_bf16 v185, v140, v232, v234
    v_dot2_f32_bf16 v186, v141, v231, v234
    v_dot2_f32_bf16 v187, v141, v232, v234
    v_dot2_f32_bf16 v188, v142, v231, v234
    v_dot2_f32_bf16 v189, v142, v232, v234
    v_dot2_f32_bf16 v190, v143, v231, v234
    v_dot2_f32_bf16 v191, v143, v232, v234
    v_cvt_pk_bf16_f32 v128, v160, v161
    v_cvt_pk_bf16_f32 v129, v162, v163
    v_cvt_pk_bf16_f32 v130, v164, v165
    v_cvt_pk_bf16_f32 v131, v166, v167
    v_cvt_pk_bf16_f32 v132, v168, v169
    v_cvt_pk_bf16_f32 v133, v170, v171
    v_cvt_pk_bf16_f32 v134, v172, v173
    v_cvt_pk_bf16_f32 v135, v174, v175
    v_cvt_pk_bf16_f32 v136, v176, v177
    v_cvt_pk_bf16_f32 v137, v178, v179
    v_cvt_pk_bf16_f32 v138, v180, v181
    v_cvt_pk_bf16_f32 v139, v182, v183
    v_cvt_pk_bf16_f32 v140, v184, v185
    v_cvt_pk_bf16_f32 v141, v186, v187
    v_cvt_pk_bf16_f32 v142, v188, v189
    v_cvt_pk_bf16_f32 v143, v190, v191
    v_dot2_f32_bf16 v160, v144, v231, v234
    v_dot2_f32_bf16 v161, v144, v232, v234
    v_dot2_f32_bf16 v162, v145, v231, v234
    v_dot2_f32_bf16 v163, v145, v232, v234
    v_dot2_f32_bf16 v164, v146, v231, v234
    v_dot2_f32_bf16 v165, v146, v232, v234
    v_dot2_f32_bf16 v166, v147, v231, v234
    v_dot2_f32_bf16 v167, v147, v232, v234
    v_dot2_f32_bf16 v168, v148, v231, v234
    v_dot2_f32_bf16 v169, v148, v232, v234
    v_dot2_f32_bf16 v170, v149, v231, v234
    v_dot2_f32_bf16 v171, v149, v232, v234
    v_dot2_f32_bf16 v172, v150, v231, v234
    v_dot2_f32_bf16 v173, v150, v232, v234
    v_dot2_f32_bf16 v174, v151, v231, v234
    v_dot2_f32_bf16 v175, v151, v232, v234
    v_dot2_f32_bf16 v176, v152, v231, v234
    v_dot2_f32_bf16 v177, v152, v232, v234
    v_dot2_f32_bf16 v178, v153, v231, v234
    v_dot2_f32_bf16 v179, v153, v232, v234
    v_dot2_f32_bf16 v180, v154, v231, v234
    v_dot2_f32_bf16 v181, v154, v232, v234
    v_dot2_f32_bf16 v182, v155, v231, v234
    v_dot2_f32_bf16 v183, v155, v232, v234
    v_dot2_f32_bf16 v184, v156, v231, v234
    v_dot2_f32_bf16 v185, v156, v232, v234
    v_dot2_f32_bf16 v186, v157, v231, v234
    v_dot2_f32_bf16 v187, v157, v232, v234
    v_dot2_f32_bf16 v188, v158, v231, v234
    v_dot2_f32_bf16 v189, v158, v232, v234
    v_dot2_f32_bf16 v190, v159, v231, v234
    v_dot2_f32_bf16 v191, v159, v232, v234
    v_cvt_pk_bf16_f32 v144, v160, v161
    v_cvt_pk_bf16_f32 v145, v162, v163
    v_cvt_pk_bf16_f32 v146, v164, v165
    v_cvt_pk_bf16_f32 v147, v166, v167
    v_cvt_pk_bf16_f32 v148, v168, v169
    v_cvt_pk_bf16_f32 v149, v170, v171
    v_cvt_pk_bf16_f32 v150, v172, v173
    v_cvt_pk_bf16_f32 v151, v174, v175
    v_cvt_pk_bf16_f32 v152, v176, v177
    v_cvt_pk_bf16_f32 v153, v178, v179
    v_cvt_pk_bf16_f32 v154, v180, v181
    v_cvt_pk_bf16_f32 v155, v182, v183
    v_cvt_pk_bf16_f32 v156, v184, v185
    v_cvt_pk_bf16_f32 v157, v186, v187
    v_cvt_pk_bf16_f32 v158, v188, v189
    v_cvt_pk_bf16_f32 v159, v190, v191
    s_waitcnt vmcnt(6) lgkmcnt(0)
    s_barrier
    ds_read_b32 a48, v224
    v_xor_b32 v218, 64, v216
    ds_read_b64_tr_b16 a[0:1], v216 offset:0
    ds_read_b64_tr_b16 a[2:3], v216 offset:512
    ds_read_b64_tr_b16 a[4:5], v216 offset:2048
    ds_read_b64_tr_b16 a[6:7], v216 offset:2560
    ds_read_b64_tr_b16 a[8:9], v216 offset:4096
    ds_read_b64_tr_b16 a[10:11], v216 offset:4608
    ds_read_b64_tr_b16 a[12:13], v216 offset:6144
    ds_read_b64_tr_b16 a[14:15], v216 offset:6656
    ds_read_b64_tr_b16 a[16:17], v216 offset:8192
    ds_read_b64_tr_b16 a[18:19], v216 offset:8704
    ds_read_b64_tr_b16 a[20:21], v216 offset:10240
    ds_read_b64_tr_b16 a[22:23], v216 offset:10752
    ds_read_b64_tr_b16 a[24:25], v216 offset:12288
    ds_read_b64_tr_b16 a[26:27], v216 offset:12800
    ds_read_b64_tr_b16 a[28:29], v216 offset:14336
    ds_read_b64_tr_b16 a[30:31], v216 offset:14848
    v_add_u32 v217, 36864, v216
    v_add_u32 v219, 36864, v218
    v_add_u32 v225, 73728, v216
    v_add_u32 v226, 110592, v216
    v_add_u32 v227, 73728, v218
    v_add_u32 v228, 110592, v218
    s_waitcnt vmcnt(18)
    v_readfirstlane_b32 s3, v246
    s_nop 1
    s_cmp_eq_u32 s3, 0
    s_cbranch_scc1 TG_1
TGR_2:
    s_cmp_lg_u32 s32, 0
    s_cbranch_scc1 PUB_3
    s_or_b32 s101, s3, s37
    s_or_b32 s101, s101, 16
    v_mov_b32 v246, s101
    buffer_store_dword v246, v247, s[24:27], s38 offen sc0 sc1
PUB_3:
    s_waitcnt lgkmcnt(15)
    v_mfma_f32_32x32x16_bf16 v[160:175], a[48:51], v[192:195], 0
    s_and_b32 s57, s77, 0xffff
    s_and_b32 s29, s69, 0xffff
    s_and_b32 s17, s11, 0xffff
    s_or_b32 s43, s3, s37
    s_mov_b32 s40, 43691
    s_waitcnt lgkmcnt(8)
    v_mfma_f32_32x32x16_bf16 v[160:175], a[0:3], v[16:19], v[160:175]
    s_or_b32 s43, s43, 0x30
    s_mul_i32 s51, s39, 294912
    s_mul_i32 s73, s34, 384
    s_mul_i32 s41, s32, 18432
    v_mfma_f32_32x32x16_bf16 v[160:175], a[4:7], v[20:23], v[160:175]
    s_mov_b32 s56, s76
    s_mov_b32 s58, 0x510000
    s_mov_b32 s59, 0x00020000
    s_mov_b32 s28, s68
    s_mov_b32 s30, 0xa2000
    s_mov_b32 s31, 0x00020000
    v_mfma_f32_32x32x16_bf16 v[160:175], a[8:11], v[24:27], v[160:175]
    s_mov_b32 s16, s10
    s_mov_b32 s18, 0x2d1c000
    s_mov_b32 s19, 0x00020000
    s_mov_b32 s52, 43691
    s_mul_i32 s48, s32, 6144
    s_mov_b32 s36, 0
    v_mfma_f32_32x32x16_bf16 v[160:175], a[12:15], v[28:31], v[160:175]
    v_add_f32 v242, v242, v243
    v_add_f32 v244, v244, v245
    v_add_f32 v242, v242, v244
    v_mov_b32 v243, v242
    s_nop 1
    v_permlane32_swap_b32 v242, v243
    v_mul_f32 v240, v239, v239
    s_waitcnt lgkmcnt(0)
    v_mfma_f32_32x32x16_bf16 v[160:175], a[16:19], v[32:35], v[160:175]
    v_add_f32 v242, v242, v243
    v_mul_f32 v196, 0xc0135761, v239
    v_mul_f32 v240, 0x3d372713, v240
    v_mul_f32 v242, 0xbfb8aa3b, v242
    v_mul_f32 v197, v196, v240
    v_exp_f32 v244, -v242
    v_mfma_f32_32x32x16_bf16 v[160:175], a[20:23], v[36:39], v[160:175]
    v_lshrrev_b32 v254, 1, v253
    v_and_b32 v240, 1, v253
    v_exp_f32 v243, v242
    v_mul_u32_u24 v254, 1152, v254
    v_mul_u32_u24 v240, 188, v240
    v_mfma_f32_32x32x16_bf16 v[160:175], a[24:27], v[40:43], v[160:175]
    v_add_u32 v254, v254, v240
    v_add_f32 v244, 1.0, v244
    v_mul_lo_u32 v240, v253, s40
    s_lshl_b32 s40, s32, 9
    s_add_u32 s40, s40, 149504
    s_add_u32 s53, s34, 0
    v_mfma_f32_32x32x16_bf16 v[160:175], a[28:31], v[44:47], v[160:175]
    s_cmp_ge_u32 s53, 3
    s_cselect_b32 s50, 3, 0
    s_sub_u32 s53, s53, s50
    s_mul_i32 s50, s35, 3
    s_add_u32 s50, s50, s53
    s_mul_i32 s64, s50, 24576
    s_add_u32 s64, s64, s51
    s_mul_i32 s70, s50, 442368
    s_mul_i32 s51, s34, 384
    s_add_u32 s70, s70, s51
    s_mul_i32 s51, s32, 18432
    s_add_u32 s70, s70, s51
    s_add_u32 s53, s34, 1
    s_cmp_ge_u32 s53, 3
    s_cselect_b32 s50, 3, 0
    s_sub_u32 s53, s53, s50
    s_mul_i32 s50, s35, 3
    s_add_u32 s50, s50, s53
    s_mul_i32 s65, s50, 24576
    s_mul_i32 s51, s39, 294912
    s_add_u32 s65, s65, s51
    s_mul_i32 s71, s50, 442368
    s_mul_i32 s51, s34, 384
    s_add_u32 s71, s71, s51
    s_mul_i32 s51, s32, 18432
    s_add_u32 s71, s71, s51
    s_sub_u32 s51, s53, s34
    s_lshl_b32 s51, s51, 7
    s_add_u32 s44, s38, s51
    s_add_u32 s53, s34, 2
    s_cmp_ge_u32 s53, 3
    s_cselect_b32 s50, 3, 0
    s_sub_u32 s53, s53, s50
    s_mul_i32 s50, s35, 3
    s_add_u32 s50, s50, s53
    s_mul_i32 s66, s50, 24576
    s_mul_i32 s51, s39, 294912
    s_add_u32 s66, s66, s51
    s_mul_i32 s72, s50, 442368
    s_mul_i32 s51, s34, 384
    s_add_u32 s72, s72, s51
    s_mul_i32 s51, s32, 18432
    s_add_u32 s72, s72, s51
    s_sub_u32 s51, s53, s34
    s_lshl_b32 s51, s51, 7
    s_add_u32 s45, s38, s51
    s_lshr_b32 s51, s35, 1
    s_mul_i32 s51, s51, 192
    s_add_u32 s73, s73, s51
    s_mul_i32 s51, s32, 36864
    s_add_u32 s73, s73, s51
    s_cmp_ge_u32 s32, 2
    s_cselect_b32 s74, 73728, 0
    s_sub_u32 s74, s73, s74
    s_add_u32 s74, s74, 589824
    s_sub_u32 s60, s70, s41
    s_sub_u32 s61, s71, s41
    s_sub_u32 s62, s72, s41
    s_sub_u32 s63, s73, s41
    s_sub_u32 s63, s63, s41
    s_add_u32 m0, s49, 79872
    s_add_u32 s46, s47, 442496
    buffer_load_dwordx4 v220, s[20:23], s46 offen offset:0  lds
    buffer_load_dwordx4 v221, s[20:23], s46 offen offset:1024  lds
    buffer_load_dwordx4 v222, s[20:23], s46 offen offset:2048  lds
    v_add_f32 v243, 1.0, v243
    v_rcp_f32 v250, v244
    v_rcp_f32 v248, v243
    v_and_b32 v243, 31, v0
    v_mul_f32 v249, v250, v239
    v_mov_b32 v251, 0
    v_lshl_add_u32 v243, v243, 4, s40
    s_waitcnt vmcnt(28)
    v_lshl_or_b32 v229, v229, 16, v229
    v_accvgpr_write_b32 a53, 0
    v_accvgpr_write_b32 a54, 0
    v_accvgpr_write_b32 a55, 0
    v_lshrrev_b32 v240, 17, v240
    v_mul_u32_u24 v241, 3, v240
    v_sub_u32 v241, v253, v241
    v_mul_u32_u24 v240, 1152, v240
    v_lshl_add_u32 v253, v241, 7, v240
    v_add_u32 v240, 0, v0
    v_mul_lo_u32 v244, v240, s52
    v_lshrrev_b32 v241, 20, v244
    v_mul_u32_u24 v242, 24, v241
    v_sub_u32 v242, v240, v242
    v_mov_b32 v10, 0
    v_bfe_u32 v246, v0, 2, 2
    v_cmp_gt_u32 vcc, 32, v0
    v_mov_b32 v235, s3
    v_mov_b32 v236, 0x00003f80
    v_mov_b32 v237, 0x3f800000
    ds_write_b128 v243, v[248:251]
    v_lshl_add_u32 v243, v0, 2, s55
    ds_write_b32 v243, v229
    ds_read_b64_tr_b16 a[32:33], v216 offset:16384
    ds_read_b64_tr_b16 a[34:35], v216 offset:16896
    ds_read_b64_tr_b16 a[36:37], v216 offset:18432
    ds_read_b64_tr_b16 a[38:39], v216 offset:18944
    ds_read_b64_tr_b16 a[40:41], v216 offset:20480
    ds_read_b64_tr_b16 a[42:43], v216 offset:20992
    ds_read_b64_tr_b16 a[44:45], v216 offset:22528
    ds_read_b64_tr_b16 a[46:47], v216 offset:23040
    ds_read_b64_tr_b16 a[0:1], v216 offset:24576
    ds_read_b64_tr_b16 a[2:3], v216 offset:25088
    ds_read_b64_tr_b16 a[4:5], v216 offset:26624
    ds_read_b64_tr_b16 a[6:7], v216 offset:27136
    ds_read_b64_tr_b16 a[8:9], v216 offset:28672
    ds_read_b64_tr_b16 a[10:11], v216 offset:29184
    ds_read_b64_tr_b16 a[12:13], v216 offset:30720
    ds_read_b64_tr_b16 a[14:15], v216 offset:31232
    v_bfe_u32 v243, v241, 1, 1
    v_lshlrev_b32 v243, 2, v243
    v_xor_b32 v242, v242, v243
    v_mul_u32_u24 v241, 1152, v241
    v_lshl_add_u32 v241, v242, 4, v241
    v_subrev_u32 v7, 0, v241
    v_lshrrev_b32 v241, 19, v244
    v_mul_u32_u24 v242, 12, v241
    v_sub_u32 v242, v240, v242
    v_mul_u32_u24 v241, 1152, v241
    v_lshl_add_u32 v241, v242, 4, v241
    v_add_u32 v240, 64, v0
    v_subrev_u32 v13, 0, v241
    v_mul_lo_u32 v244, v240, s52
    v_lshrrev_b32 v241, 20, v244
    v_mul_u32_u24 v242, 24, v241
    v_bfe_u32 v243, v241, 1, 1
    v_sub_u32 v242, v240, v242
    v_lshlrev_b32 v243, 2, v243
    s_waitcnt lgkmcnt(8)
    v_mfma_f32_32x32x16_bf16 v[160:175], a[32:35], v[48:51], v[160:175]
    ds_read_b64_tr_b16 a[16:17], v216 offset:32768
    ds_read_b64_tr_b16 a[18:19], v216 offset:33280
    v_xor_b32 v242, v242, v243
    v_mul_u32_u24 v241, 1152, v241
    v_lshl_add_u32 v241, v242, 4, v241
    v_mfma_f32_32x32x16_bf16 v[160:175], a[36:39], v[52:55], v[160:175]
    ds_read_b64_tr_b16 a[20:21], v216 offset:34816
    ds_read_b64_tr_b16 a[22:23], v216 offset:35328
    v_subrev_u32 v8, 1024, v241
    v_lshrrev_b32 v241, 19, v244
    v_mul_u32_u24 v242, 12, v241
    v_sub_u32 v242, v240, v242
    v_mfma_f32_32x32x16_bf16 v[160:175], a[40:43], v[56:59], v[160:175]
    ds_read_b64_tr_b16 a[24:25], v217 offset:0
    ds_read_b64_tr_b16 a[26:27], v217 offset:512
    s_add_u32 m0, s49, 110592
    s_add_u32 s46, s47, 2654336
    buffer_load_dwordx4 v220, s[20:23], s46 offen offset:0  lds
    v_mul_u32_u24 v241, 1152, v241
    v_mfma_f32_32x32x16_bf16 v[160:175], a[44:47], v[60:63], v[160:175]
    ds_read_b64_tr_b16 a[28:29], v217 offset:2048
    ds_read_b64_tr_b16 a[30:31], v217 offset:2560
    v_lshl_add_u32 v241, v242, 4, v241
    v_add_u32 v240, 128, v0
    v_subrev_u32 v14, 1024, v241
    v_mul_lo_u32 v244, v240, s52
    s_waitcnt lgkmcnt(8)
    v_mfma_f32_32x32x16_bf16 v[160:175], a[0:3], v[64:67], v[160:175]
    ds_read_b64_tr_b16 a[32:33], v217 offset:4096
    ds_read_b64_tr_b16 a[34:35], v217 offset:4608
    v_lshrrev_b32 v241, 20, v244
    v_mul_u32_u24 v242, 24, v241
    v_bfe_u32 v243, v241, 1, 1
    v_sub_u32 v242, v240, v242
    v_mfma_f32_32x32x16_bf16 v[160:175], a[4:7], v[68:71], v[160:175]
    ds_read_b64_tr_b16 a[36:37], v217 offset:6144
    ds_read_b64_tr_b16 a[38:39], v217 offset:6656
    buffer_load_dwordx4 v221, s[20:23], s46 offen offset:1024  lds
    v_lshlrev_b32 v243, 2, v243
    v_xor_b32 v242, v242, v243
    v_mul_u32_u24 v241, 1152, v241
    v_mfma_f32_32x32x16_bf16 v[160:175], a[8:11], v[72:75], v[160:175]
    ds_read_b64_tr_b16 a[40:41], v217 offset:8192
    ds_read_b64_tr_b16 a[42:43], v217 offset:8704
    v_lshl_add_u32 v241, v242, 4, v241
    v_subrev_u32 v9, 2048, v241
    v_lshrrev_b32 v241, 19, v244
    v_mfma_f32_32x32x16_bf16 v[160:175], a[12:15], v[76:79], v[160:175]
    ds_read_b64_tr_b16 a[44:45], v217 offset:10240
    ds_read_b64_tr_b16 a[46:47], v217 offset:10752
    v_mul_u32_u24 v242, 12, v241
    v_sub_u32 v242, v240, v242
    v_mul_u32_u24 v241, 1152, v241
    v_lshl_add_u32 v241, v242, 4, v241
    s_waitcnt lgkmcnt(8)
    v_mfma_f32_32x32x16_bf16 v[160:175], a[16:19], v[80:83], v[160:175]
    ds_read_b64_tr_b16 a[0:1], v217 offset:12288
    ds_read_b64_tr_b16 a[2:3], v217 offset:12800
    buffer_load_dwordx4 v222, s[20:23], s46 offen offset:2048  lds
    v_subrev_u32 v15, 2048, v241
    v_lshrrev_b32 v240, 5, v0
    v_lshlrev_b32 v240, 3, v240
    v_mfma_f32_32x32x16_bf16 v[160:175], a[20:23], v[84:87], v[160:175]
    ds_read_b64_tr_b16 a[4:5], v217 offset:14336
    ds_read_b64_tr_b16 a[6:7], v217 offset:14848
    v_bfe_u32 v241, v0, 2, 2
    v_add_u32 v240, v240, v241
    v_bfe_u32 v241, v0, 4, 1
    v_lshlrev_b32 v242, 5, v241
    v_mfma_f32_32x32x16_bf16 v[160:175], a[24:27], v[88:91], v[160:175]
    ds_read_b64_tr_b16 a[8:9], v217 offset:16384
    ds_read_b64_tr_b16 a[10:11], v217 offset:16896
    v_and_b32 v241, 1, v0
    v_lshl_add_u32 v242, v241, 4, v242
    v_bfe_u32 v241, v0, 1, 1
    v_mfma_f32_32x32x16_bf16 v[160:175], a[28:31], v[92:95], v[160:175]
    ds_read_b64_tr_b16 a[12:13], v217 offset:18432
    ds_read_b64_tr_b16 a[14:15], v217 offset:18944
    s_add_u32 m0, s49, 113664
    s_add_u32 s46, s47, 2875520
    buffer_load_dwordx4 v220, s[20:23], s46 offen offset:0  lds
    v_lshl_add_u32 v12, v241, 3, v242
    s_waitcnt lgkmcnt(8)
    v_mfma_f32_32x32x16_bf16 v[160:175], a[32:35], v[96:99], v[160:175]
    ds_read_b64_tr_b16 a[16:17], v217 offset:20480
    ds_read_b64_tr_b16 a[18:19], v217 offset:20992
    v_mul_u32_u24 v240, 384, v240
    v_bfe_u32 v241, v0, 3, 1
    v_add_u32 v240, v240, v12
    v_lshlrev_b32 v241, 6, v241
    v_mfma_f32_32x32x16_bf16 v[160:175], a[36:39], v[100:103], v[160:175]
    ds_read_b64_tr_b16 a[20:21], v217 offset:22528
    ds_read_b64_tr_b16 a[22:23], v217 offset:23040
    v_add_u32 v1, v240, v241
    v_sub_u32 v4, v240, v241
    v_add_u32 v2, 49152, v1
    v_add_u32 v5, 49152, v4
    v_mfma_f32_32x32x16_bf16 v[160:175], a[40:43], v[104:107], v[160:175]
    ds_read_b64_tr_b16 a[24:25], v217 offset:24576
    ds_read_b64_tr_b16 a[26:27], v217 offset:25088
    buffer_load_dwordx4 v221, s[20:23], s46 offen offset:1024  lds
    v_add_u32 v3, 98304, v1
    v_add_u32 v6, 98304, v4
    v_mfma_f32_32x32x16_bf16 v[160:175], a[44:47], v[108:111], v[160:175]
    ds_read_b64_tr_b16 a[28:29], v217 offset:26624
    ds_read_b64_tr_b16 a[30:31], v217 offset:27136
    ds_read_b32 a52, v224 offset:128
    v_and_b32 v244, 31, v0
    v_mov_b32 v229, v223
    v_cndmask_b32 v243, v235, -1, vcc
    s_waitcnt lgkmcnt(9)
    v_mfma_f32_32x32x16_bf16 v[160:175], a[0:3], v[112:115], v[160:175]
    ds_read_b64_tr_b16 a[32:33], v217 offset:28672
    ds_read_b64_tr_b16 a[34:35], v217 offset:29184
    v_mfma_f32_32x32x16_bf16 v[160:175], a[4:7], v[116:119], v[160:175]
    ds_read_b64_tr_b16 a[36:37], v217 offset:30720
    ds_read_b64_tr_b16 a[38:39], v217 offset:31232
    buffer_load_dwordx4 v222, s[20:23], s46 offen offset:2048  lds
    v_mfma_f32_32x32x16_bf16 v[160:175], a[8:11], v[120:123], v[160:175]
    ds_read_b64_tr_b16 a[40:41], v217 offset:32768
    ds_read_b64_tr_b16 a[42:43], v217 offset:33280
    v_mfma_f32_32x32x16_bf16 v[160:175], a[12:15], v[124:127], v[160:175]
    ds_read_b64_tr_b16 a[44:45], v217 offset:34816
    ds_read_b64_tr_b16 a[46:47], v217 offset:35328
    s_waitcnt lgkmcnt(9)
    v_mfma_f32_32x32x16_bf16 v[160:175], a[16:19], v[128:131], v[160:175]
    ds_read_b64_tr_b16 a[0:1], v218 offset:0
    ds_read_b64_tr_b16 a[2:3], v218 offset:512
    s_add_u32 m0, s49, 116736
    s_add_u32 s46, s47, 3096704
    buffer_load_dwordx4 v220, s[20:23], s46 offen offset:0  lds
    v_mfma_f32_32x32x16_bf16 v[160:175], a[20:23], v[132:135], v[160:175]
    ds_read_b64_tr_b16 a[4:5], v218 offset:2048
    ds_read_b64_tr_b16 a[6:7], v218 offset:2560
    v_mfma_f32_32x32x16_bf16 v[160:175], a[24:27], v[136:139], v[160:175]
    ds_read_b64_tr_b16 a[8:9], v218 offset:4096
    ds_read_b64_tr_b16 a[10:11], v218 offset:4608
    v_mfma_f32_32x32x16_bf16 v[160:175], a[28:31], v[140:143], v[160:175]
    ds_read_b64_tr_b16 a[12:13], v218 offset:6144
    ds_read_b64_tr_b16 a[14:15], v218 offset:6656
    buffer_load_dwordx4 v221, s[20:23], s46 offen offset:1024  lds
    s_waitcnt lgkmcnt(8)
    v_mfma_f32_32x32x16_bf16 v[160:175], a[32:35], v[144:147], v[160:175]
    ds_read_b64_tr_b16 a[16:17], v218 offset:8192
    ds_read_b64_tr_b16 a[18:19], v218 offset:8704
    v_mfma_f32_32x32x16_bf16 v[160:175], a[36:39], v[148:151], v[160:175]
    ds_read_b64_tr_b16 a[20:21], v218 offset:10240
    ds_read_b64_tr_b16 a[22:23], v218 offset:10752
    v_mfma_f32_32x32x16_bf16 v[160:175], a[40:43], v[152:155], v[160:175]
    ds_read_b64_tr_b16 a[24:25], v218 offset:12288
    ds_read_b64_tr_b16 a[26:27], v218 offset:12800
    buffer_load_dwordx4 v222, s[20:23], s46 offen offset:2048  lds
    v_mfma_f32_32x32x16_bf16 v[160:175], a[44:47], v[156:159], v[160:175]
    ds_read_b64_tr_b16 a[28:29], v218 offset:14336
    ds_read_b64_tr_b16 a[30:31], v218 offset:14848
    s_waitcnt lgkmcnt(15)
    v_mfma_f32_32x32x16_bf16 v[176:191], a[52:55], v[192:195], 0
    s_nop 7
    v_mul_f32 v200, v160, v160
    s_waitcnt lgkmcnt(8)
    v_mfma_f32_32x32x16_bf16 v[176:191], a[0:3], v[16:19], v[176:191]
    ds_read_b64_tr_b16 a[32:33], v218 offset:16384
    ds_read_b64_tr_b16 a[34:35], v218 offset:16896
    buffer_load_dword v198, v198, s[56:59], 0 offen
    buffer_load_dword v199, v199, s[28:31], 0 offen
    v_mul_f32 v201, v161, v161
    v_mul_f32 v202, v162, v162
    v_mfma_f32_32x32x16_bf16 v[176:191], a[4:7], v[20:23], v[176:191]
    ds_read_b64_tr_b16 a[36:37], v218 offset:18432
    ds_read_b64_tr_b16 a[38:39], v218 offset:18944
    v_mul_f32 v203, v163, v163
    v_mul_f32 v204, v164, v164
    v_mul_f32 v205, v165, v165
    v_mfma_f32_32x32x16_bf16 v[176:191], a[8:11], v[24:27], v[176:191]
    ds_read_b64_tr_b16 a[40:41], v218 offset:20480
    ds_read_b64_tr_b16 a[42:43], v218 offset:20992
    v_mul_f32 v206, v166, v166
    v_mul_f32 v207, v167, v167
    v_fma_f32 v200, v200, v197, v196
    v_fma_f32 v201, v201, v197, v196
    v_mfma_f32_32x32x16_bf16 v[176:191], a[12:15], v[28:31], v[176:191]
    ds_read_b64_tr_b16 a[44:45], v218 offset:22528
    ds_read_b64_tr_b16 a[46:47], v218 offset:23040
    v_fma_f32 v202, v202, v197, v196
    v_fma_f32 v203, v203, v197, v196
    v_fma_f32 v204, v204, v197, v196
    v_fma_f32 v205, v205, v197, v196
    s_waitcnt lgkmcnt(8)
    v_mfma_f32_32x32x16_bf16 v[176:191], a[16:19], v[32:35], v[176:191]
    ds_read_b64_tr_b16 a[0:1], v218 offset:24576
    ds_read_b64_tr_b16 a[2:3], v218 offset:25088
    v_fma_f32 v206, v206, v197, v196
    v_fma_f32 v207, v207, v197, v196
    v_mul_f32 v200, v160, v200
    v_mul_f32 v201, v161, v201
    v_mfma_f32_32x32x16_bf16 v[176:191], a[20:23], v[36:39], v[176:191]
    ds_read_b64_tr_b16 a[4:5], v218 offset:26624
    ds_read_b64_tr_b16 a[6:7], v218 offset:27136
    v_mul_f32 v202, v162, v202
    v_mul_f32 v203, v163, v203
    v_mul_f32 v204, v164, v204
    v_mul_f32 v205, v165, v205
    v_mfma_f32_32x32x16_bf16 v[176:191], a[24:27], v[40:43], v[176:191]
    ds_read_b64_tr_b16 a[8:9], v218 offset:28672
    ds_read_b64_tr_b16 a[10:11], v218 offset:29184
    v_mul_f32 v206, v166, v206
    v_mul_f32 v207, v167, v207
    v_exp_f32 v200, v200
    v_mfma_f32_32x32x16_bf16 v[176:191], a[28:31], v[44:47], v[176:191]
    ds_read_b64_tr_b16 a[12:13], v218 offset:30720
    ds_read_b64_tr_b16 a[14:15], v218 offset:31232
    v_exp_f32 v201, v201
    v_exp_f32 v202, v202
    s_waitcnt lgkmcnt(8)
    v_mfma_f32_32x32x16_bf16 v[176:191], a[32:35], v[48:51], v[176:191]
    ds_read_b64_tr_b16 a[16:17], v218 offset:32768
    ds_read_b64_tr_b16 a[18:19], v218 offset:33280
    v_exp_f32 v203, v203
    v_exp_f32 v204, v204
    v_mfma_f32_32x32x16_bf16 v[176:191], a[36:39], v[52:55], v[176:191]
    ds_read_b64_tr_b16 a[20:21], v218 offset:34816
    ds_read_b64_tr_b16 a[22:23], v218 offset:35328
    v_exp_f32 v205, v205
    v_exp_f32 v206, v206
    v_mfma_f32_32x32x16_bf16 v[176:191], a[40:43], v[56:59], v[176:191]
    ds_read_b64_tr_b16 a[24:25], v219 offset:0
    ds_read_b64_tr_b16 a[26:27], v219 offset:512
    v_exp_f32 v207, v207
    v_add_f32 v200, 1.0, v200
    v_mfma_f32_32x32x16_bf16 v[176:191], a[44:47], v[60:63], v[176:191]
    ds_read_b64_tr_b16 a[28:29], v219 offset:2048
    ds_read_b64_tr_b16 a[30:31], v219 offset:2560
    v_add_f32 v201, 1.0, v201
    v_add_f32 v202, 1.0, v202
    v_add_f32 v203, 1.0, v203
    v_add_f32 v204, 1.0, v204
    s_waitcnt lgkmcnt(8)
    v_mfma_f32_32x32x16_bf16 v[176:191], a[0:3], v[64:67], v[176:191]
    ds_read_b64_tr_b16 a[32:33], v219 offset:4096
    ds_read_b64_tr_b16 a[34:35], v219 offset:4608
    v_add_f32 v205, 1.0, v205
    v_add_f32 v206, 1.0, v206
    v_add_f32 v207, 1.0, v207
    v_rcp_f32 v200, v200
    v_mfma_f32_32x32x16_bf16 v[176:191], a[4:7], v[68:71], v[176:191]
    ds_read_b64_tr_b16 a[36:37], v219 offset:6144
    ds_read_b64_tr_b16 a[38:39], v219 offset:6656
    v_rcp_f32 v201, v201
    v_rcp_f32 v202, v202
    v_mfma_f32_32x32x16_bf16 v[176:191], a[8:11], v[72:75], v[176:191]
    ds_read_b64_tr_b16 a[40:41], v219 offset:8192
    ds_read_b64_tr_b16 a[42:43], v219 offset:8704
    v_rcp_f32 v203, v203
    v_mfma_f32_32x32x16_bf16 v[176:191], a[12:15], v[76:79], v[176:191]
    ds_read_b64_tr_b16 a[44:45], v219 offset:10240
    ds_read_b64_tr_b16 a[46:47], v219 offset:10752
    s_waitcnt lgkmcnt(8) vmcnt(11)
    s_barrier
    v_rcp_f32 v204, v204
    v_rcp_f32 v205, v205
    v_mfma_f32_32x32x16_bf16 v[176:191], a[16:19], v[80:83], v[176:191]
    ds_read_b64_tr_b16 a[0:1], v219 offset:12288
    ds_read_b64_tr_b16 a[2:3], v219 offset:12800
    s_add_u32 m0, s49, 0
    s_add_u32 s46, s47, 256
    buffer_load_dwordx4 v220, s[20:23], s46 offen offset:0  lds
    s_add_u32 s54, s64, 0
    v_mfma_f32_32x32x16_bf16 v[176:191], a[20:23], v[84:87], v[176:191]
    ds_read_b64_tr_b16 a[4:5], v219 offset:14336
    ds_read_b64_tr_b16 a[6:7], v219 offset:14848
    v_rcp_f32 v206, v206
    v_rcp_f32 v207, v207
    v_mfma_f32_32x32x16_bf16 v[176:191], a[24:27], v[88:91], v[176:191]
    ds_read_b64_tr_b16 a[8:9], v219 offset:16384
    ds_read_b64_tr_b16 a[10:11], v219 offset:16896
    v_mul_f32 v200, v160, v200
    v_mul_f32 v201, v161, v201
    v_mul_f32 v202, v162, v202
    v_mfma_f32_32x32x16_bf16 v[176:191], a[28:31], v[92:95], v[176:191]
    ds_read_b64_tr_b16 a[12:13], v219 offset:18432
    ds_read_b64_tr_b16 a[14:15], v219 offset:18944
    buffer_load_dwordx4 v221, s[20:23], s46 offen offset:1024  lds
    v_mul_f32 v203, v163, v203
    v_mul_f32 v204, v164, v204
    v_mul_f32 v205, v165, v205
    s_waitcnt lgkmcnt(8)
    v_mfma_f32_32x32x16_bf16 v[176:191], a[32:35], v[96:99], v[176:191]
    ds_read_b64_tr_b16 a[16:17], v219 offset:20480
    ds_read_b64_tr_b16 a[18:19], v219 offset:20992
    v_mul_f32 v206, v166, v206
    v_mul_f32 v207, v167, v207
    v_cvt_pk_bf16_f32 v208, v200, v201
    v_cvt_pk_bf16_f32 v209, v202, v203
    v_mfma_f32_32x32x16_bf16 v[176:191], a[36:39], v[100:103], v[176:191]
    ds_read_b64_tr_b16 a[20:21], v219 offset:22528
    ds_read_b64_tr_b16 a[22:23], v219 offset:23040
    v_cvt_pk_bf16_f32 v210, v204, v205
    v_cvt_pk_bf16_f32 v211, v206, v207
    v_mul_f32 v200, v168, v168
    v_mul_f32 v201, v169, v169
    v_mfma_f32_32x32x16_bf16 v[176:191], a[40:43], v[104:107], v[176:191]
    ds_read_b64_tr_b16 a[24:25], v219 offset:24576
    ds_read_b64_tr_b16 a[26:27], v219 offset:25088
    buffer_store_dwordx4 v[208:211], v223, s[24:27], s54 offen offset:0
    buffer_load_dwordx4 v222, s[20:23], s46 offen offset:2048  lds
    v_mul_f32 v202, v170, v170
    v_mfma_f32_32x32x16_bf16 v[176:191], a[44:47], v[108:111], v[176:191]
    ds_read_b64_tr_b16 a[28:29], v219 offset:26624
    ds_read_b64_tr_b16 a[30:31], v219 offset:27136
    ds_read_b32 a48, v224 offset:256
    v_mul_f32 v203, v171, v171
    v_mul_f32 v204, v172, v172
    v_mul_f32 v205, v173, v173
    s_waitcnt lgkmcnt(9)
    v_mfma_f32_32x32x16_bf16 v[176:191], a[0:3], v[112:115], v[176:191]
    ds_read_b64_tr_b16 a[32:33], v219 offset:28672
    ds_read_b64_tr_b16 a[34:35], v219 offset:29184
    v_mul_f32 v206, v174, v174
    v_mul_f32 v207, v175, v175
    v_fma_f32 v200, v200, v197, v196
    v_fma_f32 v201, v201, v197, v196
    v_mfma_f32_32x32x16_bf16 v[176:191], a[4:7], v[116:119], v[176:191]
    ds_read_b64_tr_b16 a[36:37], v219 offset:30720
    ds_read_b64_tr_b16 a[38:39], v219 offset:31232
    s_add_u32 m0, s49, 3072
    s_add_u32 s46, s47, 221440
    buffer_load_dwordx4 v220, s[20:23], s46 offen offset:0  lds
    v_fma_f32 v202, v202, v197, v196
    v_mfma_f32_32x32x16_bf16 v[176:191], a[8:11], v[120:123], v[176:191]
    ds_read_b64_tr_b16 a[40:41], v219 offset:32768
    ds_read_b64_tr_b16 a[42:43], v219 offset:33280
    v_fma_f32 v203, v203, v197, v196
    v_fma_f32 v204, v204, v197, v196
    v_fma_f32 v205, v205, v197, v196
    v_mfma_f32_32x32x16_bf16 v[176:191], a[12:15], v[124:127], v[176:191]
    ds_read_b64_tr_b16 a[44:45], v219 offset:34816
    ds_read_b64_tr_b16 a[46:47], v219 offset:35328
    v_fma_f32 v206, v206, v197, v196
    v_fma_f32 v207, v207, v197, v196
    v_mul_f32 v200, v168, v200
    s_waitcnt lgkmcnt(9)
    v_mfma_f32_32x32x16_bf16 v[176:191], a[16:19], v[128:131], v[176:191]
    ds_read_b64_tr_b16 a[0:1], v225 offset:0
    ds_read_b64_tr_b16 a[2:3], v225 offset:512
    buffer_load_dwordx4 v221, s[20:23], s46 offen offset:1024  lds
    v_mul_f32 v201, v169, v201
    v_mul_f32 v202, v170, v202
    v_mul_f32 v203, v171, v203
    v_mfma_f32_32x32x16_bf16 v[176:191], a[20:23], v[132:135], v[176:191]
    ds_read_b64_tr_b16 a[4:5], v225 offset:2048
    ds_read_b64_tr_b16 a[6:7], v225 offset:2560
    v_mul_f32 v204, v172, v204
    v_mul_f32 v205, v173, v205
    v_mul_f32 v206, v174, v206
    v_mul_f32 v207, v175, v207
    v_mfma_f32_32x32x16_bf16 v[176:191], a[24:27], v[136:139], v[176:191]
    ds_read_b64_tr_b16 a[8:9], v225 offset:4096
    ds_read_b64_tr_b16 a[10:11], v225 offset:4608
    v_exp_f32 v200, v200
    v_exp_f32 v201, v201
    v_mfma_f32_32x32x16_bf16 v[176:191], a[28:31], v[140:143], v[176:191]
    ds_read_b64_tr_b16 a[12:13], v225 offset:6144
    ds_read_b64_tr_b16 a[14:15], v225 offset:6656
    buffer_load_dwordx4 v222, s[20:23], s46 offen offset:2048  lds
    v_exp_f32 v202, v202
    s_waitcnt lgkmcnt(8)
    v_mfma_f32_32x32x16_bf16 v[176:191], a[32:35], v[144:147], v[176:191]
    ds_read_b64_tr_b16 a[16:17], v225 offset:8192
    ds_read_b64_tr_b16 a[18:19], v225 offset:8704
    v_exp_f32 v203, v203
    v_exp_f32 v204, v204
    v_mfma_f32_32x32x16_bf16 v[176:191], a[36:39], v[148:151], v[176:191]
    ds_read_b64_tr_b16 a[20:21], v225 offset:10240
    ds_read_b64_tr_b16 a[22:23], v225 offset:10752
    v_exp_f32 v205, v205
    v_exp_f32 v206, v206
    v_mfma_f32_32x32x16_bf16 v[176:191], a[40:43], v[152:155], v[176:191]
    ds_read_b64_tr_b16 a[24:25], v225 offset:12288
    ds_read_b64_tr_b16 a[26:27], v225 offset:12800
    v_exp_f32 v207, v207
    v_mfma_f32_32x32x16_bf16 v[176:191], a[44:47], v[156:159], v[176:191]
    ds_read_b64_tr_b16 a[28:29], v225 offset:14336
    ds_read_b64_tr_b16 a[30:31], v225 offset:14848
    s_waitcnt vmcnt(9)
    s_barrier
    v_add_f32 v200, 1.0, v200
    v_add_f32 v201, 1.0, v201
    v_add_f32 v202, 1.0, v202
    v_add_f32 v203, 1.0, v203
    v_add_f32 v204, 1.0, v204
    v_add_f32 v205, 1.0, v205
    v_add_f32 v206, 1.0, v206
    v_add_f32 v207, 1.0, v207
    v_rcp_f32 v200, v200
    v_rcp_f32 v201, v201
    v_rcp_f32 v202, v202
    v_rcp_f32 v203, v203
    v_rcp_f32 v204, v204
    v_rcp_f32 v205, v205
    v_rcp_f32 v206, v206
    v_rcp_f32 v207, v207
    v_mul_f32 v200, v168, v200
    v_mul_f32 v201, v169, v201
    v_mul_f32 v202, v170, v202
    v_mul_f32 v203, v171, v203
    v_mul_f32 v204, v172, v204
    v_mul_f32 v205, v173, v205
    v_mul_f32 v206, v174, v206
    v_mul_f32 v207, v175, v207
    s_waitcnt lgkmcnt(15)
    v_mfma_f32_32x32x16_bf16 v[160:175], a[48:51], v[192:195], 0
    v_cvt_pk_bf16_f32 v212, v200, v201
    v_cvt_pk_bf16_f32 v213, v202, v203
    v_cvt_pk_bf16_f32 v214, v204, v205
    v_cvt_pk_bf16_f32 v215, v206, v207
    v_mul_f32 v200, v176, v176
    v_mul_f32 v201, v177, v177
    s_waitcnt lgkmcnt(8)
    v_mfma_f32_32x32x16_bf16 v[160:175], a[0:3], v[16:19], v[160:175]
    ds_read_b64_tr_b16 a[32:33], v225 offset:16384
    ds_read_b64_tr_b16 a[34:35], v225 offset:16896
    buffer_store_dwordx4 v[212:215], v223, s[24:27], s54 offen offset:1024
    v_mul_f32 v202, v178, v178
    v_mul_f32 v203, v179, v179
    v_mul_f32 v204, v180, v180
    v_mfma_f32_32x32x16_bf16 v[160:175], a[4:7], v[20:23], v[160:175]
    ds_read_b64_tr_b16 a[36:37], v225 offset:18432
    ds_read_b64_tr_b16 a[38:39], v225 offset:18944
    s_add_u32 m0, s49, 6144
    s_add_u32 s46, s47, 442624
    buffer_load_dwordx4 v220, s[20:23], s46 offen offset:0  lds
    v_mul_f32 v205, v181, v181
    v_mfma_f32_32x32x16_bf16 v[160:175], a[8:11], v[24:27], v[160:175]
    ds_read_b64_tr_b16 a[40:41], v225 offset:20480
    ds_read_b64_tr_b16 a[42:43], v225 offset:20992
    v_mul_f32 v206, v182, v182
    v_mul_f32 v207, v183, v183
    v_fma_f32 v200, v200, v197, v196
    v_fma_f32 v201, v201, v197, v196
    v_mfma_f32_32x32x16_bf16 v[160:175], a[12:15], v[28:31], v[160:175]
    ds_read_b64_tr_b16 a[44:45], v225 offset:22528
    ds_read_b64_tr_b16 a[46:47], v225 offset:23040
    v_fma_f32 v202, v202, v197, v196
    v_fma_f32 v203, v203, v197, v196
    v_fma_f32 v204, v204, v197, v196
    v_fma_f32 v205, v205, v197, v196
    s_waitcnt lgkmcnt(8)
    v_mfma_f32_32x32x16_bf16 v[160:175], a[16:19], v[32:35], v[160:175]
    ds_read_b64_tr_b16 a[0:1], v225 offset:24576
    ds_read_b64_tr_b16 a[2:3], v225 offset:25088
    buffer_load_dwordx4 v221, s[20:23], s46 offen offset:1024  lds
    v_fma_f32 v206, v206, v197, v196
    v_fma_f32 v207, v207, v197, v196
    v_mul_f32 v200, v176, v200
    v_mfma_f32_32x32x16_bf16 v[160:175], a[20:23], v[36:39], v[160:175]
    ds_read_b64_tr_b16 a[4:5], v225 offset:26624
    ds_read_b64_tr_b16 a[6:7], v225 offset:27136
    v_mul_f32 v201, v177, v201
    v_mul_f32 v202, v178, v202
    v_mul_f32 v203, v179, v203
    v_mul_f32 v204, v180, v204
    v_mfma_f32_32x32x16_bf16 v[160:175], a[24:27], v[40:43], v[160:175]
    ds_read_b64_tr_b16 a[8:9], v225 offset:28672
    ds_read_b64_tr_b16 a[10:11], v225 offset:29184
    v_mul_f32 v205, v181, v205
    v_mul_f32 v206, v182, v206
    v_mul_f32 v207, v183, v207
    v_mfma_f32_32x32x16_bf16 v[160:175], a[28:31], v[44:47], v[160:175]
    ds_read_b64_tr_b16 a[12:13], v225 offset:30720
    ds_read_b64_tr_b16 a[14:15], v225 offset:31232
    buffer_load_dwordx4 v222, s[20:23], s46 offen offset:2048  lds
    v_exp_f32 v200, v200
    v_exp_f32 v201, v201
    s_waitcnt lgkmcnt(8)
    v_mfma_f32_32x32x16_bf16 v[160:175], a[32:35], v[48:51], v[160:175]
    ds_read_b64_tr_b16 a[16:17], v225 offset:32768
    ds_read_b64_tr_b16 a[18:19], v225 offset:33280
    v_exp_f32 v202, v202
    v_exp_f32 v203, v203
    v_mfma_f32_32x32x16_bf16 v[160:175], a[36:39], v[52:55], v[160:175]
    ds_read_b64_tr_b16 a[20:21], v225 offset:34816
    ds_read_b64_tr_b16 a[22:23], v225 offset:35328
    v_exp_f32 v204, v204
    v_exp_f32 v205, v205
    v_mfma_f32_32x32x16_bf16 v[160:175], a[40:43], v[56:59], v[160:175]
    ds_read_b64_tr_b16 a[24:25], v226 offset:0
    ds_read_b64_tr_b16 a[26:27], v226 offset:512
    s_add_u32 m0, s49, 36864
    s_add_u32 s46, s47, 2654464
    buffer_load_dwordx4 v220, s[20:23], s46 offen offset:0  lds
    v_mfma_f32_32x32x16_bf16 v[160:175], a[44:47], v[60:63], v[160:175]
    ds_read_b64_tr_b16 a[28:29], v226 offset:2048
    ds_read_b64_tr_b16 a[30:31], v226 offset:2560
    v_exp_f32 v206, v206
    v_exp_f32 v207, v207
    s_waitcnt lgkmcnt(8)
    v_mfma_f32_32x32x16_bf16 v[160:175], a[0:3], v[64:67], v[160:175]
    ds_read_b64_tr_b16 a[32:33], v226 offset:4096
    ds_read_b64_tr_b16 a[34:35], v226 offset:4608
    v_add_f32 v200, 1.0, v200
    v_add_f32 v201, 1.0, v201
    v_add_f32 v202, 1.0, v202
    v_add_f32 v203, 1.0, v203
    v_mfma_f32_32x32x16_bf16 v[160:175], a[4:7], v[68:71], v[160:175]
    ds_read_b64_tr_b16 a[36:37], v226 offset:6144
    ds_read_b64_tr_b16 a[38:39], v226 offset:6656
    buffer_load_dwordx4 v221, s[20:23], s46 offen offset:1024  lds
    v_add_f32 v204, 1.0, v204
    v_add_f32 v205, 1.0, v205
    v_add_f32 v206, 1.0, v206
    v_mfma_f32_32x32x16_bf16 v[160:175], a[8:11], v[72:75], v[160:175]
    ds_read_b64_tr_b16 a[40:41], v226 offset:8192
    ds_read_b64_tr_b16 a[42:43], v226 offset:8704
    v_add_f32 v207, 1.0, v207
    v_rcp_f32 v200, v200
    v_mfma_f32_32x32x16_bf16 v[160:175], a[12:15], v[76:79], v[160:175]
    ds_read_b64_tr_b16 a[44:45], v226 offset:10240
    ds_read_b64_tr_b16 a[46:47], v226 offset:10752
    v_rcp_f32 v201, v201
    v_rcp_f32 v202, v202
    s_waitcnt lgkmcnt(8)
    v_mfma_f32_32x32x16_bf16 v[160:175], a[16:19], v[80:83], v[160:175]
    ds_read_b64_tr_b16 a[0:1], v226 offset:12288
    ds_read_b64_tr_b16 a[2:3], v226 offset:12800
    buffer_load_dwordx4 v222, s[20:23], s46 offen offset:2048  lds
    v_rcp_f32 v203, v203
    v_rcp_f32 v204, v204
    v_mfma_f32_32x32x16_bf16 v[160:175], a[20:23], v[84:87], v[160:175]
    ds_read_b64_tr_b16 a[4:5], v226 offset:14336
    ds_read_b64_tr_b16 a[6:7], v226 offset:14848
    v_rcp_f32 v205, v205
    v_rcp_f32 v206, v206
    v_mfma_f32_32x32x16_bf16 v[160:175], a[24:27], v[88:91], v[160:175]
    ds_read_b64_tr_b16 a[8:9], v226 offset:16384
    ds_read_b64_tr_b16 a[10:11], v226 offset:16896
    v_rcp_f32 v207, v207
    v_mul_f32 v200, v176, v200
    v_mfma_f32_32x32x16_bf16 v[160:175], a[28:31], v[92:95], v[160:175]
    ds_read_b64_tr_b16 a[12:13], v226 offset:18432
    ds_read_b64_tr_b16 a[14:15], v226 offset:18944
    s_add_u32 m0, s49, 39936
    s_add_u32 s46, s47, 2875648
    buffer_load_dwordx4 v220, s[20:23], s46 offen offset:0  lds
    s_add_u32 s54, s64, 2048
    s_waitcnt lgkmcnt(8)
    v_mfma_f32_32x32x16_bf16 v[160:175], a[32:35], v[96:99], v[160:175]
    ds_read_b64_tr_b16 a[16:17], v226 offset:20480
    ds_read_b64_tr_b16 a[18:19], v226 offset:20992
    v_mul_f32 v201, v177, v201
    v_mul_f32 v202, v178, v202
    v_mul_f32 v203, v179, v203
    v_mul_f32 v204, v180, v204
    v_mfma_f32_32x32x16_bf16 v[160:175], a[36:39], v[100:103], v[160:175]
    ds_read_b64_tr_b16 a[20:21], v226 offset:22528
    ds_read_b64_tr_b16 a[22:23], v226 offset:23040
    v_mul_f32 v205, v181, v205
    v_mul_f32 v206, v182, v206
    v_mul_f32 v207, v183, v207
    v_cvt_pk_bf16_f32 v208, v200, v201
    v_mfma_f32_32x32x16_bf16 v[160:175], a[40:43], v[104:107], v[160:175]
    ds_read_b64_tr_b16 a[24:25], v226 offset:24576
    ds_read_b64_tr_b16 a[26:27], v226 offset:25088
    v_cvt_pk_bf16_f32 v209, v202, v203
    v_cvt_pk_bf16_f32 v210, v204, v205
    v_cvt_pk_bf16_f32 v211, v206, v207
    v_mfma_f32_32x32x16_bf16 v[160:175], a[44:47], v[108:111], v[160:175]
    ds_read_b64_tr_b16 a[28:29], v226 offset:26624
    ds_read_b64_tr_b16 a[30:31], v226 offset:27136
    ds_read_b32 a52, v224 offset:384
    buffer_store_dwordx4 v[208:211], v223, s[24:27], s54 offen offset:0
    buffer_load_dwordx4 v221, s[20:23], s46 offen offset:1024  lds
    v_mul_f32 v200, v184, v184
    s_waitcnt lgkmcnt(9)
    v_mfma_f32_32x32x16_bf16 v[160:175], a[0:3], v[112:115], v[160:175]
    ds_read_b64_tr_b16 a[32:33], v226 offset:28672
    ds_read_b64_tr_b16 a[34:35], v226 offset:29184
    v_mul_f32 v201, v185, v185
    v_mul_f32 v202, v186, v186
    v_mul_f32 v203, v187, v187
    v_mul_f32 v204, v188, v188
    v_mfma_f32_32x32x16_bf16 v[160:175], a[4:7], v[116:119], v[160:175]
    ds_read_b64_tr_b16 a[36:37], v226 offset:30720
    ds_read_b64_tr_b16 a[38:39], v226 offset:31232
    buffer_load_dwordx4 v222, s[20:23], s46 offen offset:2048  lds
    v_mul_f32 v205, v189, v189
    v_mul_f32 v206, v190, v190
    v_mul_f32 v207, v191, v191
    v_mfma_f32_32x32x16_bf16 v[160:175], a[8:11], v[120:123], v[160:175]
    ds_read_b64_tr_b16 a[40:41], v226 offset:32768
    ds_read_b64_tr_b16 a[42:43], v226 offset:33280
    v_fma_f32 v200, v200, v197, v196
    v_fma_f32 v201, v201, v197, v196
    v_fma_f32 v202, v202, v197, v196
    v_mfma_f32_32x32x16_bf16 v[160:175], a[12:15], v[124:127], v[160:175]
    ds_read_b64_tr_b16 a[44:45], v226 offset:34816
    ds_read_b64_tr_b16 a[46:47], v226 offset:35328
    v_fma_f32 v203, v203, v197, v196
    v_fma_f32 v204, v204, v197, v196
    v_fma_f32 v205, v205, v197, v196
    s_waitcnt lgkmcnt(9)
    v_mfma_f32_32x32x16_bf16 v[160:175], a[16:19], v[128:131], v[160:175]
    ds_read_b64_tr_b16 a[0:1], v227 offset:0
    ds_read_b64_tr_b16 a[2:3], v227 offset:512
    s_add_u32 m0, s49, 43008
    s_add_u32 s46, s47, 3096832
    buffer_load_dwordx4 v220, s[20:23], s46 offen offset:0  lds
    v_fma_f32 v206, v206, v197, v196
    v_mfma_f32_32x32x16_bf16 v[160:175], a[20:23], v[132:135], v[160:175]
    ds_read_b64_tr_b16 a[4:5], v227 offset:2048
    ds_read_b64_tr_b16 a[6:7], v227 offset:2560
    v_fma_f32 v207, v207, v197, v196
    v_mul_f32 v200, v184, v200
    v_mul_f32 v201, v185, v201
    v_mul_f32 v202, v186, v202
    v_mfma_f32_32x32x16_bf16 v[160:175], a[24:27], v[136:139], v[160:175]
    ds_read_b64_tr_b16 a[8:9], v227 offset:4096
    ds_read_b64_tr_b16 a[10:11], v227 offset:4608
    v_mul_f32 v203, v187, v203
    v_mul_f32 v204, v188, v204
    v_mul_f32 v205, v189, v205
    v_mfma_f32_32x32x16_bf16 v[160:175], a[28:31], v[140:143], v[160:175]
    ds_read_b64_tr_b16 a[12:13], v227 offset:6144
    ds_read_b64_tr_b16 a[14:15], v227 offset:6656
    buffer_load_dwordx4 v221, s[20:23], s46 offen offset:1024  lds
    v_mul_f32 v206, v190, v206
    v_mul_f32 v207, v191, v207
    v_exp_f32 v200, v200
    s_waitcnt lgkmcnt(8)
    v_mfma_f32_32x32x16_bf16 v[160:175], a[32:35], v[144:147], v[160:175]
    ds_read_b64_tr_b16 a[16:17], v227 offset:8192
    ds_read_b64_tr_b16 a[18:19], v227 offset:8704
    v_exp_f32 v201, v201
    v_exp_f32 v202, v202
    v_mfma_f32_32x32x16_bf16 v[160:175], a[36:39], v[148:151], v[160:175]
    ds_read_b64_tr_b16 a[20:21], v227 offset:10240
    ds_read_b64_tr_b16 a[22:23], v227 offset:10752
    v_exp_f32 v203, v203
    v_exp_f32 v204, v204
    v_mfma_f32_32x32x16_bf16 v[160:175], a[40:43], v[152:155], v[160:175]
    ds_read_b64_tr_b16 a[24:25], v227 offset:12288
    ds_read_b64_tr_b16 a[26:27], v227 offset:12800
    buffer_load_dwordx4 v222, s[20:23], s46 offen offset:2048  lds
    v_exp_f32 v205, v205
    v_mfma_f32_32x32x16_bf16 v[160:175], a[44:47], v[156:159], v[160:175]
    ds_read_b64_tr_b16 a[28:29], v227 offset:14336
    ds_read_b64_tr_b16 a[30:31], v227 offset:14848
    v_exp_f32 v206, v206
    v_exp_f32 v207, v207
    v_add_f32 v200, 1.0, v200
    v_add_f32 v201, 1.0, v201
    v_add_f32 v202, 1.0, v202
    v_add_f32 v203, 1.0, v203
    v_add_f32 v204, 1.0, v204
    v_add_f32 v205, 1.0, v205
    v_add_f32 v206, 1.0, v206
    v_add_f32 v207, 1.0, v207
    v_rcp_f32 v200, v200
    v_rcp_f32 v201, v201
    v_rcp_f32 v202, v202
    v_rcp_f32 v203, v203
    v_rcp_f32 v204, v204
    v_rcp_f32 v205, v205
    v_rcp_f32 v206, v206
    v_rcp_f32 v207, v207
    v_mul_f32 v200, v184, v200
    v_mul_f32 v201, v185, v201
    v_mul_f32 v202, v186, v202
    v_mul_f32 v203, v187, v203
    v_mul_f32 v204, v188, v204
    v_mul_f32 v205, v189, v205
    v_mul_f32 v206, v190, v206
    v_mul_f32 v207, v191, v207
    s_waitcnt lgkmcnt(15)
    v_mfma_f32_32x32x16_bf16 v[176:191], a[52:55], v[192:195], 0
    v_cvt_pk_bf16_f32 v212, v200, v201
    v_cvt_pk_bf16_f32 v213, v202, v203
    v_cvt_pk_bf16_f32 v214, v204, v205
    v_cvt_pk_bf16_f32 v215, v206, v207
    v_mul_f32 v200, v160, v160
    v_mul_f32 v201, v161, v161
    s_waitcnt lgkmcnt(8)
    v_mfma_f32_32x32x16_bf16 v[176:191], a[0:3], v[16:19], v[176:191]
    ds_read_b64_tr_b16 a[32:33], v227 offset:16384
    ds_read_b64_tr_b16 a[34:35], v227 offset:16896
    buffer_store_dwordx4 v[212:215], v223, s[24:27], s54 offen offset:1024
    v_mul_f32 v202, v162, v162
    v_mul_f32 v203, v163, v163
    v_mul_f32 v204, v164, v164
    v_mfma_f32_32x32x16_bf16 v[176:191], a[4:7], v[20:23], v[176:191]
    ds_read_b64_tr_b16 a[36:37], v227 offset:18432
    ds_read_b64_tr_b16 a[38:39], v227 offset:18944
    v_mul_f32 v205, v165, v165
    v_mul_f32 v206, v166, v166
    v_mul_f32 v207, v167, v167
    v_fma_f32 v200, v200, v197, v196
    v_mfma_f32_32x32x16_bf16 v[176:191], a[8:11], v[24:27], v[176:191]
    ds_read_b64_tr_b16 a[40:41], v227 offset:20480
    ds_read_b64_tr_b16 a[42:43], v227 offset:20992
    v_fma_f32 v201, v201, v197, v196
    v_fma_f32 v202, v202, v197, v196
    v_fma_f32 v203, v203, v197, v196
    v_fma_f32 v204, v204, v197, v196
    v_mfma_f32_32x32x16_bf16 v[176:191], a[12:15], v[28:31], v[176:191]
    ds_read_b64_tr_b16 a[44:45], v227 offset:22528
    ds_read_b64_tr_b16 a[46:47], v227 offset:23040
    v_fma_f32 v205, v205, v197, v196
    v_fma_f32 v206, v206, v197, v196
    v_fma_f32 v207, v207, v197, v196
    s_waitcnt lgkmcnt(8)
    v_mfma_f32_32x32x16_bf16 v[176:191], a[16:19], v[32:35], v[176:191]
    ds_read_b64_tr_b16 a[0:1], v227 offset:24576
    ds_read_b64_tr_b16 a[2:3], v227 offset:25088
    v_mul_f32 v200, v160, v200
    v_mul_f32 v201, v161, v201
    v_mul_f32 v202, v162, v202
    v_mul_f32 v203, v163, v203
    v_mfma_f32_32x32x16_bf16 v[176:191], a[20:23], v[36:39], v[176:191]
    ds_read_b64_tr_b16 a[4:5], v227 offset:26624
    ds_read_b64_tr_b16 a[6:7], v227 offset:27136
    s_add_u32 s50, s64, 0
    s_waitcnt vmcnt(14)
    buffer_load_dwordx4 a[64:67], v223, s[16:19], s50 offen offset:0
    v_mul_f32 v204, v164, v204
    v_mul_f32 v205, v165, v205
    v_mfma_f32_32x32x16_bf16 v[176:191], a[24:27], v[40:43], v[176:191]
    ds_read_b64_tr_b16 a[8:9], v227 offset:28672
    ds_read_b64_tr_b16 a[10:11], v227 offset:29184
    v_mul_f32 v206, v166, v206
    v_mul_f32 v207, v167, v207
    v_exp_f32 v200, v200
    v_mfma_f32_32x32x16_bf16 v[176:191], a[28:31], v[44:47], v[176:191]
    ds_read_b64_tr_b16 a[12:13], v227 offset:30720
    ds_read_b64_tr_b16 a[14:15], v227 offset:31232
    v_exp_f32 v201, v201
    v_exp_f32 v202, v202
    s_waitcnt lgkmcnt(8)
    v_mfma_f32_32x32x16_bf16 v[176:191], a[32:35], v[48:51], v[176:191]
    ds_read_b64_tr_b16 a[16:17], v227 offset:32768
    ds_read_b64_tr_b16 a[18:19], v227 offset:33280
    v_exp_f32 v203, v203
    v_exp_f32 v204, v204
    v_mfma_f32_32x32x16_bf16 v[176:191], a[36:39], v[52:55], v[176:191]
    ds_read_b64_tr_b16 a[20:21], v227 offset:34816
    ds_read_b64_tr_b16 a[22:23], v227 offset:35328
    v_exp_f32 v205, v205
    v_exp_f32 v206, v206
    v_mfma_f32_32x32x16_bf16 v[176:191], a[40:43], v[56:59], v[176:191]
    ds_read_b64_tr_b16 a[24:25], v228 offset:0
    ds_read_b64_tr_b16 a[26:27], v228 offset:512
    v_exp_f32 v207, v207
    v_add_f32 v200, 1.0, v200
    v_mfma_f32_32x32x16_bf16 v[176:191], a[44:47], v[60:63], v[176:191]
    ds_read_b64_tr_b16 a[28:29], v228 offset:2048
    ds_read_b64_tr_b16 a[30:31], v228 offset:2560
    v_add_f32 v201, 1.0, v201
    v_add_f32 v202, 1.0, v202
    v_add_f32 v203, 1.0, v203
    v_add_f32 v204, 1.0, v204
    s_waitcnt lgkmcnt(8)
    v_mfma_f32_32x32x16_bf16 v[176:191], a[0:3], v[64:67], v[176:191]
    ds_read_b64_tr_b16 a[32:33], v228 offset:4096
    ds_read_b64_tr_b16 a[34:35], v228 offset:4608
    v_add_f32 v205, 1.0, v205
    v_add_f32 v206, 1.0, v206
    v_add_f32 v207, 1.0, v207
    v_rcp_f32 v200, v200
    v_mfma_f32_32x32x16_bf16 v[176:191], a[4:7], v[68:71], v[176:191]
    ds_read_b64_tr_b16 a[36:37], v228 offset:6144
    ds_read_b64_tr_b16 a[38:39], v228 offset:6656
    v_rcp_f32 v201, v201
    v_rcp_f32 v202, v202
    v_mfma_f32_32x32x16_bf16 v[176:191], a[8:11], v[72:75], v[176:191]
    ds_read_b64_tr_b16 a[40:41], v228 offset:8192
    ds_read_b64_tr_b16 a[42:43], v228 offset:8704
    v_rcp_f32 v203, v203
    v_mfma_f32_32x32x16_bf16 v[176:191], a[12:15], v[76:79], v[176:191]
    ds_read_b64_tr_b16 a[44:45], v228 offset:10240
    ds_read_b64_tr_b16 a[46:47], v228 offset:10752
    s_waitcnt lgkmcnt(8) vmcnt(12)
    s_barrier
    v_rcp_f32 v204, v204
    v_rcp_f32 v205, v205
    v_mfma_f32_32x32x16_bf16 v[176:191], a[16:19], v[80:83], v[176:191]
    ds_read_b64_tr_b16 a[0:1], v228 offset:12288
    ds_read_b64_tr_b16 a[2:3], v228 offset:12800
    s_add_u32 m0, s49, 73728
    s_add_u32 s46, s47, 384
    buffer_load_dwordx4 v220, s[20:23], s46 offen offset:0  lds
    s_add_u32 s54, s64, 4096
    v_mfma_f32_32x32x16_bf16 v[176:191], a[20:23], v[84:87], v[176:191]
    ds_read_b64_tr_b16 a[4:5], v228 offset:14336
    ds_read_b64_tr_b16 a[6:7], v228 offset:14848
    v_rcp_f32 v206, v206
    v_rcp_f32 v207, v207
    v_mfma_f32_32x32x16_bf16 v[176:191], a[24:27], v[88:91], v[176:191]
    ds_read_b64_tr_b16 a[8:9], v228 offset:16384
    ds_read_b64_tr_b16 a[10:11], v228 offset:16896
    v_mul_f32 v200, v160, v200
    v_mul_f32 v201, v161, v201
    v_mul_f32 v202, v162, v202
    v_mfma_f32_32x32x16_bf16 v[176:191], a[28:31], v[92:95], v[176:191]
    ds_read_b64_tr_b16 a[12:13], v228 offset:18432
    ds_read_b64_tr_b16 a[14:15], v228 offset:18944
    buffer_load_dwordx4 v221, s[20:23], s46 offen offset:1024  lds
    v_mul_f32 v203, v163, v203
    v_mul_f32 v204, v164, v204
    v_mul_f32 v205, v165, v205
    s_waitcnt lgkmcnt(8)
    v_mfma_f32_32x32x16_bf16 v[176:191], a[32:35], v[96:99], v[176:191]
    ds_read_b64_tr_b16 a[16:17], v228 offset:20480
    ds_read_b64_tr_b16 a[18:19], v228 offset:20992
    v_mul_f32 v206, v166, v206
    v_mul_f32 v207, v167, v207
    v_cvt_pk_bf16_f32 v208, v200, v201
    v_cvt_pk_bf16_f32 v209, v202, v203
    v_mfma_f32_32x32x16_bf16 v[176:191], a[36:39], v[100:103], v[176:191]
    ds_read_b64_tr_b16 a[20:21], v228 offset:22528
    ds_read_b64_tr_b16 a[22:23], v228 offset:23040
    v_cvt_pk_bf16_f32 v210, v204, v205
    v_cvt_pk_bf16_f32 v211, v206, v207
    v_mul_f32 v200, v168, v168
    v_mul_f32 v201, v169, v169
    v_mfma_f32_32x32x16_bf16 v[176:191], a[40:43], v[104:107], v[176:191]
    ds_read_b64_tr_b16 a[24:25], v228 offset:24576
    ds_read_b64_tr_b16 a[26:27], v228 offset:25088
    buffer_store_dwordx4 v[208:211], v223, s[24:27], s54 offen offset:0
    buffer_load_dwordx4 v222, s[20:23], s46 offen offset:2048  lds
    v_mul_f32 v202, v170, v170
    v_mfma_f32_32x32x16_bf16 v[176:191], a[44:47], v[108:111], v[176:191]
    ds_read_b64_tr_b16 a[28:29], v228 offset:26624
    ds_read_b64_tr_b16 a[30:31], v228 offset:27136
    ds_read_b32 a48, v224 offset:512
    v_mul_f32 v203, v171, v171
    v_mul_f32 v204, v172, v172
    v_mul_f32 v205, v173, v173
    s_waitcnt lgkmcnt(9)
    v_mfma_f32_32x32x16_bf16 v[176:191], a[0:3], v[112:115], v[176:191]
    ds_read_b64_tr_b16 a[32:33], v228 offset:28672
    ds_read_b64_tr_b16 a[34:35], v228 offset:29184
    v_mul_f32 v206, v174, v174
    v_mul_f32 v207, v175, v175
    v_fma_f32 v200, v200, v197, v196
    v_fma_f32 v201, v201, v197, v196
    v_mfma_f32_32x32x16_bf16 v[176:191], a[4:7], v[116:119], v[176:191]
    ds_read_b64_tr_b16 a[36:37], v228 offset:30720
    ds_read_b64_tr_b16 a[38:39], v228 offset:31232
    s_add_u32 m0, s49, 76800
    s_add_u32 s46, s47, 221568
    buffer_load_dwordx4 v220, s[20:23], s46 offen offset:0  lds
    v_fma_f32 v202, v202, v197, v196
    v_mfma_f32_32x32x16_bf16 v[176:191], a[8:11], v[120:123], v[176:191]
    ds_read_b64_tr_b16 a[40:41], v228 offset:32768
    ds_read_b64_tr_b16 a[42:43], v228 offset:33280
    v_fma_f32 v203, v203, v197, v196
    v_fma_f32 v204, v204, v197, v196
    v_fma_f32 v205, v205, v197, v196
    v_mfma_f32_32x32x16_bf16 v[176:191], a[12:15], v[124:127], v[176:191]
    ds_read_b64_tr_b16 a[44:45], v228 offset:34816
    ds_read_b64_tr_b16 a[46:47], v228 offset:35328
    v_fma_f32 v206, v206, v197, v196
    v_fma_f32 v207, v207, v197, v196
    v_mul_f32 v200, v168, v200
    s_waitcnt lgkmcnt(9)
    v_mfma_f32_32x32x16_bf16 v[176:191], a[16:19], v[128:131], v[176:191]
    ds_read_b64_tr_b16 a[0:1], v216 offset:0
    ds_read_b64_tr_b16 a[2:3], v216 offset:512
    buffer_load_dwordx4 v221, s[20:23], s46 offen offset:1024  lds
    v_mul_f32 v201, v169, v201
    v_mul_f32 v202, v170, v202
    v_mul_f32 v203, v171, v203
    v_mfma_f32_32x32x16_bf16 v[176:191], a[20:23], v[132:135], v[176:191]
    ds_read_b64_tr_b16 a[4:5], v216 offset:2048
    ds_read_b64_tr_b16 a[6:7], v216 offset:2560
    v_mul_f32 v204, v172, v204
    v_mul_f32 v205, v173, v205
    v_mul_f32 v206, v174, v206
    v_mul_f32 v207, v175, v207
    v_mfma_f32_32x32x16_bf16 v[176:191], a[24:27], v[136:139], v[176:191]
    ds_read_b64_tr_b16 a[8:9], v216 offset:4096
    ds_read_b64_tr_b16 a[10:11], v216 offset:4608
    v_exp_f32 v200, v200
    v_exp_f32 v201, v201
    v_mfma_f32_32x32x16_bf16 v[176:191], a[28:31], v[140:143], v[176:191]
    ds_read_b64_tr_b16 a[12:13], v216 offset:6144
    ds_read_b64_tr_b16 a[14:15], v216 offset:6656
    buffer_load_dwordx4 v222, s[20:23], s46 offen offset:2048  lds
    s_waitcnt lgkmcnt(8) vmcnt(9)
    s_barrier
    v_mfma_f32_32x32x16_bf16 v[176:191], a[32:35], v[144:147], v[176:191]
    ds_read_b64_tr_b16 a[16:17], v216 offset:8192
    ds_read_b64_tr_b16 a[18:19], v216 offset:8704
    v_exp_f32 v202, v202
    v_exp_f32 v203, v203
    v_mfma_f32_32x32x16_bf16 v[176:191], a[36:39], v[148:151], v[176:191]
    ds_read_b64_tr_b16 a[20:21], v216 offset:10240
    ds_read_b64_tr_b16 a[22:23], v216 offset:10752
    buffer_load_dwordx4 a[68:71], v223, s[16:19], s50 offen offset:1024
    v_exp_f32 v204, v204
    v_exp_f32 v205, v205
    v_mfma_f32_32x32x16_bf16 v[176:191], a[40:43], v[152:155], v[176:191]
    ds_read_b64_tr_b16 a[24:25], v216 offset:12288
    ds_read_b64_tr_b16 a[26:27], v216 offset:12800
    v_exp_f32 v206, v206
    v_exp_f32 v207, v207
    v_mfma_f32_32x32x16_bf16 v[176:191], a[44:47], v[156:159], v[176:191]
    ds_read_b64_tr_b16 a[28:29], v216 offset:14336
    ds_read_b64_tr_b16 a[30:31], v216 offset:14848
    v_add_f32 v200, 1.0, v200
    v_add_f32 v201, 1.0, v201
    v_add_f32 v202, 1.0, v202
    v_add_f32 v203, 1.0, v203
    v_add_f32 v204, 1.0, v204
    v_add_f32 v205, 1.0, v205
    v_add_f32 v206, 1.0, v206
    v_add_f32 v207, 1.0, v207
    v_rcp_f32 v200, v200
    v_rcp_f32 v201, v201
    v_rcp_f32 v202, v202
    v_rcp_f32 v203, v203
    v_rcp_f32 v204, v204
    v_rcp_f32 v205, v205
    v_rcp_f32 v206, v206
    v_rcp_f32 v207, v207
    v_mul_f32 v200, v168, v200
    v_mul_f32 v201, v169, v201
    v_mul_f32 v202, v170, v202
    v_mul_f32 v203, v171, v203
    v_mul_f32 v204, v172, v204
    v_mul_f32 v205, v173, v205
    v_mul_f32 v206, v174, v206
    v_mul_f32 v207, v175, v207
    s_waitcnt lgkmcnt(15)
    v_mfma_f32_32x32x16_bf16 v[160:175], a[48:51], v[192:195], 0
    v_cvt_pk_bf16_f32 v212, v200, v201
    v_cvt_pk_bf16_f32 v213, v202, v203
    v_cvt_pk_bf16_f32 v214, v204, v205
    v_cvt_pk_bf16_f32 v215, v206, v207
    v_mul_f32 v200, v176, v176
    v_mul_f32 v201, v177, v177
    s_waitcnt lgkmcnt(8)
    v_mfma_f32_32x32x16_bf16 v[160:175], a[0:3], v[16:19], v[160:175]
    ds_read_b64_tr_b16 a[32:33], v216 offset:16384
    ds_read_b64_tr_b16 a[34:35], v216 offset:16896
    buffer_store_dwordx4 v[212:215], v223, s[24:27], s54 offen offset:1024
    v_mul_f32 v202, v178, v178
    v_mul_f32 v203, v179, v179
    v_mul_f32 v204, v180, v180
    v_mfma_f32_32x32x16_bf16 v[160:175], a[4:7], v[20:23], v[160:175]
    ds_read_b64_tr_b16 a[36:37], v216 offset:18432
    ds_read_b64_tr_b16 a[38:39], v216 offset:18944
    s_add_u32 m0, s49, 79872
    s_add_u32 s46, s47, 442752
    buffer_load_dwordx4 v220, s[20:23], s46 offen offset:0  lds
    v_mfma_f32_32x32x16_bf16 v[160:175], a[8:11], v[24:27], v[160:175]
    ds_read_b64_tr_b16 a[40:41], v216 offset:20480
    ds_read_b64_tr_b16 a[42:43], v216 offset:20992
    v_mul_f32 v205, v181, v181
    v_mul_f32 v206, v182, v182
    v_mul_f32 v207, v183, v183
    v_fma_f32 v200, v200, v197, v196
    v_mfma_f32_32x32x16_bf16 v[160:175], a[12:15], v[28:31], v[160:175]
    ds_read_b64_tr_b16 a[44:45], v216 offset:22528
    ds_read_b64_tr_b16 a[46:47], v216 offset:23040
    v_fma_f32 v201, v201, v197, v196
    v_fma_f32 v202, v202, v197, v196
    v_fma_f32 v203, v203, v197, v196
    s_waitcnt lgkmcnt(8)
    v_mfma_f32_32x32x16_bf16 v[160:175], a[16:19], v[32:35], v[160:175]
    ds_read_b64_tr_b16 a[0:1], v216 offset:24576
    ds_read_b64_tr_b16 a[2:3], v216 offset:25088
    buffer_load_dwordx4 v221, s[20:23], s46 offen offset:1024  lds
    v_fma_f32 v204, v204, v197, v196
    v_fma_f32 v205, v205, v197, v196
    v_fma_f32 v206, v206, v197, v196
    v_mfma_f32_32x32x16_bf16 v[160:175], a[20:23], v[36:39], v[160:175]
    ds_read_b64_tr_b16 a[4:5], v216 offset:26624
    ds_read_b64_tr_b16 a[6:7], v216 offset:27136
    s_add_u32 s50, s64, 2048
    s_waitcnt vmcnt(12)
    buffer_load_dwordx4 a[72:75], v223, s[16:19], s50 offen offset:0
    v_fma_f32 v207, v207, v197, v196
    v_mul_f32 v200, v176, v200
    v_mfma_f32_32x32x16_bf16 v[160:175], a[24:27], v[40:43], v[160:175]
    ds_read_b64_tr_b16 a[8:9], v216 offset:28672
    ds_read_b64_tr_b16 a[10:11], v216 offset:29184
    v_mul_f32 v201, v177, v201
    v_mul_f32 v202, v178, v202
    v_mul_f32 v203, v179, v203
    v_mfma_f32_32x32x16_bf16 v[160:175], a[28:31], v[44:47], v[160:175]
    ds_read_b64_tr_b16 a[12:13], v216 offset:30720
    ds_read_b64_tr_b16 a[14:15], v216 offset:31232
    buffer_load_dwordx4 v222, s[20:23], s46 offen offset:2048  lds
    v_mul_f32 v204, v180, v204
    v_mul_f32 v205, v181, v205
    v_mul_f32 v206, v182, v206
    s_waitcnt lgkmcnt(8)
    v_mfma_f32_32x32x16_bf16 v[160:175], a[32:35], v[48:51], v[160:175]
    ds_read_b64_tr_b16 a[16:17], v216 offset:32768
    ds_read_b64_tr_b16 a[18:19], v216 offset:33280
    v_mul_f32 v207, v183, v207
    v_exp_f32 v200, v200
    v_exp_f32 v201, v201
    v_mfma_f32_32x32x16_bf16 v[160:175], a[36:39], v[52:55], v[160:175]
    ds_read_b64_tr_b16 a[20:21], v216 offset:34816
    ds_read_b64_tr_b16 a[22:23], v216 offset:35328
    v_exp_f32 v202, v202
    v_exp_f32 v203, v203
    v_mfma_f32_32x32x16_bf16 v[160:175], a[40:43], v[56:59], v[160:175]
    ds_read_b64_tr_b16 a[24:25], v217 offset:0
    ds_read_b64_tr_b16 a[26:27], v217 offset:512
    s_add_u32 m0, s49, 110592
    s_add_u32 s46, s47, 2654592
    buffer_load_dwordx4 v220, s[20:23], s46 offen offset:0  lds
    v_mfma_f32_32x32x16_bf16 v[160:175], a[44:47], v[60:63], v[160:175]
    ds_read_b64_tr_b16 a[28:29], v217 offset:2048
    ds_read_b64_tr_b16 a[30:31], v217 offset:2560
    v_exp_f32 v204, v204
    v_exp_f32 v205, v205
    s_waitcnt lgkmcnt(8)
    v_mfma_f32_32x32x16_bf16 v[160:175], a[0:3], v[64:67], v[160:175]
    ds_read_b64_tr_b16 a[32:33], v217 offset:4096
    ds_read_b64_tr_b16 a[34:35], v217 offset:4608
    v_exp_f32 v206, v206
    v_exp_f32 v207, v207
    v_mfma_f32_32x32x16_bf16 v[160:175], a[4:7], v[68:71], v[160:175]
    ds_read_b64_tr_b16 a[36:37], v217 offset:6144
    ds_read_b64_tr_b16 a[38:39], v217 offset:6656
    buffer_load_dwordx4 v221, s[20:23], s46 offen offset:1024  lds
    v_add_f32 v200, 1.0, v200
    v_add_f32 v201, 1.0, v201
    v_add_f32 v202, 1.0, v202
    v_mfma_f32_32x32x16_bf16 v[160:175], a[8:11], v[72:75], v[160:175]
    ds_read_b64_tr_b16 a[40:41], v217 offset:8192
    ds_read_b64_tr_b16 a[42:43], v217 offset:8704
    v_add_f32 v203, 1.0, v203
    v_add_f32 v204, 1.0, v204
    v_add_f32 v205, 1.0, v205
    v_mfma_f32_32x32x16_bf16 v[160:175], a[12:15], v[76:79], v[160:175]
    ds_read_b64_tr_b16 a[44:45], v217 offset:10240
    ds_read_b64_tr_b16 a[46:47], v217 offset:10752
    v_add_f32 v206, 1.0, v206
    v_add_f32 v207, 1.0, v207
    v_rcp_f32 v200, v200
    s_waitcnt lgkmcnt(8)
    v_mfma_f32_32x32x16_bf16 v[160:175], a[16:19], v[80:83], v[160:175]
    ds_read_b64_tr_b16 a[0:1], v217 offset:12288
    ds_read_b64_tr_b16 a[2:3], v217 offset:12800
    buffer_load_dwordx4 v222, s[20:23], s46 offen offset:2048  lds
    v_rcp_f32 v201, v201
    v_rcp_f32 v202, v202
    v_mfma_f32_32x32x16_bf16 v[160:175], a[20:23], v[84:87], v[160:175]
    ds_read_b64_tr_b16 a[4:5], v217 offset:14336
    ds_read_b64_tr_b16 a[6:7], v217 offset:14848
    v_rcp_f32 v203, v203
    v_rcp_f32 v204, v204
    v_mfma_f32_32x32x16_bf16 v[160:175], a[24:27], v[88:91], v[160:175]
    ds_read_b64_tr_b16 a[8:9], v217 offset:16384
    ds_read_b64_tr_b16 a[10:11], v217 offset:16896
    v_rcp_f32 v205, v205
    v_rcp_f32 v206, v206
    v_mfma_f32_32x32x16_bf16 v[160:175], a[28:31], v[92:95], v[160:175]
    ds_read_b64_tr_b16 a[12:13], v217 offset:18432
    ds_read_b64_tr_b16 a[14:15], v217 offset:18944
    s_add_u32 m0, s49, 113664
    s_add_u32 s46, s47, 2875776
    buffer_load_dwordx4 v220, s[20:23], s46 offen offset:0  lds
    s_add_u32 s54, s64, 6144
    s_waitcnt lgkmcnt(8)
    v_mfma_f32_32x32x16_bf16 v[160:175], a[32:35], v[96:99], v[160:175]
    ds_read_b64_tr_b16 a[16:17], v217 offset:20480
    ds_read_b64_tr_b16 a[18:19], v217 offset:20992
    v_rcp_f32 v207, v207
    v_mul_f32 v200, v176, v200
    v_mul_f32 v201, v177, v201
    v_mfma_f32_32x32x16_bf16 v[160:175], a[36:39], v[100:103], v[160:175]
    ds_read_b64_tr_b16 a[20:21], v217 offset:22528
    ds_read_b64_tr_b16 a[22:23], v217 offset:23040
    v_mul_f32 v202, v178, v202
    v_mul_f32 v203, v179, v203
    v_mul_f32 v204, v180, v204
    v_mul_f32 v205, v181, v205
    v_mfma_f32_32x32x16_bf16 v[160:175], a[40:43], v[104:107], v[160:175]
    ds_read_b64_tr_b16 a[24:25], v217 offset:24576
    ds_read_b64_tr_b16 a[26:27], v217 offset:25088
    v_mul_f32 v206, v182, v206
    v_mul_f32 v207, v183, v207
    v_cvt_pk_bf16_f32 v208, v200, v201
    v_mfma_f32_32x32x16_bf16 v[160:175], a[44:47], v[108:111], v[160:175]
    ds_read_b64_tr_b16 a[28:29], v217 offset:26624
    ds_read_b64_tr_b16 a[30:31], v217 offset:27136
    ds_read_b32 a52, v224 offset:640
    v_cvt_pk_bf16_f32 v209, v202, v203
    v_cvt_pk_bf16_f32 v210, v204, v205
    v_cvt_pk_bf16_f32 v211, v206, v207
    s_waitcnt lgkmcnt(9)
    v_mfma_f32_32x32x16_bf16 v[160:175], a[0:3], v[112:115], v[160:175]
    ds_read_b64_tr_b16 a[32:33], v217 offset:28672
    ds_read_b64_tr_b16 a[34:35], v217 offset:29184
    buffer_store_dwordx4 v[208:211], v223, s[24:27], s54 offen offset:0
    buffer_load_dwordx4 v221, s[20:23], s46 offen offset:1024  lds
    v_mul_f32 v200, v184, v184
    v_mul_f32 v201, v185, v185
    v_mfma_f32_32x32x16_bf16 v[160:175], a[4:7], v[116:119], v[160:175]
    ds_read_b64_tr_b16 a[36:37], v217 offset:30720
    ds_read_b64_tr_b16 a[38:39], v217 offset:31232
    buffer_load_dwordx4 v222, s[20:23], s46 offen offset:2048  lds
    v_mul_f32 v202, v186, v186
    v_mul_f32 v203, v187, v187
    v_mul_f32 v204, v188, v188
    v_mfma_f32_32x32x16_bf16 v[160:175], a[8:11], v[120:123], v[160:175]
    ds_read_b64_tr_b16 a[40:41], v217 offset:32768
    ds_read_b64_tr_b16 a[42:43], v217 offset:33280
    v_mul_f32 v205, v189, v189
    v_mul_f32 v206, v190, v190
    v_mul_f32 v207, v191, v191
    v_mfma_f32_32x32x16_bf16 v[160:175], a[12:15], v[124:127], v[160:175]
    ds_read_b64_tr_b16 a[44:45], v217 offset:34816
    ds_read_b64_tr_b16 a[46:47], v217 offset:35328
    v_fma_f32 v200, v200, v197, v196
    v_fma_f32 v201, v201, v197, v196
    v_fma_f32 v202, v202, v197, v196
    s_waitcnt lgkmcnt(9)
    v_mfma_f32_32x32x16_bf16 v[160:175], a[16:19], v[128:131], v[160:175]
    ds_read_b64_tr_b16 a[0:1], v218 offset:0
    ds_read_b64_tr_b16 a[2:3], v218 offset:512
    s_add_u32 m0, s49, 116736
    s_add_u32 s46, s47, 3096960
    buffer_load_dwordx4 v220, s[20:23], s46 offen offset:0  lds
    v_fma_f32 v203, v203, v197, v196
    v_mfma_f32_32x32x16_bf16 v[160:175], a[20:23], v[132:135], v[160:175]
    ds_read_b64_tr_b16 a[4:5], v218 offset:2048
    ds_read_b64_tr_b16 a[6:7], v218 offset:2560
    v_fma_f32 v204, v204, v197, v196
    v_fma_f32 v205, v205, v197, v196
    v_fma_f32 v206, v206, v197, v196
    v_mfma_f32_32x32x16_bf16 v[160:175], a[24:27], v[136:139], v[160:175]
    ds_read_b64_tr_b16 a[8:9], v218 offset:4096
    ds_read_b64_tr_b16 a[10:11], v218 offset:4608
    v_fma_f32 v207, v207, v197, v196
    v_mul_f32 v200, v184, v200
    v_mul_f32 v201, v185, v201
    v_mfma_f32_32x32x16_bf16 v[160:175], a[28:31], v[140:143], v[160:175]
    ds_read_b64_tr_b16 a[12:13], v218 offset:6144
    ds_read_b64_tr_b16 a[14:15], v218 offset:6656
    buffer_load_dwordx4 v221, s[20:23], s46 offen offset:1024  lds
    v_mul_f32 v202, v186, v202
    v_mul_f32 v203, v187, v203
    v_mul_f32 v204, v188, v204
    s_waitcnt lgkmcnt(8)
    v_mfma_f32_32x32x16_bf16 v[160:175], a[32:35], v[144:147], v[160:175]
    ds_read_b64_tr_b16 a[16:17], v218 offset:8192
    ds_read_b64_tr_b16 a[18:19], v218 offset:8704
    v_mul_f32 v205, v189, v205
    v_mul_f32 v206, v190, v206
    v_mul_f32 v207, v191, v207
    v_exp_f32 v200, v200
    v_mfma_f32_32x32x16_bf16 v[160:175], a[36:39], v[148:151], v[160:175]
    ds_read_b64_tr_b16 a[20:21], v218 offset:10240
    ds_read_b64_tr_b16 a[22:23], v218 offset:10752
    buffer_load_dwordx4 a[76:79], v223, s[16:19], s50 offen offset:1024
    v_exp_f32 v201, v201
    v_exp_f32 v202, v202
    v_mfma_f32_32x32x16_bf16 v[160:175], a[40:43], v[152:155], v[160:175]
    ds_read_b64_tr_b16 a[24:25], v218 offset:12288
    ds_read_b64_tr_b16 a[26:27], v218 offset:12800
    buffer_load_dwordx4 v222, s[20:23], s46 offen offset:2048  lds
    v_exp_f32 v203, v203
    v_mfma_f32_32x32x16_bf16 v[160:175], a[44:47], v[156:159], v[160:175]
    ds_read_b64_tr_b16 a[28:29], v218 offset:14336
    ds_read_b64_tr_b16 a[30:31], v218 offset:14848
    v_exp_f32 v204, v204
    v_exp_f32 v205, v205
    v_exp_f32 v206, v206
    v_exp_f32 v207, v207
    v_add_f32 v200, 1.0, v200
    v_add_f32 v201, 1.0, v201
    v_add_f32 v202, 1.0, v202
    v_add_f32 v203, 1.0, v203
    v_add_f32 v204, 1.0, v204
    v_add_f32 v205, 1.0, v205
    v_add_f32 v206, 1.0, v206
    v_add_f32 v207, 1.0, v207
    v_rcp_f32 v200, v200
    v_rcp_f32 v201, v201
    v_rcp_f32 v202, v202
    v_rcp_f32 v203, v203
    v_rcp_f32 v204, v204
    v_rcp_f32 v205, v205
    v_rcp_f32 v206, v206
    v_rcp_f32 v207, v207
    v_mul_f32 v200, v184, v200
    v_mul_f32 v201, v185, v201
    v_mul_f32 v202, v186, v202
    v_mul_f32 v203, v187, v203
    v_mul_f32 v204, v188, v204
    v_mul_f32 v205, v189, v205
    v_mul_f32 v206, v190, v206
    v_mul_f32 v207, v191, v207
    s_waitcnt lgkmcnt(15)
    v_mfma_f32_32x32x16_bf16 v[176:191], a[52:55], v[192:195], 0
    v_cvt_pk_bf16_f32 v212, v200, v201
    v_cvt_pk_bf16_f32 v213, v202, v203
    v_cvt_pk_bf16_f32 v214, v204, v205
    v_cvt_pk_bf16_f32 v215, v206, v207
    v_mul_f32 v200, v160, v160
    v_mul_f32 v201, v161, v161
    s_waitcnt lgkmcnt(8)
    v_mfma_f32_32x32x16_bf16 v[176:191], a[0:3], v[16:19], v[176:191]
    ds_read_b64_tr_b16 a[32:33], v218 offset:16384
    ds_read_b64_tr_b16 a[34:35], v218 offset:16896
    buffer_store_dwordx4 v[212:215], v223, s[24:27], s54 offen offset:1024
    v_mul_f32 v202, v162, v162
    v_mul_f32 v203, v163, v163
    v_mfma_f32_32x32x16_bf16 v[176:191], a[4:7], v[20:23], v[176:191]
    ds_read_b64_tr_b16 a[36:37], v218 offset:18432
    ds_read_b64_tr_b16 a[38:39], v218 offset:18944
    v_mul_f32 v204, v164, v164
    v_mul_f32 v205, v165, v165
    v_mul_f32 v206, v166, v166
    v_mul_f32 v207, v167, v167
    v_mfma_f32_32x32x16_bf16 v[176:191], a[8:11], v[24:27], v[176:191]
    ds_read_b64_tr_b16 a[40:41], v218 offset:20480
    ds_read_b64_tr_b16 a[42:43], v218 offset:20992
    v_fma_f32 v200, v200, v197, v196
    v_fma_f32 v201, v201, v197, v196
    v_fma_f32 v202, v202, v197, v196
    v_fma_f32 v203, v203, v197, v196
    v_mfma_f32_32x32x16_bf16 v[176:191], a[12:15], v[28:31], v[176:191]
    ds_read_b64_tr_b16 a[44:45], v218 offset:22528
    ds_read_b64_tr_b16 a[46:47], v218 offset:23040
    v_fma_f32 v204, v204, v197, v196
    v_fma_f32 v205, v205, v197, v196
    v_fma_f32 v206, v206, v197, v196
    s_waitcnt lgkmcnt(8)
    v_mfma_f32_32x32x16_bf16 v[176:191], a[16:19], v[32:35], v[176:191]
    ds_read_b64_tr_b16 a[0:1], v218 offset:24576
    ds_read_b64_tr_b16 a[2:3], v218 offset:25088
    v_fma_f32 v207, v207, v197, v196
    v_mul_f32 v200, v160, v200
    v_mul_f32 v201, v161, v201
    v_mul_f32 v202, v162, v202
    v_mfma_f32_32x32x16_bf16 v[176:191], a[20:23], v[36:39], v[176:191]
    ds_read_b64_tr_b16 a[4:5], v218 offset:26624
    ds_read_b64_tr_b16 a[6:7], v218 offset:27136
    s_add_u32 s50, s64, 4096
    s_waitcnt vmcnt(16)
    buffer_load_dwordx4 a[80:83], v223, s[16:19], s50 offen offset:0
    v_mul_f32 v203, v163, v203
    v_mul_f32 v204, v164, v204
    v_mfma_f32_32x32x16_bf16 v[176:191], a[24:27], v[40:43], v[176:191]
    ds_read_b64_tr_b16 a[8:9], v218 offset:28672
    ds_read_b64_tr_b16 a[10:11], v218 offset:29184
    v_mul_f32 v205, v165, v205
    v_mul_f32 v206, v166, v206
    v_mul_f32 v207, v167, v207
    v_mfma_f32_32x32x16_bf16 v[176:191], a[28:31], v[44:47], v[176:191]
    ds_read_b64_tr_b16 a[12:13], v218 offset:30720
    ds_read_b64_tr_b16 a[14:15], v218 offset:31232
    v_exp_f32 v200, v200
    v_exp_f32 v201, v201
    s_waitcnt lgkmcnt(8)
    v_mfma_f32_32x32x16_bf16 v[176:191], a[32:35], v[48:51], v[176:191]
    ds_read_b64_tr_b16 a[16:17], v218 offset:32768
    ds_read_b64_tr_b16 a[18:19], v218 offset:33280
    v_exp_f32 v202, v202
    v_exp_f32 v203, v203
    v_mfma_f32_32x32x16_bf16 v[176:191], a[36:39], v[52:55], v[176:191]
    ds_read_b64_tr_b16 a[20:21], v218 offset:34816
    ds_read_b64_tr_b16 a[22:23], v218 offset:35328
    v_exp_f32 v204, v204
    v_exp_f32 v205, v205
    v_mfma_f32_32x32x16_bf16 v[176:191], a[40:43], v[56:59], v[176:191]
    ds_read_b64_tr_b16 a[24:25], v219 offset:0
    ds_read_b64_tr_b16 a[26:27], v219 offset:512
    v_exp_f32 v206, v206
    v_exp_f32 v207, v207
    v_mfma_f32_32x32x16_bf16 v[176:191], a[44:47], v[60:63], v[176:191]
    ds_read_b64_tr_b16 a[28:29], v219 offset:2048
    ds_read_b64_tr_b16 a[30:31], v219 offset:2560
    v_add_f32 v200, 1.0, v200
    v_add_f32 v201, 1.0, v201
    v_add_f32 v202, 1.0, v202
    s_waitcnt lgkmcnt(8)
    v_mfma_f32_32x32x16_bf16 v[176:191], a[0:3], v[64:67], v[176:191]
    ds_read_b64_tr_b16 a[32:33], v219 offset:4096
    ds_read_b64_tr_b16 a[34:35], v219 offset:4608
    v_add_f32 v203, 1.0, v203
    v_add_f32 v204, 1.0, v204
    v_add_f32 v205, 1.0, v205
    v_add_f32 v206, 1.0, v206
    v_mfma_f32_32x32x16_bf16 v[176:191], a[4:7], v[68:71], v[176:191]
    ds_read_b64_tr_b16 a[36:37], v219 offset:6144
    ds_read_b64_tr_b16 a[38:39], v219 offset:6656
    v_add_f32 v207, 1.0, v207
    v_rcp_f32 v200, v200
    v_rcp_f32 v201, v201
    v_mfma_f32_32x32x16_bf16 v[176:191], a[8:11], v[72:75], v[176:191]
    ds_read_b64_tr_b16 a[40:41], v219 offset:8192
    ds_read_b64_tr_b16 a[42:43], v219 offset:8704
    v_rcp_f32 v202, v202
    v_mfma_f32_32x32x16_bf16 v[176:191], a[12:15], v[76:79], v[176:191]
    ds_read_b64_tr_b16 a[44:45], v219 offset:10240
    ds_read_b64_tr_b16 a[46:47], v219 offset:10752
    s_waitcnt lgkmcnt(8) vmcnt(13)
    s_barrier
    v_rcp_f32 v203, v203
    v_rcp_f32 v204, v204
    v_mfma_f32_32x32x16_bf16 v[176:191], a[16:19], v[80:83], v[176:191]
    ds_read_b64_tr_b16 a[0:1], v219 offset:12288
    ds_read_b64_tr_b16 a[2:3], v219 offset:12800
    s_add_u32 m0, s49, 0
    s_add_u32 s46, s47, 512
    buffer_load_dwordx4 v220, s[20:23], s46 offen offset:0  lds
    s_add_u32 s54, s64, 8192
    v_mfma_f32_32x32x16_bf16 v[176:191], a[20:23], v[84:87], v[176:191]
    ds_read_b64_tr_b16 a[4:5], v219 offset:14336
    ds_read_b64_tr_b16 a[6:7], v219 offset:14848
    v_rcp_f32 v205, v205
    v_rcp_f32 v206, v206
    v_mfma_f32_32x32x16_bf16 v[176:191], a[24:27], v[88:91], v[176:191]
    ds_read_b64_tr_b16 a[8:9], v219 offset:16384
    ds_read_b64_tr_b16 a[10:11], v219 offset:16896
    v_rcp_f32 v207, v207
    v_mul_f32 v200, v160, v200
    v_mfma_f32_32x32x16_bf16 v[176:191], a[28:31], v[92:95], v[176:191]
    ds_read_b64_tr_b16 a[12:13], v219 offset:18432
    ds_read_b64_tr_b16 a[14:15], v219 offset:18944
    buffer_load_dwordx4 v221, s[20:23], s46 offen offset:1024  lds
    v_mul_f32 v201, v161, v201
    v_mul_f32 v202, v162, v202
    v_mul_f32 v203, v163, v203
    s_waitcnt lgkmcnt(8)
    v_mfma_f32_32x32x16_bf16 v[176:191], a[32:35], v[96:99], v[176:191]
    ds_read_b64_tr_b16 a[16:17], v219 offset:20480
    ds_read_b64_tr_b16 a[18:19], v219 offset:20992
    v_mul_f32 v204, v164, v204
    v_mul_f32 v205, v165, v205
    v_mul_f32 v206, v166, v206
    v_mul_f32 v207, v167, v207
    v_mfma_f32_32x32x16_bf16 v[176:191], a[36:39], v[100:103], v[176:191]
    ds_read_b64_tr_b16 a[20:21], v219 offset:22528
    ds_read_b64_tr_b16 a[22:23], v219 offset:23040
    v_cvt_pk_bf16_f32 v208, v200, v201
    v_cvt_pk_bf16_f32 v209, v202, v203
    v_cvt_pk_bf16_f32 v210, v204, v205
    v_cvt_pk_bf16_f32 v211, v206, v207
    v_mfma_f32_32x32x16_bf16 v[176:191], a[40:43], v[104:107], v[176:191]
    ds_read_b64_tr_b16 a[24:25], v219 offset:24576
    ds_read_b64_tr_b16 a[26:27], v219 offset:25088
    buffer_store_dwordx4 v[208:211], v223, s[24:27], s54 offen offset:0
    buffer_load_dwordx4 v222, s[20:23], s46 offen offset:2048  lds
    v_mul_f32 v200, v168, v168
    v_mfma_f32_32x32x16_bf16 v[176:191], a[44:47], v[108:111], v[176:191]
    ds_read_b64_tr_b16 a[28:29], v219 offset:26624
    ds_read_b64_tr_b16 a[30:31], v219 offset:27136
    ds_read_b32 a48, v224 offset:768
    v_mul_f32 v201, v169, v169
    v_mul_f32 v202, v170, v170
    v_mul_f32 v203, v171, v171
    s_waitcnt lgkmcnt(9)
    v_mfma_f32_32x32x16_bf16 v[176:191], a[0:3], v[112:115], v[176:191]
    ds_read_b64_tr_b16 a[32:33], v219 offset:28672
    ds_read_b64_tr_b16 a[34:35], v219 offset:29184
    v_mul_f32 v204, v172, v172
    v_mul_f32 v205, v173, v173
    v_mul_f32 v206, v174, v174
    v_mul_f32 v207, v175, v175
    v_mfma_f32_32x32x16_bf16 v[176:191], a[4:7], v[116:119], v[176:191]
    ds_read_b64_tr_b16 a[36:37], v219 offset:30720
    ds_read_b64_tr_b16 a[38:39], v219 offset:31232
    s_add_u32 m0, s49, 3072
    s_add_u32 s46, s47, 221696
    buffer_load_dwordx4 v220, s[20:23], s46 offen offset:0  lds
    v_fma_f32 v200, v200, v197, v196
    v_mfma_f32_32x32x16_bf16 v[176:191], a[8:11], v[120:123], v[176:191]
    ds_read_b64_tr_b16 a[40:41], v219 offset:32768
    ds_read_b64_tr_b16 a[42:43], v219 offset:33280
    v_fma_f32 v201, v201, v197, v196
    v_fma_f32 v202, v202, v197, v196
    v_fma_f32 v203, v203, v197, v196
    v_mfma_f32_32x32x16_bf16 v[176:191], a[12:15], v[124:127], v[176:191]
    ds_read_b64_tr_b16 a[44:45], v219 offset:34816
    ds_read_b64_tr_b16 a[46:47], v219 offset:35328
    v_fma_f32 v204, v204, v197, v196
    v_fma_f32 v205, v205, v197, v196
    v_fma_f32 v206, v206, v197, v196
    s_waitcnt lgkmcnt(9)
    v_mfma_f32_32x32x16_bf16 v[176:191], a[16:19], v[128:131], v[176:191]
    ds_read_b64_tr_b16 a[0:1], v225 offset:0
    ds_read_b64_tr_b16 a[2:3], v225 offset:512
    buffer_load_dwordx4 v221, s[20:23], s46 offen offset:1024  lds
    v_fma_f32 v207, v207, v197, v196
    v_mul_f32 v200, v168, v200
    v_mul_f32 v201, v169, v201
    v_mfma_f32_32x32x16_bf16 v[176:191], a[20:23], v[132:135], v[176:191]
    ds_read_b64_tr_b16 a[4:5], v225 offset:2048
    ds_read_b64_tr_b16 a[6:7], v225 offset:2560
    v_mul_f32 v202, v170, v202
    v_mul_f32 v203, v171, v203
    v_mul_f32 v204, v172, v204
    v_mfma_f32_32x32x16_bf16 v[176:191], a[24:27], v[136:139], v[176:191]
    ds_read_b64_tr_b16 a[8:9], v225 offset:4096
    ds_read_b64_tr_b16 a[10:11], v225 offset:4608
    v_mul_f32 v205, v173, v205
    v_mul_f32 v206, v174, v206
    v_mul_f32 v207, v175, v207
    v_mfma_f32_32x32x16_bf16 v[176:191], a[28:31], v[140:143], v[176:191]
    ds_read_b64_tr_b16 a[12:13], v225 offset:6144
    ds_read_b64_tr_b16 a[14:15], v225 offset:6656
    buffer_load_dwordx4 v222, s[20:23], s46 offen offset:2048  lds
    s_waitcnt lgkmcnt(8) vmcnt(9)
    s_barrier
    v_exp_f32 v200, v200
    v_mfma_f32_32x32x16_bf16 v[176:191], a[32:35], v[144:147], v[176:191]
    ds_read_b64_tr_b16 a[16:17], v225 offset:8192
    ds_read_b64_tr_b16 a[18:19], v225 offset:8704
    v_exp_f32 v201, v201
    v_exp_f32 v202, v202
    v_mfma_f32_32x32x16_bf16 v[176:191], a[36:39], v[148:151], v[176:191]
    ds_read_b64_tr_b16 a[20:21], v225 offset:10240
    ds_read_b64_tr_b16 a[22:23], v225 offset:10752
    buffer_load_dwordx4 a[84:87], v223, s[16:19], s50 offen offset:1024
    v_exp_f32 v203, v203
    v_exp_f32 v204, v204
    v_mfma_f32_32x32x16_bf16 v[176:191], a[40:43], v[152:155], v[176:191]
    ds_read_b64_tr_b16 a[24:25], v225 offset:12288
    ds_read_b64_tr_b16 a[26:27], v225 offset:12800
    v_exp_f32 v205, v205
    v_exp_f32 v206, v206
    v_mfma_f32_32x32x16_bf16 v[176:191], a[44:47], v[156:159], v[176:191]
    ds_read_b64_tr_b16 a[28:29], v225 offset:14336
    ds_read_b64_tr_b16 a[30:31], v225 offset:14848
    v_exp_f32 v207, v207
    v_add_f32 v200, 1.0, v200
    v_add_f32 v201, 1.0, v201
    v_add_f32 v202, 1.0, v202
    v_add_f32 v203, 1.0, v203
    v_add_f32 v204, 1.0, v204
    v_add_f32 v205, 1.0, v205
    v_add_f32 v206, 1.0, v206
    v_add_f32 v207, 1.0, v207
    v_rcp_f32 v200, v200
    v_rcp_f32 v201, v201
    v_rcp_f32 v202, v202
    v_rcp_f32 v203, v203
    v_rcp_f32 v204, v204
    v_rcp_f32 v205, v205
    v_rcp_f32 v206, v206
    v_rcp_f32 v207, v207
    v_mul_f32 v200, v168, v200
    v_mul_f32 v201, v169, v201
    v_mul_f32 v202, v170, v202
    v_mul_f32 v203, v171, v203
    v_mul_f32 v204, v172, v204
    v_mul_f32 v205, v173, v205
    v_mul_f32 v206, v174, v206
    v_mul_f32 v207, v175, v207
    s_waitcnt lgkmcnt(15)
    v_mfma_f32_32x32x16_bf16 v[160:175], a[48:51], v[192:195], 0
    v_cvt_pk_bf16_f32 v212, v200, v201
    v_cvt_pk_bf16_f32 v213, v202, v203
    v_cvt_pk_bf16_f32 v214, v204, v205
    v_cvt_pk_bf16_f32 v215, v206, v207
    v_mul_f32 v200, v176, v176
    v_mul_f32 v201, v177, v177
    s_waitcnt lgkmcnt(8)
    v_mfma_f32_32x32x16_bf16 v[160:175], a[0:3], v[16:19], v[160:175]
    ds_read_b64_tr_b16 a[32:33], v225 offset:16384
    ds_read_b64_tr_b16 a[34:35], v225 offset:16896
    buffer_store_dwordx4 v[212:215], v223, s[24:27], s54 offen offset:1024
    v_mul_f32 v202, v178, v178
    v_mul_f32 v203, v179, v179
    v_mul_f32 v204, v180, v180
    v_mfma_f32_32x32x16_bf16 v[160:175], a[4:7], v[20:23], v[160:175]
    ds_read_b64_tr_b16 a[36:37], v225 offset:18432
    ds_read_b64_tr_b16 a[38:39], v225 offset:18944
    s_add_u32 m0, s49, 6144
    s_add_u32 s46, s47, 442880
    buffer_load_dwordx4 v220, s[20:23], s46 offen offset:0  lds
    v_mfma_f32_32x32x16_bf16 v[160:175], a[8:11], v[24:27], v[160:175]
    ds_read_b64_tr_b16 a[40:41], v225 offset:20480
    ds_read_b64_tr_b16 a[42:43], v225 offset:20992
    v_mul_f32 v205, v181, v181
    v_mul_f32 v206, v182, v182
    v_mul_f32 v207, v183, v183
    v_fma_f32 v200, v200, v197, v196
    v_mfma_f32_32x32x16_bf16 v[160:175], a[12:15], v[28:31], v[160:175]
    ds_read_b64_tr_b16 a[44:45], v225 offset:22528
    ds_read_b64_tr_b16 a[46:47], v225 offset:23040
    v_fma_f32 v201, v201, v197, v196
    v_fma_f32 v202, v202, v197, v196
    v_fma_f32 v203, v203, v197, v196
    s_waitcnt lgkmcnt(8)
    v_mfma_f32_32x32x16_bf16 v[160:175], a[16:19], v[32:35], v[160:175]
    ds_read_b64_tr_b16 a[0:1], v225 offset:24576
    ds_read_b64_tr_b16 a[2:3], v225 offset:25088
    buffer_load_dwordx4 v221, s[20:23], s46 offen offset:1024  lds
    v_fma_f32 v204, v204, v197, v196
    v_fma_f32 v205, v205, v197, v196
    v_fma_f32 v206, v206, v197, v196
    v_mfma_f32_32x32x16_bf16 v[160:175], a[20:23], v[36:39], v[160:175]
    ds_read_b64_tr_b16 a[4:5], v225 offset:26624
    ds_read_b64_tr_b16 a[6:7], v225 offset:27136
    s_add_u32 s50, s64, 6144
    s_waitcnt vmcnt(12)
    buffer_load_dwordx4 a[88:91], v223, s[16:19], s50 offen offset:0
    v_fma_f32 v207, v207, v197, v196
    v_mul_f32 v200, v176, v200
    v_mfma_f32_32x32x16_bf16 v[160:175], a[24:27], v[40:43], v[160:175]
    ds_read_b64_tr_b16 a[8:9], v225 offset:28672
    ds_read_b64_tr_b16 a[10:11], v225 offset:29184
    v_mul_f32 v201, v177, v201
    v_mul_f32 v202, v178, v202
    v_mul_f32 v203, v179, v203
    v_mfma_f32_32x32x16_bf16 v[160:175], a[28:31], v[44:47], v[160:175]
    ds_read_b64_tr_b16 a[12:13], v225 offset:30720
    ds_read_b64_tr_b16 a[14:15], v225 offset:31232
    buffer_load_dwordx4 v222, s[20:23], s46 offen offset:2048  lds
    v_mul_f32 v204, v180, v204
    v_mul_f32 v205, v181, v205
    v_mul_f32 v206, v182, v206
    s_waitcnt lgkmcnt(8)
    v_mfma_f32_32x32x16_bf16 v[160:175], a[32:35], v[48:51], v[160:175]
    ds_read_b64_tr_b16 a[16:17], v225 offset:32768
    ds_read_b64_tr_b16 a[18:19], v225 offset:33280
    v_mul_f32 v207, v183, v207
    v_exp_f32 v200, v200
    v_exp_f32 v201, v201
    v_mfma_f32_32x32x16_bf16 v[160:175], a[36:39], v[52:55], v[160:175]
    ds_read_b64_tr_b16 a[20:21], v225 offset:34816
    ds_read_b64_tr_b16 a[22:23], v225 offset:35328
    v_exp_f32 v202, v202
    v_exp_f32 v203, v203
    v_mfma_f32_32x32x16_bf16 v[160:175], a[40:43], v[56:59], v[160:175]
    ds_read_b64_tr_b16 a[24:25], v226 offset:0
    ds_read_b64_tr_b16 a[26:27], v226 offset:512
    s_add_u32 m0, s49, 36864
    s_add_u32 s46, s47, 2654720
    buffer_load_dwordx4 v220, s[20:23], s46 offen offset:0  lds
    v_mfma_f32_32x32x16_bf16 v[160:175], a[44:47], v[60:63], v[160:175]
    ds_read_b64_tr_b16 a[28:29], v226 offset:2048
    ds_read_b64_tr_b16 a[30:31], v226 offset:2560
    v_exp_f32 v204, v204
    v_exp_f32 v205, v205
    s_waitcnt lgkmcnt(8)
    v_mfma_f32_32x32x16_bf16 v[160:175], a[0:3], v[64:67], v[160:175]
    ds_read_b64_tr_b16 a[32:33], v226 offset:4096
    ds_read_b64_tr_b16 a[34:35], v226 offset:4608
    v_exp_f32 v206, v206
    v_exp_f32 v207, v207
    v_mfma_f32_32x32x16_bf16 v[160:175], a[4:7], v[68:71], v[160:175]
    ds_read_b64_tr_b16 a[36:37], v226 offset:6144
    ds_read_b64_tr_b16 a[38:39], v226 offset:6656
    buffer_load_dwordx4 v221, s[20:23], s46 offen offset:1024  lds
    v_add_f32 v200, 1.0, v200
    v_add_f32 v201, 1.0, v201
    v_add_f32 v202, 1.0, v202
    v_mfma_f32_32x32x16_bf16 v[160:175], a[8:11], v[72:75], v[160:175]
    ds_read_b64_tr_b16 a[40:41], v226 offset:8192
    ds_read_b64_tr_b16 a[42:43], v226 offset:8704
    v_add_f32 v203, 1.0, v203
    v_add_f32 v204, 1.0, v204
    v_add_f32 v205, 1.0, v205
    v_mfma_f32_32x32x16_bf16 v[160:175], a[12:15], v[76:79], v[160:175]
    ds_read_b64_tr_b16 a[44:45], v226 offset:10240
    ds_read_b64_tr_b16 a[46:47], v226 offset:10752
    v_add_f32 v206, 1.0, v206
    v_add_f32 v207, 1.0, v207
    v_rcp_f32 v200, v200
    s_waitcnt lgkmcnt(8)
    v_mfma_f32_32x32x16_bf16 v[160:175], a[16:19], v[80:83], v[160:175]
    ds_read_b64_tr_b16 a[0:1], v226 offset:12288
    ds_read_b64_tr_b16 a[2:3], v226 offset:12800
    buffer_load_dwordx4 v222, s[20:23], s46 offen offset:2048  lds
    v_rcp_f32 v201, v201
    v_rcp_f32 v202, v202
    v_mfma_f32_32x32x16_bf16 v[160:175], a[20:23], v[84:87], v[160:175]
    ds_read_b64_tr_b16 a[4:5], v226 offset:14336
    ds_read_b64_tr_b16 a[6:7], v226 offset:14848
    v_rcp_f32 v203, v203
    v_rcp_f32 v204, v204
    v_mfma_f32_32x32x16_bf16 v[160:175], a[24:27], v[88:91], v[160:175]
    ds_read_b64_tr_b16 a[8:9], v226 offset:16384
    ds_read_b64_tr_b16 a[10:11], v226 offset:16896
    v_rcp_f32 v205, v205
    v_rcp_f32 v206, v206
    v_mfma_f32_32x32x16_bf16 v[160:175], a[28:31], v[92:95], v[160:175]
    ds_read_b64_tr_b16 a[12:13], v226 offset:18432
    ds_read_b64_tr_b16 a[14:15], v226 offset:18944
    s_add_u32 m0, s49, 39936
    s_add_u32 s46, s47, 2875904
    buffer_load_dwordx4 v220, s[20:23], s46 offen offset:0  lds
    s_add_u32 s54, s64, 10240
    s_waitcnt lgkmcnt(8)
    v_mfma_f32_32x32x16_bf16 v[160:175], a[32:35], v[96:99], v[160:175]
    ds_read_b64_tr_b16 a[16:17], v226 offset:20480
    ds_read_b64_tr_b16 a[18:19], v226 offset:20992
    v_rcp_f32 v207, v207
    v_mul_f32 v200, v176, v200
    v_mul_f32 v201, v177, v201
    v_mfma_f32_32x32x16_bf16 v[160:175], a[36:39], v[100:103], v[160:175]
    ds_read_b64_tr_b16 a[20:21], v226 offset:22528
    ds_read_b64_tr_b16 a[22:23], v226 offset:23040
    v_mul_f32 v202, v178, v202
    v_mul_f32 v203, v179, v203
    v_mul_f32 v204, v180, v204
    v_mul_f32 v205, v181, v205
    v_mfma_f32_32x32x16_bf16 v[160:175], a[40:43], v[104:107], v[160:175]
    ds_read_b64_tr_b16 a[24:25], v226 offset:24576
    ds_read_b64_tr_b16 a[26:27], v226 offset:25088
    v_mul_f32 v206, v182, v206
    v_mul_f32 v207, v183, v207
    v_cvt_pk_bf16_f32 v208, v200, v201
    v_mfma_f32_32x32x16_bf16 v[160:175], a[44:47], v[108:111], v[160:175]
    ds_read_b64_tr_b16 a[28:29], v226 offset:26624
    ds_read_b64_tr_b16 a[30:31], v226 offset:27136
    ds_read_b32 a52, v224 offset:896
    v_cvt_pk_bf16_f32 v209, v202, v203
    v_cvt_pk_bf16_f32 v210, v204, v205
    v_cvt_pk_bf16_f32 v211, v206, v207
    s_waitcnt lgkmcnt(9)
    v_mfma_f32_32x32x16_bf16 v[160:175], a[0:3], v[112:115], v[160:175]
    ds_read_b64_tr_b16 a[32:33], v226 offset:28672
    ds_read_b64_tr_b16 a[34:35], v226 offset:29184
    buffer_store_dwordx4 v[208:211], v223, s[24:27], s54 offen offset:0
    buffer_load_dwordx4 v221, s[20:23], s46 offen offset:1024  lds
    v_mul_f32 v200, v184, v184
    v_mul_f32 v201, v185, v185
    v_mfma_f32_32x32x16_bf16 v[160:175], a[4:7], v[116:119], v[160:175]
    ds_read_b64_tr_b16 a[36:37], v226 offset:30720
    ds_read_b64_tr_b16 a[38:39], v226 offset:31232
    buffer_load_dwordx4 v222, s[20:23], s46 offen offset:2048  lds
    v_mul_f32 v202, v186, v186
    v_mul_f32 v203, v187, v187
    v_mul_f32 v204, v188, v188
    v_mfma_f32_32x32x16_bf16 v[160:175], a[8:11], v[120:123], v[160:175]
    ds_read_b64_tr_b16 a[40:41], v226 offset:32768
    ds_read_b64_tr_b16 a[42:43], v226 offset:33280
    v_mul_f32 v205, v189, v189
    v_mul_f32 v206, v190, v190
    v_mul_f32 v207, v191, v191
    v_mfma_f32_32x32x16_bf16 v[160:175], a[12:15], v[124:127], v[160:175]
    ds_read_b64_tr_b16 a[44:45], v226 offset:34816
    ds_read_b64_tr_b16 a[46:47], v226 offset:35328
    v_fma_f32 v200, v200, v197, v196
    v_fma_f32 v201, v201, v197, v196
    v_fma_f32 v202, v202, v197, v196
    s_waitcnt lgkmcnt(9)
    v_mfma_f32_32x32x16_bf16 v[160:175], a[16:19], v[128:131], v[160:175]
    ds_read_b64_tr_b16 a[0:1], v227 offset:0
    ds_read_b64_tr_b16 a[2:3], v227 offset:512
    s_add_u32 m0, s49, 43008
    s_add_u32 s46, s47, 3097088
    buffer_load_dwordx4 v220, s[20:23], s46 offen offset:0  lds
    v_fma_f32 v203, v203, v197, v196
    v_mfma_f32_32x32x16_bf16 v[160:175], a[20:23], v[132:135], v[160:175]
    ds_read_b64_tr_b16 a[4:5], v227 offset:2048
    ds_read_b64_tr_b16 a[6:7], v227 offset:2560
    v_fma_f32 v204, v204, v197, v196
    v_fma_f32 v205, v205, v197, v196
    v_fma_f32 v206, v206, v197, v196
    v_mfma_f32_32x32x16_bf16 v[160:175], a[24:27], v[136:139], v[160:175]
    ds_read_b64_tr_b16 a[8:9], v227 offset:4096
    ds_read_b64_tr_b16 a[10:11], v227 offset:4608
    v_fma_f32 v207, v207, v197, v196
    v_mul_f32 v200, v184, v200
    v_mul_f32 v201, v185, v201
    v_mfma_f32_32x32x16_bf16 v[160:175], a[28:31], v[140:143], v[160:175]
    ds_read_b64_tr_b16 a[12:13], v227 offset:6144
    ds_read_b64_tr_b16 a[14:15], v227 offset:6656
    buffer_load_dwordx4 v221, s[20:23], s46 offen offset:1024  lds
    v_mul_f32 v202, v186, v202
    v_mul_f32 v203, v187, v203
    v_mul_f32 v204, v188, v204
    s_waitcnt lgkmcnt(8)
    v_mfma_f32_32x32x16_bf16 v[160:175], a[32:35], v[144:147], v[160:175]
    ds_read_b64_tr_b16 a[16:17], v227 offset:8192
    ds_read_b64_tr_b16 a[18:19], v227 offset:8704
    v_mul_f32 v205, v189, v205
    v_mul_f32 v206, v190, v206
    v_mul_f32 v207, v191, v207
    v_exp_f32 v200, v200
    v_mfma_f32_32x32x16_bf16 v[160:175], a[36:39], v[148:151], v[160:175]
    ds_read_b64_tr_b16 a[20:21], v227 offset:10240
    ds_read_b64_tr_b16 a[22:23], v227 offset:10752
    buffer_load_dwordx4 a[92:95], v223, s[16:19], s50 offen offset:1024
    v_exp_f32 v201, v201
    v_exp_f32 v202, v202
    v_mfma_f32_32x32x16_bf16 v[160:175], a[40:43], v[152:155], v[160:175]
    ds_read_b64_tr_b16 a[24:25], v227 offset:12288
    ds_read_b64_tr_b16 a[26:27], v227 offset:12800
    buffer_load_dwordx4 v222, s[20:23], s46 offen offset:2048  lds
    v_exp_f32 v203, v203
    v_mfma_f32_32x32x16_bf16 v[160:175], a[44:47], v[156:159], v[160:175]
    ds_read_b64_tr_b16 a[28:29], v227 offset:14336
    ds_read_b64_tr_b16 a[30:31], v227 offset:14848
    v_exp_f32 v204, v204
    v_exp_f32 v205, v205
    v_exp_f32 v206, v206
    v_exp_f32 v207, v207
    v_add_f32 v200, 1.0, v200
    v_add_f32 v201, 1.0, v201
    v_add_f32 v202, 1.0, v202
    v_add_f32 v203, 1.0, v203
    v_add_f32 v204, 1.0, v204
    v_add_f32 v205, 1.0, v205
    v_add_f32 v206, 1.0, v206
    v_add_f32 v207, 1.0, v207
    v_rcp_f32 v200, v200
    v_rcp_f32 v201, v201
    v_rcp_f32 v202, v202
    v_rcp_f32 v203, v203
    v_rcp_f32 v204, v204
    v_rcp_f32 v205, v205
    v_rcp_f32 v206, v206
    v_rcp_f32 v207, v207
    v_mul_f32 v200, v184, v200
    v_mul_f32 v201, v185, v201
    v_mul_f32 v202, v186, v202
    v_mul_f32 v203, v187, v203
    v_mul_f32 v204, v188, v204
    v_mul_f32 v205, v189, v205
    v_mul_f32 v206, v190, v206
    v_mul_f32 v207, v191, v207
    s_waitcnt lgkmcnt(15)
    v_mfma_f32_32x32x16_bf16 v[176:191], a[52:55], v[192:195], 0
    v_cvt_pk_bf16_f32 v212, v200, v201
    v_cvt_pk_bf16_f32 v213, v202, v203
    v_cvt_pk_bf16_f32 v214, v204, v205
    v_cvt_pk_bf16_f32 v215, v206, v207
    v_mul_f32 v200, v160, v160
    v_mul_f32 v201, v161, v161
    s_waitcnt lgkmcnt(8)
    v_mfma_f32_32x32x16_bf16 v[176:191], a[0:3], v[16:19], v[176:191]
    ds_read_b64_tr_b16 a[32:33], v227 offset:16384
    ds_read_b64_tr_b16 a[34:35], v227 offset:16896
    buffer_store_dwordx4 v[212:215], v223, s[24:27], s54 offen offset:1024
    v_mul_f32 v202, v162, v162
    v_mul_f32 v203, v163, v163
    v_mfma_f32_32x32x16_bf16 v[176:191], a[4:7], v[20:23], v[176:191]
    ds_read_b64_tr_b16 a[36:37], v227 offset:18432
    ds_read_b64_tr_b16 a[38:39], v227 offset:18944
    v_mul_f32 v204, v164, v164
    v_mul_f32 v205, v165, v165
    v_mul_f32 v206, v166, v166
    v_mul_f32 v207, v167, v167
    v_mfma_f32_32x32x16_bf16 v[176:191], a[8:11], v[24:27], v[176:191]
    ds_read_b64_tr_b16 a[40:41], v227 offset:20480
    ds_read_b64_tr_b16 a[42:43], v227 offset:20992
    v_fma_f32 v200, v200, v197, v196
    v_fma_f32 v201, v201, v197, v196
    v_fma_f32 v202, v202, v197, v196
    v_fma_f32 v203, v203, v197, v196
    v_mfma_f32_32x32x16_bf16 v[176:191], a[12:15], v[28:31], v[176:191]
    ds_read_b64_tr_b16 a[44:45], v227 offset:22528
    ds_read_b64_tr_b16 a[46:47], v227 offset:23040
    v_fma_f32 v204, v204, v197, v196
    v_fma_f32 v205, v205, v197, v196
    v_fma_f32 v206, v206, v197, v196
    s_waitcnt lgkmcnt(8)
    v_mfma_f32_32x32x16_bf16 v[176:191], a[16:19], v[32:35], v[176:191]
    ds_read_b64_tr_b16 a[0:1], v227 offset:24576
    ds_read_b64_tr_b16 a[2:3], v227 offset:25088
    v_fma_f32 v207, v207, v197, v196
    v_mul_f32 v200, v160, v200
    v_mul_f32 v201, v161, v201
    v_mul_f32 v202, v162, v202
    v_mfma_f32_32x32x16_bf16 v[176:191], a[20:23], v[36:39], v[176:191]
    ds_read_b64_tr_b16 a[4:5], v227 offset:26624
    ds_read_b64_tr_b16 a[6:7], v227 offset:27136
    s_add_u32 s50, s64, 8192
    s_waitcnt vmcnt(16)
    buffer_load_dwordx4 a[96:99], v223, s[16:19], s50 offen offset:0
    v_mul_f32 v203, v163, v203
    v_mul_f32 v204, v164, v204
    v_mfma_f32_32x32x16_bf16 v[176:191], a[24:27], v[40:43], v[176:191]
    ds_read_b64_tr_b16 a[8:9], v227 offset:28672
    ds_read_b64_tr_b16 a[10:11], v227 offset:29184
    v_mul_f32 v205, v165, v205
    v_mul_f32 v206, v166, v206
    v_mul_f32 v207, v167, v207
    v_mfma_f32_32x32x16_bf16 v[176:191], a[28:31], v[44:47], v[176:191]
    ds_read_b64_tr_b16 a[12:13], v227 offset:30720
    ds_read_b64_tr_b16 a[14:15], v227 offset:31232
    v_exp_f32 v200, v200
    v_exp_f32 v201, v201
    s_waitcnt lgkmcnt(8)
    v_mfma_f32_32x32x16_bf16 v[176:191], a[32:35], v[48:51], v[176:191]
    ds_read_b64_tr_b16 a[16:17], v227 offset:32768
    ds_read_b64_tr_b16 a[18:19], v227 offset:33280
    v_exp_f32 v202, v202
    v_exp_f32 v203, v203
    v_mfma_f32_32x32x16_bf16 v[176:191], a[36:39], v[52:55], v[176:191]
    ds_read_b64_tr_b16 a[20:21], v227 offset:34816
    ds_read_b64_tr_b16 a[22:23], v227 offset:35328
    v_exp_f32 v204, v204
    v_exp_f32 v205, v205
    v_mfma_f32_32x32x16_bf16 v[176:191], a[40:43], v[56:59], v[176:191]
    ds_read_b64_tr_b16 a[24:25], v228 offset:0
    ds_read_b64_tr_b16 a[26:27], v228 offset:512
    v_exp_f32 v206, v206
    v_exp_f32 v207, v207
    v_mfma_f32_32x32x16_bf16 v[176:191], a[44:47], v[60:63], v[176:191]
    ds_read_b64_tr_b16 a[28:29], v228 offset:2048
    ds_read_b64_tr_b16 a[30:31], v228 offset:2560
    v_add_f32 v200, 1.0, v200
    v_add_f32 v201, 1.0, v201
    v_add_f32 v202, 1.0, v202
    s_waitcnt lgkmcnt(8)
    v_mfma_f32_32x32x16_bf16 v[176:191], a[0:3], v[64:67], v[176:191]
    ds_read_b64_tr_b16 a[32:33], v228 offset:4096
    ds_read_b64_tr_b16 a[34:35], v228 offset:4608
    v_add_f32 v203, 1.0, v203
    v_add_f32 v204, 1.0, v204
    v_add_f32 v205, 1.0, v205
    v_add_f32 v206, 1.0, v206
    v_mfma_f32_32x32x16_bf16 v[176:191], a[4:7], v[68:71], v[176:191]
    ds_read_b64_tr_b16 a[36:37], v228 offset:6144
    ds_read_b64_tr_b16 a[38:39], v228 offset:6656
    v_add_f32 v207, 1.0, v207
    v_rcp_f32 v200, v200
    v_rcp_f32 v201, v201
    v_mfma_f32_32x32x16_bf16 v[176:191], a[8:11], v[72:75], v[176:191]
    ds_read_b64_tr_b16 a[40:41], v228 offset:8192
    ds_read_b64_tr_b16 a[42:43], v228 offset:8704
    v_rcp_f32 v202, v202
    v_mfma_f32_32x32x16_bf16 v[176:191], a[12:15], v[76:79], v[176:191]
    ds_read_b64_tr_b16 a[44:45], v228 offset:10240
    ds_read_b64_tr_b16 a[46:47], v228 offset:10752
    s_waitcnt lgkmcnt(8) vmcnt(13)
    s_barrier
    v_rcp_f32 v203, v203
    v_rcp_f32 v204, v204
    v_mfma_f32_32x32x16_bf16 v[176:191], a[16:19], v[80:83], v[176:191]
    ds_read_b64_tr_b16 a[0:1], v228 offset:12288
    ds_read_b64_tr_b16 a[2:3], v228 offset:12800
    s_add_u32 m0, s49, 73728
    s_add_u32 s46, s47, 640
    buffer_load_dwordx4 v220, s[20:23], s46 offen offset:0  lds
    s_add_u32 s54, s64, 12288
    v_mfma_f32_32x32x16_bf16 v[176:191], a[20:23], v[84:87], v[176:191]
    ds_read_b64_tr_b16 a[4:5], v228 offset:14336
    ds_read_b64_tr_b16 a[6:7], v228 offset:14848
    v_rcp_f32 v205, v205
    v_rcp_f32 v206, v206
    v_mfma_f32_32x32x16_bf16 v[176:191], a[24:27], v[88:91], v[176:191]
    ds_read_b64_tr_b16 a[8:9], v228 offset:16384
    ds_read_b64_tr_b16 a[10:11], v228 offset:16896
    v_rcp_f32 v207, v207
    v_mul_f32 v200, v160, v200
    v_mfma_f32_32x32x16_bf16 v[176:191], a[28:31], v[92:95], v[176:191]
    ds_read_b64_tr_b16 a[12:13], v228 offset:18432
    ds_read_b64_tr_b16 a[14:15], v228 offset:18944
    buffer_load_dwordx4 v221, s[20:23], s46 offen offset:1024  lds
    v_mul_f32 v201, v161, v201
    v_mul_f32 v202, v162, v202
    v_mul_f32 v203, v163, v203
    s_waitcnt lgkmcnt(8)
    v_mfma_f32_32x32x16_bf16 v[176:191], a[32:35], v[96:99], v[176:191]
    ds_read_b64_tr_b16 a[16:17], v228 offset:20480
    ds_read_b64_tr_b16 a[18:19], v228 offset:20992
    v_mul_f32 v204, v164, v204
    v_mul_f32 v205, v165, v205
    v_mul_f32 v206, v166, v206
    v_mul_f32 v207, v167, v207
    v_mfma_f32_32x32x16_bf16 v[176:191], a[36:39], v[100:103], v[176:191]
    ds_read_b64_tr_b16 a[20:21], v228 offset:22528
    ds_read_b64_tr_b16 a[22:23], v228 offset:23040
    v_cvt_pk_bf16_f32 v208, v200, v201
    v_cvt_pk_bf16_f32 v209, v202, v203
    v_cvt_pk_bf16_f32 v210, v204, v205
    v_cvt_pk_bf16_f32 v211, v206, v207
    v_mfma_f32_32x32x16_bf16 v[176:191], a[40:43], v[104:107], v[176:191]
    ds_read_b64_tr_b16 a[24:25], v228 offset:24576
    ds_read_b64_tr_b16 a[26:27], v228 offset:25088
    buffer_store_dwordx4 v[208:211], v223, s[24:27], s54 offen offset:0
    buffer_load_dwordx4 v222, s[20:23], s46 offen offset:2048  lds
    v_mul_f32 v200, v168, v168
    v_mfma_f32_32x32x16_bf16 v[176:191], a[44:47], v[108:111], v[176:191]
    ds_read_b64_tr_b16 a[28:29], v228 offset:26624
    ds_read_b64_tr_b16 a[30:31], v228 offset:27136
    ds_read_b32 a48, v224 offset:1024
    v_mul_f32 v201, v169, v169
    v_mul_f32 v202, v170, v170
    v_mul_f32 v203, v171, v171
    s_waitcnt lgkmcnt(9)
    v_mfma_f32_32x32x16_bf16 v[176:191], a[0:3], v[112:115], v[176:191]
    ds_read_b64_tr_b16 a[32:33], v228 offset:28672
    ds_read_b64_tr_b16 a[34:35], v228 offset:29184
    v_mul_f32 v204, v172, v172
    v_mul_f32 v205, v173, v173
    v_mul_f32 v206, v174, v174
    v_mul_f32 v207, v175, v175
    v_mfma_f32_32x32x16_bf16 v[176:191], a[4:7], v[116:119], v[176:191]
    ds_read_b64_tr_b16 a[36:37], v228 offset:30720
    ds_read_b64_tr_b16 a[38:39], v228 offset:31232
    s_add_u32 m0, s49, 76800
    s_add_u32 s46, s47, 221824
    buffer_load_dwordx4 v220, s[20:23], s46 offen offset:0  lds
    v_fma_f32 v200, v200, v197, v196
    v_mfma_f32_32x32x16_bf16 v[176:191], a[8:11], v[120:123], v[176:191]
    ds_read_b64_tr_b16 a[40:41], v228 offset:32768
    ds_read_b64_tr_b16 a[42:43], v228 offset:33280
    v_fma_f32 v201, v201, v197, v196
    v_fma_f32 v202, v202, v197, v196
    v_fma_f32 v203, v203, v197, v196
    v_mfma_f32_32x32x16_bf16 v[176:191], a[12:15], v[124:127], v[176:191]
    ds_read_b64_tr_b16 a[44:45], v228 offset:34816
    ds_read_b64_tr_b16 a[46:47], v228 offset:35328
    v_fma_f32 v204, v204, v197, v196
    v_fma_f32 v205, v205, v197, v196
    v_fma_f32 v206, v206, v197, v196
    s_waitcnt lgkmcnt(9)
    v_mfma_f32_32x32x16_bf16 v[176:191], a[16:19], v[128:131], v[176:191]
    ds_read_b64_tr_b16 a[0:1], v216 offset:0
    ds_read_b64_tr_b16 a[2:3], v216 offset:512
    buffer_load_dwordx4 v221, s[20:23], s46 offen offset:1024  lds
    v_fma_f32 v207, v207, v197, v196
    v_mul_f32 v200, v168, v200
    v_mul_f32 v201, v169, v201
    v_mfma_f32_32x32x16_bf16 v[176:191], a[20:23], v[132:135], v[176:191]
    ds_read_b64_tr_b16 a[4:5], v216 offset:2048
    ds_read_b64_tr_b16 a[6:7], v216 offset:2560
    v_mul_f32 v202, v170, v202
    v_mul_f32 v203, v171, v203
    v_mul_f32 v204, v172, v204
    v_mfma_f32_32x32x16_bf16 v[176:191], a[24:27], v[136:139], v[176:191]
    ds_read_b64_tr_b16 a[8:9], v216 offset:4096
    ds_read_b64_tr_b16 a[10:11], v216 offset:4608
    v_mul_f32 v205, v173, v205
    v_mul_f32 v206, v174, v206
    v_mul_f32 v207, v175, v207
    v_mfma_f32_32x32x16_bf16 v[176:191], a[28:31], v[140:143], v[176:191]
    ds_read_b64_tr_b16 a[12:13], v216 offset:6144
    ds_read_b64_tr_b16 a[14:15], v216 offset:6656
    buffer_load_dwordx4 v222, s[20:23], s46 offen offset:2048  lds
    s_waitcnt lgkmcnt(8) vmcnt(9)
    s_barrier
    v_exp_f32 v200, v200
    v_mfma_f32_32x32x16_bf16 v[176:191], a[32:35], v[144:147], v[176:191]
    ds_read_b64_tr_b16 a[16:17], v216 offset:8192
    ds_read_b64_tr_b16 a[18:19], v216 offset:8704
    v_exp_f32 v201, v201
    v_exp_f32 v202, v202
    v_mfma_f32_32x32x16_bf16 v[176:191], a[36:39], v[148:151], v[176:191]
    ds_read_b64_tr_b16 a[20:21], v216 offset:10240
    ds_read_b64_tr_b16 a[22:23], v216 offset:10752
    buffer_load_dwordx4 a[100:103], v223, s[16:19], s50 offen offset:1024
    v_exp_f32 v203, v203
    v_exp_f32 v204, v204
    v_mfma_f32_32x32x16_bf16 v[176:191], a[40:43], v[152:155], v[176:191]
    ds_read_b64_tr_b16 a[24:25], v216 offset:12288
    ds_read_b64_tr_b16 a[26:27], v216 offset:12800
    v_exp_f32 v205, v205
    v_exp_f32 v206, v206
    v_mfma_f32_32x32x16_bf16 v[176:191], a[44:47], v[156:159], v[176:191]
    ds_read_b64_tr_b16 a[28:29], v216 offset:14336
    ds_read_b64_tr_b16 a[30:31], v216 offset:14848
    v_exp_f32 v207, v207
    v_add_f32 v200, 1.0, v200
    v_add_f32 v201, 1.0, v201
    v_add_f32 v202, 1.0, v202
    v_add_f32 v203, 1.0, v203
    v_add_f32 v204, 1.0, v204
    v_add_f32 v205, 1.0, v205
    v_add_f32 v206, 1.0, v206
    v_add_f32 v207, 1.0, v207
    v_rcp_f32 v200, v200
    v_rcp_f32 v201, v201
    v_rcp_f32 v202, v202
    v_rcp_f32 v203, v203
    v_rcp_f32 v204, v204
    v_rcp_f32 v205, v205
    v_rcp_f32 v206, v206
    v_rcp_f32 v207, v207
    v_mul_f32 v200, v168, v200
    v_mul_f32 v201, v169, v201
    v_mul_f32 v202, v170, v202
    v_mul_f32 v203, v171, v203
    v_mul_f32 v204, v172, v204
    v_mul_f32 v205, v173, v205
    v_mul_f32 v206, v174, v206
    v_mul_f32 v207, v175, v207
    s_waitcnt lgkmcnt(15)
    v_mfma_f32_32x32x16_bf16 v[160:175], a[48:51], v[192:195], 0
    v_cvt_pk_bf16_f32 v212, v200, v201
    v_cvt_pk_bf16_f32 v213, v202, v203
    v_cvt_pk_bf16_f32 v214, v204, v205
    v_cvt_pk_bf16_f32 v215, v206, v207
    v_mul_f32 v200, v176, v176
    v_mul_f32 v201, v177, v177
    s_waitcnt lgkmcnt(8)
    v_mfma_f32_32x32x16_bf16 v[160:175], a[0:3], v[16:19], v[160:175]
    ds_read_b64_tr_b16 a[32:33], v216 offset:16384
    ds_read_b64_tr_b16 a[34:35], v216 offset:16896
    buffer_store_dwordx4 v[212:215], v223, s[24:27], s54 offen offset:1024
    v_mul_f32 v202, v178, v178
    v_mul_f32 v203, v179, v179
    v_mul_f32 v204, v180, v180
    v_mfma_f32_32x32x16_bf16 v[160:175], a[4:7], v[20:23], v[160:175]
    ds_read_b64_tr_b16 a[36:37], v216 offset:18432
    ds_read_b64_tr_b16 a[38:39], v216 offset:18944
    s_add_u32 m0, s49, 79872
    s_add_u32 s46, s47, 443008
    buffer_load_dwordx4 v220, s[20:23], s46 offen offset:0  lds
    v_mfma_f32_32x32x16_bf16 v[160:175], a[8:11], v[24:27], v[160:175]
    ds_read_b64_tr_b16 a[40:41], v216 offset:20480
    ds_read_b64_tr_b16 a[42:43], v216 offset:20992
    v_mul_f32 v205, v181, v181
    v_mul_f32 v206, v182, v182
    v_mul_f32 v207, v183, v183
    v_fma_f32 v200, v200, v197, v196
    v_mfma_f32_32x32x16_bf16 v[160:175], a[12:15], v[28:31], v[160:175]
    ds_read_b64_tr_b16 a[44:45], v216 offset:22528
    ds_read_b64_tr_b16 a[46:47], v216 offset:23040
    v_fma_f32 v201, v201, v197, v196
    v_fma_f32 v202, v202, v197, v196
    v_fma_f32 v203, v203, v197, v196
    s_waitcnt lgkmcnt(8)
    v_mfma_f32_32x32x16_bf16 v[160:175], a[16:19], v[32:35], v[160:175]
    ds_read_b64_tr_b16 a[0:1], v216 offset:24576
    ds_read_b64_tr_b16 a[2:3], v216 offset:25088
    buffer_load_dwordx4 v221, s[20:23], s46 offen offset:1024  lds
    v_fma_f32 v204, v204, v197, v196
    v_fma_f32 v205, v205, v197, v196
    v_fma_f32 v206, v206, v197, v196
    v_mfma_f32_32x32x16_bf16 v[160:175], a[20:23], v[36:39], v[160:175]
    ds_read_b64_tr_b16 a[4:5], v216 offset:26624
    ds_read_b64_tr_b16 a[6:7], v216 offset:27136
    s_add_u32 s50, s64, 10240
    s_waitcnt vmcnt(12)
    buffer_load_dwordx4 a[104:107], v223, s[16:19], s50 offen offset:0
    v_fma_f32 v207, v207, v197, v196
    v_mul_f32 v200, v176, v200
    v_mfma_f32_32x32x16_bf16 v[160:175], a[24:27], v[40:43], v[160:175]
    ds_read_b64_tr_b16 a[8:9], v216 offset:28672
    ds_read_b64_tr_b16 a[10:11], v216 offset:29184
    v_mul_f32 v201, v177, v201
    v_mul_f32 v202, v178, v202
    v_mul_f32 v203, v179, v203
    v_mfma_f32_32x32x16_bf16 v[160:175], a[28:31], v[44:47], v[160:175]
    ds_read_b64_tr_b16 a[12:13], v216 offset:30720
    ds_read_b64_tr_b16 a[14:15], v216 offset:31232
    buffer_load_dwordx4 v222, s[20:23], s46 offen offset:2048  lds
    v_mul_f32 v204, v180, v204
    v_mul_f32 v205, v181, v205
    v_mul_f32 v206, v182, v206
    s_waitcnt lgkmcnt(8)
    v_mfma_f32_32x32x16_bf16 v[160:175], a[32:35], v[48:51], v[160:175]
    ds_read_b64_tr_b16 a[16:17], v216 offset:32768
    ds_read_b64_tr_b16 a[18:19], v216 offset:33280
    v_mul_f32 v207, v183, v207
    v_exp_f32 v200, v200
    v_exp_f32 v201, v201
    v_mfma_f32_32x32x16_bf16 v[160:175], a[36:39], v[52:55], v[160:175]
    ds_read_b64_tr_b16 a[20:21], v216 offset:34816
    ds_read_b64_tr_b16 a[22:23], v216 offset:35328
    v_exp_f32 v202, v202
    v_exp_f32 v203, v203
    v_mfma_f32_32x32x16_bf16 v[160:175], a[40:43], v[56:59], v[160:175]
    ds_read_b64_tr_b16 a[24:25], v217 offset:0
    ds_read_b64_tr_b16 a[26:27], v217 offset:512
    s_add_u32 m0, s49, 110592
    s_add_u32 s46, s47, 2654848
    buffer_load_dwordx4 v220, s[20:23], s46 offen offset:0  lds
    v_mfma_f32_32x32x16_bf16 v[160:175], a[44:47], v[60:63], v[160:175]
    ds_read_b64_tr_b16 a[28:29], v217 offset:2048
    ds_read_b64_tr_b16 a[30:31], v217 offset:2560
    v_exp_f32 v204, v204
    v_exp_f32 v205, v205
    s_waitcnt lgkmcnt(8)
    v_mfma_f32_32x32x16_bf16 v[160:175], a[0:3], v[64:67], v[160:175]
    ds_read_b64_tr_b16 a[32:33], v217 offset:4096
    ds_read_b64_tr_b16 a[34:35], v217 offset:4608
    v_exp_f32 v206, v206
    v_exp_f32 v207, v207
    v_mfma_f32_32x32x16_bf16 v[160:175], a[4:7], v[68:71], v[160:175]
    ds_read_b64_tr_b16 a[36:37], v217 offset:6144
    ds_read_b64_tr_b16 a[38:39], v217 offset:6656
    buffer_load_dwordx4 v221, s[20:23], s46 offen offset:1024  lds
    v_add_f32 v200, 1.0, v200
    v_add_f32 v201, 1.0, v201
    v_add_f32 v202, 1.0, v202
    v_mfma_f32_32x32x16_bf16 v[160:175], a[8:11], v[72:75], v[160:175]
    ds_read_b64_tr_b16 a[40:41], v217 offset:8192
    ds_read_b64_tr_b16 a[42:43], v217 offset:8704
    v_add_f32 v203, 1.0, v203
    v_add_f32 v204, 1.0, v204
    v_add_f32 v205, 1.0, v205
    v_mfma_f32_32x32x16_bf16 v[160:175], a[12:15], v[76:79], v[160:175]
    ds_read_b64_tr_b16 a[44:45], v217 offset:10240
    ds_read_b64_tr_b16 a[46:47], v217 offset:10752
    v_add_f32 v206, 1.0, v206
    v_add_f32 v207, 1.0, v207
    v_rcp_f32 v200, v200
    s_waitcnt lgkmcnt(8)
    v_mfma_f32_32x32x16_bf16 v[160:175], a[16:19], v[80:83], v[160:175]
    ds_read_b64_tr_b16 a[0:1], v217 offset:12288
    ds_read_b64_tr_b16 a[2:3], v217 offset:12800
    buffer_load_dwordx4 v222, s[20:23], s46 offen offset:2048  lds
    v_rcp_f32 v201, v201
    v_rcp_f32 v202, v202
    v_mfma_f32_32x32x16_bf16 v[160:175], a[20:23], v[84:87], v[160:175]
    ds_read_b64_tr_b16 a[4:5], v217 offset:14336
    ds_read_b64_tr_b16 a[6:7], v217 offset:14848
    v_rcp_f32 v203, v203
    v_rcp_f32 v204, v204
    v_mfma_f32_32x32x16_bf16 v[160:175], a[24:27], v[88:91], v[160:175]
    ds_read_b64_tr_b16 a[8:9], v217 offset:16384
    ds_read_b64_tr_b16 a[10:11], v217 offset:16896
    v_rcp_f32 v205, v205
    v_rcp_f32 v206, v206
    v_mfma_f32_32x32x16_bf16 v[160:175], a[28:31], v[92:95], v[160:175]
    ds_read_b64_tr_b16 a[12:13], v217 offset:18432
    ds_read_b64_tr_b16 a[14:15], v217 offset:18944
    s_add_u32 m0, s49, 113664
    s_add_u32 s46, s47, 2876032
    buffer_load_dwordx4 v220, s[20:23], s46 offen offset:0  lds
    s_add_u32 s54, s64, 14336
    s_waitcnt lgkmcnt(8)
    v_mfma_f32_32x32x16_bf16 v[160:175], a[32:35], v[96:99], v[160:175]
    ds_read_b64_tr_b16 a[16:17], v217 offset:20480
    ds_read_b64_tr_b16 a[18:19], v217 offset:20992
    v_rcp_f32 v207, v207
    v_mul_f32 v200, v176, v200
    v_mul_f32 v201, v177, v201
    v_mfma_f32_32x32x16_bf16 v[160:175], a[36:39], v[100:103], v[160:175]
    ds_read_b64_tr_b16 a[20:21], v217 offset:22528
    ds_read_b64_tr_b16 a[22:23], v217 offset:23040
    v_mul_f32 v202, v178, v202
    v_mul_f32 v203, v179, v203
    v_mul_f32 v204, v180, v204
    v_mul_f32 v205, v181, v205
    v_mfma_f32_32x32x16_bf16 v[160:175], a[40:43], v[104:107], v[160:175]
    ds_read_b64_tr_b16 a[24:25], v217 offset:24576
    ds_read_b64_tr_b16 a[26:27], v217 offset:25088
    v_mul_f32 v206, v182, v206
    v_mul_f32 v207, v183, v207
    v_cvt_pk_bf16_f32 v208, v200, v201
    v_mfma_f32_32x32x16_bf16 v[160:175], a[44:47], v[108:111], v[160:175]
    ds_read_b64_tr_b16 a[28:29], v217 offset:26624
    ds_read_b64_tr_b16 a[30:31], v217 offset:27136
    ds_read_b32 a52, v224 offset:1152
    v_cvt_pk_bf16_f32 v209, v202, v203
    v_cvt_pk_bf16_f32 v210, v204, v205
    v_cvt_pk_bf16_f32 v211, v206, v207
    s_waitcnt lgkmcnt(9)
    v_mfma_f32_32x32x16_bf16 v[160:175], a[0:3], v[112:115], v[160:175]
    ds_read_b64_tr_b16 a[32:33], v217 offset:28672
    ds_read_b64_tr_b16 a[34:35], v217 offset:29184
    buffer_store_dwordx4 v[208:211], v223, s[24:27], s54 offen offset:0
    buffer_load_dwordx4 v221, s[20:23], s46 offen offset:1024  lds
    v_mul_f32 v200, v184, v184
    v_mul_f32 v201, v185, v185
    v_mfma_f32_32x32x16_bf16 v[160:175], a[4:7], v[116:119], v[160:175]
    ds_read_b64_tr_b16 a[36:37], v217 offset:30720
    ds_read_b64_tr_b16 a[38:39], v217 offset:31232
    buffer_load_dwordx4 v222, s[20:23], s46 offen offset:2048  lds
    v_mul_f32 v202, v186, v186
    v_mul_f32 v203, v187, v187
    v_mul_f32 v204, v188, v188
    v_mfma_f32_32x32x16_bf16 v[160:175], a[8:11], v[120:123], v[160:175]
    ds_read_b64_tr_b16 a[40:41], v217 offset:32768
    ds_read_b64_tr_b16 a[42:43], v217 offset:33280
    v_mul_f32 v205, v189, v189
    v_mul_f32 v206, v190, v190
    v_mul_f32 v207, v191, v191
    v_mfma_f32_32x32x16_bf16 v[160:175], a[12:15], v[124:127], v[160:175]
    ds_read_b64_tr_b16 a[44:45], v217 offset:34816
    ds_read_b64_tr_b16 a[46:47], v217 offset:35328
    v_fma_f32 v200, v200, v197, v196
    v_fma_f32 v201, v201, v197, v196
    v_fma_f32 v202, v202, v197, v196
    s_waitcnt lgkmcnt(9)
    v_mfma_f32_32x32x16_bf16 v[160:175], a[16:19], v[128:131], v[160:175]
    ds_read_b64_tr_b16 a[0:1], v218 offset:0
    ds_read_b64_tr_b16 a[2:3], v218 offset:512
    s_add_u32 m0, s49, 116736
    s_add_u32 s46, s47, 3097216
    buffer_load_dwordx4 v220, s[20:23], s46 offen offset:0  lds
    v_fma_f32 v203, v203, v197, v196
    v_mfma_f32_32x32x16_bf16 v[160:175], a[20:23], v[132:135], v[160:175]
    ds_read_b64_tr_b16 a[4:5], v218 offset:2048
    ds_read_b64_tr_b16 a[6:7], v218 offset:2560
    v_fma_f32 v204, v204, v197, v196
    v_fma_f32 v205, v205, v197, v196
    v_fma_f32 v206, v206, v197, v196
    v_mfma_f32_32x32x16_bf16 v[160:175], a[24:27], v[136:139], v[160:175]
    ds_read_b64_tr_b16 a[8:9], v218 offset:4096
    ds_read_b64_tr_b16 a[10:11], v218 offset:4608
    v_fma_f32 v207, v207, v197, v196
    v_mul_f32 v200, v184, v200
    v_mul_f32 v201, v185, v201
    v_mfma_f32_32x32x16_bf16 v[160:175], a[28:31], v[140:143], v[160:175]
    ds_read_b64_tr_b16 a[12:13], v218 offset:6144
    ds_read_b64_tr_b16 a[14:15], v218 offset:6656
    buffer_load_dwordx4 v221, s[20:23], s46 offen offset:1024  lds
    v_mul_f32 v202, v186, v202
    v_mul_f32 v203, v187, v203
    v_mul_f32 v204, v188, v204
    s_waitcnt lgkmcnt(8)
    v_mfma_f32_32x32x16_bf16 v[160:175], a[32:35], v[144:147], v[160:175]
    ds_read_b64_tr_b16 a[16:17], v218 offset:8192
    ds_read_b64_tr_b16 a[18:19], v218 offset:8704
    v_mul_f32 v205, v189, v205
    v_mul_f32 v206, v190, v206
    v_mul_f32 v207, v191, v207
    v_exp_f32 v200, v200
    v_mfma_f32_32x32x16_bf16 v[160:175], a[36:39], v[148:151], v[160:175]
    ds_read_b64_tr_b16 a[20:21], v218 offset:10240
    ds_read_b64_tr_b16 a[22:23], v218 offset:10752
    buffer_load_dwordx4 a[108:111], v223, s[16:19], s50 offen offset:1024
    v_exp_f32 v201, v201
    v_exp_f32 v202, v202
    v_mfma_f32_32x32x16_bf16 v[160:175], a[40:43], v[152:155], v[160:175]
    ds_read_b64_tr_b16 a[24:25], v218 offset:12288
    ds_read_b64_tr_b16 a[26:27], v218 offset:12800
    buffer_load_dwordx4 v222, s[20:23], s46 offen offset:2048  lds
    v_exp_f32 v203, v203
    v_mfma_f32_32x32x16_bf16 v[160:175], a[44:47], v[156:159], v[160:175]
    ds_read_b64_tr_b16 a[28:29], v218 offset:14336
    ds_read_b64_tr_b16 a[30:31], v218 offset:14848
    s_mov_b32 s22, 0x2d1c000
    s_mov_b32 s20, s10
    s_mov_b32 s23, 0x00020000
    v_exp_f32 v204, v204
    v_exp_f32 v205, v205
    v_exp_f32 v206, v206
    v_exp_f32 v207, v207
    v_add_f32 v200, 1.0, v200
    v_add_f32 v201, 1.0, v201
    v_add_f32 v202, 1.0, v202
    v_add_f32 v203, 1.0, v203
    v_add_f32 v204, 1.0, v204
    v_add_f32 v205, 1.0, v205
    v_add_f32 v206, 1.0, v206
    v_add_f32 v207, 1.0, v207
    v_rcp_f32 v200, v200
    v_rcp_f32 v201, v201
    v_rcp_f32 v202, v202
    v_rcp_f32 v203, v203
    v_rcp_f32 v204, v204
    v_rcp_f32 v205, v205
    v_rcp_f32 v206, v206
    v_rcp_f32 v207, v207
    v_mul_f32 v200, v184, v200
    v_mul_f32 v201, v185, v201
    v_mul_f32 v202, v186, v202
    v_mul_f32 v203, v187, v203
    v_mul_f32 v204, v188, v204
    v_mul_f32 v205, v189, v205
    v_mul_f32 v206, v190, v206
    v_mul_f32 v207, v191, v207
    s_waitcnt lgkmcnt(15)
    v_mfma_f32_32x32x16_bf16 v[176:191], a[52:55], v[192:195], 0
    v_cvt_pk_bf16_f32 v212, v200, v201
    v_cvt_pk_bf16_f32 v213, v202, v203
    v_cvt_pk_bf16_f32 v214, v204, v205
    v_cvt_pk_bf16_f32 v215, v206, v207
    v_mul_f32 v200, v160, v160
    v_mul_f32 v201, v161, v161
    s_waitcnt lgkmcnt(8)
    v_mfma_f32_32x32x16_bf16 v[176:191], a[0:3], v[16:19], v[176:191]
    ds_read_b64_tr_b16 a[32:33], v218 offset:16384
    ds_read_b64_tr_b16 a[34:35], v218 offset:16896
    buffer_store_dwordx4 v[212:215], v223, s[24:27], s54 offen offset:1024
    v_mul_f32 v202, v162, v162
    v_mul_f32 v203, v163, v163
    v_mfma_f32_32x32x16_bf16 v[176:191], a[4:7], v[20:23], v[176:191]
    ds_read_b64_tr_b16 a[36:37], v218 offset:18432
    ds_read_b64_tr_b16 a[38:39], v218 offset:18944
    v_mul_f32 v204, v164, v164
    v_mul_f32 v205, v165, v165
    v_mul_f32 v206, v166, v166
    v_mul_f32 v207, v167, v167
    v_mfma_f32_32x32x16_bf16 v[176:191], a[8:11], v[24:27], v[176:191]
    ds_read_b64_tr_b16 a[40:41], v218 offset:20480
    ds_read_b64_tr_b16 a[42:43], v218 offset:20992
    v_fma_f32 v200, v200, v197, v196
    v_fma_f32 v201, v201, v197, v196
    v_fma_f32 v202, v202, v197, v196
    v_fma_f32 v203, v203, v197, v196
    v_mfma_f32_32x32x16_bf16 v[176:191], a[12:15], v[28:31], v[176:191]
    ds_read_b64_tr_b16 a[44:45], v218 offset:22528
    ds_read_b64_tr_b16 a[46:47], v218 offset:23040
    v_fma_f32 v204, v204, v197, v196
    v_fma_f32 v205, v205, v197, v196
    v_fma_f32 v206, v206, v197, v196
    s_waitcnt lgkmcnt(8)
    v_mfma_f32_32x32x16_bf16 v[176:191], a[16:19], v[32:35], v[176:191]
    ds_read_b64_tr_b16 a[0:1], v218 offset:24576
    ds_read_b64_tr_b16 a[2:3], v218 offset:25088
    v_fma_f32 v207, v207, v197, v196
    v_mul_f32 v200, v160, v200
    v_mul_f32 v201, v161, v201
    v_mul_f32 v202, v162, v202
    v_mfma_f32_32x32x16_bf16 v[176:191], a[20:23], v[36:39], v[176:191]
    ds_read_b64_tr_b16 a[4:5], v218 offset:26624
    ds_read_b64_tr_b16 a[6:7], v218 offset:27136
    s_add_u32 s50, s64, 12288
    s_waitcnt vmcnt(16)
    buffer_load_dwordx4 a[112:115], v223, s[16:19], s50 offen offset:0
    v_mul_f32 v203, v163, v203
    v_mul_f32 v204, v164, v204
    v_mfma_f32_32x32x16_bf16 v[176:191], a[24:27], v[40:43], v[176:191]
    ds_read_b64_tr_b16 a[8:9], v218 offset:28672
    ds_read_b64_tr_b16 a[10:11], v218 offset:29184
    v_mul_f32 v205, v165, v205
    v_mul_f32 v206, v166, v206
    v_mul_f32 v207, v167, v207
    v_mfma_f32_32x32x16_bf16 v[176:191], a[28:31], v[44:47], v[176:191]
    ds_read_b64_tr_b16 a[12:13], v218 offset:30720
    ds_read_b64_tr_b16 a[14:15], v218 offset:31232
    v_exp_f32 v200, v200
    v_exp_f32 v201, v201
    s_waitcnt lgkmcnt(8)
    v_mfma_f32_32x32x16_bf16 v[176:191], a[32:35], v[48:51], v[176:191]
    ds_read_b64_tr_b16 a[16:17], v218 offset:32768
    ds_read_b64_tr_b16 a[18:19], v218 offset:33280
    v_exp_f32 v202, v202
    v_exp_f32 v203, v203
    v_mfma_f32_32x32x16_bf16 v[176:191], a[36:39], v[52:55], v[176:191]
    ds_read_b64_tr_b16 a[20:21], v218 offset:34816
    ds_read_b64_tr_b16 a[22:23], v218 offset:35328
    v_exp_f32 v204, v204
    v_exp_f32 v205, v205
    v_mfma_f32_32x32x16_bf16 v[176:191], a[40:43], v[56:59], v[176:191]
    ds_read_b64_tr_b16 a[24:25], v219 offset:0
    ds_read_b64_tr_b16 a[26:27], v219 offset:512
    v_exp_f32 v206, v206
    v_exp_f32 v207, v207
    v_mfma_f32_32x32x16_bf16 v[176:191], a[44:47], v[60:63], v[176:191]
    ds_read_b64_tr_b16 a[28:29], v219 offset:2048
    ds_read_b64_tr_b16 a[30:31], v219 offset:2560
    v_add_f32 v200, 1.0, v200
    v_add_f32 v201, 1.0, v201
    v_add_f32 v202, 1.0, v202
    s_waitcnt lgkmcnt(8)
    v_mfma_f32_32x32x16_bf16 v[176:191], a[0:3], v[64:67], v[176:191]
    ds_read_b64_tr_b16 a[32:33], v219 offset:4096
    ds_read_b64_tr_b16 a[34:35], v219 offset:4608
    v_add_f32 v203, 1.0, v203
    v_add_f32 v204, 1.0, v204
    v_add_f32 v205, 1.0, v205
    v_add_f32 v206, 1.0, v206
    v_mfma_f32_32x32x16_bf16 v[176:191], a[4:7], v[68:71], v[176:191]
    ds_read_b64_tr_b16 a[36:37], v219 offset:6144
    ds_read_b64_tr_b16 a[38:39], v219 offset:6656
    v_add_f32 v207, 1.0, v207
    v_rcp_f32 v200, v200
    v_rcp_f32 v201, v201
    v_mfma_f32_32x32x16_bf16 v[176:191], a[8:11], v[72:75], v[176:191]
    ds_read_b64_tr_b16 a[40:41], v219 offset:8192
    ds_read_b64_tr_b16 a[42:43], v219 offset:8704
    v_rcp_f32 v202, v202
    v_mfma_f32_32x32x16_bf16 v[176:191], a[12:15], v[76:79], v[176:191]
    ds_read_b64_tr_b16 a[44:45], v219 offset:10240
    ds_read_b64_tr_b16 a[46:47], v219 offset:10752
    s_waitcnt lgkmcnt(8) vmcnt(13)
    s_barrier
    v_rcp_f32 v203, v203
    v_rcp_f32 v204, v204
    v_mfma_f32_32x32x16_bf16 v[176:191], a[16:19], v[80:83], v[176:191]
    ds_read_b64_tr_b16 a[0:1], v219 offset:12288
    ds_read_b64_tr_b16 a[2:3], v219 offset:12800
    s_add_u32 m0, s48, 0
    s_add_u32 s46, s70, 0
    buffer_load_dwordx4 v7, s[56:59], s46 offen offset:0  lds
    s_add_u32 s54, s64, 16384
    v_mfma_f32_32x32x16_bf16 v[176:191], a[20:23], v[84:87], v[176:191]
    ds_read_b64_tr_b16 a[4:5], v219 offset:14336
    ds_read_b64_tr_b16 a[6:7], v219 offset:14848
    v_rcp_f32 v205, v205
    v_rcp_f32 v206, v206
    v_mfma_f32_32x32x16_bf16 v[176:191], a[24:27], v[88:91], v[176:191]
    ds_read_b64_tr_b16 a[8:9], v219 offset:16384
    ds_read_b64_tr_b16 a[10:11], v219 offset:16896
    v_rcp_f32 v207, v207
    v_mul_f32 v200, v160, v200
    v_mfma_f32_32x32x16_bf16 v[176:191], a[28:31], v[92:95], v[176:191]
    ds_read_b64_tr_b16 a[12:13], v219 offset:18432
    ds_read_b64_tr_b16 a[14:15], v219 offset:18944
    buffer_load_dwordx4 v8, s[56:59], s46 offen offset:1024  lds
    v_mul_f32 v201, v161, v201
    v_mul_f32 v202, v162, v202
    v_mul_f32 v203, v163, v203
    s_waitcnt lgkmcnt(8)
    v_mfma_f32_32x32x16_bf16 v[176:191], a[32:35], v[96:99], v[176:191]
    ds_read_b64_tr_b16 a[16:17], v219 offset:20480
    ds_read_b64_tr_b16 a[18:19], v219 offset:20992
    v_mul_f32 v204, v164, v204
    v_mul_f32 v205, v165, v205
    v_mul_f32 v206, v166, v206
    v_mul_f32 v207, v167, v207
    v_mfma_f32_32x32x16_bf16 v[176:191], a[36:39], v[100:103], v[176:191]
    ds_read_b64_tr_b16 a[20:21], v219 offset:22528
    ds_read_b64_tr_b16 a[22:23], v219 offset:23040
    v_cvt_pk_bf16_f32 v208, v200, v201
    v_cvt_pk_bf16_f32 v209, v202, v203
    v_cvt_pk_bf16_f32 v210, v204, v205
    v_cvt_pk_bf16_f32 v211, v206, v207
    v_mfma_f32_32x32x16_bf16 v[176:191], a[40:43], v[104:107], v[176:191]
    ds_read_b64_tr_b16 a[24:25], v219 offset:24576
    ds_read_b64_tr_b16 a[26:27], v219 offset:25088
    buffer_store_dwordx4 v[208:211], v223, s[24:27], s54 offen offset:0
    buffer_load_dwordx4 v9, s[56:59], s46 offen offset:2048  lds
    v_mul_f32 v200, v168, v168
    v_mfma_f32_32x32x16_bf16 v[176:191], a[44:47], v[108:111], v[176:191]
    ds_read_b64_tr_b16 a[28:29], v219 offset:26624
    ds_read_b64_tr_b16 a[30:31], v219 offset:27136
    ds_read_b32 a48, v224 offset:1280
    v_mul_f32 v201, v169, v169
    v_mul_f32 v202, v170, v170
    v_mul_f32 v203, v171, v171
    s_waitcnt lgkmcnt(9)
    v_mfma_f32_32x32x16_bf16 v[176:191], a[0:3], v[112:115], v[176:191]
    ds_read_b64_tr_b16 a[32:33], v219 offset:28672
    ds_read_b64_tr_b16 a[34:35], v219 offset:29184
    v_mul_f32 v204, v172, v172
    v_mul_f32 v205, v173, v173
    v_mul_f32 v206, v174, v174
    v_mul_f32 v207, v175, v175
    v_mfma_f32_32x32x16_bf16 v[176:191], a[4:7], v[116:119], v[176:191]
    ds_read_b64_tr_b16 a[36:37], v219 offset:30720
    ds_read_b64_tr_b16 a[38:39], v219 offset:31232
    s_add_u32 m0, s48, 3072
    s_add_u32 s46, s70, 9216
    buffer_load_dwordx4 v7, s[56:59], s46 offen offset:0  lds
    v_fma_f32 v200, v200, v197, v196
    v_mfma_f32_32x32x16_bf16 v[176:191], a[8:11], v[120:123], v[176:191]
    ds_read_b64_tr_b16 a[40:41], v219 offset:32768
    ds_read_b64_tr_b16 a[42:43], v219 offset:33280
    v_fma_f32 v201, v201, v197, v196
    v_fma_f32 v202, v202, v197, v196
    v_fma_f32 v203, v203, v197, v196
    v_mfma_f32_32x32x16_bf16 v[176:191], a[12:15], v[124:127], v[176:191]
    ds_read_b64_tr_b16 a[44:45], v219 offset:34816
    ds_read_b64_tr_b16 a[46:47], v219 offset:35328
    v_fma_f32 v204, v204, v197, v196
    v_fma_f32 v205, v205, v197, v196
    v_fma_f32 v206, v206, v197, v196
    s_waitcnt lgkmcnt(9)
    v_mfma_f32_32x32x16_bf16 v[176:191], a[16:19], v[128:131], v[176:191]
    ds_read_b64_tr_b16 a[0:1], v225 offset:0
    ds_read_b64_tr_b16 a[2:3], v225 offset:512
    buffer_load_dwordx4 v8, s[56:59], s46 offen offset:1024  lds
    v_fma_f32 v207, v207, v197, v196
    v_mul_f32 v200, v168, v200
    v_mfma_f32_32x32x16_bf16 v[176:191], a[20:23], v[132:135], v[176:191]
    ds_read_b64_tr_b16 a[4:5], v225 offset:2048
    ds_read_b64_tr_b16 a[6:7], v225 offset:2560
    v_mul_f32 v201, v169, v201
    v_mul_f32 v202, v170, v202
    v_mul_f32 v203, v171, v203
    v_mul_f32 v204, v172, v204
    v_mfma_f32_32x32x16_bf16 v[176:191], a[24:27], v[136:139], v[176:191]
    ds_read_b64_tr_b16 a[8:9], v225 offset:4096
    ds_read_b64_tr_b16 a[10:11], v225 offset:4608
    v_mul_f32 v205, v173, v205
    v_mul_f32 v206, v174, v206
    v_mul_f32 v207, v175, v207
    v_mfma_f32_32x32x16_bf16 v[176:191], a[28:31], v[140:143], v[176:191]
    ds_read_b64_tr_b16 a[12:13], v225 offset:6144
    ds_read_b64_tr_b16 a[14:15], v225 offset:6656
    buffer_load_dwordx4 v9, s[56:59], s46 offen offset:2048  lds
    s_waitcnt lgkmcnt(8) vmcnt(9)
    s_barrier
    v_exp_f32 v200, v200
    v_mfma_f32_32x32x16_bf16 v[176:191], a[32:35], v[144:147], v[176:191]
    ds_read_b64_tr_b16 a[16:17], v225 offset:8192
    ds_read_b64_tr_b16 a[18:19], v225 offset:8704
    v_exp_f32 v201, v201
    v_exp_f32 v202, v202
    v_mfma_f32_32x32x16_bf16 v[176:191], a[36:39], v[148:151], v[176:191]
    ds_read_b64_tr_b16 a[20:21], v225 offset:10240
    ds_read_b64_tr_b16 a[22:23], v225 offset:10752
    buffer_load_dwordx4 a[116:119], v223, s[16:19], s50 offen offset:1024
    v_exp_f32 v203, v203
    v_exp_f32 v204, v204
    v_mfma_f32_32x32x16_bf16 v[176:191], a[40:43], v[152:155], v[176:191]
    ds_read_b64_tr_b16 a[24:25], v225 offset:12288
    ds_read_b64_tr_b16 a[26:27], v225 offset:12800
    v_exp_f32 v205, v205
    v_exp_f32 v206, v206
    v_mfma_f32_32x32x16_bf16 v[176:191], a[44:47], v[156:159], v[176:191]
    ds_read_b64_tr_b16 a[28:29], v225 offset:14336
    ds_read_b64_tr_b16 a[30:31], v225 offset:14848
    v_exp_f32 v207, v207
    v_add_f32 v200, 1.0, v200
    v_add_f32 v201, 1.0, v201
    v_add_f32 v202, 1.0, v202
    v_add_f32 v203, 1.0, v203
    v_add_f32 v204, 1.0, v204
    v_add_f32 v205, 1.0, v205
    v_add_f32 v206, 1.0, v206
    v_add_f32 v207, 1.0, v207
    v_rcp_f32 v200, v200
    v_rcp_f32 v201, v201
    v_rcp_f32 v202, v202
    v_rcp_f32 v203, v203
    v_rcp_f32 v204, v204
    v_rcp_f32 v205, v205
    v_rcp_f32 v206, v206
    v_rcp_f32 v207, v207
    v_mul_f32 v200, v168, v200
    v_mul_f32 v201, v169, v201
    v_mul_f32 v202, v170, v202
    v_mul_f32 v203, v171, v203
    v_mul_f32 v204, v172, v204
    v_mul_f32 v205, v173, v205
    v_mul_f32 v206, v174, v206
    v_mul_f32 v207, v175, v207
    s_waitcnt lgkmcnt(15)
    v_mfma_f32_32x32x16_bf16 v[160:175], a[48:51], v[192:195], 0
    v_cvt_pk_bf16_f32 v212, v200, v201
    v_cvt_pk_bf16_f32 v213, v202, v203
    v_cvt_pk_bf16_f32 v214, v204, v205
    v_cvt_pk_bf16_f32 v215, v206, v207
    v_mul_f32 v200, v176, v176
    v_mul_f32 v201, v177, v177
    s_waitcnt lgkmcnt(8)
    v_mfma_f32_32x32x16_bf16 v[160:175], a[0:3], v[16:19], v[160:175]
    ds_read_b64_tr_b16 a[32:33], v225 offset:16384
    ds_read_b64_tr_b16 a[34:35], v225 offset:16896
    buffer_store_dwordx4 v[212:215], v223, s[24:27], s54 offen offset:1024
    v_mul_f32 v202, v178, v178
    v_mul_f32 v203, v179, v179
    v_mul_f32 v204, v180, v180
    v_mfma_f32_32x32x16_bf16 v[160:175], a[4:7], v[20:23], v[160:175]
    ds_read_b64_tr_b16 a[36:37], v225 offset:18432
    ds_read_b64_tr_b16 a[38:39], v225 offset:18944
    v_mul_f32 v205, v181, v181
    v_mul_f32 v206, v182, v182
    v_mul_f32 v207, v183, v183
    v_mfma_f32_32x32x16_bf16 v[160:175], a[8:11], v[24:27], v[160:175]
    ds_read_b64_tr_b16 a[40:41], v225 offset:20480
    ds_read_b64_tr_b16 a[42:43], v225 offset:20992
    s_add_u32 m0, s48, 24576
    s_add_u32 s46, s70, 73728
    buffer_load_dwordx4 v7, s[56:59], s46 offen offset:0  lds
    v_fma_f32 v200, v200, v197, v196
    v_mfma_f32_32x32x16_bf16 v[160:175], a[12:15], v[28:31], v[160:175]
    ds_read_b64_tr_b16 a[44:45], v225 offset:22528
    ds_read_b64_tr_b16 a[46:47], v225 offset:23040
    v_fma_f32 v201, v201, v197, v196
    v_fma_f32 v202, v202, v197, v196
    v_fma_f32 v203, v203, v197, v196
    s_waitcnt lgkmcnt(8)
    v_mfma_f32_32x32x16_bf16 v[160:175], a[16:19], v[32:35], v[160:175]
    ds_read_b64_tr_b16 a[0:1], v225 offset:24576
    ds_read_b64_tr_b16 a[2:3], v225 offset:25088
    v_fma_f32 v204, v204, v197, v196
    v_fma_f32 v205, v205, v197, v196
    v_fma_f32 v206, v206, v197, v196
    v_fma_f32 v207, v207, v197, v196
    v_mfma_f32_32x32x16_bf16 v[160:175], a[20:23], v[36:39], v[160:175]
    ds_read_b64_tr_b16 a[4:5], v225 offset:26624
    ds_read_b64_tr_b16 a[6:7], v225 offset:27136
    s_add_u32 s50, s64, 14336
    s_waitcnt vmcnt(11)
    buffer_load_dwordx4 a[120:123], v223, s[16:19], s50 offen offset:0
    v_mul_f32 v200, v176, v200
    v_mul_f32 v201, v177, v201
    v_mfma_f32_32x32x16_bf16 v[160:175], a[24:27], v[40:43], v[160:175]
    ds_read_b64_tr_b16 a[8:9], v225 offset:28672
    ds_read_b64_tr_b16 a[10:11], v225 offset:29184
    buffer_load_dwordx4 v8, s[56:59], s46 offen offset:1024  lds
    v_mul_f32 v202, v178, v202
    v_mul_f32 v203, v179, v203
    v_mfma_f32_32x32x16_bf16 v[160:175], a[28:31], v[44:47], v[160:175]
    ds_read_b64_tr_b16 a[12:13], v225 offset:30720
    ds_read_b64_tr_b16 a[14:15], v225 offset:31232
    v_mul_f32 v204, v180, v204
    v_mul_f32 v205, v181, v205
    v_mul_f32 v206, v182, v206
    v_mul_f32 v207, v183, v207
    s_waitcnt lgkmcnt(8)
    v_mfma_f32_32x32x16_bf16 v[160:175], a[32:35], v[48:51], v[160:175]
    ds_read_b64_tr_b16 a[16:17], v225 offset:32768
    ds_read_b64_tr_b16 a[18:19], v225 offset:33280
    v_exp_f32 v200, v200
    v_exp_f32 v201, v201
    v_mfma_f32_32x32x16_bf16 v[160:175], a[36:39], v[52:55], v[160:175]
    ds_read_b64_tr_b16 a[20:21], v225 offset:34816
    ds_read_b64_tr_b16 a[22:23], v225 offset:35328
    v_exp_f32 v202, v202
    v_exp_f32 v203, v203
    v_mfma_f32_32x32x16_bf16 v[160:175], a[40:43], v[56:59], v[160:175]
    ds_read_b64_tr_b16 a[24:25], v226 offset:0
    ds_read_b64_tr_b16 a[26:27], v226 offset:512
    buffer_load_dwordx4 v9, s[56:59], s46 offen offset:2048  lds
    v_exp_f32 v204, v204
    v_mfma_f32_32x32x16_bf16 v[160:175], a[44:47], v[60:63], v[160:175]
    ds_read_b64_tr_b16 a[28:29], v226 offset:2048
    ds_read_b64_tr_b16 a[30:31], v226 offset:2560
    v_exp_f32 v205, v205
    v_exp_f32 v206, v206
    s_waitcnt lgkmcnt(8)
    v_mfma_f32_32x32x16_bf16 v[160:175], a[0:3], v[64:67], v[160:175]
    ds_read_b64_tr_b16 a[32:33], v226 offset:4096
    ds_read_b64_tr_b16 a[34:35], v226 offset:4608
    v_exp_f32 v207, v207
    v_add_f32 v200, 1.0, v200
    v_add_f32 v201, 1.0, v201
    v_mfma_f32_32x32x16_bf16 v[160:175], a[4:7], v[68:71], v[160:175]
    ds_read_b64_tr_b16 a[36:37], v226 offset:6144
    ds_read_b64_tr_b16 a[38:39], v226 offset:6656
    v_add_f32 v202, 1.0, v202
    v_add_f32 v203, 1.0, v203
    v_add_f32 v204, 1.0, v204
    v_add_f32 v205, 1.0, v205
    v_mfma_f32_32x32x16_bf16 v[160:175], a[8:11], v[72:75], v[160:175]
    ds_read_b64_tr_b16 a[40:41], v226 offset:8192
    ds_read_b64_tr_b16 a[42:43], v226 offset:8704
    s_add_u32 m0, s48, 27648
    s_add_u32 s46, s70, 82944
    buffer_load_dwordx4 v7, s[56:59], s46 offen offset:0  lds
    v_mfma_f32_32x32x16_bf16 v[160:175], a[12:15], v[76:79], v[160:175]
    ds_read_b64_tr_b16 a[44:45], v226 offset:10240
    ds_read_b64_tr_b16 a[46:47], v226 offset:10752
    s_add_u32 s54, s64, 18432
    v_add_f32 v206, 1.0, v206
    v_add_f32 v207, 1.0, v207
    v_rcp_f32 v200, v200
    s_waitcnt lgkmcnt(8)
    v_mfma_f32_32x32x16_bf16 v[160:175], a[16:19], v[80:83], v[160:175]
    ds_read_b64_tr_b16 a[0:1], v226 offset:12288
    ds_read_b64_tr_b16 a[2:3], v226 offset:12800
    v_rcp_f32 v201, v201
    v_rcp_f32 v202, v202
    v_mfma_f32_32x32x16_bf16 v[160:175], a[20:23], v[84:87], v[160:175]
    ds_read_b64_tr_b16 a[4:5], v226 offset:14336
    ds_read_b64_tr_b16 a[6:7], v226 offset:14848
    v_rcp_f32 v203, v203
    v_rcp_f32 v204, v204
    v_mfma_f32_32x32x16_bf16 v[160:175], a[24:27], v[88:91], v[160:175]
    ds_read_b64_tr_b16 a[8:9], v226 offset:16384
    ds_read_b64_tr_b16 a[10:11], v226 offset:16896
    buffer_load_dwordx4 v8, s[56:59], s46 offen offset:1024  lds
    v_rcp_f32 v205, v205
    v_mfma_f32_32x32x16_bf16 v[160:175], a[28:31], v[92:95], v[160:175]
    ds_read_b64_tr_b16 a[12:13], v226 offset:18432
    ds_read_b64_tr_b16 a[14:15], v226 offset:18944
    v_rcp_f32 v206, v206
    v_rcp_f32 v207, v207
    s_waitcnt lgkmcnt(8)
    v_mfma_f32_32x32x16_bf16 v[160:175], a[32:35], v[96:99], v[160:175]
    ds_read_b64_tr_b16 a[16:17], v226 offset:20480
    ds_read_b64_tr_b16 a[18:19], v226 offset:20992
    v_mul_f32 v200, v176, v200
    v_mul_f32 v201, v177, v201
    v_mul_f32 v202, v178, v202
    v_mul_f32 v203, v179, v203
    v_mfma_f32_32x32x16_bf16 v[160:175], a[36:39], v[100:103], v[160:175]
    ds_read_b64_tr_b16 a[20:21], v226 offset:22528
    ds_read_b64_tr_b16 a[22:23], v226 offset:23040
    v_mul_f32 v204, v180, v204
    v_mul_f32 v205, v181, v205
    v_mul_f32 v206, v182, v206
    v_mul_f32 v207, v183, v207
    v_mfma_f32_32x32x16_bf16 v[160:175], a[40:43], v[104:107], v[160:175]
    ds_read_b64_tr_b16 a[24:25], v226 offset:24576
    ds_read_b64_tr_b16 a[26:27], v226 offset:25088
    v_cvt_pk_bf16_f32 v208, v200, v201
    v_cvt_pk_bf16_f32 v209, v202, v203
    v_cvt_pk_bf16_f32 v210, v204, v205
    v_mfma_f32_32x32x16_bf16 v[160:175], a[44:47], v[108:111], v[160:175]
    ds_read_b64_tr_b16 a[28:29], v226 offset:26624
    ds_read_b64_tr_b16 a[30:31], v226 offset:27136
    ds_read_b32 a52, v224 offset:1408
    v_cvt_pk_bf16_f32 v211, v206, v207
    v_mul_f32 v200, v184, v184
    v_mul_f32 v201, v185, v185
    s_waitcnt lgkmcnt(9)
    v_mfma_f32_32x32x16_bf16 v[160:175], a[0:3], v[112:115], v[160:175]
    ds_read_b64_tr_b16 a[32:33], v226 offset:28672
    ds_read_b64_tr_b16 a[34:35], v226 offset:29184
    buffer_store_dwordx4 v[208:211], v223, s[24:27], s54 offen offset:0
    buffer_load_dwordx4 v9, s[56:59], s46 offen offset:2048  lds
    v_mul_f32 v202, v186, v186
    v_mul_f32 v203, v187, v187
    v_mfma_f32_32x32x16_bf16 v[160:175], a[4:7], v[116:119], v[160:175]
    ds_read_b64_tr_b16 a[36:37], v226 offset:30720
    ds_read_b64_tr_b16 a[38:39], v226 offset:31232
    v_mul_f32 v204, v188, v188
    v_mul_f32 v205, v189, v189
    v_mul_f32 v206, v190, v190
    v_mul_f32 v207, v191, v191
    v_mfma_f32_32x32x16_bf16 v[160:175], a[8:11], v[120:123], v[160:175]
    ds_read_b64_tr_b16 a[40:41], v226 offset:32768
    ds_read_b64_tr_b16 a[42:43], v226 offset:33280
    s_add_u32 m0, s48, 49152
    s_add_u32 s46, s70, 147456
    buffer_load_dwordx4 v7, s[56:59], s46 offen offset:0  lds
    v_mfma_f32_32x32x16_bf16 v[160:175], a[12:15], v[124:127], v[160:175]
    ds_read_b64_tr_b16 a[44:45], v226 offset:34816
    ds_read_b64_tr_b16 a[46:47], v226 offset:35328
    v_fma_f32 v200, v200, v197, v196
    v_fma_f32 v201, v201, v197, v196
    v_fma_f32 v202, v202, v197, v196
    s_waitcnt lgkmcnt(9)
    v_mfma_f32_32x32x16_bf16 v[160:175], a[16:19], v[128:131], v[160:175]
    ds_read_b64_tr_b16 a[0:1], v227 offset:0
    ds_read_b64_tr_b16 a[2:3], v227 offset:512
    v_fma_f32 v203, v203, v197, v196
    v_fma_f32 v204, v204, v197, v196
    v_fma_f32 v205, v205, v197, v196
    v_fma_f32 v206, v206, v197, v196
    v_mfma_f32_32x32x16_bf16 v[160:175], a[20:23], v[132:135], v[160:175]
    ds_read_b64_tr_b16 a[4:5], v227 offset:2048
    ds_read_b64_tr_b16 a[6:7], v227 offset:2560
    v_fma_f32 v207, v207, v197, v196
    v_mul_f32 v200, v184, v200
    v_mul_f32 v201, v185, v201
    v_mfma_f32_32x32x16_bf16 v[160:175], a[24:27], v[136:139], v[160:175]
    ds_read_b64_tr_b16 a[8:9], v227 offset:4096
    ds_read_b64_tr_b16 a[10:11], v227 offset:4608
    buffer_load_dwordx4 v8, s[56:59], s46 offen offset:1024  lds
    v_mul_f32 v202, v186, v202
    v_mul_f32 v203, v187, v203
    v_mfma_f32_32x32x16_bf16 v[160:175], a[28:31], v[140:143], v[160:175]
    ds_read_b64_tr_b16 a[12:13], v227 offset:6144
    ds_read_b64_tr_b16 a[14:15], v227 offset:6656
    v_mul_f32 v204, v188, v204
    v_mul_f32 v205, v189, v205
    v_mul_f32 v206, v190, v206
    v_mul_f32 v207, v191, v207
    s_waitcnt lgkmcnt(8)
    v_mfma_f32_32x32x16_bf16 v[160:175], a[32:35], v[144:147], v[160:175]
    ds_read_b64_tr_b16 a[16:17], v227 offset:8192
    ds_read_b64_tr_b16 a[18:19], v227 offset:8704
    v_exp_f32 v200, v200
    v_exp_f32 v201, v201
    v_mfma_f32_32x32x16_bf16 v[160:175], a[36:39], v[148:151], v[160:175]
    ds_read_b64_tr_b16 a[20:21], v227 offset:10240
    ds_read_b64_tr_b16 a[22:23], v227 offset:10752
    buffer_load_dwordx4 a[124:127], v223, s[16:19], s50 offen offset:1024
    v_exp_f32 v202, v202
    v_exp_f32 v203, v203
    v_mfma_f32_32x32x16_bf16 v[160:175], a[40:43], v[152:155], v[160:175]
    ds_read_b64_tr_b16 a[24:25], v227 offset:12288
    ds_read_b64_tr_b16 a[26:27], v227 offset:12800
    buffer_load_dwordx4 v9, s[56:59], s46 offen offset:2048  lds
    v_exp_f32 v204, v204
    v_mfma_f32_32x32x16_bf16 v[160:175], a[44:47], v[156:159], v[160:175]
    ds_read_b64_tr_b16 a[28:29], v227 offset:14336
    ds_read_b64_tr_b16 a[30:31], v227 offset:14848
    v_exp_f32 v205, v205
    v_exp_f32 v206, v206
    v_exp_f32 v207, v207
    v_add_f32 v200, 1.0, v200
    v_add_f32 v201, 1.0, v201
    v_add_f32 v202, 1.0, v202
    v_add_f32 v203, 1.0, v203
    v_add_f32 v204, 1.0, v204
    v_add_f32 v205, 1.0, v205
    v_add_f32 v206, 1.0, v206
    v_add_f32 v207, 1.0, v207
    v_rcp_f32 v200, v200
    v_rcp_f32 v201, v201
    v_rcp_f32 v202, v202
    v_rcp_f32 v203, v203
    v_rcp_f32 v204, v204
    v_rcp_f32 v205, v205
    v_rcp_f32 v206, v206
    v_rcp_f32 v207, v207
    v_mul_f32 v200, v184, v200
    v_mul_f32 v201, v185, v201
    v_mul_f32 v202, v186, v202
    v_mul_f32 v203, v187, v203
    v_mul_f32 v204, v188, v204
    v_mul_f32 v205, v189, v205
    v_mul_f32 v206, v190, v206
    v_mul_f32 v207, v191, v207
    s_waitcnt lgkmcnt(15)
    v_mfma_f32_32x32x16_bf16 v[176:191], a[52:55], v[192:195], 0
    v_cvt_pk_bf16_f32 v212, v200, v201
    v_cvt_pk_bf16_f32 v213, v202, v203
    v_cvt_pk_bf16_f32 v214, v204, v205
    v_cvt_pk_bf16_f32 v215, v206, v207
    v_mul_f32 v200, v160, v160
    v_mul_f32 v201, v161, v161
    s_waitcnt lgkmcnt(8)
    v_mfma_f32_32x32x16_bf16 v[176:191], a[0:3], v[16:19], v[176:191]
    ds_read_b64_tr_b16 a[32:33], v227 offset:16384
    ds_read_b64_tr_b16 a[34:35], v227 offset:16896
    buffer_store_dwordx4 v[212:215], v223, s[24:27], s54 offen offset:1024
    v_mul_f32 v202, v162, v162
    v_mul_f32 v203, v163, v163
    v_mul_f32 v204, v164, v164
    v_mfma_f32_32x32x16_bf16 v[176:191], a[4:7], v[20:23], v[176:191]
    ds_read_b64_tr_b16 a[36:37], v227 offset:18432
    ds_read_b64_tr_b16 a[38:39], v227 offset:18944
    v_mul_f32 v205, v165, v165
    v_mul_f32 v206, v166, v166
    v_mul_f32 v207, v167, v167
    v_mfma_f32_32x32x16_bf16 v[176:191], a[8:11], v[24:27], v[176:191]
    ds_read_b64_tr_b16 a[40:41], v227 offset:20480
    ds_read_b64_tr_b16 a[42:43], v227 offset:20992
    s_add_u32 m0, s48, 52224
    s_add_u32 s46, s70, 156672
    buffer_load_dwordx4 v7, s[56:59], s46 offen offset:0  lds
    v_fma_f32 v200, v200, v197, v196
    v_mfma_f32_32x32x16_bf16 v[176:191], a[12:15], v[28:31], v[176:191]
    ds_read_b64_tr_b16 a[44:45], v227 offset:22528
    ds_read_b64_tr_b16 a[46:47], v227 offset:23040
    v_fma_f32 v201, v201, v197, v196
    v_fma_f32 v202, v202, v197, v196
    v_fma_f32 v203, v203, v197, v196
    s_waitcnt lgkmcnt(8)
    v_mfma_f32_32x32x16_bf16 v[176:191], a[16:19], v[32:35], v[176:191]
    ds_read_b64_tr_b16 a[0:1], v227 offset:24576
    ds_read_b64_tr_b16 a[2:3], v227 offset:25088
    v_fma_f32 v204, v204, v197, v196
    v_fma_f32 v205, v205, v197, v196
    v_fma_f32 v206, v206, v197, v196
    v_fma_f32 v207, v207, v197, v196
    v_mfma_f32_32x32x16_bf16 v[176:191], a[20:23], v[36:39], v[176:191]
    ds_read_b64_tr_b16 a[4:5], v227 offset:26624
    ds_read_b64_tr_b16 a[6:7], v227 offset:27136
    s_add_u32 s50, s64, 16384
    s_waitcnt vmcnt(14)
    buffer_load_dwordx4 a[128:131], v223, s[16:19], s50 offen offset:0
    s_add_u32 s54, s64, 20480
    v_mul_f32 v200, v160, v200
    v_mfma_f32_32x32x16_bf16 v[176:191], a[24:27], v[40:43], v[176:191]
    ds_read_b64_tr_b16 a[8:9], v227 offset:28672
    ds_read_b64_tr_b16 a[10:11], v227 offset:29184
    buffer_load_dwordx4 v8, s[56:59], s46 offen offset:1024  lds
    v_mul_f32 v201, v161, v201
    v_mul_f32 v202, v162, v202
    v_mfma_f32_32x32x16_bf16 v[176:191], a[28:31], v[44:47], v[176:191]
    ds_read_b64_tr_b16 a[12:13], v227 offset:30720
    ds_read_b64_tr_b16 a[14:15], v227 offset:31232
    v_mul_f32 v203, v163, v203
    v_mul_f32 v204, v164, v204
    v_mul_f32 v205, v165, v205
    v_mul_f32 v206, v166, v206
    s_waitcnt lgkmcnt(8)
    v_mfma_f32_32x32x16_bf16 v[176:191], a[32:35], v[48:51], v[176:191]
    ds_read_b64_tr_b16 a[16:17], v227 offset:32768
    ds_read_b64_tr_b16 a[18:19], v227 offset:33280
    v_mul_f32 v207, v167, v207
    v_exp_f32 v200, v200
    v_exp_f32 v201, v201
    v_mfma_f32_32x32x16_bf16 v[176:191], a[36:39], v[52:55], v[176:191]
    ds_read_b64_tr_b16 a[20:21], v227 offset:34816
    ds_read_b64_tr_b16 a[22:23], v227 offset:35328
    v_exp_f32 v202, v202
    v_exp_f32 v203, v203
    v_mfma_f32_32x32x16_bf16 v[176:191], a[40:43], v[56:59], v[176:191]
    ds_read_b64_tr_b16 a[24:25], v228 offset:0
    ds_read_b64_tr_b16 a[26:27], v228 offset:512
    buffer_load_dwordx4 v9, s[56:59], s46 offen offset:2048  lds
    v_exp_f32 v204, v204
    v_mfma_f32_32x32x16_bf16 v[176:191], a[44:47], v[60:63], v[176:191]
    ds_read_b64_tr_b16 a[28:29], v228 offset:2048
    ds_read_b64_tr_b16 a[30:31], v228 offset:2560
    v_exp_f32 v205, v205
    v_exp_f32 v206, v206
    s_waitcnt lgkmcnt(8)
    v_mfma_f32_32x32x16_bf16 v[176:191], a[0:3], v[64:67], v[176:191]
    ds_read_b64_tr_b16 a[32:33], v228 offset:4096
    ds_read_b64_tr_b16 a[34:35], v228 offset:4608
    v_exp_f32 v207, v207
    v_add_f32 v200, 1.0, v200
    v_add_f32 v201, 1.0, v201
    v_mfma_f32_32x32x16_bf16 v[176:191], a[4:7], v[68:71], v[176:191]
    ds_read_b64_tr_b16 a[36:37], v228 offset:6144
    ds_read_b64_tr_b16 a[38:39], v228 offset:6656
    v_add_f32 v202, 1.0, v202
    v_add_f32 v203, 1.0, v203
    v_add_f32 v204, 1.0, v204
    v_add_f32 v205, 1.0, v205
    v_mfma_f32_32x32x16_bf16 v[176:191], a[8:11], v[72:75], v[176:191]
    ds_read_b64_tr_b16 a[40:41], v228 offset:8192
    ds_read_b64_tr_b16 a[42:43], v228 offset:8704
    buffer_load_dword v240, v10, s[24:27], s44 offen sc0 sc1
    v_add_f32 v206, 1.0, v206
    v_add_f32 v207, 1.0, v207
    v_mfma_f32_32x32x16_bf16 v[176:191], a[12:15], v[76:79], v[176:191]
    ds_read_b64_tr_b16 a[44:45], v228 offset:10240
    ds_read_b64_tr_b16 a[46:47], v228 offset:10752
    v_rcp_f32 v200, v200
    v_rcp_f32 v201, v201
    s_waitcnt lgkmcnt(8)
    v_mfma_f32_32x32x16_bf16 v[176:191], a[16:19], v[80:83], v[176:191]
    ds_read_b64_tr_b16 a[0:1], v228 offset:12288
    ds_read_b64_tr_b16 a[2:3], v228 offset:12800
    buffer_load_dword v241, v10, s[24:27], s45 offen sc0 sc1
    v_rcp_f32 v202, v202
    v_rcp_f32 v203, v203
    v_mfma_f32_32x32x16_bf16 v[176:191], a[20:23], v[84:87], v[176:191]
    ds_read_b64_tr_b16 a[4:5], v228 offset:14336
    ds_read_b64_tr_b16 a[6:7], v228 offset:14848
    v_rcp_f32 v204, v204
    v_rcp_f32 v205, v205
    v_mfma_f32_32x32x16_bf16 v[176:191], a[24:27], v[88:91], v[176:191]
    ds_read_b64_tr_b16 a[8:9], v228 offset:16384
    ds_read_b64_tr_b16 a[10:11], v228 offset:16896
    v_rcp_f32 v206, v206
    v_rcp_f32 v207, v207
    v_mfma_f32_32x32x16_bf16 v[176:191], a[28:31], v[92:95], v[176:191]
    ds_read_b64_tr_b16 a[12:13], v228 offset:18432
    ds_read_b64_tr_b16 a[14:15], v228 offset:18944
    v_mul_f32 v200, v160, v200
    v_mul_f32 v201, v161, v201
    v_mul_f32 v202, v162, v202
    v_mul_f32 v203, v163, v203
    s_waitcnt lgkmcnt(8)
    v_mfma_f32_32x32x16_bf16 v[176:191], a[32:35], v[96:99], v[176:191]
    ds_read_b64_tr_b16 a[16:17], v228 offset:20480
    ds_read_b64_tr_b16 a[18:19], v228 offset:20992
    v_mul_f32 v204, v164, v204
    v_mul_f32 v205, v165, v205
    v_mul_f32 v206, v166, v206
    v_mul_f32 v207, v167, v207
    v_mfma_f32_32x32x16_bf16 v[176:191], a[36:39], v[100:103], v[176:191]
    ds_read_b64_tr_b16 a[20:21], v228 offset:22528
    ds_read_b64_tr_b16 a[22:23], v228 offset:23040
    v_cvt_pk_bf16_f32 v208, v200, v201
    v_cvt_pk_bf16_f32 v209, v202, v203
    v_cvt_pk_bf16_f32 v210, v204, v205
    v_cvt_pk_bf16_f32 v211, v206, v207
    v_mfma_f32_32x32x16_bf16 v[176:191], a[40:43], v[104:107], v[176:191]
    ds_read_b64_tr_b16 a[24:25], v228 offset:24576
    ds_read_b64_tr_b16 a[26:27], v228 offset:25088
    buffer_store_dwordx4 v[208:211], v223, s[24:27], s54 offen offset:0
    v_mul_f32 v200, v168, v168
    v_mul_f32 v201, v169, v169
    v_mfma_f32_32x32x16_bf16 v[176:191], a[44:47], v[108:111], v[176:191]
    ds_read_b64_tr_b16 a[28:29], v228 offset:26624
    ds_read_b64_tr_b16 a[30:31], v228 offset:27136
    v_mul_f32 v202, v170, v170
    v_mul_f32 v203, v171, v171
    v_mul_f32 v204, v172, v172
    v_mul_f32 v205, v173, v173
    s_waitcnt lgkmcnt(8)
    v_mfma_f32_32x32x16_bf16 v[176:191], a[0:3], v[112:115], v[176:191]
    ds_read_b64_tr_b16 a[32:33], v228 offset:28672
    ds_read_b64_tr_b16 a[34:35], v228 offset:29184
    v_mul_f32 v206, v174, v174
    v_mul_f32 v207, v175, v175
    v_fma_f32 v200, v200, v197, v196
    v_fma_f32 v201, v201, v197, v196
    v_mfma_f32_32x32x16_bf16 v[176:191], a[4:7], v[116:119], v[176:191]
    ds_read_b64_tr_b16 a[36:37], v228 offset:30720
    ds_read_b64_tr_b16 a[38:39], v228 offset:31232
    v_fma_f32 v202, v202, v197, v196
    v_fma_f32 v203, v203, v197, v196
    v_fma_f32 v204, v204, v197, v196
    v_fma_f32 v205, v205, v197, v196
    v_mfma_f32_32x32x16_bf16 v[176:191], a[8:11], v[120:123], v[176:191]
    ds_read_b64_tr_b16 a[40:41], v228 offset:32768
    ds_read_b64_tr_b16 a[42:43], v228 offset:33280
    v_fma_f32 v206, v206, v197, v196
    v_fma_f32 v207, v207, v197, v196
    v_mul_f32 v200, v168, v200
    v_mfma_f32_32x32x16_bf16 v[176:191], a[12:15], v[124:127], v[176:191]
    ds_read_b64_tr_b16 a[44:45], v228 offset:34816
    ds_read_b64_tr_b16 a[46:47], v228 offset:35328
    v_mul_f32 v201, v169, v201
    v_mul_f32 v202, v170, v202
    v_mul_f32 v203, v171, v203
    v_mul_f32 v204, v172, v204
    s_waitcnt lgkmcnt(8)
    v_mfma_f32_32x32x16_bf16 v[176:191], a[16:19], v[128:131], v[176:191]
    v_mul_f32 v205, v173, v205
    v_mul_f32 v206, v174, v206
    v_mul_f32 v207, v175, v207
    v_exp_f32 v200, v200
    v_exp_f32 v201, v201
    v_mfma_f32_32x32x16_bf16 v[176:191], a[20:23], v[132:135], v[176:191]
    v_exp_f32 v202, v202
    v_exp_f32 v203, v203
    v_exp_f32 v204, v204
    v_mfma_f32_32x32x16_bf16 v[176:191], a[24:27], v[136:139], v[176:191]
    v_exp_f32 v205, v205
    v_exp_f32 v206, v206
    v_mfma_f32_32x32x16_bf16 v[176:191], a[28:31], v[140:143], v[176:191]
    s_waitcnt lgkmcnt(0) vmcnt(22)
    s_barrier
    v_exp_f32 v207, v207
    v_add_f32 v200, 1.0, v200
    v_add_f32 v201, 1.0, v201
    v_add_f32 v202, 1.0, v202
    v_mfma_f32_32x32x16_bf16 v[176:191], a[32:35], v[144:147], v[176:191]
    ds_read_b64_tr_b16 a[160:161], v1 offset:0
    ds_read_b64_tr_b16 a[162:163], v1 offset:1536
    ds_read_b64_tr_b16 a[164:165], v4 offset:64
    ds_read_b64_tr_b16 a[166:167], v4 offset:1600
    v_add_f32 v203, 1.0, v203
    v_add_f32 v204, 1.0, v204
    v_mfma_f32_32x32x16_bf16 v[176:191], a[36:39], v[148:151], v[176:191]
    ds_read_b64_tr_b16 a[168:169], v1 offset:128
    ds_read_b64_tr_b16 a[170:171], v1 offset:1664
    ds_read_b64_tr_b16 a[172:173], v4 offset:192
    ds_read_b64_tr_b16 a[174:175], v4 offset:1728
    buffer_load_dwordx4 a[132:135], v223, s[16:19], s50 offen offset:1024
    v_add_f32 v205, 1.0, v205
    v_mfma_f32_32x32x16_bf16 v[176:191], a[40:43], v[152:155], v[176:191]
    ds_read_b64_tr_b16 a[176:177], v1 offset:256
    ds_read_b64_tr_b16 a[178:179], v1 offset:1792
    ds_read_b64_tr_b16 a[180:181], v4 offset:320
    ds_read_b64_tr_b16 a[182:183], v4 offset:1856
    v_add_f32 v206, 1.0, v206
    v_add_f32 v207, 1.0, v207
    v_mfma_f32_32x32x16_bf16 v[176:191], a[44:47], v[156:159], v[176:191]
    ds_read_b64_tr_b16 a[184:185], v1 offset:6144
    ds_read_b64_tr_b16 a[186:187], v1 offset:7680
    ds_read_b64_tr_b16 a[188:189], v4 offset:6208
    ds_read_b64_tr_b16 a[190:191], v4 offset:7744
    ds_read_b32 a48, v224 offset:4096
    ds_read_b32 a52, v224 offset:4224
    v_rcp_f32 v200, v200
    v_rcp_f32 v201, v201
    v_rcp_f32 v202, v202
    v_rcp_f32 v203, v203
    v_rcp_f32 v204, v204
    v_rcp_f32 v205, v205
    v_rcp_f32 v206, v206
    v_rcp_f32 v207, v207
    v_mul_f32 v200, v168, v200
    v_mul_f32 v201, v169, v201
    v_mul_f32 v202, v170, v202
    v_mul_f32 v203, v171, v203
    v_mul_f32 v204, v172, v204
    v_mul_f32 v205, v173, v205
    v_mul_f32 v206, v174, v206
    v_mul_f32 v207, v175, v207
    s_waitcnt lgkmcnt(1)
    v_mfma_f32_32x32x16_bf16 v[16:31], a[48:51], v[192:195], 0
    ds_read_b32 a48, v224 offset:5376
    v_cvt_pk_bf16_f32 v212, v200, v201
    v_cvt_pk_bf16_f32 v213, v202, v203
    v_cvt_pk_bf16_f32 v214, v204, v205
    v_cvt_pk_bf16_f32 v215, v206, v207
    s_waitcnt lgkmcnt(1)
    v_mfma_f32_32x32x16_bf16 v[32:47], a[52:55], v[192:195], 0
    ds_read_b32 a52, v224 offset:5504
    buffer_store_dwordx4 v[212:215], v223, s[24:27], s54 offen offset:1024
    v_mul_f32 v200, v176, v176
    v_mul_f32 v201, v177, v177
    v_mul_f32 v202, v178, v178
    v_mul_f32 v203, v179, v179
    v_mul_f32 v204, v180, v180
    v_mul_f32 v205, v181, v181
    v_mul_f32 v206, v182, v182
    v_mul_f32 v207, v183, v183
    v_fma_f32 v200, v200, v197, v196
    v_fma_f32 v201, v201, v197, v196
    v_fma_f32 v202, v202, v197, v196
    v_fma_f32 v203, v203, v197, v196
    v_fma_f32 v204, v204, v197, v196
    v_fma_f32 v205, v205, v197, v196
    v_fma_f32 v206, v206, v197, v196
    v_fma_f32 v207, v207, v197, v196
    v_mul_f32 v200, v176, v200
    s_waitcnt lgkmcnt(1)
    v_mfma_f32_32x32x16_bf16 v[48:63], a[48:51], v[192:195], 0
    ds_read_b32 a48, v224 offset:6656
    v_mul_f32 v201, v177, v201
    v_mul_f32 v202, v178, v202
    v_mul_f32 v203, v179, v203
    v_mul_f32 v204, v180, v204
    s_waitcnt lgkmcnt(1)
    v_mfma_f32_32x32x16_bf16 v[64:79], a[52:55], v[192:195], 0
    ds_read_b32 a52, v224 offset:6784
    v_mul_f32 v205, v181, v205
    v_mul_f32 v206, v182, v206
    v_mul_f32 v207, v183, v207
    v_exp_f32 v200, v200
    v_exp_f32 v201, v201
    v_exp_f32 v202, v202
    v_exp_f32 v203, v203
    v_exp_f32 v204, v204
    v_exp_f32 v205, v205
    v_exp_f32 v206, v206
    v_exp_f32 v207, v207
    s_waitcnt lgkmcnt(1)
    v_mfma_f32_32x32x16_bf16 v[80:95], a[48:51], v[192:195], 0
    v_add_f32 v200, 1.0, v200
    v_add_f32 v201, 1.0, v201
    v_add_f32 v202, 1.0, v202
    v_add_f32 v203, 1.0, v203
    v_add_f32 v204, 1.0, v204
    s_waitcnt lgkmcnt(0)
    v_mfma_f32_32x32x16_bf16 v[96:111], a[52:55], v[192:195], 0
    v_add_f32 v205, 1.0, v205
    v_add_f32 v206, 1.0, v206
    v_add_f32 v207, 1.0, v207
    v_rcp_f32 v200, v200
    v_rcp_f32 v201, v201
    s_waitcnt lgkmcnt(14) vmcnt(63)
    v_mfma_f32_32x32x16_bf16 v[16:31], a[160:163], a[64:67], v[16:31]
    ds_read_b64_tr_b16 a[192:193], v1 offset:6272
    ds_read_b64_tr_b16 a[194:195], v1 offset:7808
    s_add_u32 m0, s48, 73728
    s_add_u32 s46, s70, 221184
    buffer_load_dwordx4 v7, s[56:59], s46 offen offset:0  lds
    v_rcp_f32 v202, v202
    v_mfma_f32_32x32x16_bf16 v[32:47], a[164:167], a[64:67], v[32:47]
    ds_read_b64_tr_b16 a[196:197], v4 offset:6336
    ds_read_b64_tr_b16 a[198:199], v4 offset:7872
    v_rcp_f32 v203, v203
    v_rcp_f32 v204, v204
    v_mfma_f32_32x32x16_bf16 v[48:63], a[168:171], a[64:67], v[48:63]
    ds_read_b64_tr_b16 a[200:201], v1 offset:6400
    ds_read_b64_tr_b16 a[202:203], v1 offset:7936
    buffer_load_dwordx4 v8, s[56:59], s46 offen offset:1024  lds
    v_rcp_f32 v205, v205
    v_rcp_f32 v206, v206
    v_mfma_f32_32x32x16_bf16 v[64:79], a[172:175], a[64:67], v[64:79]
    ds_read_b64_tr_b16 a[204:205], v4 offset:6464
    ds_read_b64_tr_b16 a[206:207], v4 offset:8000
    v_rcp_f32 v207, v207
    v_mul_f32 v200, v176, v200
    v_mul_f32 v201, v177, v201
    s_waitcnt lgkmcnt(14)
    v_mfma_f32_32x32x16_bf16 v[80:95], a[176:179], a[64:67], v[80:95]
    ds_read_b64_tr_b16 a[160:161], v1 offset:12288
    ds_read_b64_tr_b16 a[162:163], v1 offset:13824
    buffer_load_dwordx4 v9, s[56:59], s46 offen offset:2048  lds
    v_mul_f32 v202, v178, v202
    v_mul_f32 v203, v179, v203
    v_mul_f32 v204, v180, v204
    v_mfma_f32_32x32x16_bf16 v[96:111], a[180:183], a[64:67], v[96:111]
    ds_read_b64_tr_b16 a[164:165], v4 offset:12352
    ds_read_b64_tr_b16 a[166:167], v4 offset:13888
    v_mul_f32 v205, v181, v205
    v_mul_f32 v206, v182, v206
    v_mul_f32 v207, v183, v207
    v_cvt_pk_bf16_f32 v208, v200, v201
    s_waitcnt vmcnt(63)
    v_mfma_f32_32x32x16_bf16 v[16:31], a[184:187], a[68:71], v[16:31]
    ds_read_b64_tr_b16 a[168:169], v1 offset:12416
    ds_read_b64_tr_b16 a[170:171], v1 offset:13952
    v_cvt_pk_bf16_f32 v209, v202, v203
    v_cvt_pk_bf16_f32 v210, v204, v205
    v_mfma_f32_32x32x16_bf16 v[32:47], a[188:191], a[68:71], v[32:47]
    ds_read_b64_tr_b16 a[172:173], v4 offset:12480
    ds_read_b64_tr_b16 a[174:175], v4 offset:14016
    s_add_u32 m0, s48, 76800
    s_add_u32 s46, s70, 230400
    buffer_load_dwordx4 v7, s[56:59], s46 offen offset:0  lds
    s_add_u32 s50, s64, 18432
    s_waitcnt lgkmcnt(8)
    v_mfma_f32_32x32x16_bf16 v[48:63], a[192:195], a[68:71], v[48:63]
    ds_read_b64_tr_b16 a[176:177], v1 offset:12544
    ds_read_b64_tr_b16 a[178:179], v1 offset:14080
    s_waitcnt vmcnt(13)
    buffer_load_dwordx4 a[136:139], v223, s[16:19], s50 offen offset:0
    s_add_u32 s54, s64, 22528
    v_cvt_pk_bf16_f32 v211, v206, v207
    v_mul_f32 v200, v184, v184
    v_mfma_f32_32x32x16_bf16 v[64:79], a[196:199], a[68:71], v[64:79]
    ds_read_b64_tr_b16 a[180:181], v4 offset:12608
    ds_read_b64_tr_b16 a[182:183], v4 offset:14144
    buffer_load_dwordx4 v8, s[56:59], s46 offen offset:1024  lds
    v_mul_f32 v201, v185, v185
    v_mul_f32 v202, v186, v186
    v_mul_f32 v203, v187, v187
    v_mfma_f32_32x32x16_bf16 v[80:95], a[200:203], a[68:71], v[80:95]
    ds_read_b64_tr_b16 a[184:185], v1 offset:18432
    ds_read_b64_tr_b16 a[186:187], v1 offset:19968
    v_mul_f32 v204, v188, v188
    v_mul_f32 v205, v189, v189
    v_mul_f32 v206, v190, v190
    v_mfma_f32_32x32x16_bf16 v[96:111], a[204:207], a[68:71], v[96:111]
    ds_read_b64_tr_b16 a[188:189], v4 offset:18496
    ds_read_b64_tr_b16 a[190:191], v4 offset:20032
    buffer_load_dwordx4 v9, s[56:59], s46 offen offset:2048  lds
    buffer_load_dwordx4 a[140:143], v223, s[16:19], s50 offen offset:1024
    buffer_store_dwordx4 v[208:211], v223, s[24:27], s54 offen offset:0
    v_mul_f32 v207, v191, v191
    s_waitcnt lgkmcnt(8) vmcnt(63)
    v_mfma_f32_32x32x16_bf16 v[16:31], a[160:163], a[72:75], v[16:31]
    ds_read_b64_tr_b16 a[192:193], v1 offset:18560
    ds_read_b64_tr_b16 a[194:195], v1 offset:20096
    v_fma_f32 v200, v200, v197, v196
    v_fma_f32 v201, v201, v197, v196
    v_fma_f32 v202, v202, v197, v196
    v_fma_f32 v203, v203, v197, v196
    v_mfma_f32_32x32x16_bf16 v[32:47], a[164:167], a[72:75], v[32:47]
    ds_read_b64_tr_b16 a[196:197], v4 offset:18624
    ds_read_b64_tr_b16 a[198:199], v4 offset:20160
    v_fma_f32 v204, v204, v197, v196
    v_fma_f32 v205, v205, v197, v196
    v_fma_f32 v206, v206, v197, v196
    v_fma_f32 v207, v207, v197, v196
    v_mfma_f32_32x32x16_bf16 v[48:63], a[168:171], a[72:75], v[48:63]
    ds_read_b64_tr_b16 a[200:201], v1 offset:18688
    ds_read_b64_tr_b16 a[202:203], v1 offset:20224
    s_add_u32 m0, s48, 98304
    s_add_u32 s46, s70, 294912
    buffer_load_dwordx4 v7, s[56:59], s46 offen offset:0  lds
    v_mfma_f32_32x32x16_bf16 v[64:79], a[172:175], a[72:75], v[64:79]
    ds_read_b64_tr_b16 a[204:205], v4 offset:18752
    ds_read_b64_tr_b16 a[206:207], v4 offset:20288
    s_waitcnt lgkmcnt(8) vmcnt(24)
    s_barrier
    v_mul_f32 v200, v184, v200
    v_mul_f32 v201, v185, v201
    v_mfma_f32_32x32x16_bf16 v[80:95], a[176:179], a[72:75], v[80:95]
    buffer_load_dwordx4 v8, s[56:59], s46 offen offset:1024  lds
    ds_read_b64_tr_b16 a[160:161], v1 offset:24576
    ds_read_b64_tr_b16 a[162:163], v1 offset:26112
    v_mul_f32 v202, v186, v202
    v_mul_f32 v203, v187, v203
    v_mul_f32 v204, v188, v204
    v_mfma_f32_32x32x16_bf16 v[96:111], a[180:183], a[72:75], v[96:111]
    ds_read_b64_tr_b16 a[164:165], v4 offset:24640
    ds_read_b64_tr_b16 a[166:167], v4 offset:26176
    v_mul_f32 v205, v189, v205
    v_mul_f32 v206, v190, v206
    v_mul_f32 v207, v191, v207
    v_exp_f32 v200, v200
    s_waitcnt vmcnt(63)
    v_mfma_f32_32x32x16_bf16 v[16:31], a[184:187], a[76:79], v[16:31]
    buffer_load_dwordx4 v9, s[56:59], s46 offen offset:2048  lds
    ds_read_b64_tr_b16 a[168:169], v1 offset:24704
    ds_read_b64_tr_b16 a[170:171], v1 offset:26240
    v_exp_f32 v201, v201
    v_mfma_f32_32x32x16_bf16 v[32:47], a[188:191], a[76:79], v[32:47]
    ds_read_b64_tr_b16 a[172:173], v4 offset:24768
    ds_read_b64_tr_b16 a[174:175], v4 offset:26304
    v_exp_f32 v202, v202
    v_exp_f32 v203, v203
    s_waitcnt lgkmcnt(8)
    v_mfma_f32_32x32x16_bf16 v[48:63], a[192:195], a[76:79], v[48:63]
    ds_read_b64_tr_b16 a[176:177], v1 offset:24832
    ds_read_b64_tr_b16 a[178:179], v1 offset:26368
    v_exp_f32 v204, v204
    v_exp_f32 v205, v205
    v_mfma_f32_32x32x16_bf16 v[64:79], a[196:199], a[76:79], v[64:79]
    ds_read_b64_tr_b16 a[180:181], v4 offset:24896
    ds_read_b64_tr_b16 a[182:183], v4 offset:26432
    s_add_u32 m0, s48, 101376
    s_add_u32 s46, s70, 304128
    buffer_load_dwordx4 v7, s[56:59], s46 offen offset:0  lds
    v_mfma_f32_32x32x16_bf16 v[80:95], a[200:203], a[76:79], v[80:95]
    ds_read_b64_tr_b16 a[184:185], v1 offset:30720
    ds_read_b64_tr_b16 a[186:187], v1 offset:32256
    v_exp_f32 v206, v206
    v_exp_f32 v207, v207
    v_mfma_f32_32x32x16_bf16 v[96:111], a[204:207], a[76:79], v[96:111]
    buffer_load_dwordx4 v8, s[56:59], s46 offen offset:1024  lds
    ds_read_b64_tr_b16 a[188:189], v4 offset:30784
    ds_read_b64_tr_b16 a[190:191], v4 offset:32320
    v_add_f32 v200, 1.0, v200
    v_add_f32 v201, 1.0, v201
    s_waitcnt lgkmcnt(8) vmcnt(63)
    v_mfma_f32_32x32x16_bf16 v[16:31], a[160:163], a[80:83], v[16:31]
    ds_read_b64_tr_b16 a[192:193], v1 offset:30848
    ds_read_b64_tr_b16 a[194:195], v1 offset:32384
    v_add_f32 v202, 1.0, v202
    v_add_f32 v203, 1.0, v203
    v_add_f32 v204, 1.0, v204
    v_add_f32 v205, 1.0, v205
    v_mfma_f32_32x32x16_bf16 v[32:47], a[164:167], a[80:83], v[32:47]
    ds_read_b64_tr_b16 a[196:197], v4 offset:30912
    ds_read_b64_tr_b16 a[198:199], v4 offset:32448
    v_add_f32 v206, 1.0, v206
    v_add_f32 v207, 1.0, v207
    v_rcp_f32 v200, v200
    v_mfma_f32_32x32x16_bf16 v[48:63], a[168:171], a[80:83], v[48:63]
    ds_read_b64_tr_b16 a[200:201], v1 offset:30976
    ds_read_b64_tr_b16 a[202:203], v1 offset:32512
    v_rcp_f32 v201, v201
    v_rcp_f32 v202, v202
    v_mfma_f32_32x32x16_bf16 v[64:79], a[172:175], a[80:83], v[64:79]
    ds_read_b64_tr_b16 a[204:205], v4 offset:31040
    ds_read_b64_tr_b16 a[206:207], v4 offset:32576
    v_rcp_f32 v203, v203
    v_rcp_f32 v204, v204
    s_waitcnt lgkmcnt(8)
    v_mfma_f32_32x32x16_bf16 v[80:95], a[176:179], a[80:83], v[80:95]
    ds_read_b64_tr_b16 a[160:161], v1 offset:36864
    ds_read_b64_tr_b16 a[162:163], v1 offset:38400
    v_rcp_f32 v205, v205
    v_rcp_f32 v206, v206
    v_mfma_f32_32x32x16_bf16 v[96:111], a[180:183], a[80:83], v[96:111]
    ds_read_b64_tr_b16 a[164:165], v4 offset:36928
    ds_read_b64_tr_b16 a[166:167], v4 offset:38464
    v_rcp_f32 v207, v207
    v_mul_f32 v200, v184, v200
    v_mul_f32 v201, v185, v201
    s_waitcnt vmcnt(63)
    v_mfma_f32_32x32x16_bf16 v[16:31], a[184:187], a[84:87], v[16:31]
    ds_read_b64_tr_b16 a[168:169], v1 offset:36992
    ds_read_b64_tr_b16 a[170:171], v1 offset:38528
    v_mul_f32 v202, v186, v202
    v_mul_f32 v203, v187, v203
    v_mul_f32 v204, v188, v204
    v_mfma_f32_32x32x16_bf16 v[32:47], a[188:191], a[84:87], v[32:47]
    ds_read_b64_tr_b16 a[172:173], v4 offset:37056
    ds_read_b64_tr_b16 a[174:175], v4 offset:38592
    v_mul_f32 v205, v189, v205
    v_mul_f32 v206, v190, v206
    v_mul_f32 v207, v191, v207
    v_cvt_pk_bf16_f32 v212, v200, v201
    s_waitcnt lgkmcnt(8)
    v_mfma_f32_32x32x16_bf16 v[48:63], a[192:195], a[84:87], v[48:63]
    ds_read_b64_tr_b16 a[176:177], v1 offset:37120
    ds_read_b64_tr_b16 a[178:179], v1 offset:38656
    v_cvt_pk_bf16_f32 v213, v202, v203
    v_cvt_pk_bf16_f32 v214, v204, v205
    v_cvt_pk_bf16_f32 v215, v206, v207
    v_mov_b32 v115, s3
    v_mfma_f32_32x32x16_bf16 v[64:79], a[196:199], a[84:87], v[64:79]
    buffer_store_dwordx4 v[212:215], v223, s[24:27], s54 offen offset:1024
    ds_read_b64_tr_b16 a[180:181], v4 offset:37184
    ds_read_b64_tr_b16 a[182:183], v4 offset:38720
    buffer_load_dwordx4 v9, s[56:59], s46 offen offset:2048  lds
    v_mov_b32 v119, s3
    v_mov_b32 v123, s3
    v_mfma_f32_32x32x16_bf16 v[80:95], a[200:203], a[84:87], v[80:95]
    ds_read_b64_tr_b16 a[184:185], v1 offset:43008
    ds_read_b64_tr_b16 a[186:187], v1 offset:44544
    s_add_u32 m0, s48, 122880
    s_add_u32 s46, s70, 368640
    buffer_load_dwordx4 v7, s[56:59], s46 offen offset:0  lds
    buffer_load_dwordx4 v8, s[56:59], s46 offen offset:1024  lds
    v_mfma_f32_32x32x16_bf16 v[96:111], a[204:207], a[84:87], v[96:111]
    ds_read_b64_tr_b16 a[188:189], v4 offset:43072
    ds_read_b64_tr_b16 a[190:191], v4 offset:44608
    buffer_load_dwordx4 v9, s[56:59], s46 offen offset:2048  lds
    s_add_u32 m0, s48, 125952
    s_waitcnt lgkmcnt(8) vmcnt(63)
    v_mfma_f32_32x32x16_bf16 v[16:31], a[160:163], a[88:91], v[16:31]
    ds_read_b64_tr_b16 a[192:193], v1 offset:43136
    ds_read_b64_tr_b16 a[194:195], v1 offset:44672
    s_add_u32 s46, s70, 377856
    buffer_load_dwordx4 v7, s[56:59], s46 offen offset:0  lds
    s_add_u32 s50, s64, 20480
    s_waitcnt vmcnt(20)
    buffer_load_dwordx4 a[144:147], v223, s[16:19], s50 offen offset:0
    v_mfma_f32_32x32x16_bf16 v[32:47], a[164:167], a[88:91], v[32:47]
    ds_read_b64_tr_b16 a[196:197], v4 offset:43200
    ds_read_b64_tr_b16 a[198:199], v4 offset:44736
    buffer_load_dwordx4 v8, s[56:59], s46 offen offset:1024  lds
    v_mov_b32 v127, s3
    v_mov_b32 v131, s3
    v_mov_b32 v135, s3
    v_mfma_f32_32x32x16_bf16 v[48:63], a[168:171], a[88:91], v[48:63]
    ds_read_b64_tr_b16 a[200:201], v1 offset:43264
    ds_read_b64_tr_b16 a[202:203], v1 offset:44800
    v_mov_b32 v139, s3
    v_mov_b32 v143, s3
    v_mov_b32 v147, s3
    v_mfma_f32_32x32x16_bf16 v[64:79], a[172:175], a[88:91], v[64:79]
    ds_read_b64_tr_b16 a[204:205], v4 offset:43328
    ds_read_b64_tr_b16 a[206:207], v4 offset:44864
    buffer_load_dwordx4 v9, s[56:59], s46 offen offset:2048  lds
    buffer_load_dwordx4 a[148:151], v223, s[16:19], s50 offen offset:1024
    v_mov_b32 v151, s3
    v_mov_b32 v155, s3
    s_waitcnt lgkmcnt(8)
    v_mfma_f32_32x32x16_bf16 v[80:95], a[176:179], a[88:91], v[80:95]
    v_mov_b32 v159, s3
    v_mov_b32 v163, s3
    v_mov_b32 v167, s3
    v_mov_b32 v171, s3
    v_mov_b32 v175, s3
    v_mfma_f32_32x32x16_bf16 v[96:111], a[180:183], a[88:91], v[96:111]
    s_waitcnt vmcnt(63)
    v_mfma_f32_32x32x16_bf16 v[16:31], a[184:187], a[92:95], v[16:31]
    v_mfma_f32_32x32x16_bf16 v[32:47], a[188:191], a[92:95], v[32:47]
    s_waitcnt lgkmcnt(0)
    v_mfma_f32_32x32x16_bf16 v[48:63], a[192:195], a[92:95], v[48:63]
    v_mfma_f32_32x32x16_bf16 v[64:79], a[196:199], a[92:95], v[64:79]
    v_mfma_f32_32x32x16_bf16 v[80:95], a[200:203], a[92:95], v[80:95]
    v_mfma_f32_32x32x16_bf16 v[96:111], a[204:207], a[92:95], v[96:111]
    s_waitcnt vmcnt(9)
    s_barrier
    ds_read_b64_tr_b16 a[160:161], v2 offset:0
    ds_read_b64_tr_b16 a[162:163], v2 offset:1536
    ds_read_b64_tr_b16 a[164:165], v5 offset:64
    ds_read_b64_tr_b16 a[166:167], v5 offset:1600
    ds_read_b64_tr_b16 a[168:169], v2 offset:128
    ds_read_b64_tr_b16 a[170:171], v2 offset:1664
    ds_read_b64_tr_b16 a[172:173], v5 offset:192
    ds_read_b64_tr_b16 a[174:175], v5 offset:1728
    ds_read_b64_tr_b16 a[176:177], v2 offset:256
    ds_read_b64_tr_b16 a[178:179], v2 offset:1792
    ds_read_b64_tr_b16 a[180:181], v5 offset:320
    ds_read_b64_tr_b16 a[182:183], v5 offset:1856
    ds_read_b64_tr_b16 a[184:185], v2 offset:6144
    ds_read_b64_tr_b16 a[186:187], v2 offset:7680
    ds_read_b64_tr_b16 a[188:189], v5 offset:6208
    ds_read_b64_tr_b16 a[190:191], v5 offset:7744
    s_cmp_lg_u32 s32, 0
    s_cbranch_scc1 PUB_5
    v_readfirstlane_b32 s100, v240
    v_readfirstlane_b32 s101, v241
    s_nop 0
    s_xor_b32 s100, s100, s43
    s_xor_b32 s101, s101, s43
    s_or_b32 s100, s100, s101
    s_and_b32 s100, s100, 0xffffffcf
    s_cmp_eq_u32 s100, 0
    s_cbranch_scc1 WB_4
    buffer_wbl2 sc1
    s_waitcnt vmcnt(0)
WB_4:
    s_or_b32 s101, s3, s37
    s_or_b32 s101, s101, 32
    v_mov_b32 v242, s101
    buffer_store_dword v242, v10, s[24:27], s38 offen sc0 sc1
PUB_5:
    s_add_u32 m0, s48, 0
    s_add_u32 s46, s71, 368640
    buffer_load_dwordx4 v7, s[56:59], s46 offen offset:0  lds
    s_add_u32 s50, s64, 22528
    buffer_load_dwordx4 a[152:155], v223, s[16:19], s50 offen offset:0
    buffer_load_dwordx4 v8, s[56:59], s46 offen offset:1024  lds
    buffer_load_dwordx4 a[156:159], v223, s[16:19], s50 offen offset:1024
    s_mov_b32 s100, 0
    s_waitcnt lgkmcnt(8) vmcnt(63)
    v_mfma_f32_32x32x16_bf16 v[16:31], a[160:163], a[96:99], v[16:31]
    ds_read_b64_tr_b16 a[192:193], v2 offset:6272
    ds_read_b64_tr_b16 a[194:195], v2 offset:7808
    v_mfma_f32_32x32x16_bf16 v[32:47], a[164:167], a[96:99], v[32:47]
    ds_read_b64_tr_b16 a[196:197], v5 offset:6336
    ds_read_b64_tr_b16 a[198:199], v5 offset:7872
    v_mfma_f32_32x32x16_bf16 v[48:63], a[168:171], a[96:99], v[48:63]
    ds_read_b64_tr_b16 a[200:201], v2 offset:6400
    ds_read_b64_tr_b16 a[202:203], v2 offset:7936
    buffer_load_dwordx4 v9, s[56:59], s46 offen offset:2048  lds
    v_mfma_f32_32x32x16_bf16 v[64:79], a[172:175], a[96:99], v[64:79]
    ds_read_b64_tr_b16 a[204:205], v5 offset:6464
    ds_read_b64_tr_b16 a[206:207], v5 offset:8000
    s_waitcnt lgkmcnt(8)
    v_mfma_f32_32x32x16_bf16 v[80:95], a[176:179], a[96:99], v[80:95]
    ds_read_b64_tr_b16 a[160:161], v2 offset:12288
    ds_read_b64_tr_b16 a[162:163], v2 offset:13824
    v_mfma_f32_32x32x16_bf16 v[96:111], a[180:183], a[96:99], v[96:111]
    ds_read_b64_tr_b16 a[164:165], v5 offset:12352
    ds_read_b64_tr_b16 a[166:167], v5 offset:13888
    s_add_u32 m0, s48, 3072
    s_add_u32 s46, s71, 377856
    buffer_load_dwordx4 v7, s[56:59], s46 offen offset:0  lds
    s_waitcnt vmcnt(63)
    v_mfma_f32_32x32x16_bf16 v[16:31], a[184:187], a[100:103], v[16:31]
    ds_read_b64_tr_b16 a[168:169], v2 offset:12416
    ds_read_b64_tr_b16 a[170:171], v2 offset:13952
    v_mfma_f32_32x32x16_bf16 v[32:47], a[188:191], a[100:103], v[32:47]
    ds_read_b64_tr_b16 a[172:173], v5 offset:12480
    ds_read_b64_tr_b16 a[174:175], v5 offset:14016
    s_waitcnt lgkmcnt(8)
    v_mfma_f32_32x32x16_bf16 v[48:63], a[192:195], a[100:103], v[48:63]
    ds_read_b64_tr_b16 a[176:177], v2 offset:12544
    ds_read_b64_tr_b16 a[178:179], v2 offset:14080
    v_mfma_f32_32x32x16_bf16 v[64:79], a[196:199], a[100:103], v[64:79]
    ds_read_b64_tr_b16 a[180:181], v5 offset:12608
    ds_read_b64_tr_b16 a[182:183], v5 offset:14144
    buffer_load_dwordx4 v8, s[56:59], s46 offen offset:1024  lds
    v_mfma_f32_32x32x16_bf16 v[80:95], a[200:203], a[100:103], v[80:95]
    ds_read_b64_tr_b16 a[184:185], v2 offset:18432
    ds_read_b64_tr_b16 a[186:187], v2 offset:19968
    v_mfma_f32_32x32x16_bf16 v[96:111], a[204:207], a[100:103], v[96:111]
    ds_read_b64_tr_b16 a[188:189], v5 offset:18496
    ds_read_b64_tr_b16 a[190:191], v5 offset:20032
    s_waitcnt lgkmcnt(8) vmcnt(63)
    v_mfma_f32_32x32x16_bf16 v[16:31], a[160:163], a[104:107], v[16:31]
    ds_read_b64_tr_b16 a[192:193], v2 offset:18560
    ds_read_b64_tr_b16 a[194:195], v2 offset:20096
    v_mfma_f32_32x32x16_bf16 v[32:47], a[164:167], a[104:107], v[32:47]
    ds_read_b64_tr_b16 a[196:197], v5 offset:18624
    ds_read_b64_tr_b16 a[198:199], v5 offset:20160
    buffer_load_dwordx4 v9, s[56:59], s46 offen offset:2048  lds
    v_mfma_f32_32x32x16_bf16 v[48:63], a[168:171], a[104:107], v[48:63]
    ds_read_b64_tr_b16 a[200:201], v2 offset:18688
    ds_read_b64_tr_b16 a[202:203], v2 offset:20224
    v_mfma_f32_32x32x16_bf16 v[64:79], a[172:175], a[104:107], v[64:79]
    ds_read_b64_tr_b16 a[204:205], v5 offset:18752
    ds_read_b64_tr_b16 a[206:207], v5 offset:20288
    s_waitcnt lgkmcnt(8) vmcnt(25)
    s_barrier
    v_mfma_f32_32x32x16_bf16 v[80:95], a[176:179], a[104:107], v[80:95]
    ds_read_b64_tr_b16 a[160:161], v2 offset:24576
    ds_read_b64_tr_b16 a[162:163], v2 offset:26112
    v_mfma_f32_32x32x16_bf16 v[96:111], a[180:183], a[104:107], v[96:111]
    ds_read_b64_tr_b16 a[164:165], v5 offset:24640
    ds_read_b64_tr_b16 a[166:167], v5 offset:26176
    s_waitcnt vmcnt(63)
    v_mfma_f32_32x32x16_bf16 v[16:31], a[184:187], a[108:111], v[16:31]
    ds_read_b64_tr_b16 a[168:169], v2 offset:24704
    ds_read_b64_tr_b16 a[170:171], v2 offset:26240
    s_add_u32 m0, s48, 24576
    s_add_u32 s46, s71, 294912
    buffer_load_dwordx4 v7, s[56:59], s46 offen offset:0  lds
    v_mfma_f32_32x32x16_bf16 v[32:47], a[188:191], a[108:111], v[32:47]
    ds_read_b64_tr_b16 a[172:173], v5 offset:24768
    ds_read_b64_tr_b16 a[174:175], v5 offset:26304
    s_waitcnt lgkmcnt(8)
    v_mfma_f32_32x32x16_bf16 v[48:63], a[192:195], a[108:111], v[48:63]
    ds_read_b64_tr_b16 a[176:177], v2 offset:24832
    ds_read_b64_tr_b16 a[178:179], v2 offset:26368
    v_mfma_f32_32x32x16_bf16 v[64:79], a[196:199], a[108:111], v[64:79]
    ds_read_b64_tr_b16 a[180:181], v5 offset:24896
    ds_read_b64_tr_b16 a[182:183], v5 offset:26432
    v_mfma_f32_32x32x16_bf16 v[80:95], a[200:203], a[108:111], v[80:95]
    ds_read_b64_tr_b16 a[184:185], v2 offset:30720
    ds_read_b64_tr_b16 a[186:187], v2 offset:32256
    buffer_load_dwordx4 v8, s[56:59], s46 offen offset:1024  lds
    v_mfma_f32_32x32x16_bf16 v[96:111], a[204:207], a[108:111], v[96:111]
    ds_read_b64_tr_b16 a[188:189], v5 offset:30784
    ds_read_b64_tr_b16 a[190:191], v5 offset:32320
    s_waitcnt lgkmcnt(8) vmcnt(63)
    v_mfma_f32_32x32x16_bf16 v[16:31], a[160:163], a[112:115], v[16:31]
    ds_read_b64_tr_b16 a[192:193], v2 offset:30848
    ds_read_b64_tr_b16 a[194:195], v2 offset:32384
    v_mfma_f32_32x32x16_bf16 v[32:47], a[164:167], a[112:115], v[32:47]
    ds_read_b64_tr_b16 a[196:197], v5 offset:30912
    ds_read_b64_tr_b16 a[198:199], v5 offset:32448
    v_mfma_f32_32x32x16_bf16 v[48:63], a[168:171], a[112:115], v[48:63]
    ds_read_b64_tr_b16 a[200:201], v2 offset:30976
    ds_read_b64_tr_b16 a[202:203], v2 offset:32512
    buffer_load_dwordx4 v9, s[56:59], s46 offen offset:2048  lds
    v_mfma_f32_32x32x16_bf16 v[64:79], a[172:175], a[112:115], v[64:79]
    ds_read_b64_tr_b16 a[204:205], v5 offset:31040
    ds_read_b64_tr_b16 a[206:207], v5 offset:32576
    s_waitcnt lgkmcnt(8)
    v_mfma_f32_32x32x16_bf16 v[80:95], a[176:179], a[112:115], v[80:95]
    ds_read_b64_tr_b16 a[160:161], v2 offset:36864
    ds_read_b64_tr_b16 a[162:163], v2 offset:38400
    v_mfma_f32_32x32x16_bf16 v[96:111], a[180:183], a[112:115], v[96:111]
    ds_read_b64_tr_b16 a[164:165], v5 offset:36928
    ds_read_b64_tr_b16 a[166:167], v5 offset:38464
    s_add_u32 m0, s48, 27648
    s_add_u32 s46, s71, 304128
    buffer_load_dwordx4 v7, s[56:59], s46 offen offset:0  lds
    s_waitcnt vmcnt(59)
    v_mfma_f32_32x32x16_bf16 v[16:31], a[184:187], a[116:119], v[16:31]
    ds_read_b64_tr_b16 a[168:169], v2 offset:36992
    ds_read_b64_tr_b16 a[170:171], v2 offset:38528
    v_mfma_f32_32x32x16_bf16 v[32:47], a[188:191], a[116:119], v[32:47]
    ds_read_b64_tr_b16 a[172:173], v5 offset:37056
    ds_read_b64_tr_b16 a[174:175], v5 offset:38592
    s_waitcnt lgkmcnt(8)
    v_mfma_f32_32x32x16_bf16 v[48:63], a[192:195], a[116:119], v[48:63]
    ds_read_b64_tr_b16 a[176:177], v2 offset:37120
    ds_read_b64_tr_b16 a[178:179], v2 offset:38656
    v_mfma_f32_32x32x16_bf16 v[64:79], a[196:199], a[116:119], v[64:79]
    ds_read_b64_tr_b16 a[180:181], v5 offset:37184
    ds_read_b64_tr_b16 a[182:183], v5 offset:38720
    buffer_load_dwordx4 v8, s[56:59], s46 offen offset:1024  lds
    v_mfma_f32_32x32x16_bf16 v[80:95], a[200:203], a[116:119], v[80:95]
    ds_read_b64_tr_b16 a[184:185], v2 offset:43008
    ds_read_b64_tr_b16 a[186:187], v2 offset:44544
    v_mfma_f32_32x32x16_bf16 v[96:111], a[204:207], a[116:119], v[96:111]
    ds_read_b64_tr_b16 a[188:189], v5 offset:43072
    ds_read_b64_tr_b16 a[190:191], v5 offset:44608
    s_waitcnt lgkmcnt(8) vmcnt(57)
    v_mfma_f32_32x32x16_bf16 v[16:31], a[160:163], a[120:123], v[16:31]
    ds_read_b64_tr_b16 a[192:193], v2 offset:43136
    ds_read_b64_tr_b16 a[194:195], v2 offset:44672
    v_mfma_f32_32x32x16_bf16 v[32:47], a[164:167], a[120:123], v[32:47]
    ds_read_b64_tr_b16 a[196:197], v5 offset:43200
    ds_read_b64_tr_b16 a[198:199], v5 offset:44736
    buffer_load_dwordx4 v9, s[56:59], s46 offen offset:2048  lds
    v_mfma_f32_32x32x16_bf16 v[48:63], a[168:171], a[120:123], v[48:63]
    ds_read_b64_tr_b16 a[200:201], v2 offset:43264
    ds_read_b64_tr_b16 a[202:203], v2 offset:44800
    v_mfma_f32_32x32x16_bf16 v[64:79], a[172:175], a[120:123], v[64:79]
    ds_read_b64_tr_b16 a[204:205], v5 offset:43328
    ds_read_b64_tr_b16 a[206:207], v5 offset:44864
    s_waitcnt lgkmcnt(8) vmcnt(22)
    s_barrier
    v_mfma_f32_32x32x16_bf16 v[80:95], a[176:179], a[120:123], v[80:95]
    ds_read_b64_tr_b16 a[160:161], v3 offset:0
    ds_read_b64_tr_b16 a[162:163], v3 offset:1536
    v_mfma_f32_32x32x16_bf16 v[96:111], a[180:183], a[120:123], v[96:111]
    ds_read_b64_tr_b16 a[164:165], v6 offset:64
    ds_read_b64_tr_b16 a[166:167], v6 offset:1600
    s_waitcnt vmcnt(49)
    v_mfma_f32_32x32x16_bf16 v[16:31], a[184:187], a[124:127], v[16:31]
    ds_read_b64_tr_b16 a[168:169], v3 offset:128
    ds_read_b64_tr_b16 a[170:171], v3 offset:1664
    s_add_u32 m0, s48, 49152
    s_add_u32 s46, s71, 221184
    buffer_load_dwordx4 v7, s[56:59], s46 offen offset:0  lds
    v_mfma_f32_32x32x16_bf16 v[32:47], a[188:191], a[124:127], v[32:47]
    ds_read_b64_tr_b16 a[172:173], v6 offset:192
    ds_read_b64_tr_b16 a[174:175], v6 offset:1728
    s_waitcnt lgkmcnt(8)
    v_mfma_f32_32x32x16_bf16 v[48:63], a[192:195], a[124:127], v[48:63]
    ds_read_b64_tr_b16 a[176:177], v3 offset:256
    ds_read_b64_tr_b16 a[178:179], v3 offset:1792
    v_mfma_f32_32x32x16_bf16 v[64:79], a[196:199], a[124:127], v[64:79]
    ds_read_b64_tr_b16 a[180:181], v6 offset:320
    ds_read_b64_tr_b16 a[182:183], v6 offset:1856
    v_mfma_f32_32x32x16_bf16 v[80:95], a[200:203], a[124:127], v[80:95]
    ds_read_b64_tr_b16 a[184:185], v3 offset:6144
    ds_read_b64_tr_b16 a[186:187], v3 offset:7680
    buffer_load_dwordx4 v8, s[56:59], s46 offen offset:1024  lds
    v_mfma_f32_32x32x16_bf16 v[96:111], a[204:207], a[124:127], v[96:111]
    ds_read_b64_tr_b16 a[188:189], v6 offset:6208
    ds_read_b64_tr_b16 a[190:191], v6 offset:7744
    s_waitcnt lgkmcnt(8) vmcnt(47)
    v_mfma_f32_32x32x16_bf16 v[16:31], a[160:163], a[128:131], v[16:31]
    ds_read_b64_tr_b16 a[192:193], v3 offset:6272
    ds_read_b64_tr_b16 a[194:195], v3 offset:7808
    v_mfma_f32_32x32x16_bf16 v[32:47], a[164:167], a[128:131], v[32:47]
    ds_read_b64_tr_b16 a[196:197], v6 offset:6336
    ds_read_b64_tr_b16 a[198:199], v6 offset:7872
    v_mfma_f32_32x32x16_bf16 v[48:63], a[168:171], a[128:131], v[48:63]
    buffer_load_dwordx4 v9, s[56:59], s46 offen offset:2048  lds
    ds_read_b64_tr_b16 a[200:201], v3 offset:6400
    ds_read_b64_tr_b16 a[202:203], v3 offset:7936
    v_mfma_f32_32x32x16_bf16 v[64:79], a[172:175], a[128:131], v[64:79]
    ds_read_b64_tr_b16 a[204:205], v6 offset:6464
    ds_read_b64_tr_b16 a[206:207], v6 offset:8000
    s_waitcnt lgkmcnt(8)
    v_mfma_f32_32x32x16_bf16 v[80:95], a[176:179], a[128:131], v[80:95]
    ds_read_b64_tr_b16 a[160:161], v3 offset:12288
    ds_read_b64_tr_b16 a[162:163], v3 offset:13824
    v_mfma_f32_32x32x16_bf16 v[96:111], a[180:183], a[128:131], v[96:111]
    ds_read_b64_tr_b16 a[164:165], v6 offset:12352
    ds_read_b64_tr_b16 a[166:167], v6 offset:13888
    s_add_u32 m0, s48, 52224
    s_add_u32 s46, s71, 230400
    buffer_load_dwordx4 v7, s[56:59], s46 offen offset:0  lds
    s_waitcnt vmcnt(43)
    v_mfma_f32_32x32x16_bf16 v[16:31], a[184:187], a[132:135], v[16:31]
    ds_read_b64_tr_b16 a[168:169], v3 offset:12416
    ds_read_b64_tr_b16 a[170:171], v3 offset:13952
    v_mfma_f32_32x32x16_bf16 v[32:47], a[188:191], a[132:135], v[32:47]
    buffer_load_dword v11, v10, s[24:27], s44 offen sc0 sc1
    ds_read_b64_tr_b16 a[172:173], v6 offset:12480
    ds_read_b64_tr_b16 a[174:175], v6 offset:14016
    s_waitcnt lgkmcnt(8)
    v_mfma_f32_32x32x16_bf16 v[48:63], a[192:195], a[132:135], v[48:63]
    ds_read_b64_tr_b16 a[176:177], v3 offset:12544
    ds_read_b64_tr_b16 a[178:179], v3 offset:14080
    v_mfma_f32_32x32x16_bf16 v[64:79], a[196:199], a[132:135], v[64:79]
    ds_read_b64_tr_b16 a[180:181], v6 offset:12608
    ds_read_b64_tr_b16 a[182:183], v6 offset:14144
    buffer_load_dwordx4 v8, s[56:59], s46 offen offset:1024  lds
    v_mfma_f32_32x32x16_bf16 v[80:95], a[200:203], a[132:135], v[80:95]
    ds_read_b64_tr_b16 a[184:185], v3 offset:18432
    ds_read_b64_tr_b16 a[186:187], v3 offset:19968
    v_mfma_f32_32x32x16_bf16 v[96:111], a[204:207], a[132:135], v[96:111]
    ds_read_b64_tr_b16 a[188:189], v6 offset:18496
    ds_read_b64_tr_b16 a[190:191], v6 offset:20032
    s_waitcnt lgkmcnt(8) vmcnt(39)
    v_mfma_f32_32x32x16_bf16 v[16:31], a[160:163], a[136:139], v[16:31]
    ds_read_b64_tr_b16 a[192:193], v3 offset:18560
    ds_read_b64_tr_b16 a[194:195], v3 offset:20096
    v_mfma_f32_32x32x16_bf16 v[32:47], a[164:167], a[136:139], v[32:47]
    ds_read_b64_tr_b16 a[196:197], v6 offset:18624
    ds_read_b64_tr_b16 a[198:199], v6 offset:20160
    buffer_load_dwordx4 v9, s[56:59], s46 offen offset:2048  lds
    v_mfma_f32_32x32x16_bf16 v[48:63], a[168:171], a[136:139], v[48:63]
    ds_read_b64_tr_b16 a[200:201], v3 offset:18688
    ds_read_b64_tr_b16 a[202:203], v3 offset:20224
    v_mfma_f32_32x32x16_bf16 v[64:79], a[172:175], a[136:139], v[64:79]
    ds_read_b64_tr_b16 a[204:205], v6 offset:18752
    ds_read_b64_tr_b16 a[206:207], v6 offset:20288
    s_waitcnt lgkmcnt(8) vmcnt(22)
    s_barrier
    v_mfma_f32_32x32x16_bf16 v[80:95], a[176:179], a[136:139], v[80:95]
    ds_read_b64_tr_b16 a[160:161], v3 offset:24576
    ds_read_b64_tr_b16 a[162:163], v3 offset:26112
    v_mfma_f32_32x32x16_bf16 v[96:111], a[180:183], a[136:139], v[96:111]
    ds_read_b64_tr_b16 a[164:165], v6 offset:24640
    ds_read_b64_tr_b16 a[166:167], v6 offset:26176
    s_waitcnt vmcnt(37)
    v_mfma_f32_32x32x16_bf16 v[16:31], a[184:187], a[140:143], v[16:31]
    ds_read_b64_tr_b16 a[168:169], v3 offset:24704
    ds_read_b64_tr_b16 a[170:171], v3 offset:26240
    s_add_u32 m0, s48, 73728
    s_add_u32 s46, s71, 147456
    buffer_load_dwordx4 v7, s[56:59], s46 offen offset:0  lds
    v_mfma_f32_32x32x16_bf16 v[32:47], a[188:191], a[140:143], v[32:47]
    ds_read_b64_tr_b16 a[172:173], v6 offset:24768
    ds_read_b64_tr_b16 a[174:175], v6 offset:26304
    s_waitcnt lgkmcnt(8)
    v_mfma_f32_32x32x16_bf16 v[48:63], a[192:195], a[140:143], v[48:63]
    ds_read_b64_tr_b16 a[176:177], v3 offset:24832
    ds_read_b64_tr_b16 a[178:179], v3 offset:26368
    v_mfma_f32_32x32x16_bf16 v[64:79], a[196:199], a[140:143], v[64:79]
    ds_read_b64_tr_b16 a[180:181], v6 offset:24896
    ds_read_b64_tr_b16 a[182:183], v6 offset:26432
    v_mfma_f32_32x32x16_bf16 v[80:95], a[200:203], a[140:143], v[80:95]
    buffer_load_dwordx4 v8, s[56:59], s46 offen offset:1024  lds
    ds_read_b64_tr_b16 a[184:185], v3 offset:30720
    ds_read_b64_tr_b16 a[186:187], v3 offset:32256
    v_mfma_f32_32x32x16_bf16 v[96:111], a[204:207], a[140:143], v[96:111]
    ds_read_b64_tr_b16 a[188:189], v6 offset:30784
    ds_read_b64_tr_b16 a[190:191], v6 offset:32320
    s_waitcnt lgkmcnt(8) vmcnt(26)
    v_mfma_f32_32x32x16_bf16 v[16:31], a[160:163], a[144:147], v[16:31]
    ds_read_b64_tr_b16 a[192:193], v3 offset:30848
    ds_read_b64_tr_b16 a[194:195], v3 offset:32384
    v_mfma_f32_32x32x16_bf16 v[32:47], a[164:167], a[144:147], v[32:47]
    ds_read_b64_tr_b16 a[196:197], v6 offset:30912
    ds_read_b64_tr_b16 a[198:199], v6 offset:32448
    s_waitcnt vmcnt(4)
    v_readfirstlane_b32 s101, v11
    s_nop 1
    s_xor_b32 s101, s101, s43
    s_and_b32 s101, s101, 0xffffffef
    s_cmp_lg_u32 s101, 0
    s_cbranch_scc1 PC_6
PCR_7:
    v_mfma_f32_32x32x16_bf16 v[48:63], a[168:171], a[144:147], v[48:63]
    ds_read_b64_tr_b16 a[200:201], v3 offset:30976
    ds_read_b64_tr_b16 a[202:203], v3 offset:32512
    s_add_u32 s51, s65, 22528
    buffer_load_dwordx4 a[64:67], v223, s[16:19], s51 offen offset:1024
    buffer_load_dwordx4 v9, s[56:59], s46 offen offset:2048  lds
    v_mfma_f32_32x32x16_bf16 v[64:79], a[172:175], a[144:147], v[64:79]
    buffer_load_dwordx4 a[68:71], v223, s[16:19], s51 offen offset:0
    ds_read_b64_tr_b16 a[204:205], v6 offset:31040
    ds_read_b64_tr_b16 a[206:207], v6 offset:32576
    s_waitcnt lgkmcnt(8)
    v_mfma_f32_32x32x16_bf16 v[80:95], a[176:179], a[144:147], v[80:95]
    ds_read_b64_tr_b16 a[160:161], v3 offset:36864
    ds_read_b64_tr_b16 a[162:163], v3 offset:38400
    v_mfma_f32_32x32x16_bf16 v[96:111], a[180:183], a[144:147], v[96:111]
    ds_read_b64_tr_b16 a[164:165], v6 offset:36928
    ds_read_b64_tr_b16 a[166:167], v6 offset:38464
    s_add_u32 m0, s48, 76800
    s_add_u32 s46, s71, 156672
    buffer_load_dwordx4 v7, s[56:59], s46 offen offset:0  lds
    s_add_u32 s51, s65, 20480
    s_waitcnt vmcnt(27)
    v_mfma_f32_32x32x16_bf16 v[16:31], a[184:187], a[148:151], v[16:31]
    buffer_load_dwordx4 a[72:75], v223, s[16:19], s51 offen offset:1024
    ds_read_b64_tr_b16 a[168:169], v3 offset:36992
    ds_read_b64_tr_b16 a[170:171], v3 offset:38528
    v_mfma_f32_32x32x16_bf16 v[32:47], a[188:191], a[148:151], v[32:47]
    buffer_load_dwordx4 a[76:79], v223, s[16:19], s51 offen offset:0
    ds_read_b64_tr_b16 a[172:173], v6 offset:37056
    ds_read_b64_tr_b16 a[174:175], v6 offset:38592
    s_waitcnt lgkmcnt(8)
    v_mfma_f32_32x32x16_bf16 v[48:63], a[192:195], a[148:151], v[48:63]
    ds_read_b64_tr_b16 a[176:177], v3 offset:37120
    ds_read_b64_tr_b16 a[178:179], v3 offset:38656
    v_mfma_f32_32x32x16_bf16 v[64:79], a[196:199], a[148:151], v[64:79]
    buffer_load_dwordx4 v8, s[56:59], s46 offen offset:1024  lds
    ds_read_b64_tr_b16 a[180:181], v6 offset:37184
    ds_read_b64_tr_b16 a[182:183], v6 offset:38720
    s_add_u32 s51, s65, 18432
    buffer_load_dwordx4 a[80:83], v223, s[16:19], s51 offen offset:1024
    v_mfma_f32_32x32x16_bf16 v[80:95], a[200:203], a[148:151], v[80:95]
    ds_read_b64_tr_b16 a[184:185], v3 offset:43008
    ds_read_b64_tr_b16 a[186:187], v3 offset:44544
    v_mfma_f32_32x32x16_bf16 v[96:111], a[204:207], a[148:151], v[96:111]
    buffer_load_dwordx4 a[84:87], v223, s[16:19], s51 offen offset:0
    ds_read_b64_tr_b16 a[188:189], v6 offset:43072
    ds_read_b64_tr_b16 a[190:191], v6 offset:44608
    s_waitcnt lgkmcnt(8) vmcnt(30)
    v_mfma_f32_32x32x16_bf16 v[16:31], a[160:163], a[152:155], v[16:31]
    ds_read_b64_tr_b16 a[192:193], v3 offset:43136
    ds_read_b64_tr_b16 a[194:195], v3 offset:44672
    v_mfma_f32_32x32x16_bf16 v[32:47], a[164:167], a[152:155], v[32:47]
    buffer_load_dwordx4 v9, s[56:59], s46 offen offset:2048  lds
    ds_read_b64_tr_b16 a[196:197], v6 offset:43200
    ds_read_b64_tr_b16 a[198:199], v6 offset:44736
    s_add_u32 s51, s65, 16384
    buffer_load_dwordx4 a[88:91], v223, s[16:19], s51 offen offset:1024
    v_mfma_f32_32x32x16_bf16 v[48:63], a[168:171], a[152:155], v[48:63]
    ds_read_b64_tr_b16 a[200:201], v3 offset:43264
    ds_read_b64_tr_b16 a[202:203], v3 offset:44800
    v_mfma_f32_32x32x16_bf16 v[64:79], a[172:175], a[152:155], v[64:79]
    buffer_load_dwordx4 a[92:95], v223, s[16:19], s51 offen offset:0
    ds_read_b64_tr_b16 a[204:205], v6 offset:43328
    ds_read_b64_tr_b16 a[206:207], v6 offset:44864
    s_waitcnt lgkmcnt(8) vmcnt(27)
    s_barrier
    v_mfma_f32_32x32x16_bf16 v[80:95], a[176:179], a[152:155], v[80:95]
    ds_read_b64_tr_b16 a[160:161], v1 offset:18432
    ds_read_b64_tr_b16 a[162:163], v1 offset:19968
    v_mfma_f32_32x32x16_bf16 v[96:111], a[180:183], a[152:155], v[96:111]
    ds_read_b64_tr_b16 a[164:165], v4 offset:18496
    ds_read_b64_tr_b16 a[166:167], v4 offset:20032
    s_add_u32 s51, s65, 14336
    buffer_load_dwordx4 a[96:99], v223, s[16:19], s51 offen offset:1024
    s_waitcnt vmcnt(32)
    v_mfma_f32_32x32x16_bf16 v[16:31], a[184:187], a[156:159], v[16:31]
    ds_read_b64_tr_b16 a[168:169], v1 offset:18560
    ds_read_b64_tr_b16 a[170:171], v1 offset:20096
    s_add_u32 m0, s48, 98304
    s_add_u32 s46, s71, 73728
    buffer_load_dwordx4 v7, s[56:59], s46 offen offset:0  lds
    v_mfma_f32_32x32x16_bf16 v[32:47], a[188:191], a[156:159], v[32:47]
    buffer_load_dwordx4 a[100:103], v223, s[16:19], s51 offen offset:0
    ds_read_b64_tr_b16 a[172:173], v4 offset:18624
    ds_read_b64_tr_b16 a[174:175], v4 offset:20160
    s_waitcnt lgkmcnt(8)
    v_mfma_f32_32x32x16_bf16 v[48:63], a[192:195], a[156:159], v[48:63]
    ds_read_b64_tr_b16 a[176:177], v1 offset:18688
    ds_read_b64_tr_b16 a[178:179], v1 offset:20224
    v_mfma_f32_32x32x16_bf16 v[64:79], a[196:199], a[156:159], v[64:79]
    ds_read_b64_tr_b16 a[180:181], v4 offset:18752
    ds_read_b64_tr_b16 a[182:183], v4 offset:20288
    s_add_u32 s51, s65, 12288
    buffer_load_dwordx4 a[104:107], v223, s[16:19], s51 offen offset:1024
    v_mfma_f32_32x32x16_bf16 v[80:95], a[200:203], a[156:159], v[80:95]
    ds_read_b64_tr_b16 a[184:185], v1 offset:12288
    ds_read_b64_tr_b16 a[186:187], v1 offset:13824
    buffer_load_dwordx4 v8, s[56:59], s46 offen offset:1024  lds
    v_mfma_f32_32x32x16_bf16 v[96:111], a[204:207], a[156:159], v[96:111]
    ds_read_b64_tr_b16 a[188:189], v4 offset:12352
    ds_read_b64_tr_b16 a[190:191], v4 offset:13888
    buffer_load_dwordx4 a[108:111], v223, s[16:19], s51 offen offset:0
    s_waitcnt vmcnt(17) lgkmcnt(8)
    v_mfma_f32_32x32x16_bf16 v[16:31], a[160:163], a[64:67], v[16:31]
    ds_read_b64_tr_b16 a[192:193], v1 offset:12416
    ds_read_b64_tr_b16 a[194:195], v1 offset:13952
    v_mfma_f32_32x32x16_bf16 v[32:47], a[164:167], a[64:67], v[32:47]
    ds_read_b64_tr_b16 a[196:197], v4 offset:12480
    ds_read_b64_tr_b16 a[198:199], v4 offset:14016
    s_add_u32 s51, s65, 10240
    buffer_load_dwordx4 a[112:115], v223, s[16:19], s51 offen offset:1024
    v_mfma_f32_32x32x16_bf16 v[48:63], a[168:171], a[64:67], v[48:63]
    ds_read_b64_tr_b16 a[200:201], v1 offset:12544
    ds_read_b64_tr_b16 a[202:203], v1 offset:14080
    buffer_load_dwordx4 v9, s[56:59], s46 offen offset:2048  lds
    v_mfma_f32_32x32x16_bf16 v[64:79], a[172:175], a[64:67], v[64:79]
    ds_read_b64_tr_b16 a[204:205], v4 offset:12608
    ds_read_b64_tr_b16 a[206:207], v4 offset:14144
    buffer_load_dwordx4 a[116:119], v223, s[16:19], s51 offen offset:0
    s_waitcnt lgkmcnt(8)
    v_mfma_f32_32x32x16_bf16 v[80:95], a[176:179], a[64:67], v[80:95]
    ds_read_b64_tr_b16 a[160:161], v1 offset:6144
    ds_read_b64_tr_b16 a[162:163], v1 offset:7680
    v_mfma_f32_32x32x16_bf16 v[96:111], a[180:183], a[64:67], v[96:111]
    ds_read_b64_tr_b16 a[164:165], v4 offset:6208
    ds_read_b64_tr_b16 a[166:167], v4 offset:7744
    s_add_u32 m0, s48, 101376
    s_add_u32 s46, s71, 82944
    buffer_load_dwordx4 v7, s[56:59], s46 offen offset:0  lds
    s_add_u32 s51, s65, 8192
    s_waitcnt vmcnt(19)
    v_mfma_f32_32x32x16_bf16 v[16:31], a[184:187], a[68:71], v[16:31]
    ds_read_b64_tr_b16 a[168:169], v1 offset:6272
    ds_read_b64_tr_b16 a[170:171], v1 offset:7808
    buffer_load_dwordx4 a[120:123], v223, s[16:19], s51 offen offset:1024
    v_mfma_f32_32x32x16_bf16 v[32:47], a[188:191], a[68:71], v[32:47]
    ds_read_b64_tr_b16 a[172:173], v4 offset:6336
    ds_read_b64_tr_b16 a[174:175], v4 offset:7872
    buffer_load_dwordx4 a[124:127], v223, s[16:19], s51 offen offset:0
    s_waitcnt lgkmcnt(8)
    v_mfma_f32_32x32x16_bf16 v[48:63], a[192:195], a[68:71], v[48:63]
    ds_read_b64_tr_b16 a[176:177], v1 offset:6400
    ds_read_b64_tr_b16 a[178:179], v1 offset:7936
    v_mfma_f32_32x32x16_bf16 v[64:79], a[196:199], a[68:71], v[64:79]
    ds_read_b64_tr_b16 a[180:181], v4 offset:6464
    ds_read_b64_tr_b16 a[182:183], v4 offset:8000
    buffer_load_dwordx4 v8, s[56:59], s46 offen offset:1024  lds
    s_add_u32 s51, s65, 6144
    buffer_load_dwordx4 a[128:131], v223, s[16:19], s51 offen offset:1024
    v_mfma_f32_32x32x16_bf16 v[80:95], a[200:203], a[68:71], v[80:95]
    ds_read_b64_tr_b16 a[184:185], v1 offset:0
    ds_read_b64_tr_b16 a[186:187], v1 offset:1536
    buffer_load_dword v11, v10, s[24:27], s45 offen sc0 sc1
    v_mfma_f32_32x32x16_bf16 v[96:111], a[204:207], a[68:71], v[96:111]
    ds_read_b64_tr_b16 a[188:189], v4 offset:64
    ds_read_b64_tr_b16 a[190:191], v4 offset:1600
    buffer_load_dwordx4 a[132:135], v223, s[16:19], s51 offen offset:0
    s_waitcnt lgkmcnt(8) vmcnt(23)
    v_mfma_f32_32x32x16_bf16 v[16:31], a[160:163], a[72:75], v[16:31]
    ds_read_b64_tr_b16 a[192:193], v1 offset:128
    ds_read_b64_tr_b16 a[194:195], v1 offset:1664
    v_mfma_f32_32x32x16_bf16 v[32:47], a[164:167], a[72:75], v[32:47]
    ds_read_b64_tr_b16 a[196:197], v4 offset:192
    ds_read_b64_tr_b16 a[198:199], v4 offset:1728
    buffer_load_dwordx4 v9, s[56:59], s46 offen offset:2048  lds
    s_add_u32 s51, s65, 4096
    buffer_load_dwordx4 a[136:139], v223, s[16:19], s51 offen offset:1024
    v_mfma_f32_32x32x16_bf16 v[48:63], a[168:171], a[72:75], v[48:63]
    ds_read_b64_tr_b16 a[200:201], v1 offset:256
    ds_read_b64_tr_b16 a[202:203], v1 offset:1792
    v_mfma_f32_32x32x16_bf16 v[64:79], a[172:175], a[72:75], v[64:79]
    ds_read_b64_tr_b16 a[204:205], v4 offset:320
    ds_read_b64_tr_b16 a[206:207], v4 offset:1856
    buffer_load_dwordx4 a[140:143], v223, s[16:19], s51 offen offset:0
    s_waitcnt lgkmcnt(8) vmcnt(40)
    s_barrier
    v_mfma_f32_32x32x16_bf16 v[80:95], a[176:179], a[72:75], v[80:95]
    ds_read_b64_tr_b16 a[160:161], v1 offset:43008
    ds_read_b64_tr_b16 a[162:163], v1 offset:44544
    v_mfma_f32_32x32x16_bf16 v[96:111], a[180:183], a[72:75], v[96:111]
    ds_read_b64_tr_b16 a[164:165], v4 offset:43072
    ds_read_b64_tr_b16 a[166:167], v4 offset:44608
    s_add_u32 s51, s65, 2048
    buffer_load_dwordx4 a[144:147], v223, s[16:19], s51 offen offset:1024
    s_waitcnt vmcnt(26)
    v_mfma_f32_32x32x16_bf16 v[16:31], a[184:187], a[76:79], v[16:31]
    ds_read_b64_tr_b16 a[168:169], v1 offset:43136
    ds_read_b64_tr_b16 a[170:171], v1 offset:44672
    s_add_u32 m0, s48, 122880
    s_add_u32 s46, s71, 0
    buffer_load_dwordx4 v7, s[56:59], s46 offen offset:0  lds
    v_mfma_f32_32x32x16_bf16 v[32:47], a[188:191], a[76:79], v[32:47]
    ds_read_b64_tr_b16 a[172:173], v4 offset:43200
    ds_read_b64_tr_b16 a[174:175], v4 offset:44736
    buffer_load_dwordx4 a[148:151], v223, s[16:19], s51 offen offset:0
    s_waitcnt lgkmcnt(8)
    v_mfma_f32_32x32x16_bf16 v[48:63], a[192:195], a[76:79], v[48:63]
    ds_read_b64_tr_b16 a[176:177], v1 offset:43264
    ds_read_b64_tr_b16 a[178:179], v1 offset:44800
    v_mfma_f32_32x32x16_bf16 v[64:79], a[196:199], a[76:79], v[64:79]
    ds_read_b64_tr_b16 a[180:181], v4 offset:43328
    ds_read_b64_tr_b16 a[182:183], v4 offset:44864
    s_add_u32 s51, s65, 0
    buffer_load_dwordx4 a[152:155], v223, s[16:19], s51 offen offset:1024
    v_mfma_f32_32x32x16_bf16 v[80:95], a[200:203], a[76:79], v[80:95]
    ds_read_b64_tr_b16 a[184:185], v1 offset:36864
    ds_read_b64_tr_b16 a[186:187], v1 offset:38400
    buffer_load_dwordx4 v8, s[56:59], s46 offen offset:1024  lds
    v_mfma_f32_32x32x16_bf16 v[96:111], a[204:207], a[76:79], v[96:111]
    ds_read_b64_tr_b16 a[188:189], v4 offset:36928
    ds_read_b64_tr_b16 a[190:191], v4 offset:38464
    buffer_load_dwordx4 a[156:159], v223, s[16:19], s51 offen offset:0
    s_waitcnt lgkmcnt(8) vmcnt(29)
    v_mfma_f32_32x32x16_bf16 v[16:31], a[160:163], a[80:83], v[16:31]
    ds_read_b64_tr_b16 a[192:193], v1 offset:36992
    ds_read_b64_tr_b16 a[194:195], v1 offset:38528
    v_mfma_f32_32x32x16_bf16 v[32:47], a[164:167], a[80:83], v[32:47]
    ds_read_b64_tr_b16 a[196:197], v4 offset:37056
    ds_read_b64_tr_b16 a[198:199], v4 offset:38592
    v_mfma_f32_32x32x16_bf16 v[48:63], a[168:171], a[80:83], v[48:63]
    ds_read_b64_tr_b16 a[200:201], v1 offset:37120
    ds_read_b64_tr_b16 a[202:203], v1 offset:38656
    buffer_load_dwordx4 v9, s[56:59], s46 offen offset:2048  lds
    v_mfma_f32_32x32x16_bf16 v[64:79], a[172:175], a[80:83], v[64:79]
    ds_read_b64_tr_b16 a[204:205], v4 offset:37184
    ds_read_b64_tr_b16 a[206:207], v4 offset:38720
    s_waitcnt lgkmcnt(8)
    v_mfma_f32_32x32x16_bf16 v[80:95], a[176:179], a[80:83], v[80:95]
    ds_read_b64_tr_b16 a[160:161], v1 offset:30720
    ds_read_b64_tr_b16 a[162:163], v1 offset:32256
    v_mfma_f32_32x32x16_bf16 v[96:111], a[180:183], a[80:83], v[96:111]
    ds_read_b64_tr_b16 a[164:165], v4 offset:30784
    ds_read_b64_tr_b16 a[166:167], v4 offset:32320
    s_waitcnt vmcnt(11)
    v_readfirstlane_b32 s101, v11
    s_nop 1
    s_xor_b32 s101, s101, s43
    s_and_b32 s101, s101, 0xffffffef
    s_cmp_lg_u32 s101, 0
    s_cbranch_scc1 PC_8
PCR_9:
    s_waitcnt vmcnt(29)
    v_mfma_f32_32x32x16_bf16 v[16:31], a[184:187], a[84:87], v[16:31]
    ds_read_b64_tr_b16 a[168:169], v1 offset:30848
    ds_read_b64_tr_b16 a[170:171], v1 offset:32384
    s_add_u32 s52, s66, 22528
    buffer_load_dwordx4 a[0:3], v223, s[16:19], s52 offen offset:1024
    s_add_u32 m0, s48, 125952
    v_mfma_f32_32x32x16_bf16 v[32:47], a[188:191], a[84:87], v[32:47]
    ds_read_b64_tr_b16 a[172:173], v4 offset:30912
    ds_read_b64_tr_b16 a[174:175], v4 offset:32448
    s_add_u32 s46, s71, 9216
    buffer_load_dwordx4 v7, s[56:59], s46 offen offset:0  lds
    s_waitcnt lgkmcnt(8)
    v_mfma_f32_32x32x16_bf16 v[48:63], a[192:195], a[84:87], v[48:63]
    ds_read_b64_tr_b16 a[176:177], v1 offset:30976
    ds_read_b64_tr_b16 a[178:179], v1 offset:32512
    v_mfma_f32_32x32x16_bf16 v[64:79], a[196:199], a[84:87], v[64:79]
    ds_read_b64_tr_b16 a[180:181], v4 offset:31040
    ds_read_b64_tr_b16 a[182:183], v4 offset:32576
    buffer_load_dwordx4 v8, s[56:59], s46 offen offset:1024  lds
    buffer_load_dwordx4 a[4:7], v223, s[16:19], s52 offen offset:0
    v_mfma_f32_32x32x16_bf16 v[80:95], a[200:203], a[84:87], v[80:95]
    ds_read_b64_tr_b16 a[184:185], v1 offset:24576
    ds_read_b64_tr_b16 a[186:187], v1 offset:26112
    v_mfma_f32_32x32x16_bf16 v[96:111], a[204:207], a[84:87], v[96:111]
    ds_read_b64_tr_b16 a[188:189], v4 offset:24640
    ds_read_b64_tr_b16 a[190:191], v4 offset:26176
    s_waitcnt lgkmcnt(8) vmcnt(31)
    v_mfma_f32_32x32x16_bf16 v[16:31], a[160:163], a[88:91], v[16:31]
    ds_read_b64_tr_b16 a[192:193], v1 offset:24704
    ds_read_b64_tr_b16 a[194:195], v1 offset:26240
    v_mfma_f32_32x32x16_bf16 v[32:47], a[164:167], a[88:91], v[32:47]
    ds_read_b64_tr_b16 a[196:197], v4 offset:24768
    ds_read_b64_tr_b16 a[198:199], v4 offset:26304
    buffer_load_dwordx4 v9, s[56:59], s46 offen offset:2048  lds
    v_mfma_f32_32x32x16_bf16 v[48:63], a[168:171], a[88:91], v[48:63]
    ds_read_b64_tr_b16 a[200:201], v1 offset:24832
    ds_read_b64_tr_b16 a[202:203], v1 offset:26368
    s_add_u32 s52, s66, 20480
    buffer_load_dwordx4 a[8:11], v223, s[16:19], s52 offen offset:1024
    v_mfma_f32_32x32x16_bf16 v[64:79], a[172:175], a[88:91], v[64:79]
    ds_read_b64_tr_b16 a[204:205], v4 offset:24896
    ds_read_b64_tr_b16 a[206:207], v4 offset:26432
    s_waitcnt lgkmcnt(8) vmcnt(46)
    s_barrier
    v_mfma_f32_32x32x16_bf16 v[80:95], a[176:179], a[88:91], v[80:95]
    ds_read_b64_tr_b16 a[160:161], v2 offset:18432
    ds_read_b64_tr_b16 a[162:163], v2 offset:19968
    v_mfma_f32_32x32x16_bf16 v[96:111], a[180:183], a[88:91], v[96:111]
    ds_read_b64_tr_b16 a[164:165], v5 offset:18496
    ds_read_b64_tr_b16 a[166:167], v5 offset:20032
    s_waitcnt vmcnt(32)
    v_mfma_f32_32x32x16_bf16 v[16:31], a[184:187], a[92:95], v[16:31]
    ds_read_b64_tr_b16 a[168:169], v2 offset:18560
    ds_read_b64_tr_b16 a[170:171], v2 offset:20096
    s_add_u32 m0, s48, 0
    s_add_u32 s46, s72, 368640
    buffer_load_dwordx4 v7, s[56:59], s46 offen offset:0  lds
    v_mfma_f32_32x32x16_bf16 v[32:47], a[188:191], a[92:95], v[32:47]
    ds_read_b64_tr_b16 a[172:173], v5 offset:18624
    ds_read_b64_tr_b16 a[174:175], v5 offset:20160
    buffer_load_dwordx4 a[12:15], v223, s[16:19], s52 offen offset:0
    s_waitcnt lgkmcnt(8)
    v_mfma_f32_32x32x16_bf16 v[48:63], a[192:195], a[92:95], v[48:63]
    ds_read_b64_tr_b16 a[176:177], v2 offset:18688
    ds_read_b64_tr_b16 a[178:179], v2 offset:20224
    v_mfma_f32_32x32x16_bf16 v[64:79], a[196:199], a[92:95], v[64:79]
    ds_read_b64_tr_b16 a[180:181], v5 offset:18752
    ds_read_b64_tr_b16 a[182:183], v5 offset:20288
    v_mfma_f32_32x32x16_bf16 v[80:95], a[200:203], a[92:95], v[80:95]
    ds_read_b64_tr_b16 a[184:185], v2 offset:12288
    ds_read_b64_tr_b16 a[186:187], v2 offset:13824
    buffer_load_dwordx4 v8, s[56:59], s46 offen offset:1024  lds
    v_mfma_f32_32x32x16_bf16 v[96:111], a[204:207], a[92:95], v[96:111]
    ds_read_b64_tr_b16 a[188:189], v5 offset:12352
    ds_read_b64_tr_b16 a[190:191], v5 offset:13888
    s_waitcnt lgkmcnt(8) vmcnt(34)
    v_mfma_f32_32x32x16_bf16 v[16:31], a[160:163], a[96:99], v[16:31]
    ds_read_b64_tr_b16 a[192:193], v2 offset:12416
    ds_read_b64_tr_b16 a[194:195], v2 offset:13952
    s_add_u32 s52, s66, 18432
    buffer_load_dwordx4 a[16:19], v223, s[16:19], s52 offen offset:1024
    v_mfma_f32_32x32x16_bf16 v[32:47], a[164:167], a[96:99], v[32:47]
    ds_read_b64_tr_b16 a[196:197], v5 offset:12480
    ds_read_b64_tr_b16 a[198:199], v5 offset:14016
    v_mfma_f32_32x32x16_bf16 v[48:63], a[168:171], a[96:99], v[48:63]
    ds_read_b64_tr_b16 a[200:201], v2 offset:12544
    ds_read_b64_tr_b16 a[202:203], v2 offset:14080
    buffer_load_dwordx4 v9, s[56:59], s46 offen offset:2048  lds
    v_mfma_f32_32x32x16_bf16 v[64:79], a[172:175], a[96:99], v[64:79]
    ds_read_b64_tr_b16 a[204:205], v5 offset:12608
    ds_read_b64_tr_b16 a[206:207], v5 offset:14144
    s_waitcnt lgkmcnt(8)
    v_mfma_f32_32x32x16_bf16 v[80:95], a[176:179], a[96:99], v[80:95]
    ds_read_b64_tr_b16 a[160:161], v2 offset:6144
    ds_read_b64_tr_b16 a[162:163], v2 offset:7680
    v_mfma_f32_32x32x16_bf16 v[96:111], a[180:183], a[96:99], v[96:111]
    ds_read_b64_tr_b16 a[164:165], v5 offset:6208
    ds_read_b64_tr_b16 a[166:167], v5 offset:7744
    s_add_u32 m0, s48, 3072
    s_add_u32 s46, s72, 377856
    buffer_load_dwordx4 v7, s[56:59], s46 offen offset:0  lds
    buffer_load_dwordx4 a[20:23], v223, s[16:19], s52 offen offset:0
    s_waitcnt vmcnt(36)
    v_mfma_f32_32x32x16_bf16 v[16:31], a[184:187], a[100:103], v[16:31]
    ds_read_b64_tr_b16 a[168:169], v2 offset:6272
    ds_read_b64_tr_b16 a[170:171], v2 offset:7808
    s_and_b32 s67, s35, 1
    s_lshl_b32 s41, s67, 1
    s_and_b32 s75, s32, 1
    v_mfma_f32_32x32x16_bf16 v[32:47], a[188:191], a[100:103], v[32:47]
    ds_read_b64_tr_b16 a[172:173], v5 offset:6336
    ds_read_b64_tr_b16 a[174:175], v5 offset:7872
    s_add_u32 s41, s41, s75
    s_lshl_b32 s60, s41, 9
    s_add_u32 s60, s60, 149504
    s_mul_i32 s75, s75, 12288
    s_waitcnt lgkmcnt(8)
    v_mfma_f32_32x32x16_bf16 v[48:63], a[192:195], a[100:103], v[48:63]
    ds_read_b64_tr_b16 a[176:177], v2 offset:6400
    ds_read_b64_tr_b16 a[178:179], v2 offset:7936
    v_lshl_add_u32 v245, v244, 4, s60
    s_lshl_b32 s60, s33, 2
    v_mfma_f32_32x32x16_bf16 v[64:79], a[196:199], a[100:103], v[64:79]
    ds_read_b128 v[224:227], v245
    ds_read_b64_tr_b16 a[180:181], v5 offset:6464
    ds_read_b64_tr_b16 a[182:183], v5 offset:8000
    s_add_u32 s41, s41, s60
    s_add_u32 s75, s75, 110592
    s_mul_i32 s63, s41, 36864
    v_mfma_f32_32x32x16_bf16 v[80:95], a[200:203], a[100:103], v[80:95]
    ds_read_b64_tr_b16 a[184:185], v2 offset:0
    ds_read_b64_tr_b16 a[186:187], v2 offset:1536
    s_mul_i32 s61, s41, 3
    v_add_u32 v232, s75, v223
    v_mfma_f32_32x32x16_bf16 v[96:111], a[204:207], a[100:103], v[96:111]
    ds_read_b64_tr_b16 a[188:189], v5 offset:64
    ds_read_b64_tr_b16 a[190:191], v5 offset:1600
    s_lshr_b32 s75, s35, 1
    s_lshr_b32 s60, s32, 1
    s_add_u32 s40, s75, 1
    s_cmp_eq_u32 s60, s67
    s_waitcnt lgkmcnt(9) vmcnt(35)
    v_mfma_f32_32x32x16_bf16 v[16:31], a[160:163], a[104:107], v[16:31]
    ds_read_b64_tr_b16 a[192:193], v2 offset:128
    ds_read_b64_tr_b16 a[194:195], v2 offset:1664
    s_cselect_b32 s40, s40, 0
    s_cselect_b32 s67, 0, 62208
    s_cselect_b32 s62, 0, 18432
    s_add_u32 s62, s62, s63
    v_mfma_f32_32x32x16_bf16 v[32:47], a[164:167], a[104:107], v[32:47]
    ds_read_b64_tr_b16 a[196:197], v5 offset:192
    ds_read_b64_tr_b16 a[198:199], v5 offset:1728
    s_add_u32 s62, s62, 25952256
    v_lshrrev_b32 v245, 5, v0
    v_lshl_add_u32 v247, v245, 2, v246
    v_mfma_f32_32x32x16_bf16 v[48:63], a[168:171], a[104:107], v[48:63]
    ds_read_b64_tr_b16 a[200:201], v2 offset:256
    ds_read_b64_tr_b16 a[202:203], v2 offset:1792
    v_mul_u32_u24 v247, 192, v247
    v_add3_u32 v228, v247, v12, s67
    s_mul_i32 s67, s34, 384
    v_mfma_f32_32x32x16_bf16 v[64:79], a[172:175], a[104:107], v[64:79]
    ds_read_b64_tr_b16 a[204:205], v5 offset:320
    ds_read_b64_tr_b16 a[206:207], v5 offset:1856
    s_waitcnt lgkmcnt(8) vmcnt(41)
    s_barrier
    s_add_u32 s63, s63, s67
    s_mul_i32 s67, s75, 192
    v_mfma_f32_32x32x16_bf16 v[80:95], a[176:179], a[104:107], v[80:95]
    ds_read_b64_tr_b16 a[160:161], v2 offset:43008
    ds_read_b64_tr_b16 a[162:163], v2 offset:44544
    s_add_u32 s63, s63, s67
    s_lshl_b32 s60, s35, 6
    s_add_u32 s60, s60, s39
    s_mul_i32 s60, s60, 3
    v_mfma_f32_32x32x16_bf16 v[96:111], a[180:183], a[104:107], v[96:111]
    ds_read_b64_tr_b16 a[164:165], v5 offset:43072
    ds_read_b64_tr_b16 a[166:167], v5 offset:44608
    s_add_u32 s60, s60, s34
    s_lshl_b32 s60, s60, 14
    s_add_u32 s60, s60, 28426240
    s_add_u32 s61, s61, s34
    s_waitcnt vmcnt(33)
    v_mfma_f32_32x32x16_bf16 v[16:31], a[184:187], a[108:111], v[16:31]
    ds_read_b64_tr_b16 a[168:169], v2 offset:43136
    ds_read_b64_tr_b16 a[170:171], v2 offset:44672
    s_lshl_b32 s61, s61, 1
    s_add_u32 s61, s61, s75
    s_lshl_b32 s61, s61, 13
    v_mfma_f32_32x32x16_bf16 v[32:47], a[188:191], a[108:111], v[32:47]
    ds_read_b64_tr_b16 a[172:173], v5 offset:43200
    ds_read_b64_tr_b16 a[174:175], v5 offset:44736
    s_add_u32 s61, s61, 28426240
    s_and_b32 s21, s11, 0xffff
    s_cmp_eq_u32 s40, 1
    s_cselect_b32 s22, 0, s22
    s_waitcnt lgkmcnt(8)
    v_mfma_f32_32x32x16_bf16 v[48:63], a[192:195], a[108:111], v[48:63]
    ds_read_b64_tr_b16 a[176:177], v2 offset:43264
    ds_read_b64_tr_b16 a[178:179], v2 offset:44800
    s_mul_i32 s67, s41, 36864
    s_add_u32 s67, s67, 25985520
    v_lshrrev_b32 v247, 1, v246
    v_mfma_f32_32x32x16_bf16 v[64:79], a[196:199], a[108:111], v[64:79]
    ds_read_b64_tr_b16 a[180:181], v5 offset:43328
    ds_read_b64_tr_b16 a[182:183], v5 offset:44864
    v_mul_u32_u24 v244, 1152, v244
    v_lshl_add_u32 v247, v245, 2, v247
    v_lshl_add_u32 v234, v245, 4, v244
    v_bfe_u32 v245, v0, 3, 2
    v_mfma_f32_32x32x16_bf16 v[80:95], a[200:203], a[108:111], v[80:95]
    ds_read_b64_tr_b16 a[184:185], v2 offset:36864
    ds_read_b64_tr_b16 a[186:187], v2 offset:38400
    v_lshlrev_b32 v245, 10, v245
    v_bfe_u32 v244, v0, 2, 1
    v_lshl_add_u32 v245, v244, 9, v245
    v_mfma_f32_32x32x16_bf16 v[96:111], a[204:207], a[108:111], v[96:111]
    ds_read_b64_tr_b16 a[188:189], v5 offset:36928
    ds_read_b64_tr_b16 a[190:191], v5 offset:38464
    v_and_b32 v244, 3, v0
    v_lshl_add_u32 v245, v244, 2, v245
    v_add_u32 v244, 1, v244
    s_waitcnt lgkmcnt(8) vmcnt(32)
    v_mfma_f32_32x32x16_bf16 v[16:31], a[160:163], a[112:115], v[16:31]
    ds_read_b64_tr_b16 a[192:193], v2 offset:36992
    ds_read_b64_tr_b16 a[194:195], v2 offset:38528
    v_add_u32 v245, s67, v245
    s_mov_b32 s67, 3145728
    v_xor_b32 v244, s35, v244
    v_and_b32 v244, 3, v244
    v_mfma_f32_32x32x16_bf16 v[32:47], a[164:167], a[112:115], v[32:47]
    ds_read_b64_tr_b16 a[196:197], v5 offset:37056
    ds_read_b64_tr_b16 a[198:199], v5 offset:38592
    v_mul_lo_u32 v244, v244, s67
    s_add_u32 s67, s61, 8188
    v_add_u32 v244, s67, v244
    s_lshr_b32 s67, s33, 1
    v_mfma_f32_32x32x16_bf16 v[48:63], a[168:171], a[112:115], v[48:63]
    ds_read_b64_tr_b16 a[200:201], v2 offset:37120
    ds_read_b64_tr_b16 a[202:203], v2 offset:38656
    s_lshl_b32 s67, s67, 12
    s_add_u32 s67, s67, 28393856
    s_add_u32 s52, s66, 16384
    v_mfma_f32_32x32x16_bf16 v[64:79], a[172:175], a[112:115], v[64:79]
    ds_read_b64_tr_b16 a[204:205], v5 offset:37184
    ds_read_b64_tr_b16 a[206:207], v5 offset:38720
    v_mul_u32_u24 v247, 18, v247
    v_and_b32 v246, 1, v246
    v_cndmask_b32 v233, v244, v245, vcc
    v_add3_u32 v247, v247, v246, 16
    s_waitcnt lgkmcnt(8)
    v_mfma_f32_32x32x16_bf16 v[80:95], a[176:179], a[112:115], v[80:95]
    ds_read_b64_tr_b16 a[160:161], v2 offset:30720
    ds_read_b64_tr_b16 a[162:163], v2 offset:32256
    v_and_b32 v245, 7, v0
    v_mul_u32_u24 v247, 192, v247
    v_lshlrev_b32 v245, 9, v245
    v_mfma_f32_32x32x16_bf16 v[96:111], a[180:183], a[112:115], v[96:111]
    ds_read_b64_tr_b16 a[164:165], v5 offset:30784
    ds_read_b64_tr_b16 a[166:167], v5 offset:32320
    v_add_u32 v230, v247, v12
    v_add_u32 v246, s67, v245
    v_add_u32 v231, 55296, v230
    buffer_load_dword v247, v246, s[24:27], 0 offen sc0 sc1
    s_waitcnt vmcnt(31)
    v_mfma_f32_32x32x16_bf16 v[16:31], a[184:187], a[116:119], v[16:31]
    ds_read_b64_tr_b16 a[168:169], v2 offset:30848
    ds_read_b64_tr_b16 a[170:171], v2 offset:32384
    buffer_load_dwordx4 v8, s[56:59], s46 offen offset:1024  lds
    buffer_load_dwordx4 a[24:27], v223, s[16:19], s52 offen offset:1024
    buffer_load_dwordx4 v9, s[56:59], s46 offen offset:2048  lds
    buffer_load_dwordx4 a[28:31], v223, s[16:19], s52 offen offset:0
    v_mfma_f32_32x32x16_bf16 v[32:47], a[188:191], a[116:119], v[32:47]
    ds_read_b64_tr_b16 a[172:173], v5 offset:30912
    ds_read_b64_tr_b16 a[174:175], v5 offset:32448
    s_add_u32 m0, s48, 24576
    s_add_u32 s46, s72, 294912
    buffer_load_dwordx4 v7, s[56:59], s46 offen offset:0  lds
    s_waitcnt lgkmcnt(8)
    v_mfma_f32_32x32x16_bf16 v[48:63], a[192:195], a[116:119], v[48:63]
    ds_read_b64_tr_b16 a[176:177], v2 offset:30976
    ds_read_b64_tr_b16 a[178:179], v2 offset:32512
    s_add_u32 s52, s66, 14336
    buffer_load_dwordx4 a[32:35], v223, s[16:19], s52 offen offset:1024
    buffer_load_dwordx4 v8, s[56:59], s46 offen offset:1024  lds
    buffer_load_dwordx4 a[36:39], v223, s[16:19], s52 offen offset:0
    v_mfma_f32_32x32x16_bf16 v[64:79], a[196:199], a[116:119], v[64:79]
    ds_read_b64_tr_b16 a[180:181], v5 offset:31040
    ds_read_b64_tr_b16 a[182:183], v5 offset:32576
    buffer_load_dwordx4 v9, s[56:59], s46 offen offset:2048  lds
    s_add_u32 m0, s48, 27648
    v_mfma_f32_32x32x16_bf16 v[80:95], a[200:203], a[116:119], v[80:95]
    ds_read_b64_tr_b16 a[184:185], v2 offset:24576
    ds_read_b64_tr_b16 a[186:187], v2 offset:26112
    s_add_u32 s46, s72, 304128
    buffer_load_dwordx4 v7, s[56:59], s46 offen offset:0  lds
    s_add_u32 s52, s66, 12288
    buffer_load_dwordx4 a[40:43], v223, s[16:19], s52 offen offset:1024
    v_mfma_f32_32x32x16_bf16 v[96:111], a[204:207], a[116:119], v[96:111]
    ds_read_b64_tr_b16 a[188:189], v5 offset:24640
    ds_read_b64_tr_b16 a[190:191], v5 offset:26176
    buffer_load_dwordx4 v8, s[56:59], s46 offen offset:1024  lds
    buffer_load_dwordx4 a[44:47], v223, s[16:19], s52 offen offset:0
    s_waitcnt lgkmcnt(8) vmcnt(42)
    v_mfma_f32_32x32x16_bf16 v[16:31], a[160:163], a[120:123], v[16:31]
    ds_read_b64_tr_b16 a[192:193], v2 offset:24704
    ds_read_b64_tr_b16 a[194:195], v2 offset:26240
    v_mfma_f32_32x32x16_bf16 v[32:47], a[164:167], a[120:123], v[32:47]
    ds_read_b64_tr_b16 a[196:197], v5 offset:24768
    ds_read_b64_tr_b16 a[198:199], v5 offset:26304
    buffer_load_dwordx4 v9, s[56:59], s46 offen offset:2048  lds
    v_mfma_f32_32x32x16_bf16 v[48:63], a[168:171], a[120:123], v[48:63]
    ds_read_b64_tr_b16 a[200:201], v2 offset:24832
    ds_read_b64_tr_b16 a[202:203], v2 offset:26368
    v_mfma_f32_32x32x16_bf16 v[64:79], a[172:175], a[120:123], v[64:79]
    ds_read_b64_tr_b16 a[204:205], v5 offset:24896
    ds_read_b64_tr_b16 a[206:207], v5 offset:26432
    s_waitcnt lgkmcnt(8) vmcnt(37)
    s_barrier
    v_mfma_f32_32x32x16_bf16 v[80:95], a[176:179], a[120:123], v[80:95]
    ds_read_b64_tr_b16 a[160:161], v3 offset:18432
    ds_read_b64_tr_b16 a[162:163], v3 offset:19968
    s_add_u32 s52, s66, 10240
    buffer_load_dwordx4 a[48:51], v223, s[16:19], s52 offen offset:1024
    v_mfma_f32_32x32x16_bf16 v[96:111], a[180:183], a[120:123], v[96:111]
    ds_read_b64_tr_b16 a[164:165], v6 offset:18496
    ds_read_b64_tr_b16 a[166:167], v6 offset:20032
    s_waitcnt vmcnt(43)
    v_mfma_f32_32x32x16_bf16 v[16:31], a[184:187], a[124:127], v[16:31]
    ds_read_b64_tr_b16 a[168:169], v3 offset:18560
    ds_read_b64_tr_b16 a[170:171], v3 offset:20096
    s_add_u32 m0, s48, 49152
    s_add_u32 s46, s72, 221184
    buffer_load_dwordx4 v7, s[56:59], s46 offen offset:0  lds
    v_mfma_f32_32x32x16_bf16 v[32:47], a[188:191], a[124:127], v[32:47]
    ds_read_b64_tr_b16 a[172:173], v6 offset:18624
    ds_read_b64_tr_b16 a[174:175], v6 offset:20160
    s_waitcnt lgkmcnt(8)
    v_mfma_f32_32x32x16_bf16 v[48:63], a[192:195], a[124:127], v[48:63]
    ds_read_b64_tr_b16 a[176:177], v3 offset:18688
    ds_read_b64_tr_b16 a[178:179], v3 offset:20224
    v_mfma_f32_32x32x16_bf16 v[64:79], a[196:199], a[124:127], v[64:79]
    ds_read_b64_tr_b16 a[180:181], v6 offset:18752
    ds_read_b64_tr_b16 a[182:183], v6 offset:20288
    buffer_load_dwordx4 a[52:55], v223, s[16:19], s52 offen offset:0
    v_mfma_f32_32x32x16_bf16 v[80:95], a[200:203], a[124:127], v[80:95]
    ds_read_b64_tr_b16 a[184:185], v3 offset:12288
    ds_read_b64_tr_b16 a[186:187], v3 offset:13824
    buffer_load_dwordx4 v8, s[56:59], s46 offen offset:1024  lds
    v_mfma_f32_32x32x16_bf16 v[96:111], a[204:207], a[124:127], v[96:111]
    ds_read_b64_tr_b16 a[188:189], v6 offset:12352
    ds_read_b64_tr_b16 a[190:191], v6 offset:13888
    s_waitcnt lgkmcnt(8) vmcnt(44)
    v_mfma_f32_32x32x16_bf16 v[16:31], a[160:163], a[128:131], v[16:31]
    ds_read_b64_tr_b16 a[192:193], v3 offset:12416
    ds_read_b64_tr_b16 a[194:195], v3 offset:13952
    v_mfma_f32_32x32x16_bf16 v[32:47], a[164:167], a[128:131], v[32:47]
    ds_read_b64_tr_b16 a[196:197], v6 offset:12480
    ds_read_b64_tr_b16 a[198:199], v6 offset:14016
    v_mfma_f32_32x32x16_bf16 v[48:63], a[168:171], a[128:131], v[48:63]
    ds_read_b64_tr_b16 a[200:201], v3 offset:12544
    ds_read_b64_tr_b16 a[202:203], v3 offset:14080
    buffer_load_dwordx4 v9, s[56:59], s46 offen offset:2048  lds
    s_add_u32 s52, s66, 8192
    buffer_load_dwordx4 a[56:59], v223, s[16:19], s52 offen offset:1024
    v_mfma_f32_32x32x16_bf16 v[64:79], a[172:175], a[128:131], v[64:79]
    ds_read_b64_tr_b16 a[204:205], v6 offset:12608
    ds_read_b64_tr_b16 a[206:207], v6 offset:14144
    s_waitcnt lgkmcnt(8)
    v_mfma_f32_32x32x16_bf16 v[80:95], a[176:179], a[128:131], v[80:95]
    ds_read_b64_tr_b16 a[160:161], v3 offset:6144
    ds_read_b64_tr_b16 a[162:163], v3 offset:7680
    v_mfma_f32_32x32x16_bf16 v[96:111], a[180:183], a[128:131], v[96:111]
    ds_read_b64_tr_b16 a[164:165], v6 offset:6208
    ds_read_b64_tr_b16 a[166:167], v6 offset:7744
    s_add_u32 m0, s48, 52224
    s_add_u32 s46, s72, 230400
    buffer_load_dwordx4 v7, s[56:59], s46 offen offset:0  lds
    s_waitcnt vmcnt(45)
    v_mfma_f32_32x32x16_bf16 v[16:31], a[184:187], a[132:135], v[16:31]
    ds_read_b64_tr_b16 a[168:169], v3 offset:6272
    ds_read_b64_tr_b16 a[170:171], v3 offset:7808
    v_mfma_f32_32x32x16_bf16 v[32:47], a[188:191], a[132:135], v[32:47]
    ds_read_b64_tr_b16 a[172:173], v6 offset:6336
    ds_read_b64_tr_b16 a[174:175], v6 offset:7872
    buffer_load_dwordx4 a[60:63], v223, s[16:19], s52 offen offset:0
    s_waitcnt lgkmcnt(8)
    v_mfma_f32_32x32x16_bf16 v[48:63], a[192:195], a[132:135], v[48:63]
    ds_read_b64_tr_b16 a[176:177], v3 offset:6400
    ds_read_b64_tr_b16 a[178:179], v3 offset:7936
    v_mfma_f32_32x32x16_bf16 v[64:79], a[196:199], a[132:135], v[64:79]
    buffer_load_dwordx4 v8, s[56:59], s46 offen offset:1024  lds
    ds_read_b64_tr_b16 a[180:181], v6 offset:6464
    ds_read_b64_tr_b16 a[182:183], v6 offset:8000
    v_mfma_f32_32x32x16_bf16 v[80:95], a[200:203], a[132:135], v[80:95]
    ds_read_b64_tr_b16 a[184:185], v3 offset:0
    ds_read_b64_tr_b16 a[186:187], v3 offset:1536
    v_mfma_f32_32x32x16_bf16 v[96:111], a[204:207], a[132:135], v[96:111]
    ds_read_b64_tr_b16 a[188:189], v6 offset:64
    ds_read_b64_tr_b16 a[190:191], v6 offset:1600
    s_waitcnt lgkmcnt(8) vmcnt(45)
    v_mfma_f32_32x32x16_bf16 v[16:31], a[160:163], a[136:139], v[16:31]
    ds_read_b64_tr_b16 a[192:193], v3 offset:128
    ds_read_b64_tr_b16 a[194:195], v3 offset:1664
    s_add_u32 s52, s66, 6144
    buffer_load_dwordx4 a[208:211], v223, s[16:19], s52 offen offset:1024
    v_mfma_f32_32x32x16_bf16 v[32:47], a[164:167], a[136:139], v[32:47]
    buffer_load_dwordx4 v9, s[56:59], s46 offen offset:2048  lds
    ds_read_b64_tr_b16 a[196:197], v6 offset:192
    ds_read_b64_tr_b16 a[198:199], v6 offset:1728
    v_mfma_f32_32x32x16_bf16 v[48:63], a[168:171], a[136:139], v[48:63]
    ds_read_b64_tr_b16 a[200:201], v3 offset:256
    ds_read_b64_tr_b16 a[202:203], v3 offset:1792
    v_mfma_f32_32x32x16_bf16 v[64:79], a[172:175], a[136:139], v[64:79]
    ds_read_b64_tr_b16 a[204:205], v6 offset:320
    ds_read_b64_tr_b16 a[206:207], v6 offset:1856
    s_waitcnt lgkmcnt(8) vmcnt(34)
    s_barrier
    v_mfma_f32_32x32x16_bf16 v[80:95], a[176:179], a[136:139], v[80:95]
    ds_read_b64_tr_b16 a[160:161], v3 offset:43008
    ds_read_b64_tr_b16 a[162:163], v3 offset:44544
    v_mfma_f32_32x32x16_bf16 v[96:111], a[180:183], a[136:139], v[96:111]
    ds_read_b64_tr_b16 a[164:165], v6 offset:43072
    ds_read_b64_tr_b16 a[166:167], v6 offset:44608
    buffer_load_dwordx4 a[212:215], v223, s[16:19], s52 offen offset:0
    s_waitcnt vmcnt(47)
    v_mfma_f32_32x32x16_bf16 v[16:31], a[184:187], a[140:143], v[16:31]
    ds_read_b64_tr_b16 a[168:169], v3 offset:43136
    ds_read_b64_tr_b16 a[170:171], v3 offset:44672
    s_add_u32 m0, s48, 73728
    s_add_u32 s46, s72, 147456
    buffer_load_dwordx4 v7, s[56:59], s46 offen offset:0  lds
    v_mfma_f32_32x32x16_bf16 v[32:47], a[188:191], a[140:143], v[32:47]
    ds_read_b64_tr_b16 a[172:173], v6 offset:43200
    ds_read_b64_tr_b16 a[174:175], v6 offset:44736
    s_waitcnt lgkmcnt(8)
    v_mfma_f32_32x32x16_bf16 v[48:63], a[192:195], a[140:143], v[48:63]
    ds_read_b64_tr_b16 a[176:177], v3 offset:43264
    ds_read_b64_tr_b16 a[178:179], v3 offset:44800
    v_mfma_f32_32x32x16_bf16 v[64:79], a[196:199], a[140:143], v[64:79]
    ds_read_b64_tr_b16 a[180:181], v6 offset:43328
    ds_read_b64_tr_b16 a[182:183], v6 offset:44864
    v_mfma_f32_32x32x16_bf16 v[80:95], a[200:203], a[140:143], v[80:95]
    ds_read_b64_tr_b16 a[184:185], v3 offset:36864
    ds_read_b64_tr_b16 a[186:187], v3 offset:38400
    buffer_load_dwordx4 v8, s[56:59], s46 offen offset:1024  lds
    s_add_u32 s52, s66, 4096
    buffer_load_dwordx4 a[216:219], v223, s[16:19], s52 offen offset:1024
    v_mfma_f32_32x32x16_bf16 v[96:111], a[204:207], a[140:143], v[96:111]
    ds_read_b64_tr_b16 a[188:189], v6 offset:36928
    ds_read_b64_tr_b16 a[190:191], v6 offset:38464
    s_waitcnt lgkmcnt(8) vmcnt(49)
    v_mfma_f32_32x32x16_bf16 v[16:31], a[160:163], a[144:147], v[16:31]
    ds_read_b64_tr_b16 a[192:193], v3 offset:36992
    ds_read_b64_tr_b16 a[194:195], v3 offset:38528
    v_mfma_f32_32x32x16_bf16 v[32:47], a[164:167], a[144:147], v[32:47]
    ds_read_b64_tr_b16 a[196:197], v6 offset:37056
    ds_read_b64_tr_b16 a[198:199], v6 offset:38592
    v_mfma_f32_32x32x16_bf16 v[48:63], a[168:171], a[144:147], v[48:63]
    ds_read_b64_tr_b16 a[200:201], v3 offset:37120
    ds_read_b64_tr_b16 a[202:203], v3 offset:38656
    buffer_load_dwordx4 v9, s[56:59], s46 offen offset:2048  lds
    v_mfma_f32_32x32x16_bf16 v[64:79], a[172:175], a[144:147], v[64:79]
    ds_read_b64_tr_b16 a[204:205], v6 offset:37184
    ds_read_b64_tr_b16 a[206:207], v6 offset:38720
    buffer_load_dwordx4 a[220:223], v223, s[16:19], s52 offen offset:0
    s_waitcnt lgkmcnt(8)
    v_mfma_f32_32x32x16_bf16 v[80:95], a[176:179], a[144:147], v[80:95]
    ds_read_b64_tr_b16 a[160:161], v3 offset:30720
    ds_read_b64_tr_b16 a[162:163], v3 offset:32256
    v_mfma_f32_32x32x16_bf16 v[96:111], a[180:183], a[144:147], v[96:111]
    ds_read_b64_tr_b16 a[164:165], v6 offset:30784
    ds_read_b64_tr_b16 a[166:167], v6 offset:32320
    s_add_u32 m0, s48, 76800
    s_add_u32 s46, s72, 156672
    buffer_load_dwordx4 v7, s[56:59], s46 offen offset:0  lds
    s_waitcnt vmcnt(50)
    v_mfma_f32_32x32x16_bf16 v[16:31], a[184:187], a[148:151], v[16:31]
    ds_read_b64_tr_b16 a[168:169], v3 offset:30848
    ds_read_b64_tr_b16 a[170:171], v3 offset:32384
    v_mfma_f32_32x32x16_bf16 v[32:47], a[188:191], a[148:151], v[32:47]
    ds_read_b64_tr_b16 a[172:173], v6 offset:30912
    ds_read_b64_tr_b16 a[174:175], v6 offset:32448
    s_waitcnt lgkmcnt(8)
    v_mfma_f32_32x32x16_bf16 v[48:63], a[192:195], a[148:151], v[48:63]
    ds_read_b64_tr_b16 a[176:177], v3 offset:30976
    ds_read_b64_tr_b16 a[178:179], v3 offset:32512
    s_add_u32 s52, s66, 2048
    buffer_load_dwordx4 a[224:227], v223, s[16:19], s52 offen offset:1024
    v_mfma_f32_32x32x16_bf16 v[64:79], a[196:199], a[148:151], v[64:79]
    ds_read_b64_tr_b16 a[180:181], v6 offset:31040
    ds_read_b64_tr_b16 a[182:183], v6 offset:32576
    buffer_load_dwordx4 v8, s[56:59], s46 offen offset:1024  lds
    v_mfma_f32_32x32x16_bf16 v[80:95], a[200:203], a[148:151], v[80:95]
    ds_read_b64_tr_b16 a[184:185], v3 offset:24576
    ds_read_b64_tr_b16 a[186:187], v3 offset:26112
    v_mfma_f32_32x32x16_bf16 v[96:111], a[204:207], a[148:151], v[96:111]
    ds_read_b64_tr_b16 a[188:189], v6 offset:24640
    ds_read_b64_tr_b16 a[190:191], v6 offset:26176
    s_waitcnt lgkmcnt(8) vmcnt(51)
    v_mfma_f32_32x32x16_bf16 v[16:31], a[160:163], a[152:155], v[16:31]
    ds_read_b64_tr_b16 a[192:193], v3 offset:24704
    ds_read_b64_tr_b16 a[194:195], v3 offset:26240
    v_mfma_f32_32x32x16_bf16 v[32:47], a[164:167], a[152:155], v[32:47]
    ds_read_b64_tr_b16 a[196:197], v6 offset:24768
    ds_read_b64_tr_b16 a[198:199], v6 offset:26304
    buffer_load_dwordx4 v9, s[56:59], s46 offen offset:2048  lds
    buffer_load_dwordx4 a[228:231], v223, s[16:19], s52 offen offset:0
    v_mfma_f32_32x32x16_bf16 v[48:63], a[168:171], a[152:155], v[48:63]
    ds_read_b64_tr_b16 a[200:201], v3 offset:24832
    ds_read_b64_tr_b16 a[202:203], v3 offset:26368
    v_mfma_f32_32x32x16_bf16 v[64:79], a[172:175], a[152:155], v[64:79]
    ds_read_b64_tr_b16 a[204:205], v6 offset:24896
    ds_read_b64_tr_b16 a[206:207], v6 offset:26432
    s_waitcnt lgkmcnt(8) vmcnt(33)
    s_barrier
    v_mfma_f32_32x32x16_bf16 v[80:95], a[176:179], a[152:155], v[80:95]
    ds_read_b64_tr_b16 a[160:161], v1 offset:18432
    ds_read_b64_tr_b16 a[162:163], v1 offset:19968
    v_mfma_f32_32x32x16_bf16 v[96:111], a[180:183], a[152:155], v[96:111]
    ds_read_b64_tr_b16 a[164:165], v4 offset:18496
    ds_read_b64_tr_b16 a[166:167], v4 offset:20032
    s_waitcnt vmcnt(51)
    v_mfma_f32_32x32x16_bf16 v[16:31], a[184:187], a[156:159], v[16:31]
    ds_read_b64_tr_b16 a[168:169], v1 offset:18560
    ds_read_b64_tr_b16 a[170:171], v1 offset:20096
    s_add_u32 m0, s48, 98304
    s_add_u32 s46, s72, 73728
    buffer_load_dwordx4 v7, s[56:59], s46 offen offset:0  lds
    s_add_u32 s52, s66, 0
    v_mfma_f32_32x32x16_bf16 v[32:47], a[188:191], a[156:159], v[32:47]
    buffer_load_dwordx4 a[232:235], v223, s[16:19], s52 offen offset:1024
    buffer_load_dwordx4 v8, s[56:59], s46 offen offset:1024  lds
    ds_read_b64_tr_b16 a[172:173], v1 offset:12288
    ds_read_b64_tr_b16 a[174:175], v1 offset:13824
    s_waitcnt lgkmcnt(8)
    v_mfma_f32_32x32x16_bf16 v[48:63], a[192:195], a[156:159], v[48:63]
    buffer_load_dwordx4 v9, s[56:59], s46 offen offset:2048  lds
    ds_read_b64_tr_b16 a[176:177], v4 offset:12352
    ds_read_b64_tr_b16 a[178:179], v4 offset:13888
    v_mfma_f32_32x32x16_bf16 v[64:79], a[196:199], a[156:159], v[64:79]
    ds_read_b64_tr_b16 a[180:181], v1 offset:12416
    ds_read_b64_tr_b16 a[182:183], v1 offset:13952
    s_add_u32 m0, s48, 101376
    s_add_u32 s46, s72, 82944
    buffer_load_dwordx4 v7, s[56:59], s46 offen offset:0  lds
    v_mfma_f32_32x32x16_bf16 v[80:95], a[200:203], a[156:159], v[80:95]
    buffer_load_dwordx4 v8, s[56:59], s46 offen offset:1024  lds
    ds_read_b64_tr_b16 a[184:185], v1 offset:6144
    ds_read_b64_tr_b16 a[186:187], v1 offset:7680
    v_mfma_f32_32x32x16_bf16 v[96:111], a[204:207], a[156:159], v[96:111]
    buffer_load_dwordx4 v9, s[56:59], s46 offen offset:2048  lds
    ds_read_b64_tr_b16 a[188:189], v4 offset:6208
    ds_read_b64_tr_b16 a[190:191], v4 offset:7744
    buffer_load_dwordx4 a[236:239], v223, s[16:19], s52 offen offset:0
    s_waitcnt lgkmcnt(8) vmcnt(57)
    v_mfma_f32_32x32x16_bf16 v[16:31], a[160:163], a[0:3], v[16:31]
    ds_read_b64_tr_b16 a[192:193], v1 offset:6272
    ds_read_b64_tr_b16 a[194:195], v1 offset:7808
    v_mfma_f32_32x32x16_bf16 v[32:47], a[164:167], a[0:3], v[32:47]
    ds_read_b64_tr_b16 a[196:197], v1 offset:0
    ds_read_b64_tr_b16 a[198:199], v1 offset:1536
    v_mfma_f32_32x32x16_bf16 v[48:63], a[168:171], a[0:3], v[48:63]
    ds_read_b64_tr_b16 a[200:201], v4 offset:64
    ds_read_b64_tr_b16 a[202:203], v4 offset:1600
    s_waitcnt vmcnt(54)
    v_mfma_f32_32x32x16_bf16 v[16:31], a[172:175], a[4:7], v[16:31]
    ds_read_b64_tr_b16 a[204:205], v1 offset:128
    ds_read_b64_tr_b16 a[206:207], v1 offset:1664
    s_waitcnt lgkmcnt(8) vmcnt(19)
    s_barrier
    v_mfma_f32_32x32x16_bf16 v[32:47], a[176:179], a[4:7], v[32:47]
    ds_read_b64_tr_b16 a[160:161], v1 offset:43008
    ds_read_b64_tr_b16 a[162:163], v1 offset:44544
    v_mfma_f32_32x32x16_bf16 v[48:63], a[180:183], a[4:7], v[48:63]
    ds_read_b64_tr_b16 a[164:165], v4 offset:43072
    ds_read_b64_tr_b16 a[166:167], v4 offset:44608
    s_add_u32 m0, s48, 122880
    s_add_u32 s46, s72, 0
    buffer_load_dwordx4 v7, s[56:59], s46 offen offset:0  lds
    s_waitcnt vmcnt(53)
    v_mfma_f32_32x32x16_bf16 v[16:31], a[184:187], a[8:11], v[16:31]
    ds_read_b64_tr_b16 a[168:169], v1 offset:43136
    ds_read_b64_tr_b16 a[170:171], v1 offset:44672
    v_mfma_f32_32x32x16_bf16 v[32:47], a[188:191], a[8:11], v[32:47]
    ds_read_b64_tr_b16 a[172:173], v1 offset:36864
    ds_read_b64_tr_b16 a[174:175], v1 offset:38400
    buffer_load_dwordx4 v8, s[56:59], s46 offen offset:1024  lds
    s_waitcnt lgkmcnt(8)
    v_mfma_f32_32x32x16_bf16 v[48:63], a[192:195], a[8:11], v[48:63]
    ds_read_b64_tr_b16 a[176:177], v4 offset:36928
    ds_read_b64_tr_b16 a[178:179], v4 offset:38464
    s_waitcnt vmcnt(52)
    v_mfma_f32_32x32x16_bf16 v[16:31], a[196:199], a[12:15], v[16:31]
    buffer_load_dwordx4 v9, s[56:59], s46 offen offset:2048  lds
    ds_read_b64_tr_b16 a[180:181], v1 offset:36992
    ds_read_b64_tr_b16 a[182:183], v1 offset:38528
    v_mfma_f32_32x32x16_bf16 v[32:47], a[200:203], a[12:15], v[32:47]
    ds_read_b64_tr_b16 a[184:185], v1 offset:30720
    ds_read_b64_tr_b16 a[186:187], v1 offset:32256
    v_mfma_f32_32x32x16_bf16 v[48:63], a[204:207], a[12:15], v[48:63]
    ds_read_b64_tr_b16 a[188:189], v4 offset:30784
    ds_read_b64_tr_b16 a[190:191], v4 offset:32320
    s_add_u32 m0, s48, 125952
    s_add_u32 s46, s72, 9216
    buffer_load_dwordx4 v7, s[56:59], s46 offen offset:0  lds
    s_waitcnt lgkmcnt(8) vmcnt(52)
    v_mfma_f32_32x32x16_bf16 v[16:31], a[160:163], a[16:19], v[16:31]
    ds_read_b64_tr_b16 a[192:193], v1 offset:30848
    ds_read_b64_tr_b16 a[194:195], v1 offset:32384
    v_mfma_f32_32x32x16_bf16 v[32:47], a[164:167], a[16:19], v[32:47]
    buffer_load_dwordx4 v8, s[56:59], s46 offen offset:1024  lds
    ds_read_b64_tr_b16 a[196:197], v1 offset:24576
    ds_read_b64_tr_b16 a[198:199], v1 offset:26112
    v_mfma_f32_32x32x16_bf16 v[48:63], a[168:171], a[16:19], v[48:63]
    ds_read_b64_tr_b16 a[200:201], v4 offset:24640
    ds_read_b64_tr_b16 a[202:203], v4 offset:26176
    s_waitcnt vmcnt(50)
    v_mfma_f32_32x32x16_bf16 v[16:31], a[172:175], a[20:23], v[16:31]
    buffer_load_dwordx4 v9, s[56:59], s46 offen offset:2048  lds
    ds_read_b64_tr_b16 a[204:205], v1 offset:24704
    ds_read_b64_tr_b16 a[206:207], v1 offset:26240
    s_waitcnt lgkmcnt(8)
    v_mfma_f32_32x32x16_bf16 v[32:47], a[176:179], a[20:23], v[32:47]
    ds_read_b64_tr_b16 a[160:161], v2 offset:18432
    ds_read_b64_tr_b16 a[162:163], v2 offset:19968
    v_mfma_f32_32x32x16_bf16 v[48:63], a[180:183], a[20:23], v[48:63]
    ds_read_b64_tr_b16 a[164:165], v5 offset:18496
    ds_read_b64_tr_b16 a[166:167], v5 offset:20032
    s_waitcnt vmcnt(48)
    v_mfma_f32_32x32x16_bf16 v[16:31], a[184:187], a[24:27], v[16:31]
    ds_read_b64_tr_b16 a[168:169], v2 offset:18560
    ds_read_b64_tr_b16 a[170:171], v2 offset:20096
    v_mfma_f32_32x32x16_bf16 v[32:47], a[188:191], a[24:27], v[32:47]
    ds_read_b64_tr_b16 a[172:173], v2 offset:12288
    ds_read_b64_tr_b16 a[174:175], v2 offset:13824
    s_waitcnt lgkmcnt(8)
    v_mfma_f32_32x32x16_bf16 v[48:63], a[192:195], a[24:27], v[48:63]
    ds_read_b64_tr_b16 a[176:177], v5 offset:12352
    ds_read_b64_tr_b16 a[178:179], v5 offset:13888
    s_waitcnt vmcnt(46)
    v_mfma_f32_32x32x16_bf16 v[16:31], a[196:199], a[28:31], v[16:31]
    ds_read_b64_tr_b16 a[180:181], v2 offset:12416
    ds_read_b64_tr_b16 a[182:183], v2 offset:13952
    v_mfma_f32_32x32x16_bf16 v[32:47], a[200:203], a[28:31], v[32:47]
    ds_read_b64_tr_b16 a[184:185], v2 offset:6144
    ds_read_b64_tr_b16 a[186:187], v2 offset:7680
    v_mfma_f32_32x32x16_bf16 v[48:63], a[204:207], a[28:31], v[48:63]
    ds_read_b64_tr_b16 a[188:189], v5 offset:6208
    ds_read_b64_tr_b16 a[190:191], v5 offset:7744
    s_waitcnt lgkmcnt(8) vmcnt(44)
    v_mfma_f32_32x32x16_bf16 v[16:31], a[160:163], a[32:35], v[16:31]
    ds_read_b64_tr_b16 a[192:193], v2 offset:6272
    ds_read_b64_tr_b16 a[194:195], v2 offset:7808
    v_mfma_f32_32x32x16_bf16 v[32:47], a[164:167], a[32:35], v[32:47]
    ds_read_b64_tr_b16 a[196:197], v2 offset:0
    ds_read_b64_tr_b16 a[198:199], v2 offset:1536
    v_mfma_f32_32x32x16_bf16 v[48:63], a[168:171], a[32:35], v[48:63]
    ds_read_b64_tr_b16 a[200:201], v5 offset:64
    ds_read_b64_tr_b16 a[202:203], v5 offset:1600
    s_waitcnt vmcnt(42)
    v_mfma_f32_32x32x16_bf16 v[16:31], a[172:175], a[36:39], v[16:31]
    ds_read_b64_tr_b16 a[204:205], v2 offset:128
    ds_read_b64_tr_b16 a[206:207], v2 offset:1664
    s_waitcnt lgkmcnt(8)
    v_mfma_f32_32x32x16_bf16 v[32:47], a[176:179], a[36:39], v[32:47]
    v_mfma_f32_32x32x16_bf16 v[48:63], a[180:183], a[36:39], v[48:63]
    s_waitcnt vmcnt(39)
    v_mfma_f32_32x32x16_bf16 v[16:31], a[184:187], a[40:43], v[16:31]
    v_mfma_f32_32x32x16_bf16 v[32:47], a[188:191], a[40:43], v[32:47]
    s_waitcnt lgkmcnt(0)
    v_mfma_f32_32x32x16_bf16 v[48:63], a[192:195], a[40:43], v[48:63]
    s_waitcnt vmcnt(37)
    v_mfma_f32_32x32x16_bf16 v[16:31], a[196:199], a[44:47], v[16:31]
    v_mfma_f32_32x32x16_bf16 v[32:47], a[200:203], a[44:47], v[32:47]
    v_mfma_f32_32x32x16_bf16 v[48:63], a[204:207], a[44:47], v[48:63]
    s_waitcnt vmcnt(7)
    s_barrier
    ds_read_b64_tr_b16 a[160:161], v2 offset:43008
    ds_read_b64_tr_b16 a[162:163], v2 offset:44544
    ds_read_b64_tr_b16 a[164:165], v5 offset:43072
    ds_read_b64_tr_b16 a[166:167], v5 offset:44608
    ds_read_b64_tr_b16 a[168:169], v2 offset:43136
    ds_read_b64_tr_b16 a[170:171], v2 offset:44672
    ds_read_b64_tr_b16 a[172:173], v2 offset:36864
    ds_read_b64_tr_b16 a[174:175], v2 offset:38400
    ds_read_b64_tr_b16 a[176:177], v5 offset:36928
    ds_read_b64_tr_b16 a[178:179], v5 offset:38464
    ds_read_b64_tr_b16 a[180:181], v2 offset:36992
    ds_read_b64_tr_b16 a[182:183], v2 offset:38528
    ds_read_b64_tr_b16 a[184:185], v2 offset:30720
    ds_read_b64_tr_b16 a[186:187], v2 offset:32256
    ds_read_b64_tr_b16 a[188:189], v5 offset:30784
    ds_read_b64_tr_b16 a[190:191], v5 offset:32320
    s_waitcnt lgkmcnt(8) vmcnt(35)
    v_mfma_f32_32x32x16_bf16 v[16:31], a[160:163], a[48:51], v[16:31]
    ds_read_b64_tr_b16 a[192:193], v2 offset:30848
    ds_read_b64_tr_b16 a[194:195], v2 offset:32384
    v_mfma_f32_32x32x16_bf16 v[32:47], a[164:167], a[48:51], v[32:47]
    ds_read_b64_tr_b16 a[196:197], v2 offset:24576
    ds_read_b64_tr_b16 a[198:199], v2 offset:26112
    v_mfma_f32_32x32x16_bf16 v[48:63], a[168:171], a[48:51], v[48:63]
    ds_read_b64_tr_b16 a[200:201], v5 offset:24640
    ds_read_b64_tr_b16 a[202:203], v5 offset:26176
    s_waitcnt vmcnt(33)
    v_mfma_f32_32x32x16_bf16 v[16:31], a[172:175], a[52:55], v[16:31]
    ds_read_b64_tr_b16 a[204:205], v2 offset:24704
    ds_read_b64_tr_b16 a[206:207], v2 offset:26240
    s_waitcnt lgkmcnt(8)
    v_mfma_f32_32x32x16_bf16 v[32:47], a[176:179], a[52:55], v[32:47]
    ds_read_b64_tr_b16 a[160:161], v3 offset:18432
    ds_read_b64_tr_b16 a[162:163], v3 offset:19968
    v_mfma_f32_32x32x16_bf16 v[48:63], a[180:183], a[52:55], v[48:63]
    ds_read_b64_tr_b16 a[164:165], v6 offset:18496
    ds_read_b64_tr_b16 a[166:167], v6 offset:20032
    s_waitcnt vmcnt(30)
    v_mfma_f32_32x32x16_bf16 v[16:31], a[184:187], a[56:59], v[16:31]
    ds_read_b64_tr_b16 a[168:169], v3 offset:18560
    ds_read_b64_tr_b16 a[170:171], v3 offset:20096
    s_waitcnt vmcnt(50)
AC_10t:
    v_xor_b32 v247, v235, v247
    v_lshrrev_b32 v247, 4, v247
    v_cmp_ne_u32 vcc, 2, v247
    s_nop 1
    s_cmp_lg_u64 vcc, 0
    s_cbranch_scc1 AC_10
ACR_11:
    v_mfma_f32_32x32x16_bf16 v[32:47], a[188:191], a[56:59], v[32:47]
    ds_read_b64_tr_b16 a[172:173], v3 offset:12288
    ds_read_b64_tr_b16 a[174:175], v3 offset:13824
    s_add_u32 s53, s60, 4096
    s_waitcnt lgkmcnt(8)
    v_mfma_f32_32x32x16_bf16 v[48:63], a[192:195], a[56:59], v[48:63]
    ds_read_b64_tr_b16 a[176:177], v6 offset:12352
    ds_read_b64_tr_b16 a[178:179], v6 offset:13888
    s_waitcnt vmcnt(28)
    v_mfma_f32_32x32x16_bf16 v[16:31], a[196:199], a[60:63], v[16:31]
    ds_read_b64_tr_b16 a[180:181], v3 offset:12416
    ds_read_b64_tr_b16 a[182:183], v3 offset:13952
    v_mfma_f32_32x32x16_bf16 v[32:47], a[200:203], a[60:63], v[32:47]
    ds_read_b64_tr_b16 a[184:185], v3 offset:6144
    ds_read_b64_tr_b16 a[186:187], v3 offset:7680
    v_mfma_f32_32x32x16_bf16 v[48:63], a[204:207], a[60:63], v[48:63]
    ds_read_b64_tr_b16 a[188:189], v6 offset:6208
    ds_read_b64_tr_b16 a[190:191], v6 offset:7744
    s_waitcnt lgkmcnt(8) vmcnt(26)
    v_mfma_f32_32x32x16_bf16 v[16:31], a[160:163], a[208:211], v[16:31]
    ds_read_b64_tr_b16 a[192:193], v3 offset:6272
    ds_read_b64_tr_b16 a[194:195], v3 offset:7808
    v_mfma_f32_32x32x16_bf16 v[32:47], a[164:167], a[208:211], v[32:47]
    ds_read_b64_tr_b16 a[196:197], v3 offset:0
    ds_read_b64_tr_b16 a[198:199], v3 offset:1536
    v_mfma_f32_32x32x16_bf16 v[48:63], a[168:171], a[208:211], v[48:63]
    ds_read_b64_tr_b16 a[200:201], v6 offset:64
    ds_read_b64_tr_b16 a[202:203], v6 offset:1600
    s_waitcnt vmcnt(24)
    v_mfma_f32_32x32x16_bf16 v[16:31], a[172:175], a[212:215], v[16:31]
    ds_read_b64_tr_b16 a[204:205], v3 offset:128
    ds_read_b64_tr_b16 a[206:207], v3 offset:1664
    s_waitcnt lgkmcnt(8) vmcnt(0)
    s_barrier
    v_mfma_f32_32x32x16_bf16 v[32:47], a[176:179], a[212:215], v[32:47]
    ds_read_b64_tr_b16 a[160:161], v3 offset:43008
    ds_read_b64_tr_b16 a[162:163], v3 offset:44544
    v_mfma_f32_32x32x16_bf16 v[48:63], a[180:183], a[212:215], v[48:63]
    ds_read_b64_tr_b16 a[164:165], v6 offset:43072
    ds_read_b64_tr_b16 a[166:167], v6 offset:44608
    s_waitcnt vmcnt(21)
    v_mfma_f32_32x32x16_bf16 v[16:31], a[184:187], a[216:219], v[16:31]
    ds_read_b64_tr_b16 a[168:169], v3 offset:43136
    ds_read_b64_tr_b16 a[170:171], v3 offset:44672
    v_mfma_f32_32x32x16_bf16 v[32:47], a[188:191], a[216:219], v[32:47]
    ds_read_b64_tr_b16 a[172:173], v3 offset:36864
    ds_read_b64_tr_b16 a[174:175], v3 offset:38400
    s_waitcnt lgkmcnt(8)
    v_mfma_f32_32x32x16_bf16 v[48:63], a[192:195], a[216:219], v[48:63]
    ds_read_b64_tr_b16 a[176:177], v6 offset:36928
    ds_read_b64_tr_b16 a[178:179], v6 offset:38464
    s_waitcnt vmcnt(19)
    v_mfma_f32_32x32x16_bf16 v[16:31], a[196:199], a[220:223], v[16:31]
    ds_read_b64_tr_b16 a[180:181], v3 offset:36992
    ds_read_b64_tr_b16 a[182:183], v3 offset:38528
    v_mfma_f32_32x32x16_bf16 v[32:47], a[200:203], a[220:223], v[32:47]
    ds_read_b64_tr_b16 a[184:185], v3 offset:30720
    ds_read_b64_tr_b16 a[186:187], v3 offset:32256
    v_mfma_f32_32x32x16_bf16 v[48:63], a[204:207], a[220:223], v[48:63]
    ds_read_b64_tr_b16 a[188:189], v6 offset:30784
    ds_read_b64_tr_b16 a[190:191], v6 offset:32320
    s_waitcnt lgkmcnt(8) vmcnt(17)
    v_mfma_f32_32x32x16_bf16 v[16:31], a[160:163], a[224:227], v[16:31]
    ds_read_b64_tr_b16 a[192:193], v3 offset:30848
    ds_read_b64_tr_b16 a[194:195], v3 offset:32384
    v_mfma_f32_32x32x16_bf16 v[32:47], a[164:167], a[224:227], v[32:47]
    ds_read_b64_tr_b16 a[196:197], v3 offset:24576
    ds_read_b64_tr_b16 a[198:199], v3 offset:26112
    v_mfma_f32_32x32x16_bf16 v[48:63], a[168:171], a[224:227], v[48:63]
    ds_read_b64_tr_b16 a[200:201], v6 offset:24640
    ds_read_b64_tr_b16 a[202:203], v6 offset:26176
    s_waitcnt vmcnt(14)
    v_mfma_f32_32x32x16_bf16 v[16:31], a[172:175], a[228:231], v[16:31]
    ds_read_b64_tr_b16 a[204:205], v3 offset:24704
    ds_read_b64_tr_b16 a[206:207], v3 offset:26240
    s_waitcnt lgkmcnt(8)
    v_mfma_f32_32x32x16_bf16 v[32:47], a[176:179], a[228:231], v[32:47]
    ds_read_b64_tr_b16 a[160:161], v4 offset:18624
    ds_read_b64_tr_b16 a[162:163], v4 offset:20160
    v_mfma_f32_32x32x16_bf16 v[48:63], a[180:183], a[228:231], v[48:63]
    ds_read_b64_tr_b16 a[164:165], v1 offset:18688
    ds_read_b64_tr_b16 a[166:167], v1 offset:20224
    s_waitcnt vmcnt(12)
    v_mfma_f32_32x32x16_bf16 v[16:31], a[184:187], a[232:235], v[16:31]
    ds_read_b64_tr_b16 a[168:169], v4 offset:18752
    ds_read_b64_tr_b16 a[170:171], v4 offset:20288
    v_mfma_f32_32x32x16_bf16 v[32:47], a[188:191], a[232:235], v[32:47]
    ds_read_b64_tr_b16 a[172:173], v4 offset:12480
    ds_read_b64_tr_b16 a[174:175], v4 offset:14016
    s_waitcnt lgkmcnt(8)
    v_mfma_f32_32x32x16_bf16 v[48:63], a[192:195], a[232:235], v[48:63]
    ds_read_b64_tr_b16 a[176:177], v1 offset:12544
    ds_read_b64_tr_b16 a[178:179], v1 offset:14080
    s_waitcnt vmcnt(6)
    v_mfma_f32_32x32x16_bf16 v[16:31], a[196:199], a[236:239], v[16:31]
    ds_read_b64_tr_b16 a[180:181], v4 offset:12608
    ds_read_b64_tr_b16 a[182:183], v4 offset:14144
    v_mfma_f32_32x32x16_bf16 v[32:47], a[200:203], a[236:239], v[32:47]
    ds_read_b64_tr_b16 a[184:185], v4 offset:6336
    ds_read_b64_tr_b16 a[186:187], v4 offset:7872
    s_nop 6
    v_cvt_pk_bf16_f32 v112, v16, v17
    v_mfma_f32_32x32x16_bf16 v[48:63], a[204:207], a[236:239], v[48:63]
    ds_read_b64_tr_b16 a[188:189], v1 offset:6400
    ds_read_b64_tr_b16 a[190:191], v1 offset:7936
    v_cvt_pk_bf16_f32 v113, v18, v19
    v_cvt_pk_bf16_f32 v114, v20, v21
    v_cvt_pk_bf16_f32 v116, v22, v23
    v_cvt_pk_bf16_f32 v117, v24, v25
    s_waitcnt lgkmcnt(8)
    v_mfma_f32_32x32x16_bf16 v[64:79], a[160:163], a[0:3], v[64:79]
    ds_read_b64_tr_b16 a[192:193], v4 offset:6464
    ds_read_b64_tr_b16 a[194:195], v4 offset:8000
    v_cvt_pk_bf16_f32 v118, v26, v27
    v_cvt_pk_bf16_f32 v120, v28, v29
    v_cvt_pk_bf16_f32 v121, v30, v31
    v_cvt_pk_bf16_f32 v122, v32, v33
    v_mfma_f32_32x32x16_bf16 v[80:95], a[164:167], a[0:3], v[80:95]
    ds_read_b64_tr_b16 a[196:197], v4 offset:192
    ds_read_b64_tr_b16 a[198:199], v4 offset:1728
    v_cvt_pk_bf16_f32 v124, v34, v35
    v_cvt_pk_bf16_f32 v125, v36, v37
    v_cvt_pk_bf16_f32 v126, v38, v39
    v_cvt_pk_bf16_f32 v128, v40, v41
    v_mfma_f32_32x32x16_bf16 v[96:111], a[168:171], a[0:3], v[96:111]
    ds_read_b64_tr_b16 a[200:201], v1 offset:256
    ds_read_b64_tr_b16 a[202:203], v1 offset:1792
    v_cvt_pk_bf16_f32 v129, v42, v43
    v_cvt_pk_bf16_f32 v130, v44, v45
    v_cvt_pk_bf16_f32 v132, v46, v47
    v_mfma_f32_32x32x16_bf16 v[64:79], a[172:175], a[4:7], v[64:79]
    ds_read_b64_tr_b16 a[204:205], v4 offset:320
    ds_read_b64_tr_b16 a[206:207], v4 offset:1856
    v_cvt_pk_bf16_f32 v133, v48, v49
    v_cvt_pk_bf16_f32 v134, v50, v51
    v_cvt_pk_bf16_f32 v136, v52, v53
    v_cvt_pk_bf16_f32 v137, v54, v55
    s_waitcnt lgkmcnt(8)
    v_mfma_f32_32x32x16_bf16 v[80:95], a[176:179], a[4:7], v[80:95]
    ds_read_b64_tr_b16 a[160:161], v4 offset:43200
    ds_read_b64_tr_b16 a[162:163], v4 offset:44736
    buffer_store_dwordx4 v[112:115], v229, s[20:23], s60 offen offset:0 sc0 sc1
    v_cvt_pk_bf16_f32 v138, v56, v57
    v_cvt_pk_bf16_f32 v140, v58, v59
    v_cvt_pk_bf16_f32 v141, v60, v61
    v_mfma_f32_32x32x16_bf16 v[96:111], a[180:183], a[4:7], v[96:111]
    ds_read_b64_tr_b16 a[164:165], v1 offset:43264
    ds_read_b64_tr_b16 a[166:167], v1 offset:44800
    v_cvt_pk_bf16_f32 v142, v62, v63
    v_mfma_f32_32x32x16_bf16 v[64:79], a[184:187], a[8:11], v[64:79]
    ds_read_b64_tr_b16 a[168:169], v4 offset:43328
    ds_read_b64_tr_b16 a[170:171], v4 offset:44864
    v_mfma_f32_32x32x16_bf16 v[80:95], a[188:191], a[8:11], v[80:95]
    ds_read_b64_tr_b16 a[172:173], v4 offset:37056
    ds_read_b64_tr_b16 a[174:175], v4 offset:38592
    buffer_store_dwordx4 v[116:119], v229, s[20:23], s60 offen offset:1024 sc0 sc1
    s_waitcnt lgkmcnt(8)
    v_mfma_f32_32x32x16_bf16 v[96:111], a[192:195], a[8:11], v[96:111]
    ds_read_b64_tr_b16 a[176:177], v1 offset:37120
    ds_read_b64_tr_b16 a[178:179], v1 offset:38656
    v_mfma_f32_32x32x16_bf16 v[64:79], a[196:199], a[12:15], v[64:79]
    ds_read_b64_tr_b16 a[180:181], v4 offset:37184
    ds_read_b64_tr_b16 a[182:183], v4 offset:38720
    v_mfma_f32_32x32x16_bf16 v[80:95], a[200:203], a[12:15], v[80:95]
    ds_read_b64_tr_b16 a[184:185], v4 offset:30912
    ds_read_b64_tr_b16 a[186:187], v4 offset:32448
    buffer_store_dwordx4 v[120:123], v229, s[20:23], s60 offen offset:2048 sc0 sc1
    v_mfma_f32_32x32x16_bf16 v[96:111], a[204:207], a[12:15], v[96:111]
    ds_read_b64_tr_b16 a[188:189], v1 offset:30976
    ds_read_b64_tr_b16 a[190:191], v1 offset:32512
    s_waitcnt lgkmcnt(8)
    v_mfma_f32_32x32x16_bf16 v[64:79], a[160:163], a[16:19], v[64:79]
    ds_read_b64_tr_b16 a[192:193], v4 offset:31040
    ds_read_b64_tr_b16 a[194:195], v4 offset:32576
    v_mfma_f32_32x32x16_bf16 v[80:95], a[164:167], a[16:19], v[80:95]
    ds_read_b64_tr_b16 a[196:197], v4 offset:24768
    ds_read_b64_tr_b16 a[198:199], v4 offset:26304
    buffer_store_dwordx4 v[124:127], v229, s[20:23], s60 offen offset:3072 sc0 sc1
    v_mfma_f32_32x32x16_bf16 v[96:111], a[168:171], a[16:19], v[96:111]
    ds_read_b64_tr_b16 a[200:201], v1 offset:24832
    ds_read_b64_tr_b16 a[202:203], v1 offset:26368
    v_mfma_f32_32x32x16_bf16 v[64:79], a[172:175], a[20:23], v[64:79]
    ds_read_b64_tr_b16 a[204:205], v4 offset:24896
    ds_read_b64_tr_b16 a[206:207], v4 offset:26432
    s_waitcnt lgkmcnt(8)
    v_mfma_f32_32x32x16_bf16 v[80:95], a[176:179], a[20:23], v[80:95]
    ds_read_b64_tr_b16 a[160:161], v5 offset:18624
    ds_read_b64_tr_b16 a[162:163], v5 offset:20160
    buffer_store_dwordx4 v[128:131], v229, s[20:23], s53 offen offset:0 sc0 sc1
    v_mfma_f32_32x32x16_bf16 v[96:111], a[180:183], a[20:23], v[96:111]
    ds_read_b64_tr_b16 a[164:165], v2 offset:18688
    ds_read_b64_tr_b16 a[166:167], v2 offset:20224
    v_mfma_f32_32x32x16_bf16 v[64:79], a[184:187], a[24:27], v[64:79]
    ds_read_b64_tr_b16 a[168:169], v5 offset:18752
    ds_read_b64_tr_b16 a[170:171], v5 offset:20288
    v_mfma_f32_32x32x16_bf16 v[80:95], a[188:191], a[24:27], v[80:95]
    ds_read_b64_tr_b16 a[172:173], v5 offset:12480
    ds_read_b64_tr_b16 a[174:175], v5 offset:14016
    buffer_store_dwordx4 v[132:135], v229, s[20:23], s53 offen offset:1024 sc0 sc1
    s_waitcnt lgkmcnt(8)
    v_mfma_f32_32x32x16_bf16 v[96:111], a[192:195], a[24:27], v[96:111]
    ds_read_b64_tr_b16 a[176:177], v2 offset:12544
    ds_read_b64_tr_b16 a[178:179], v2 offset:14080
    v_mfma_f32_32x32x16_bf16 v[64:79], a[196:199], a[28:31], v[64:79]
    ds_read_b64_tr_b16 a[180:181], v5 offset:12608
    ds_read_b64_tr_b16 a[182:183], v5 offset:14144
    v_mfma_f32_32x32x16_bf16 v[80:95], a[200:203], a[28:31], v[80:95]
    ds_read_b64_tr_b16 a[184:185], v5 offset:6336
    ds_read_b64_tr_b16 a[186:187], v5 offset:7872
    buffer_store_dwordx4 v[136:139], v229, s[20:23], s53 offen offset:2048 sc0 sc1
    v_mfma_f32_32x32x16_bf16 v[96:111], a[204:207], a[28:31], v[96:111]
    ds_read_b64_tr_b16 a[188:189], v2 offset:6400
    ds_read_b64_tr_b16 a[190:191], v2 offset:7936
    s_waitcnt lgkmcnt(8)
    v_mfma_f32_32x32x16_bf16 v[64:79], a[160:163], a[32:35], v[64:79]
    ds_read_b64_tr_b16 a[192:193], v5 offset:6464
    ds_read_b64_tr_b16 a[194:195], v5 offset:8000
    v_mfma_f32_32x32x16_bf16 v[80:95], a[164:167], a[32:35], v[80:95]
    ds_read_b64_tr_b16 a[196:197], v5 offset:192
    ds_read_b64_tr_b16 a[198:199], v5 offset:1728
    buffer_store_dwordx4 v[140:143], v229, s[20:23], s53 offen offset:3072 sc0 sc1
    v_mfma_f32_32x32x16_bf16 v[96:111], a[168:171], a[32:35], v[96:111]
    ds_read_b64_tr_b16 a[200:201], v2 offset:256
    ds_read_b64_tr_b16 a[202:203], v2 offset:1792
    s_waitcnt lgkmcnt(6)
    s_barrier
    v_mfma_f32_32x32x16_bf16 v[64:79], a[172:175], a[36:39], v[64:79]
    ds_read_b64_tr_b16 a[204:205], v5 offset:320
    ds_read_b64_tr_b16 a[206:207], v5 offset:1856
    v_mfma_f32_32x32x16_bf16 v[80:95], a[176:179], a[36:39], v[80:95]
    ds_read_b64_tr_b16 a[160:161], v5 offset:43200
    ds_read_b64_tr_b16 a[162:163], v5 offset:44736
    v_mfma_f32_32x32x16_bf16 v[96:111], a[180:183], a[36:39], v[96:111]
    ds_read_b64_tr_b16 a[164:165], v2 offset:43264
    ds_read_b64_tr_b16 a[166:167], v2 offset:44800
    s_add_u32 m0, s48, 0
    s_add_u32 s46, s73, 0
    buffer_load_dwordx4 v13, s[28:31], s46 offen offset:0  lds
    v_mfma_f32_32x32x16_bf16 v[64:79], a[184:187], a[40:43], v[64:79]
    ds_read_b64_tr_b16 a[168:169], v5 offset:43328
    ds_read_b64_tr_b16 a[170:171], v5 offset:44864
    v_mfma_f32_32x32x16_bf16 v[80:95], a[188:191], a[40:43], v[80:95]
    ds_read_b64_tr_b16 a[172:173], v5 offset:37056
    ds_read_b64_tr_b16 a[174:175], v5 offset:38592
    buffer_load_dwordx4 v14, s[28:31], s46 offen offset:1024  lds
    s_waitcnt lgkmcnt(8)
    v_mfma_f32_32x32x16_bf16 v[96:111], a[192:195], a[40:43], v[96:111]
    ds_read_b64_tr_b16 a[176:177], v2 offset:37120
    ds_read_b64_tr_b16 a[178:179], v2 offset:38656
    v_mfma_f32_32x32x16_bf16 v[64:79], a[196:199], a[44:47], v[64:79]
    ds_read_b64_tr_b16 a[180:181], v5 offset:37184
    ds_read_b64_tr_b16 a[182:183], v5 offset:38720
    buffer_load_dwordx4 v15, s[28:31], s46 offen offset:2048  lds
    v_mfma_f32_32x32x16_bf16 v[80:95], a[200:203], a[44:47], v[80:95]
    ds_read_b64_tr_b16 a[184:185], v5 offset:30912
    ds_read_b64_tr_b16 a[186:187], v5 offset:32448
    v_mfma_f32_32x32x16_bf16 v[96:111], a[204:207], a[44:47], v[96:111]
    ds_read_b64_tr_b16 a[188:189], v2 offset:30976
    ds_read_b64_tr_b16 a[190:191], v2 offset:32512
    s_add_u32 m0, s48, 3072
    s_add_u32 s46, s73, 18432
    buffer_load_dwordx4 v13, s[28:31], s46 offen offset:0  lds
    s_waitcnt lgkmcnt(8)
    v_mfma_f32_32x32x16_bf16 v[64:79], a[160:163], a[48:51], v[64:79]
    ds_read_b64_tr_b16 a[192:193], v5 offset:31040
    ds_read_b64_tr_b16 a[194:195], v5 offset:32576
    v_mfma_f32_32x32x16_bf16 v[80:95], a[164:167], a[48:51], v[80:95]
    ds_read_b64_tr_b16 a[196:197], v5 offset:24768
    ds_read_b64_tr_b16 a[198:199], v5 offset:26304
    buffer_load_dwordx4 v14, s[28:31], s46 offen offset:1024  lds
    v_mfma_f32_32x32x16_bf16 v[96:111], a[168:171], a[48:51], v[96:111]
    ds_read_b64_tr_b16 a[200:201], v2 offset:24832
    ds_read_b64_tr_b16 a[202:203], v2 offset:26368
    v_mfma_f32_32x32x16_bf16 v[64:79], a[172:175], a[52:55], v[64:79]
    ds_read_b64_tr_b16 a[204:205], v5 offset:24896
    ds_read_b64_tr_b16 a[206:207], v5 offset:26432
    buffer_load_dwordx4 v15, s[28:31], s46 offen offset:2048  lds
    s_waitcnt lgkmcnt(8)
    v_mfma_f32_32x32x16_bf16 v[80:95], a[176:179], a[52:55], v[80:95]
    ds_read_b64_tr_b16 a[160:161], v6 offset:18624
    ds_read_b64_tr_b16 a[162:163], v6 offset:20160
    v_mfma_f32_32x32x16_bf16 v[96:111], a[180:183], a[52:55], v[96:111]
    ds_read_b64_tr_b16 a[164:165], v3 offset:18688
    ds_read_b64_tr_b16 a[166:167], v3 offset:20224
    s_add_u32 m0, s48, 24576
    s_add_u32 s46, s73, 147456
    buffer_load_dwordx4 v13, s[28:31], s46 offen offset:0  lds
    v_mfma_f32_32x32x16_bf16 v[64:79], a[184:187], a[56:59], v[64:79]
    ds_read_b64_tr_b16 a[168:169], v6 offset:18752
    ds_read_b64_tr_b16 a[170:171], v6 offset:20288
    v_mfma_f32_32x32x16_bf16 v[80:95], a[188:191], a[56:59], v[80:95]
    ds_read_b64_tr_b16 a[172:173], v6 offset:12480
    ds_read_b64_tr_b16 a[174:175], v6 offset:14016
    buffer_load_dwordx4 v14, s[28:31], s46 offen offset:1024  lds
    s_waitcnt lgkmcnt(8)
    v_mfma_f32_32x32x16_bf16 v[96:111], a[192:195], a[56:59], v[96:111]
    ds_read_b64_tr_b16 a[176:177], v3 offset:12544
    ds_read_b64_tr_b16 a[178:179], v3 offset:14080
    v_mfma_f32_32x32x16_bf16 v[64:79], a[196:199], a[60:63], v[64:79]
    ds_read_b64_tr_b16 a[180:181], v6 offset:12608
    ds_read_b64_tr_b16 a[182:183], v6 offset:14144
    buffer_load_dwordx4 v15, s[28:31], s46 offen offset:2048  lds
    v_mfma_f32_32x32x16_bf16 v[80:95], a[200:203], a[60:63], v[80:95]
    ds_read_b64_tr_b16 a[184:185], v6 offset:6336
    ds_read_b64_tr_b16 a[186:187], v6 offset:7872
    v_mfma_f32_32x32x16_bf16 v[96:111], a[204:207], a[60:63], v[96:111]
    ds_read_b64_tr_b16 a[188:189], v3 offset:6400
    ds_read_b64_tr_b16 a[190:191], v3 offset:7936
    s_add_u32 m0, s48, 27648
    s_add_u32 s46, s73, 165888
    buffer_load_dwordx4 v13, s[28:31], s46 offen offset:0  lds
    s_waitcnt lgkmcnt(8)
    v_mfma_f32_32x32x16_bf16 v[64:79], a[160:163], a[208:211], v[64:79]
    ds_read_b64_tr_b16 a[192:193], v6 offset:6464
    ds_read_b64_tr_b16 a[194:195], v6 offset:8000
    v_mfma_f32_32x32x16_bf16 v[80:95], a[164:167], a[208:211], v[80:95]
    ds_read_b64_tr_b16 a[196:197], v6 offset:192
    ds_read_b64_tr_b16 a[198:199], v6 offset:1728
    buffer_load_dwordx4 v14, s[28:31], s46 offen offset:1024  lds
    v_mfma_f32_32x32x16_bf16 v[96:111], a[168:171], a[208:211], v[96:111]
    ds_read_b64_tr_b16 a[200:201], v3 offset:256
    ds_read_b64_tr_b16 a[202:203], v3 offset:1792
    s_waitcnt lgkmcnt(6)
    s_barrier
    v_mfma_f32_32x32x16_bf16 v[64:79], a[172:175], a[212:215], v[64:79]
    ds_read_b64_tr_b16 a[204:205], v6 offset:320
    ds_read_b64_tr_b16 a[206:207], v6 offset:1856
    buffer_load_dwordx4 v15, s[28:31], s46 offen offset:2048  lds
    v_mfma_f32_32x32x16_bf16 v[80:95], a[176:179], a[212:215], v[80:95]
    ds_read_b64_tr_b16 a[160:161], v6 offset:43200
    ds_read_b64_tr_b16 a[162:163], v6 offset:44736
    v_mfma_f32_32x32x16_bf16 v[96:111], a[180:183], a[212:215], v[96:111]
    ds_read_b64_tr_b16 a[164:165], v3 offset:43264
    ds_read_b64_tr_b16 a[166:167], v3 offset:44800
    s_add_u32 m0, s48, 49152
    s_add_u32 s46, s73, 294912
    buffer_load_dwordx4 v13, s[28:31], s46 offen offset:0  lds
    v_mfma_f32_32x32x16_bf16 v[64:79], a[184:187], a[216:219], v[64:79]
    ds_read_b64_tr_b16 a[168:169], v6 offset:43328
    ds_read_b64_tr_b16 a[170:171], v6 offset:44864
    buffer_load_dwordx4 v14, s[28:31], s46 offen offset:1024  lds
    v_mfma_f32_32x32x16_bf16 v[80:95], a[188:191], a[216:219], v[80:95]
    ds_read_b64_tr_b16 a[172:173], v6 offset:37056
    ds_read_b64_tr_b16 a[174:175], v6 offset:38592
    buffer_load_dwordx4 v15, s[28:31], s46 offen offset:2048  lds
    s_waitcnt lgkmcnt(8)
    v_mfma_f32_32x32x16_bf16 v[96:111], a[192:195], a[216:219], v[96:111]
    ds_read_b64_tr_b16 a[176:177], v3 offset:37120
    ds_read_b64_tr_b16 a[178:179], v3 offset:38656
    s_add_u32 m0, s48, 52224
    s_add_u32 s46, s73, 313344
    buffer_load_dwordx4 v13, s[28:31], s46 offen offset:0  lds
    v_mfma_f32_32x32x16_bf16 v[64:79], a[196:199], a[220:223], v[64:79]
    ds_read_b64_tr_b16 a[180:181], v6 offset:37184
    ds_read_b64_tr_b16 a[182:183], v6 offset:38720
    buffer_load_dwordx4 v14, s[28:31], s46 offen offset:1024  lds
    v_mfma_f32_32x32x16_bf16 v[80:95], a[200:203], a[220:223], v[80:95]
    ds_read_b64_tr_b16 a[184:185], v6 offset:30912
    ds_read_b64_tr_b16 a[186:187], v6 offset:32448
    buffer_load_dwordx4 v15, s[28:31], s46 offen offset:2048  lds
    v_mfma_f32_32x32x16_bf16 v[96:111], a[204:207], a[220:223], v[96:111]
    ds_read_b64_tr_b16 a[188:189], v3 offset:30976
    ds_read_b64_tr_b16 a[190:191], v3 offset:32512
    s_waitcnt lgkmcnt(8)
    v_mfma_f32_32x32x16_bf16 v[64:79], a[160:163], a[224:227], v[64:79]
    ds_read_b64_tr_b16 a[192:193], v6 offset:31040
    ds_read_b64_tr_b16 a[194:195], v6 offset:32576
    v_mfma_f32_32x32x16_bf16 v[80:95], a[164:167], a[224:227], v[80:95]
    ds_read_b64_tr_b16 a[196:197], v6 offset:24768
    ds_read_b64_tr_b16 a[198:199], v6 offset:26304
    s_add_u32 m0, s48, 73728
    s_add_u32 s46, s73, 442368
    buffer_load_dwordx4 v13, s[28:31], s46 offen offset:0  lds
    v_mfma_f32_32x32x16_bf16 v[96:111], a[168:171], a[224:227], v[96:111]
    ds_read_b64_tr_b16 a[200:201], v3 offset:24832
    ds_read_b64_tr_b16 a[202:203], v3 offset:26368
    buffer_load_dwordx4 v14, s[28:31], s46 offen offset:1024  lds
    v_mfma_f32_32x32x16_bf16 v[64:79], a[172:175], a[228:231], v[64:79]
    ds_read_b64_tr_b16 a[204:205], v6 offset:24896
    ds_read_b64_tr_b16 a[206:207], v6 offset:26432
    buffer_load_dwordx4 v15, s[28:31], s46 offen offset:2048  lds
    s_waitcnt lgkmcnt(8)
    v_mfma_f32_32x32x16_bf16 v[80:95], a[176:179], a[228:231], v[80:95]
    s_add_u32 m0, s48, 76800
    s_add_u32 s46, s73, 460800
    buffer_load_dwordx4 v13, s[28:31], s46 offen offset:0  lds
    v_mfma_f32_32x32x16_bf16 v[96:111], a[180:183], a[228:231], v[96:111]
    buffer_load_dwordx4 v14, s[28:31], s46 offen offset:1024  lds
    v_mfma_f32_32x32x16_bf16 v[64:79], a[184:187], a[232:235], v[64:79]
    buffer_load_dwordx4 v15, s[28:31], s46 offen offset:2048  lds
    s_waitcnt lgkmcnt(0)
    s_barrier
    v_mfma_f32_32x32x16_bf16 v[80:95], a[188:191], a[232:235], v[80:95]
    v_mfma_f32_32x32x16_bf16 v[96:111], a[192:195], a[232:235], v[96:111]
    s_add_u32 m0, s48, 98304
    s_add_u32 s46, s74, 0
    buffer_load_dwordx4 v13, s[28:31], s46 offen offset:0  lds
    v_mfma_f32_32x32x16_bf16 v[64:79], a[196:199], a[236:239], v[64:79]
    buffer_load_dwordx4 v14, s[28:31], s46 offen offset:1024  lds
    v_mfma_f32_32x32x16_bf16 v[80:95], a[200:203], a[236:239], v[80:95]
    buffer_load_dwordx4 v15, s[28:31], s46 offen offset:2048  lds
    v_mfma_f32_32x32x16_bf16 v[96:111], a[204:207], a[236:239], v[96:111]
    s_add_u32 m0, s48, 101376
    s_add_u32 s46, s74, 18432
    buffer_load_dwordx4 v13, s[28:31], s46 offen offset:0  lds
    buffer_load_dwordx4 v14, s[28:31], s46 offen offset:1024  lds
    buffer_load_dwordx4 v15, s[28:31], s46 offen offset:2048  lds
    s_nop 9
    s_cmp_eq_u32 s40, 1
    s_cbranch_scc1 F_P3_1
    s_cmp_eq_u32 s40, 2
    s_cbranch_scc1 F_P3_2
F_P3_0:
    s_waitcnt vmcnt(40)
    s_add_u32 s46, s60, 8192
    s_add_u32 s47, s60, 12288
    v_cvt_pk_bf16_f32 v144, v64, v65
    v_cvt_pk_bf16_f32 v145, v66, v67
    v_cvt_pk_bf16_f32 v146, v68, v69
    buffer_store_dwordx4 v[144:147], v229, s[24:27], s46 offen offset:0 sc0 sc1
    v_cvt_pk_bf16_f32 v148, v70, v71
    v_cvt_pk_bf16_f32 v149, v72, v73
    v_cvt_pk_bf16_f32 v150, v74, v75
    buffer_store_dwordx4 v[148:151], v229, s[24:27], s46 offen offset:1024 sc0 sc1
    v_cvt_pk_bf16_f32 v152, v76, v77
    v_cvt_pk_bf16_f32 v153, v78, v79
    v_cvt_pk_bf16_f32 v154, v80, v81
    buffer_store_dwordx4 v[152:155], v229, s[24:27], s46 offen offset:2048 sc0 sc1
    v_cvt_pk_bf16_f32 v156, v82, v83
    v_cvt_pk_bf16_f32 v157, v84, v85
    v_cvt_pk_bf16_f32 v158, v86, v87
    buffer_store_dwordx4 v[156:159], v229, s[24:27], s46 offen offset:3072 sc0 sc1
    v_cvt_pk_bf16_f32 v160, v88, v89
    v_cvt_pk_bf16_f32 v161, v90, v91
    v_cvt_pk_bf16_f32 v162, v92, v93
    buffer_store_dwordx4 v[160:163], v229, s[24:27], s47 offen offset:0 sc0 sc1
    v_cvt_pk_bf16_f32 v164, v94, v95
    v_cvt_pk_bf16_f32 v165, v96, v97
    v_cvt_pk_bf16_f32 v166, v98, v99
    buffer_store_dwordx4 v[164:167], v229, s[24:27], s47 offen offset:1024 sc0 sc1
    v_cvt_pk_bf16_f32 v168, v100, v101
    v_cvt_pk_bf16_f32 v169, v102, v103
    v_cvt_pk_bf16_f32 v170, v104, v105
    buffer_store_dwordx4 v[168:171], v229, s[24:27], s47 offen offset:2048 sc0 sc1
    v_cvt_pk_bf16_f32 v172, v106, v107
    v_cvt_pk_bf16_f32 v173, v108, v109
    v_cvt_pk_bf16_f32 v174, v110, v111
    buffer_store_dwordx4 v[172:175], v229, s[24:27], s47 offen offset:3072 sc0 sc1
    s_waitcnt lgkmcnt(15) vmcnt(8)
    s_barrier
    s_mov_b32 s50, 0
    s_mov_b32 s51, 0
Q0_12:
    buffer_load_dword v238, v233, s[24:27], 0 offen sc0 sc1
    s_waitcnt vmcnt(0)
    v_cmp_eq_u32 vcc, v243, v238
    s_add_u32 s51, s51, 1
    s_nop 0
    s_cmp_eq_u32 vcc_lo, 0
    s_cselect_b32 s54, 1, 0
    s_and_b32 s53, vcc_hi, 7
    s_cmp_eq_u32 s53, 7
    s_cselect_b32 s53, 2, 0
    s_or_b32 s54, s54, s53
    s_cmp_lt_u32 s51, 20000
    s_cselect_b32 s54, s54, 3
    s_andn2_b32 s54, s54, s50
    s_cbranch_scc1 Q0_16
    s_sleep 4
    s_branch Q0_12
Q0_16:
    s_bitcmp1_b32 s54, 1
    s_cbranch_scc0 Q0_13
    s_xor_b32 s46, s35, 1
    s_mul_i32 s46, s46, 3145728
    s_add_u32 s46, s46, s61
    s_add_u32 s47, s46, 4096
    buffer_load_dwordx4 v[16:19], v229, s[24:27], s46 offen offset:0 sc0 sc1
    buffer_load_dwordx4 v[20:23], v229, s[24:27], s46 offen offset:1024 sc0 sc1
    buffer_load_dwordx4 v[24:27], v229, s[24:27], s46 offen offset:2048 sc0 sc1
    buffer_load_dwordx4 v[28:31], v229, s[24:27], s46 offen offset:3072 sc0 sc1
    buffer_load_dwordx4 v[32:35], v229, s[24:27], s47 offen offset:0 sc0 sc1
    buffer_load_dwordx4 v[36:39], v229, s[24:27], s47 offen offset:1024 sc0 sc1
    buffer_load_dwordx4 v[40:43], v229, s[24:27], s47 offen offset:2048 sc0 sc1
    buffer_load_dwordx4 v[44:47], v229, s[24:27], s47 offen offset:3072 sc0 sc1
    s_xor_b32 s46, s35, 2
    s_mul_i32 s46, s46, 3145728
    s_add_u32 s46, s46, s61
    s_add_u32 s47, s46, 4096
    buffer_load_dwordx4 v[48:51], v229, s[24:27], s46 offen offset:0 sc0 sc1
    buffer_load_dwordx4 v[52:55], v229, s[24:27], s46 offen offset:1024 sc0 sc1
    buffer_load_dwordx4 v[56:59], v229, s[24:27], s46 offen offset:2048 sc0 sc1
    buffer_load_dwordx4 v[60:63], v229, s[24:27], s46 offen offset:3072 sc0 sc1
    buffer_load_dwordx4 v[64:67], v229, s[24:27], s47 offen offset:0 sc0 sc1
    buffer_load_dwordx4 v[68:71], v229, s[24:27], s47 offen offset:1024 sc0 sc1
    buffer_load_dwordx4 v[72:75], v229, s[24:27], s47 offen offset:2048 sc0 sc1
    buffer_load_dwordx4 v[76:79], v229, s[24:27], s47 offen offset:3072 sc0 sc1
    s_xor_b32 s46, s35, 3
    s_mul_i32 s46, s46, 3145728
    s_add_u32 s46, s46, s61
    s_add_u32 s47, s46, 4096
    buffer_load_dwordx4 v[80:83], v229, s[24:27], s46 offen offset:0 sc0 sc1
    buffer_load_dwordx4 v[84:87], v229, s[24:27], s46 offen offset:1024 sc0 sc1
    buffer_load_dwordx4 v[88:91], v229, s[24:27], s46 offen offset:2048 sc0 sc1
    buffer_load_dwordx4 v[92:95], v229, s[24:27], s46 offen offset:3072 sc0 sc1
    buffer_load_dwordx4 v[96:99], v229, s[24:27], s47 offen offset:0 sc0 sc1
    buffer_load_dwordx4 v[100:103], v229, s[24:27], s47 offen offset:1024 sc0 sc1
    buffer_load_dwordx4 v[104:107], v229, s[24:27], s47 offen offset:2048 sc0 sc1
    buffer_load_dwordx4 v[108:111], v229, s[24:27], s47 offen offset:3072 sc0 sc1
Q0_13:
    s_bitcmp1_b32 s54, 0
    s_cbranch_scc0 Q0_14
    s_add_u32 s46, s62, 0
    buffer_load_dwordx4 a[64:67], v229, s[24:27], s46 offen offset:0 sc0 sc1
    buffer_load_dwordx4 a[68:71], v229, s[24:27], s46 offen offset:1024 sc0 sc1
    buffer_load_dwordx4 a[72:75], v229, s[24:27], s46 offen offset:2048 sc0 sc1
    buffer_load_dwordx4 a[76:79], v229, s[24:27], s46 offen offset:3072 sc0 sc1
    s_add_u32 s47, s62, 4096
    buffer_load_dwordx4 a[80:83], v229, s[24:27], s47 offen offset:0 sc0 sc1
    buffer_load_dwordx4 a[84:87], v229, s[24:27], s47 offen offset:1024 sc0 sc1
    buffer_load_dwordx4 a[88:91], v229, s[24:27], s47 offen offset:2048 sc0 sc1
    buffer_load_dwordx4 a[92:95], v229, s[24:27], s47 offen offset:3072 sc0 sc1
    s_add_u32 s46, s62, 8192
    buffer_load_dwordx4 a[96:99], v229, s[24:27], s46 offen offset:0 sc0 sc1
    buffer_load_dwordx4 a[100:103], v229, s[24:27], s46 offen offset:1024 sc0 sc1
    buffer_load_dwordx4 a[104:107], v229, s[24:27], s46 offen offset:2048 sc0 sc1
    buffer_load_dwordx4 a[108:111], v229, s[24:27], s46 offen offset:3072 sc0 sc1
    s_add_u32 s47, s62, 12288
    buffer_load_dwordx4 a[112:115], v229, s[24:27], s47 offen offset:0 sc0 sc1
    buffer_load_dwordx4 a[116:119], v229, s[24:27], s47 offen offset:1024 sc0 sc1
    buffer_load_dwordx4 a[120:123], v229, s[24:27], s47 offen offset:2048 sc0 sc1
    buffer_load_dwordx4 a[124:127], v229, s[24:27], s47 offen offset:3072 sc0 sc1
    s_add_u32 s46, s62, 16384
    buffer_load_dwordx4 a[128:131], v229, s[24:27], s46 offen offset:0 sc0 sc1
    buffer_load_dwordx4 a[132:135], v229, s[24:27], s46 offen offset:1024 sc0 sc1
Q0_18:
    ds_read_b64_tr_b16 a[160:161], v228 offset:0
    ds_read_b64_tr_b16 a[162:163], v228 offset:1536
    ds_read_b64_tr_b16 a[164:165], v228 offset:64
    ds_read_b64_tr_b16 a[166:167], v228 offset:1600
    ds_read_b64_tr_b16 a[168:169], v228 offset:128
    ds_read_b64_tr_b16 a[170:171], v228 offset:1664
    ds_read_b64_tr_b16 a[172:173], v228 offset:3456
    ds_read_b64_tr_b16 a[174:175], v228 offset:4992
    ds_read_b64_tr_b16 a[176:177], v228 offset:3520
    ds_read_b64_tr_b16 a[178:179], v228 offset:5056
    ds_read_b64_tr_b16 a[180:181], v228 offset:3584
    ds_read_b64_tr_b16 a[182:183], v228 offset:5120
    ds_read_b64_tr_b16 a[184:185], v228 offset:6912
    ds_read_b64_tr_b16 a[186:187], v228 offset:8448
    ds_read_b64_tr_b16 a[188:189], v228 offset:6976
    ds_read_b64_tr_b16 a[190:191], v228 offset:8512
    s_waitcnt vmcnt(17)
    v_accvgpr_read_b32 v160, a64
    s_waitcnt lgkmcnt(8)
    v_mfma_f32_32x32x16_bf16 v[176:191], a[160:163], a[64:67], 0
    ds_read_b64_tr_b16 a[192:193], v228 offset:7040
    ds_read_b64_tr_b16 a[194:195], v228 offset:8576
    v_accvgpr_read_b32 v161, a65
    v_accvgpr_read_b32 v162, a66
    v_accvgpr_read_b32 v163, a67
    v_mfma_f32_32x32x16_bf16 v[192:207], a[164:167], a[64:67], 0
    ds_read_b64_tr_b16 a[196:197], v228 offset:10368
    ds_read_b64_tr_b16 a[198:199], v228 offset:11904
    v_max_u32 v168, v160, v161
    v_max3_u32 v168, v162, v163, v168
    s_waitcnt vmcnt(16)
    v_accvgpr_read_b32 v164, a68
    v_accvgpr_read_b32 v165, a69
    v_mfma_f32_32x32x16_bf16 v[208:223], a[168:171], a[64:67], 0
    ds_read_b64_tr_b16 a[200:201], v228 offset:10432
    ds_read_b64_tr_b16 a[202:203], v228 offset:11968
    v_accvgpr_read_b32 v166, a70
    v_accvgpr_read_b32 v167, a71
    v_max3_u32 v168, v164, v165, v168
    v_max3_u32 v168, v166, v167, v168
    v_mfma_f32_32x32x16_bf16 v[176:191], a[172:175], a[68:71], v[176:191]
    ds_read_b64_tr_b16 a[204:205], v228 offset:10496
    ds_read_b64_tr_b16 a[206:207], v228 offset:12032
    s_waitcnt vmcnt(15)
    v_accvgpr_read_b32 v160, a72
    v_accvgpr_read_b32 v161, a73
    v_accvgpr_read_b32 v162, a74
    v_accvgpr_read_b32 v163, a75
    s_waitcnt lgkmcnt(8)
    v_mfma_f32_32x32x16_bf16 v[192:207], a[176:179], a[68:71], v[192:207]
    ds_read_b64_tr_b16 a[160:161], v228 offset:13824
    ds_read_b64_tr_b16 a[162:163], v228 offset:15360
    v_max3_u32 v168, v160, v161, v168
    v_max3_u32 v168, v162, v163, v168
    s_waitcnt vmcnt(14)
    v_accvgpr_read_b32 v164, a76
    v_accvgpr_read_b32 v165, a77
    v_mfma_f32_32x32x16_bf16 v[208:223], a[180:183], a[68:71], v[208:223]
    ds_read_b64_tr_b16 a[164:165], v228 offset:13888
    ds_read_b64_tr_b16 a[166:167], v228 offset:15424
    v_accvgpr_read_b32 v166, a78
    v_accvgpr_read_b32 v167, a79
    v_max3_u32 v168, v164, v165, v168
    v_max3_u32 v168, v166, v167, v168
    v_mfma_f32_32x32x16_bf16 v[176:191], a[184:187], a[72:75], v[176:191]
    ds_read_b64_tr_b16 a[168:169], v228 offset:13952
    ds_read_b64_tr_b16 a[170:171], v228 offset:15488
    s_waitcnt vmcnt(13)
    v_accvgpr_read_b32 v160, a80
    v_accvgpr_read_b32 v161, a81
    v_accvgpr_read_b32 v162, a82
    v_mfma_f32_32x32x16_bf16 v[192:207], a[188:191], a[72:75], v[192:207]
    ds_read_b64_tr_b16 a[172:173], v228 offset:17280
    ds_read_b64_tr_b16 a[174:175], v228 offset:18816
    v_accvgpr_read_b32 v163, a83
    v_max3_u32 v168, v160, v161, v168
    v_max3_u32 v168, v162, v163, v168
    s_waitcnt vmcnt(12)
    v_accvgpr_read_b32 v164, a84
    s_waitcnt lgkmcnt(8)
    v_mfma_f32_32x32x16_bf16 v[208:223], a[192:195], a[72:75], v[208:223]
    ds_read_b64_tr_b16 a[176:177], v228 offset:17344
    ds_read_b64_tr_b16 a[178:179], v228 offset:18880
    v_accvgpr_read_b32 v165, a85
    v_accvgpr_read_b32 v166, a86
    v_accvgpr_read_b32 v167, a87
    v_max3_u32 v168, v164, v165, v168
    v_mfma_f32_32x32x16_bf16 v[176:191], a[196:199], a[76:79], v[176:191]
    ds_read_b64_tr_b16 a[180:181], v228 offset:17408
    ds_read_b64_tr_b16 a[182:183], v228 offset:18944
    v_max3_u32 v168, v166, v167, v168
    s_waitcnt vmcnt(11)
    v_accvgpr_read_b32 v160, a88
    v_accvgpr_read_b32 v161, a89
    v_accvgpr_read_b32 v162, a90
    v_mfma_f32_32x32x16_bf16 v[192:207], a[200:203], a[76:79], v[192:207]
    ds_read_b64_tr_b16 a[184:185], v228 offset:20736
    ds_read_b64_tr_b16 a[186:187], v228 offset:22272
    v_accvgpr_read_b32 v163, a91
    v_max3_u32 v168, v160, v161, v168
    v_max3_u32 v168, v162, v163, v168
    v_mfma_f32_32x32x16_bf16 v[208:223], a[204:207], a[76:79], v[208:223]
    ds_read_b64_tr_b16 a[188:189], v228 offset:20800
    ds_read_b64_tr_b16 a[190:191], v228 offset:22336
    s_waitcnt vmcnt(10)
    v_accvgpr_read_b32 v164, a92
    v_accvgpr_read_b32 v165, a93
    v_accvgpr_read_b32 v166, a94
    v_accvgpr_read_b32 v167, a95
    s_waitcnt lgkmcnt(8)
    v_mfma_f32_32x32x16_bf16 v[176:191], a[160:163], a[80:83], v[176:191]
    ds_read_b64_tr_b16 a[192:193], v228 offset:20864
    ds_read_b64_tr_b16 a[194:195], v228 offset:22400
    v_max3_u32 v168, v164, v165, v168
    v_max3_u32 v168, v166, v167, v168
    s_waitcnt vmcnt(9)
    v_accvgpr_read_b32 v160, a96
    v_accvgpr_read_b32 v161, a97
    v_mfma_f32_32x32x16_bf16 v[192:207], a[164:167], a[80:83], v[192:207]
    ds_read_b64_tr_b16 a[196:197], v228 offset:24192
    ds_read_b64_tr_b16 a[198:199], v228 offset:25728
    v_accvgpr_read_b32 v162, a98
    v_accvgpr_read_b32 v163, a99
    v_max3_u32 v168, v160, v161, v168
    v_max3_u32 v168, v162, v163, v168
    v_mfma_f32_32x32x16_bf16 v[208:223], a[168:171], a[80:83], v[208:223]
    ds_read_b64_tr_b16 a[200:201], v228 offset:24256
    ds_read_b64_tr_b16 a[202:203], v228 offset:25792
    s_waitcnt vmcnt(8)
    v_accvgpr_read_b32 v164, a100
    v_accvgpr_read_b32 v165, a101
    v_accvgpr_read_b32 v166, a102
    v_mfma_f32_32x32x16_bf16 v[176:191], a[172:175], a[84:87], v[176:191]
    ds_read_b64_tr_b16 a[204:205], v228 offset:24320
    ds_read_b64_tr_b16 a[206:207], v228 offset:25856
    v_accvgpr_read_b32 v167, a103
    v_max3_u32 v168, v164, v165, v168
    v_max3_u32 v168, v166, v167, v168
    s_waitcnt vmcnt(7)
    v_accvgpr_read_b32 v160, a104
    s_waitcnt lgkmcnt(8)
    v_mfma_f32_32x32x16_bf16 v[192:207], a[176:179], a[84:87], v[192:207]
    ds_read_b64_tr_b16 a[160:161], v228 offset:27648
    ds_read_b64_tr_b16 a[162:163], v228 offset:29184
    v_accvgpr_read_b32 v161, a105
    v_accvgpr_read_b32 v162, a106
    v_accvgpr_read_b32 v163, a107
    v_max3_u32 v168, v160, v161, v168
    v_mfma_f32_32x32x16_bf16 v[208:223], a[180:183], a[84:87], v[208:223]
    ds_read_b64_tr_b16 a[164:165], v228 offset:27712
    ds_read_b64_tr_b16 a[166:167], v228 offset:29248
    v_max3_u32 v168, v162, v163, v168
    s_waitcnt vmcnt(6)
    v_accvgpr_read_b32 v164, a108
    v_accvgpr_read_b32 v165, a109
    v_accvgpr_read_b32 v166, a110
    v_mfma_f32_32x32x16_bf16 v[176:191], a[184:187], a[88:91], v[176:191]
    ds_read_b64_tr_b16 a[168:169], v228 offset:27776
    ds_read_b64_tr_b16 a[170:171], v228 offset:29312
    v_accvgpr_read_b32 v167, a111
    v_max3_u32 v168, v164, v165, v168
    v_max3_u32 v168, v166, v167, v168
    v_mfma_f32_32x32x16_bf16 v[192:207], a[188:191], a[88:91], v[192:207]
    ds_read_b64_tr_b16 a[172:173], v228 offset:31104
    ds_read_b64_tr_b16 a[174:175], v228 offset:32640
    s_waitcnt vmcnt(5)
    v_accvgpr_read_b32 v160, a112
    v_accvgpr_read_b32 v161, a113
    v_accvgpr_read_b32 v162, a114
    v_accvgpr_read_b32 v163, a115
    s_waitcnt lgkmcnt(8)
    v_mfma_f32_32x32x16_bf16 v[208:223], a[192:195], a[88:91], v[208:223]
    ds_read_b64_tr_b16 a[176:177], v228 offset:31168
    ds_read_b64_tr_b16 a[178:179], v228 offset:32704
    v_max3_u32 v168, v160, v161, v168
    v_max3_u32 v168, v162, v163, v168
    s_waitcnt vmcnt(4)
    v_accvgpr_read_b32 v164, a116
    v_accvgpr_read_b32 v165, a117
    v_mfma_f32_32x32x16_bf16 v[176:191], a[196:199], a[92:95], v[176:191]
    ds_read_b64_tr_b16 a[180:181], v228 offset:31232
    ds_read_b64_tr_b16 a[182:183], v228 offset:32768
    v_accvgpr_read_b32 v166, a118
    v_accvgpr_read_b32 v167, a119
    v_max3_u32 v168, v164, v165, v168
    v_max3_u32 v168, v166, v167, v168
    v_mfma_f32_32x32x16_bf16 v[192:207], a[200:203], a[92:95], v[192:207]
    ds_read_b64_tr_b16 a[184:185], v228 offset:34560
    ds_read_b64_tr_b16 a[186:187], v228 offset:36096
    s_waitcnt vmcnt(3)
    v_accvgpr_read_b32 v160, a120
    v_accvgpr_read_b32 v161, a121
    v_accvgpr_read_b32 v162, a122
    v_mfma_f32_32x32x16_bf16 v[208:223], a[204:207], a[92:95], v[208:223]
    ds_read_b64_tr_b16 a[188:189], v228 offset:34624
    ds_read_b64_tr_b16 a[190:191], v228 offset:36160
    v_accvgpr_read_b32 v163, a123
    v_max3_u32 v168, v160, v161, v168
    v_max3_u32 v168, v162, v163, v168
    s_waitcnt vmcnt(2)
    v_accvgpr_read_b32 v164, a124
    s_waitcnt lgkmcnt(8)
    v_mfma_f32_32x32x16_bf16 v[176:191], a[160:163], a[96:99], v[176:191]
    ds_read_b64_tr_b16 a[192:193], v228 offset:34688
    ds_read_b64_tr_b16 a[194:195], v228 offset:36224
    v_accvgpr_read_b32 v165, a125
    v_accvgpr_read_b32 v166, a126
    v_accvgpr_read_b32 v167, a127
    v_max3_u32 v168, v164, v165, v168
    v_mfma_f32_32x32x16_bf16 v[192:207], a[164:167], a[96:99], v[192:207]
    ds_read_b64_tr_b16 a[196:197], v228 offset:38016
    ds_read_b64_tr_b16 a[198:199], v228 offset:39552
    v_max3_u32 v168, v166, v167, v168
    s_waitcnt vmcnt(1)
    v_accvgpr_read_b32 v160, a128
    v_accvgpr_read_b32 v161, a129
    v_accvgpr_read_b32 v162, a130
    v_mfma_f32_32x32x16_bf16 v[208:223], a[168:171], a[96:99], v[208:223]
    ds_read_b64_tr_b16 a[200:201], v228 offset:38080
    ds_read_b64_tr_b16 a[202:203], v228 offset:39616
    v_accvgpr_read_b32 v163, a131
    v_max3_u32 v168, v160, v161, v168
    v_max3_u32 v168, v162, v163, v168
    v_mfma_f32_32x32x16_bf16 v[176:191], a[172:175], a[100:103], v[176:191]
    ds_read_b64_tr_b16 a[204:205], v228 offset:38144
    ds_read_b64_tr_b16 a[206:207], v228 offset:39680
    s_waitcnt vmcnt(0)
    v_accvgpr_read_b32 v164, a132
    v_accvgpr_read_b32 v165, a133
    v_accvgpr_read_b32 v166, a134
    v_accvgpr_read_b32 v167, a135
    s_waitcnt lgkmcnt(8)
    v_mfma_f32_32x32x16_bf16 v[192:207], a[176:179], a[100:103], v[192:207]
    ds_read_b64_tr_b16 a[160:161], v228 offset:41472
    ds_read_b64_tr_b16 a[162:163], v228 offset:43008
    v_max3_u32 v168, v164, v165, v168
    v_max3_u32 v168, v166, v167, v168
    v_cmp_eq_u32 vcc, -1, v168
    v_mfma_f32_32x32x16_bf16 v[208:223], a[180:183], a[100:103], v[208:223]
    ds_read_b64_tr_b16 a[164:165], v228 offset:41536
    ds_read_b64_tr_b16 a[166:167], v228 offset:43072
    v_mfma_f32_32x32x16_bf16 v[176:191], a[184:187], a[104:107], v[176:191]
    ds_read_b64_tr_b16 a[168:169], v228 offset:41600
    ds_read_b64_tr_b16 a[170:171], v228 offset:43136
    v_mfma_f32_32x32x16_bf16 v[192:207], a[188:191], a[104:107], v[192:207]
    ds_read_b64_tr_b16 a[172:173], v228 offset:44928
    ds_read_b64_tr_b16 a[174:175], v228 offset:46464
    s_waitcnt lgkmcnt(8)
    v_mfma_f32_32x32x16_bf16 v[208:223], a[192:195], a[104:107], v[208:223]
    ds_read_b64_tr_b16 a[176:177], v228 offset:44992
    ds_read_b64_tr_b16 a[178:179], v228 offset:46528
    v_mfma_f32_32x32x16_bf16 v[176:191], a[196:199], a[108:111], v[176:191]
    ds_read_b64_tr_b16 a[180:181], v228 offset:45056
    ds_read_b64_tr_b16 a[182:183], v228 offset:46592
    v_mfma_f32_32x32x16_bf16 v[192:207], a[200:203], a[108:111], v[192:207]
    ds_read_b64_tr_b16 a[184:185], v230 offset:0
    ds_read_b64_tr_b16 a[186:187], v230 offset:6912
    v_mfma_f32_32x32x16_bf16 v[208:223], a[204:207], a[108:111], v[208:223]
    ds_read_b64_tr_b16 a[188:189], v230 offset:64
    ds_read_b64_tr_b16 a[190:191], v230 offset:6976
    s_waitcnt lgkmcnt(8)
    v_mfma_f32_32x32x16_bf16 v[176:191], a[160:163], a[112:115], v[176:191]
    ds_read_b64_tr_b16 a[192:193], v230 offset:128
    ds_read_b64_tr_b16 a[194:195], v230 offset:7040
    v_mfma_f32_32x32x16_bf16 v[192:207], a[164:167], a[112:115], v[192:207]
    ds_read_b64_tr_b16 a[196:197], v230 offset:27648
    ds_read_b64_tr_b16 a[198:199], v230 offset:34560
    v_mfma_f32_32x32x16_bf16 v[208:223], a[168:171], a[112:115], v[208:223]
    ds_read_b64_tr_b16 a[200:201], v230 offset:27712
    ds_read_b64_tr_b16 a[202:203], v230 offset:34624
    v_mfma_f32_32x32x16_bf16 v[176:191], a[172:175], a[116:119], v[176:191]
    ds_read_b64_tr_b16 a[204:205], v230 offset:27776
    ds_read_b64_tr_b16 a[206:207], v230 offset:34688
    s_waitcnt lgkmcnt(8)
    v_mfma_f32_32x32x16_bf16 v[192:207], a[176:179], a[116:119], v[192:207]
    ds_read_b64_tr_b16 a[160:161], v231 offset:0
    ds_read_b64_tr_b16 a[162:163], v231 offset:6912
    v_mfma_f32_32x32x16_bf16 v[208:223], a[180:183], a[116:119], v[208:223]
    ds_read_b64_tr_b16 a[164:165], v231 offset:64
    ds_read_b64_tr_b16 a[166:167], v231 offset:6976
    v_mfma_f32_32x32x16_bf16 v[176:191], a[184:187], a[120:123], v[176:191]
    ds_read_b64_tr_b16 a[168:169], v231 offset:128
    ds_read_b64_tr_b16 a[170:171], v231 offset:7040
    v_mfma_f32_32x32x16_bf16 v[192:207], a[188:191], a[120:123], v[192:207]
    ds_read_b64_tr_b16 a[172:173], v231 offset:27648
    ds_read_b64_tr_b16 a[174:175], v231 offset:34560
    s_waitcnt lgkmcnt(8)
    v_mfma_f32_32x32x16_bf16 v[208:223], a[192:195], a[120:123], v[208:223]
    ds_read_b64_tr_b16 a[176:177], v231 offset:27712
    ds_read_b64_tr_b16 a[178:179], v231 offset:34624
    v_mfma_f32_32x32x16_bf16 v[176:191], a[196:199], a[124:127], v[176:191]
    ds_read_b64_tr_b16 a[180:181], v231 offset:27776
    ds_read_b64_tr_b16 a[182:183], v231 offset:34688
    v_mfma_f32_32x32x16_bf16 v[192:207], a[200:203], a[124:127], v[192:207]
    v_mfma_f32_32x32x16_bf16 v[208:223], a[204:207], a[124:127], v[208:223]
    s_waitcnt lgkmcnt(4)
    v_mfma_f32_32x32x16_bf16 v[176:191], a[160:163], a[128:131], v[176:191]
    v_mfma_f32_32x32x16_bf16 v[192:207], a[164:167], a[128:131], v[192:207]
    v_mfma_f32_32x32x16_bf16 v[208:223], a[168:171], a[128:131], v[208:223]
    v_mfma_f32_32x32x16_bf16 v[176:191], a[172:175], a[132:135], v[176:191]
    s_or_b32 s53, s50, s54
    s_bitcmp1_b32 s53, 1
    s_nop 6
    s_cbranch_scc1 Q0_17
    s_xor_b32 s46, s35, 1
    s_mul_i32 s46, s46, 3145728
    s_add_u32 s46, s46, s61
    s_add_u32 s47, s46, 4096
    buffer_load_dwordx4 v[16:19], v229, s[24:27], s46 offen offset:0 sc0 sc1
    buffer_load_dwordx4 v[20:23], v229, s[24:27], s46 offen offset:1024 sc0 sc1
    buffer_load_dwordx4 v[24:27], v229, s[24:27], s46 offen offset:2048 sc0 sc1
    buffer_load_dwordx4 v[28:31], v229, s[24:27], s46 offen offset:3072 sc0 sc1
    buffer_load_dwordx4 v[32:35], v229, s[24:27], s47 offen offset:0 sc0 sc1
    buffer_load_dwordx4 v[36:39], v229, s[24:27], s47 offen offset:1024 sc0 sc1
    buffer_load_dwordx4 v[40:43], v229, s[24:27], s47 offen offset:2048 sc0 sc1
    buffer_load_dwordx4 v[44:47], v229, s[24:27], s47 offen offset:3072 sc0 sc1
    s_xor_b32 s46, s35, 2
    s_mul_i32 s46, s46, 3145728
    s_add_u32 s46, s46, s61
    s_add_u32 s47, s46, 4096
    buffer_load_dwordx4 v[48:51], v229, s[24:27], s46 offen offset:0 sc0 sc1
    buffer_load_dwordx4 v[52:55], v229, s[24:27], s46 offen offset:1024 sc0 sc1
    buffer_load_dwordx4 v[56:59], v229, s[24:27], s46 offen offset:2048 sc0 sc1
    buffer_load_dwordx4 v[60:63], v229, s[24:27], s46 offen offset:3072 sc0 sc1
    buffer_load_dwordx4 v[64:67], v229, s[24:27], s47 offen offset:0 sc0 sc1
    buffer_load_dwordx4 v[68:71], v229, s[24:27], s47 offen offset:1024 sc0 sc1
    buffer_load_dwordx4 v[72:75], v229, s[24:27], s47 offen offset:2048 sc0 sc1
    buffer_load_dwordx4 v[76:79], v229, s[24:27], s47 offen offset:3072 sc0 sc1
    s_xor_b32 s46, s35, 3
    s_mul_i32 s46, s46, 3145728
    s_add_u32 s46, s46, s61
    s_add_u32 s47, s46, 4096
    buffer_load_dwordx4 v[80:83], v229, s[24:27], s46 offen offset:0 sc0 sc1
    buffer_load_dwordx4 v[84:87], v229, s[24:27], s46 offen offset:1024 sc0 sc1
    buffer_load_dwordx4 v[88:91], v229, s[24:27], s46 offen offset:2048 sc0 sc1
    buffer_load_dwordx4 v[92:95], v229, s[24:27], s46 offen offset:3072 sc0 sc1
    buffer_load_dwordx4 v[96:99], v229, s[24:27], s47 offen offset:0 sc0 sc1
    buffer_load_dwordx4 v[100:103], v229, s[24:27], s47 offen offset:1024 sc0 sc1
    buffer_load_dwordx4 v[104:107], v229, s[24:27], s47 offen offset:2048 sc0 sc1
    buffer_load_dwordx4 v[108:111], v229, s[24:27], s47 offen offset:3072 sc0 sc1
    s_or_b32 s54, s54, 2
Q0_17:
    s_waitcnt lgkmcnt(0)
    v_mfma_f32_32x32x16_bf16 v[192:207], a[176:179], a[132:135], v[192:207]
    v_mul_f32 v176, v176, v224
    v_mfma_f32_32x32x16_bf16 v[208:223], a[180:183], a[132:135], v[208:223]
    v_mul_f32 v177, v177, v224
    v_mul_f32 v178, v178, v224
    v_mul_f32 v179, v179, v224
    v_mul_f32 v180, v180, v224
    v_mul_f32 v181, v181, v224
    v_mul_f32 v182, v182, v224
    v_mul_f32 v183, v183, v224
    v_mul_f32 v184, v184, v224
    v_mul_f32 v185, v185, v224
    v_mul_f32 v186, v186, v224
    v_mul_f32 v187, v187, v224
    v_mul_f32 v188, v188, v224
    v_mul_f32 v189, v189, v224
    v_mul_f32 v190, v190, v224
    v_mul_f32 v191, v191, v224
    v_mul_f32 v192, v192, v224
    v_mul_f32 v193, v193, v224
    v_mul_f32 v194, v194, v224
    v_mul_f32 v195, v195, v224
    v_mul_f32 v196, v196, v224
    v_mul_f32 v197, v197, v224
    v_mul_f32 v198, v198, v224
    v_mul_f32 v199, v199, v224
    v_mul_f32 v200, v200, v224
    v_mul_f32 v201, v201, v224
    v_mul_f32 v202, v202, v224
    v_mul_f32 v203, v203, v224
    v_mul_f32 v204, v204, v224
    v_mul_f32 v205, v205, v224
    v_mul_f32 v206, v206, v224
    v_mul_f32 v207, v207, v224
    v_mul_f32 v208, v208, v224
    v_mul_f32 v209, v209, v224
    v_mul_f32 v210, v210, v224
    v_mul_f32 v211, v211, v224
    v_mul_f32 v212, v212, v224
    v_mul_f32 v213, v213, v224
    v_mul_f32 v214, v214, v224
    v_mul_f32 v215, v215, v224
    v_mul_f32 v216, v216, v224
    v_mul_f32 v217, v217, v224
    v_mul_f32 v218, v218, v224
    v_mul_f32 v219, v219, v224
    v_mul_f32 v220, v220, v224
    v_mul_f32 v221, v221, v224
    v_mul_f32 v222, v222, v224
    v_mul_f32 v223, v223, v224
    s_cmp_eq_u64 vcc, 0
    s_cselect_b32 s53, 1, 0
    s_cmp_lt_u32 s51, 20000
    s_cselect_b32 s53, s53, 1
    s_or_b32 s50, s50, s53
Q0_14:
    s_bitcmp1_b32 s54, 1
    s_cbranch_scc0 Q0_15
    s_waitcnt vmcnt(0)
    v_bitop3_b32 v239, 0, v19, v235 bitop3:0xf6
    v_bitop3_b32 v239, v239, v23, v235 bitop3:0xf6
    v_bitop3_b32 v239, v239, v27, v235 bitop3:0xf6
    v_bitop3_b32 v239, v239, v31, v235 bitop3:0xf6
    v_bitop3_b32 v239, v239, v35, v235 bitop3:0xf6
    v_bitop3_b32 v239, v239, v39, v235 bitop3:0xf6
    v_bitop3_b32 v239, v239, v43, v235 bitop3:0xf6
    v_bitop3_b32 v239, v239, v47, v235 bitop3:0xf6
    v_bitop3_b32 v239, v239, v51, v235 bitop3:0xf6
    v_bitop3_b32 v239, v239, v55, v235 bitop3:0xf6
    v_bitop3_b32 v239, v239, v59, v235 bitop3:0xf6
    v_bitop3_b32 v239, v239, v63, v235 bitop3:0xf6
    v_bitop3_b32 v239, v239, v67, v235 bitop3:0xf6
    v_bitop3_b32 v239, v239, v71, v235 bitop3:0xf6
    v_bitop3_b32 v239, v239, v75, v235 bitop3:0xf6
    v_bitop3_b32 v239, v239, v79, v235 bitop3:0xf6
    v_bitop3_b32 v239, v239, v83, v235 bitop3:0xf6
    v_bitop3_b32 v239, v239, v87, v235 bitop3:0xf6
    v_bitop3_b32 v239, v239, v91, v235 bitop3:0xf6
    v_bitop3_b32 v239, v239, v95, v235 bitop3:0xf6
    v_bitop3_b32 v239, v239, v99, v235 bitop3:0xf6
    v_bitop3_b32 v239, v239, v103, v235 bitop3:0xf6
    v_bitop3_b32 v239, v239, v107, v235 bitop3:0xf6
    v_bitop3_b32 v239, v239, v111, v235 bitop3:0xf6
    v_cmp_ne_u32 vcc, 0, v239
    v_dot2_f32_bf16 v112, v16, v236, 0
    v_dot2_f32_bf16 v113, v16, v237, 0
    v_dot2_f32_bf16 v114, v17, v236, 0
    v_dot2_f32_bf16 v115, v17, v237, 0
    v_dot2_f32_bf16 v116, v18, v236, 0
    v_dot2_f32_bf16 v117, v18, v237, 0
    v_dot2_f32_bf16 v118, v20, v236, 0
    v_dot2_f32_bf16 v119, v20, v237, 0
    v_dot2_f32_bf16 v120, v21, v236, 0
    v_dot2_f32_bf16 v121, v21, v237, 0
    v_dot2_f32_bf16 v122, v22, v236, 0
    v_dot2_f32_bf16 v123, v22, v237, 0
    v_dot2_f32_bf16 v124, v24, v236, 0
    v_dot2_f32_bf16 v125, v24, v237, 0
    v_dot2_f32_bf16 v126, v25, v236, 0
    v_dot2_f32_bf16 v127, v25, v237, 0
    v_dot2_f32_bf16 v128, v26, v236, 0
    v_dot2_f32_bf16 v129, v26, v237, 0
    v_dot2_f32_bf16 v130, v28, v236, 0
    v_dot2_f32_bf16 v131, v28, v237, 0
    v_dot2_f32_bf16 v132, v29, v236, 0
    v_dot2_f32_bf16 v133, v29, v237, 0
    v_dot2_f32_bf16 v134, v30, v236, 0
    v_dot2_f32_bf16 v135, v30, v237, 0
    v_dot2_f32_bf16 v136, v32, v236, 0
    v_dot2_f32_bf16 v137, v32, v237, 0
    v_dot2_f32_bf16 v138, v33, v236, 0
    v_dot2_f32_bf16 v139, v33, v237, 0
    v_dot2_f32_bf16 v140, v34, v236, 0
    v_dot2_f32_bf16 v141, v34, v237, 0
    v_dot2_f32_bf16 v142, v36, v236, 0
    v_dot2_f32_bf16 v143, v36, v237, 0
    v_dot2_f32_bf16 v144, v37, v236, 0
    v_dot2_f32_bf16 v145, v37, v237, 0
    v_dot2_f32_bf16 v146, v38, v236, 0
    v_dot2_f32_bf16 v147, v38, v237, 0
    v_dot2_f32_bf16 v148, v40, v236, 0
    v_dot2_f32_bf16 v149, v40, v237, 0
    v_dot2_f32_bf16 v150, v41, v236, 0
    v_dot2_f32_bf16 v151, v41, v237, 0
    v_dot2_f32_bf16 v152, v42, v236, 0
    v_dot2_f32_bf16 v153, v42, v237, 0
    v_dot2_f32_bf16 v154, v44, v236, 0
    v_dot2_f32_bf16 v155, v44, v237, 0
    v_dot2_f32_bf16 v156, v45, v236, 0
    v_dot2_f32_bf16 v157, v45, v237, 0
    v_dot2_f32_bf16 v158, v46, v236, 0
    v_dot2_f32_bf16 v159, v46, v237, 0
    v_dot2_f32_bf16 v112, v48, v236, v112
    v_dot2_f32_bf16 v113, v48, v237, v113
    v_dot2_f32_bf16 v114, v49, v236, v114
    v_dot2_f32_bf16 v115, v49, v237, v115
    v_dot2_f32_bf16 v116, v50, v236, v116
    v_dot2_f32_bf16 v117, v50, v237, v117
    v_dot2_f32_bf16 v118, v52, v236, v118
    v_dot2_f32_bf16 v119, v52, v237, v119
    v_dot2_f32_bf16 v120, v53, v236, v120
    v_dot2_f32_bf16 v121, v53, v237, v121
    v_dot2_f32_bf16 v122, v54, v236, v122
    v_dot2_f32_bf16 v123, v54, v237, v123
    v_dot2_f32_bf16 v124, v56, v236, v124
    v_dot2_f32_bf16 v125, v56, v237, v125
    v_dot2_f32_bf16 v126, v57, v236, v126
    v_dot2_f32_bf16 v127, v57, v237, v127
    v_dot2_f32_bf16 v128, v58, v236, v128
    v_dot2_f32_bf16 v129, v58, v237, v129
    v_dot2_f32_bf16 v130, v60, v236, v130
    v_dot2_f32_bf16 v131, v60, v237, v131
    v_dot2_f32_bf16 v132, v61, v236, v132
    v_dot2_f32_bf16 v133, v61, v237, v133
    v_dot2_f32_bf16 v134, v62, v236, v134
    v_dot2_f32_bf16 v135, v62, v237, v135
    v_dot2_f32_bf16 v136, v64, v236, v136
    v_dot2_f32_bf16 v137, v64, v237, v137
    v_dot2_f32_bf16 v138, v65, v236, v138
    v_dot2_f32_bf16 v139, v65, v237, v139
    v_dot2_f32_bf16 v140, v66, v236, v140
    v_dot2_f32_bf16 v141, v66, v237, v141
    v_dot2_f32_bf16 v142, v68, v236, v142
    v_dot2_f32_bf16 v143, v68, v237, v143
    v_dot2_f32_bf16 v144, v69, v236, v144
    v_dot2_f32_bf16 v145, v69, v237, v145
    v_dot2_f32_bf16 v146, v70, v236, v146
    v_dot2_f32_bf16 v147, v70, v237, v147
    v_dot2_f32_bf16 v148, v72, v236, v148
    v_dot2_f32_bf16 v149, v72, v237, v149
    v_dot2_f32_bf16 v150, v73, v236, v150
    v_dot2_f32_bf16 v151, v73, v237, v151
    v_dot2_f32_bf16 v152, v74, v236, v152
    v_dot2_f32_bf16 v153, v74, v237, v153
    v_dot2_f32_bf16 v154, v76, v236, v154
    v_dot2_f32_bf16 v155, v76, v237, v155
    v_dot2_f32_bf16 v156, v77, v236, v156
    v_dot2_f32_bf16 v157, v77, v237, v157
    v_dot2_f32_bf16 v158, v78, v236, v158
    v_dot2_f32_bf16 v159, v78, v237, v159
    v_dot2_f32_bf16 v112, v80, v236, v112
    v_dot2_f32_bf16 v113, v80, v237, v113
    v_dot2_f32_bf16 v114, v81, v236, v114
    v_dot2_f32_bf16 v115, v81, v237, v115
    v_dot2_f32_bf16 v116, v82, v236, v116
    v_dot2_f32_bf16 v117, v82, v237, v117
    v_dot2_f32_bf16 v118, v84, v236, v118
    v_dot2_f32_bf16 v119, v84, v237, v119
    v_dot2_f32_bf16 v120, v85, v236, v120
    v_dot2_f32_bf16 v121, v85, v237, v121
    v_dot2_f32_bf16 v122, v86, v236, v122
    v_dot2_f32_bf16 v123, v86, v237, v123
    v_dot2_f32_bf16 v124, v88, v236, v124
    v_dot2_f32_bf16 v125, v88, v237, v125
    v_dot2_f32_bf16 v126, v89, v236, v126
    v_dot2_f32_bf16 v127, v89, v237, v127
    v_dot2_f32_bf16 v128, v90, v236, v128
    v_dot2_f32_bf16 v129, v90, v237, v129
    v_dot2_f32_bf16 v130, v92, v236, v130
    v_dot2_f32_bf16 v131, v92, v237, v131
    v_dot2_f32_bf16 v132, v93, v236, v132
    v_dot2_f32_bf16 v133, v93, v237, v133
    v_dot2_f32_bf16 v134, v94, v236, v134
    v_dot2_f32_bf16 v135, v94, v237, v135
    v_dot2_f32_bf16 v136, v96, v236, v136
    v_dot2_f32_bf16 v137, v96, v237, v137
    v_dot2_f32_bf16 v138, v97, v236, v138
    v_dot2_f32_bf16 v139, v97, v237, v139
    v_dot2_f32_bf16 v140, v98, v236, v140
    v_dot2_f32_bf16 v141, v98, v237, v141
    v_dot2_f32_bf16 v142, v100, v236, v142
    v_dot2_f32_bf16 v143, v100, v237, v143
    v_dot2_f32_bf16 v144, v101, v236, v144
    v_dot2_f32_bf16 v145, v101, v237, v145
    v_dot2_f32_bf16 v146, v102, v236, v146
    v_dot2_f32_bf16 v147, v102, v237, v147
    v_dot2_f32_bf16 v148, v104, v236, v148
    v_dot2_f32_bf16 v149, v104, v237, v149
    v_dot2_f32_bf16 v150, v105, v236, v150
    v_dot2_f32_bf16 v151, v105, v237, v151
    v_dot2_f32_bf16 v152, v106, v236, v152
    v_dot2_f32_bf16 v153, v106, v237, v153
    v_dot2_f32_bf16 v154, v108, v236, v154
    v_dot2_f32_bf16 v155, v108, v237, v155
    v_dot2_f32_bf16 v156, v109, v236, v156
    v_dot2_f32_bf16 v157, v109, v237, v157
    v_dot2_f32_bf16 v158, v110, v236, v158
    v_dot2_f32_bf16 v159, v110, v237, v159
    s_cmp_eq_u64 vcc, 0
    s_cselect_b32 s53, 2, 0
    s_cmp_lt_u32 s51, 20000
    s_cselect_b32 s53, s53, 2
    s_or_b32 s50, s50, s53
Q0_15:
    s_cmp_eq_u32 s50, 3
    s_cbranch_scc0 Q0_12
    v_fma_f32 v112, v112, v225, v176
    v_fma_f32 v113, v113, v225, v177
    v_fma_f32 v114, v114, v225, v178
    v_fma_f32 v115, v115, v225, v179
    v_fma_f32 v116, v116, v225, v180
    v_fma_f32 v117, v117, v225, v181
    v_fma_f32 v118, v118, v225, v182
    v_fma_f32 v119, v119, v225, v183
    v_fma_f32 v120, v120, v225, v184
    v_fma_f32 v121, v121, v225, v185
    v_fma_f32 v122, v122, v225, v186
    v_fma_f32 v123, v123, v225, v187
    v_fma_f32 v124, v124, v225, v188
    v_fma_f32 v125, v125, v225, v189
    v_fma_f32 v126, v126, v225, v190
    v_fma_f32 v127, v127, v225, v191
    v_fma_f32 v128, v128, v225, v192
    v_fma_f32 v129, v129, v225, v193
    v_fma_f32 v130, v130, v225, v194
    v_fma_f32 v131, v131, v225, v195
    v_fma_f32 v132, v132, v225, v196
    v_fma_f32 v133, v133, v225, v197
    v_fma_f32 v134, v134, v225, v198
    v_fma_f32 v135, v135, v225, v199
    v_fma_f32 v136, v136, v225, v200
    v_fma_f32 v137, v137, v225, v201
    v_fma_f32 v138, v138, v225, v202
    v_fma_f32 v139, v139, v225, v203
    v_fma_f32 v140, v140, v225, v204
    v_fma_f32 v141, v141, v225, v205
    v_fma_f32 v142, v142, v225, v206
    v_fma_f32 v143, v143, v225, v207
    v_fma_f32 v144, v144, v225, v208
    v_fma_f32 v145, v145, v225, v209
    v_fma_f32 v146, v146, v225, v210
    v_fma_f32 v147, v147, v225, v211
    v_fma_f32 v148, v148, v225, v212
    v_fma_f32 v149, v149, v225, v213
    v_fma_f32 v150, v150, v225, v214
    v_fma_f32 v151, v151, v225, v215
    v_fma_f32 v152, v152, v225, v216
    v_fma_f32 v153, v153, v225, v217
    v_fma_f32 v154, v154, v225, v218
    v_fma_f32 v155, v155, v225, v219
    v_fma_f32 v156, v156, v225, v220
    v_fma_f32 v157, v157, v225, v221
    v_fma_f32 v158, v158, v225, v222
    v_fma_f32 v159, v159, v225, v223
    ds_write_b128 v232, v[112:115] offset:0
    ds_write_b128 v232, v[116:119] offset:1024
    ds_write_b128 v232, v[120:123] offset:2048
    ds_write_b128 v232, v[124:127] offset:3072
    ds_write_b128 v232, v[128:131] offset:4096
    ds_write_b128 v232, v[132:135] offset:5120
    ds_write_b128 v232, v[136:139] offset:6144
    ds_write_b128 v232, v[140:143] offset:7168
    ds_write_b128 v232, v[144:147] offset:8192
    ds_write_b128 v232, v[148:151] offset:9216
    ds_write_b128 v232, v[152:155] offset:10240
    ds_write_b128 v232, v[156:159] offset:11264
    s_waitcnt lgkmcnt(0)
    s_barrier
    s_endpgm
F_P3_1:
    s_waitcnt vmcnt(40)
    s_add_u32 s46, s60, 8192
    s_add_u32 s47, s60, 12288
    v_cvt_pk_bf16_f32 v144, v64, v65
    v_cvt_pk_bf16_f32 v145, v66, v67
    v_cvt_pk_bf16_f32 v146, v68, v69
    buffer_store_dwordx4 v[144:147], v229, s[24:27], s46 offen offset:0 sc0 sc1
    v_cvt_pk_bf16_f32 v148, v70, v71
    v_cvt_pk_bf16_f32 v149, v72, v73
    v_cvt_pk_bf16_f32 v150, v74, v75
    buffer_store_dwordx4 v[148:151], v229, s[24:27], s46 offen offset:1024 sc0 sc1
    v_cvt_pk_bf16_f32 v152, v76, v77
    v_cvt_pk_bf16_f32 v153, v78, v79
    v_cvt_pk_bf16_f32 v154, v80, v81
    buffer_store_dwordx4 v[152:155], v229, s[24:27], s46 offen offset:2048 sc0 sc1
    v_cvt_pk_bf16_f32 v156, v82, v83
    v_cvt_pk_bf16_f32 v157, v84, v85
    v_cvt_pk_bf16_f32 v158, v86, v87
    buffer_store_dwordx4 v[156:159], v229, s[24:27], s46 offen offset:3072 sc0 sc1
    v_cvt_pk_bf16_f32 v160, v88, v89
    v_cvt_pk_bf16_f32 v161, v90, v91
    v_cvt_pk_bf16_f32 v162, v92, v93
    buffer_store_dwordx4 v[160:163], v229, s[24:27], s47 offen offset:0 sc0 sc1
    v_cvt_pk_bf16_f32 v164, v94, v95
    v_cvt_pk_bf16_f32 v165, v96, v97
    v_cvt_pk_bf16_f32 v166, v98, v99
    buffer_store_dwordx4 v[164:167], v229, s[24:27], s47 offen offset:1024 sc0 sc1
    v_cvt_pk_bf16_f32 v168, v100, v101
    v_cvt_pk_bf16_f32 v169, v102, v103
    v_cvt_pk_bf16_f32 v170, v104, v105
    buffer_store_dwordx4 v[168:171], v229, s[24:27], s47 offen offset:2048 sc0 sc1
    v_cvt_pk_bf16_f32 v172, v106, v107
    v_cvt_pk_bf16_f32 v173, v108, v109
    v_cvt_pk_bf16_f32 v174, v110, v111
    buffer_store_dwordx4 v[172:175], v229, s[24:27], s47 offen offset:3072 sc0 sc1
    s_waitcnt lgkmcnt(15)
    s_mov_b32 s20, s6
    s_and_b32 s21, s7, 0xffff
    s_mov_b32 s22, 0x240000
    s_mov_b32 s23, 0x00020000
    v_mul_f32 v16, v16, v225
    v_mul_f32 v17, v17, v225
    v_mul_f32 v18, v18, v225
    v_mul_f32 v19, v19, v225
    v_mul_f32 v20, v20, v225
    v_mul_f32 v21, v21, v225
    v_mul_f32 v22, v22, v225
    v_mul_f32 v23, v23, v225
    v_mul_f32 v24, v24, v225
    v_mul_f32 v25, v25, v225
    v_mul_f32 v26, v26, v225
    v_mul_f32 v27, v27, v225
    v_mul_f32 v28, v28, v225
    v_mul_f32 v29, v29, v225
    v_mul_f32 v30, v30, v225
    v_mul_f32 v31, v31, v225
    v_mul_f32 v32, v32, v225
    v_mul_f32 v33, v33, v225
    v_mul_f32 v34, v34, v225
    v_mul_f32 v35, v35, v225
    v_mul_f32 v36, v36, v225
    v_mul_f32 v37, v37, v225
    v_mul_f32 v38, v38, v225
    v_mul_f32 v39, v39, v225
    v_mul_f32 v40, v40, v225
    v_mul_f32 v41, v41, v225
    v_mul_f32 v42, v42, v225
    v_mul_f32 v43, v43, v225
    v_mul_f32 v44, v44, v225
    v_mul_f32 v45, v45, v225
    v_mul_f32 v46, v46, v225
    v_mul_f32 v47, v47, v225
    v_mul_f32 v48, v48, v225
    v_mul_f32 v49, v49, v225
    v_mul_f32 v50, v50, v225
    v_mul_f32 v51, v51, v225
    v_mul_f32 v52, v52, v225
    v_mul_f32 v53, v53, v225
    v_mul_f32 v54, v54, v225
    v_mul_f32 v55, v55, v225
    v_mul_f32 v56, v56, v225
    v_mul_f32 v57, v57, v225
    v_mul_f32 v58, v58, v225
    v_mul_f32 v59, v59, v225
    v_mul_f32 v60, v60, v225
    v_mul_f32 v61, v61, v225
    v_mul_f32 v62, v62, v225
    v_mul_f32 v63, v63, v225
    s_waitcnt vmcnt(8)
    s_barrier
    s_mov_b32 s50, 2
    s_mov_b32 s51, 0
Q1_19:
    buffer_load_dword v238, v233, s[24:27], 0 offen sc0 sc1
    s_waitcnt vmcnt(0)
    v_cmp_eq_u32 vcc, v243, v238
    s_add_u32 s51, s51, 1
    s_nop 0
    s_cmp_eq_u32 vcc_lo, 0
    s_cselect_b32 s54, 1, 0
    s_and_b32 s53, vcc_hi, 7
    s_cmp_eq_u32 s53, 7
    s_cselect_b32 s53, 2, 0
    s_or_b32 s54, s54, s53
    s_cmp_lt_u32 s51, 20000
    s_cselect_b32 s54, s54, 3
    s_andn2_b32 s54, s54, s50
    s_cbranch_scc1 Q1_23
    s_sleep 4
    s_branch Q1_19
Q1_23:
    s_bitcmp1_b32 s54, 0
    s_cbranch_scc0 Q1_21
    s_add_u32 s46, s62, 0
    buffer_load_dwordx4 a[64:67], v229, s[24:27], s46 offen offset:0 sc0 sc1
    buffer_load_dwordx4 a[68:71], v229, s[24:27], s46 offen offset:1024 sc0 sc1
    buffer_load_dwordx4 a[72:75], v229, s[24:27], s46 offen offset:2048 sc0 sc1
    buffer_load_dwordx4 a[76:79], v229, s[24:27], s46 offen offset:3072 sc0 sc1
    s_add_u32 s47, s62, 4096
    buffer_load_dwordx4 a[80:83], v229, s[24:27], s47 offen offset:0 sc0 sc1
    buffer_load_dwordx4 a[84:87], v229, s[24:27], s47 offen offset:1024 sc0 sc1
    buffer_load_dwordx4 a[88:91], v229, s[24:27], s47 offen offset:2048 sc0 sc1
    buffer_load_dwordx4 a[92:95], v229, s[24:27], s47 offen offset:3072 sc0 sc1
    s_add_u32 s46, s62, 8192
    buffer_load_dwordx4 a[96:99], v229, s[24:27], s46 offen offset:0 sc0 sc1
    buffer_load_dwordx4 a[100:103], v229, s[24:27], s46 offen offset:1024 sc0 sc1
    buffer_load_dwordx4 a[104:107], v229, s[24:27], s46 offen offset:2048 sc0 sc1
    buffer_load_dwordx4 a[108:111], v229, s[24:27], s46 offen offset:3072 sc0 sc1
    s_add_u32 s47, s62, 12288
    buffer_load_dwordx4 a[112:115], v229, s[24:27], s47 offen offset:0 sc0 sc1
    buffer_load_dwordx4 a[116:119], v229, s[24:27], s47 offen offset:1024 sc0 sc1
    buffer_load_dwordx4 a[120:123], v229, s[24:27], s47 offen offset:2048 sc0 sc1
    buffer_load_dwordx4 a[124:127], v229, s[24:27], s47 offen offset:3072 sc0 sc1
    s_add_u32 s46, s62, 16384
    buffer_load_dwordx4 a[128:131], v229, s[24:27], s46 offen offset:0 sc0 sc1
    buffer_load_dwordx4 a[132:135], v229, s[24:27], s46 offen offset:1024 sc0 sc1
Q1_25:
    ds_read_b64_tr_b16 a[160:161], v228 offset:0
    ds_read_b64_tr_b16 a[162:163], v228 offset:1536
    ds_read_b64_tr_b16 a[164:165], v228 offset:64
    ds_read_b64_tr_b16 a[166:167], v228 offset:1600
    ds_read_b64_tr_b16 a[168:169], v228 offset:128
    ds_read_b64_tr_b16 a[170:171], v228 offset:1664
    ds_read_b64_tr_b16 a[172:173], v228 offset:3456
    ds_read_b64_tr_b16 a[174:175], v228 offset:4992
    ds_read_b64_tr_b16 a[176:177], v228 offset:3520
    ds_read_b64_tr_b16 a[178:179], v228 offset:5056
    ds_read_b64_tr_b16 a[180:181], v228 offset:3584
    ds_read_b64_tr_b16 a[182:183], v228 offset:5120
    ds_read_b64_tr_b16 a[184:185], v228 offset:6912
    ds_read_b64_tr_b16 a[186:187], v228 offset:8448
    ds_read_b64_tr_b16 a[188:189], v228 offset:6976
    ds_read_b64_tr_b16 a[190:191], v228 offset:8512
    s_waitcnt vmcnt(17)
    v_accvgpr_read_b32 v160, a64
    s_waitcnt lgkmcnt(8)
    v_mfma_f32_32x32x16_bf16 v[176:191], a[160:163], a[64:67], 0
    ds_read_b64_tr_b16 a[192:193], v228 offset:7040
    ds_read_b64_tr_b16 a[194:195], v228 offset:8576
    v_accvgpr_read_b32 v161, a65
    v_accvgpr_read_b32 v162, a66
    v_accvgpr_read_b32 v163, a67
    v_mfma_f32_32x32x16_bf16 v[192:207], a[164:167], a[64:67], 0
    ds_read_b64_tr_b16 a[196:197], v228 offset:10368
    ds_read_b64_tr_b16 a[198:199], v228 offset:11904
    v_max_u32 v168, v160, v161
    v_max3_u32 v168, v162, v163, v168
    s_waitcnt vmcnt(16)
    v_accvgpr_read_b32 v164, a68
    v_accvgpr_read_b32 v165, a69
    v_mfma_f32_32x32x16_bf16 v[208:223], a[168:171], a[64:67], 0
    ds_read_b64_tr_b16 a[200:201], v228 offset:10432
    ds_read_b64_tr_b16 a[202:203], v228 offset:11968
    v_accvgpr_read_b32 v166, a70
    v_accvgpr_read_b32 v167, a71
    v_max3_u32 v168, v164, v165, v168
    v_max3_u32 v168, v166, v167, v168
    v_mfma_f32_32x32x16_bf16 v[176:191], a[172:175], a[68:71], v[176:191]
    ds_read_b64_tr_b16 a[204:205], v228 offset:10496
    ds_read_b64_tr_b16 a[206:207], v228 offset:12032
    s_waitcnt vmcnt(15)
    v_accvgpr_read_b32 v160, a72
    v_accvgpr_read_b32 v161, a73
    v_accvgpr_read_b32 v162, a74
    v_accvgpr_read_b32 v163, a75
    s_waitcnt lgkmcnt(8)
    v_mfma_f32_32x32x16_bf16 v[192:207], a[176:179], a[68:71], v[192:207]
    ds_read_b64_tr_b16 a[160:161], v228 offset:13824
    ds_read_b64_tr_b16 a[162:163], v228 offset:15360
    v_max3_u32 v168, v160, v161, v168
    v_max3_u32 v168, v162, v163, v168
    s_waitcnt vmcnt(14)
    v_accvgpr_read_b32 v164, a76
    v_accvgpr_read_b32 v165, a77
    v_mfma_f32_32x32x16_bf16 v[208:223], a[180:183], a[68:71], v[208:223]
    ds_read_b64_tr_b16 a[164:165], v228 offset:13888
    ds_read_b64_tr_b16 a[166:167], v228 offset:15424
    v_accvgpr_read_b32 v166, a78
    v_accvgpr_read_b32 v167, a79
    v_max3_u32 v168, v164, v165, v168
    v_max3_u32 v168, v166, v167, v168
    v_mfma_f32_32x32x16_bf16 v[176:191], a[184:187], a[72:75], v[176:191]
    ds_read_b64_tr_b16 a[168:169], v228 offset:13952
    ds_read_b64_tr_b16 a[170:171], v228 offset:15488
    s_waitcnt vmcnt(13)
    v_accvgpr_read_b32 v160, a80
    v_accvgpr_read_b32 v161, a81
    v_accvgpr_read_b32 v162, a82
    v_mfma_f32_32x32x16_bf16 v[192:207], a[188:191], a[72:75], v[192:207]
    ds_read_b64_tr_b16 a[172:173], v228 offset:17280
    ds_read_b64_tr_b16 a[174:175], v228 offset:18816
    v_accvgpr_read_b32 v163, a83
    v_max3_u32 v168, v160, v161, v168
    v_max3_u32 v168, v162, v163, v168
    s_waitcnt vmcnt(12)
    v_accvgpr_read_b32 v164, a84
    s_waitcnt lgkmcnt(8)
    v_mfma_f32_32x32x16_bf16 v[208:223], a[192:195], a[72:75], v[208:223]
    ds_read_b64_tr_b16 a[176:177], v228 offset:17344
    ds_read_b64_tr_b16 a[178:179], v228 offset:18880
    v_accvgpr_read_b32 v165, a85
    v_accvgpr_read_b32 v166, a86
    v_accvgpr_read_b32 v167, a87
    v_max3_u32 v168, v164, v165, v168
    v_mfma_f32_32x32x16_bf16 v[176:191], a[196:199], a[76:79], v[176:191]
    ds_read_b64_tr_b16 a[180:181], v228 offset:17408
    ds_read_b64_tr_b16 a[182:183], v228 offset:18944
    v_max3_u32 v168, v166, v167, v168
    s_waitcnt vmcnt(11)
    v_accvgpr_read_b32 v160, a88
    v_accvgpr_read_b32 v161, a89
    v_accvgpr_read_b32 v162, a90
    v_mfma_f32_32x32x16_bf16 v[192:207], a[200:203], a[76:79], v[192:207]
    ds_read_b64_tr_b16 a[184:185], v228 offset:20736
    ds_read_b64_tr_b16 a[186:187], v228 offset:22272
    v_accvgpr_read_b32 v163, a91
    v_max3_u32 v168, v160, v161, v168
    v_max3_u32 v168, v162, v163, v168
    v_mfma_f32_32x32x16_bf16 v[208:223], a[204:207], a[76:79], v[208:223]
    ds_read_b64_tr_b16 a[188:189], v228 offset:20800
    ds_read_b64_tr_b16 a[190:191], v228 offset:22336
    s_waitcnt vmcnt(10)
    v_accvgpr_read_b32 v164, a92
    v_accvgpr_read_b32 v165, a93
    v_accvgpr_read_b32 v166, a94
    v_accvgpr_read_b32 v167, a95
    s_waitcnt lgkmcnt(8)
    v_mfma_f32_32x32x16_bf16 v[176:191], a[160:163], a[80:83], v[176:191]
    ds_read_b64_tr_b16 a[192:193], v228 offset:20864
    ds_read_b64_tr_b16 a[194:195], v228 offset:22400
    v_max3_u32 v168, v164, v165, v168
    v_max3_u32 v168, v166, v167, v168
    s_waitcnt vmcnt(9)
    v_accvgpr_read_b32 v160, a96
    v_accvgpr_read_b32 v161, a97
    v_mfma_f32_32x32x16_bf16 v[192:207], a[164:167], a[80:83], v[192:207]
    ds_read_b64_tr_b16 a[196:197], v228 offset:24192
    ds_read_b64_tr_b16 a[198:199], v228 offset:25728
    v_accvgpr_read_b32 v162, a98
    v_accvgpr_read_b32 v163, a99
    v_max3_u32 v168, v160, v161, v168
    v_max3_u32 v168, v162, v163, v168
    v_mfma_f32_32x32x16_bf16 v[208:223], a[168:171], a[80:83], v[208:223]
    ds_read_b64_tr_b16 a[200:201], v228 offset:24256
    ds_read_b64_tr_b16 a[202:203], v228 offset:25792
    s_waitcnt vmcnt(8)
    v_accvgpr_read_b32 v164, a100
    v_accvgpr_read_b32 v165, a101
    v_accvgpr_read_b32 v166, a102
    v_mfma_f32_32x32x16_bf16 v[176:191], a[172:175], a[84:87], v[176:191]
    ds_read_b64_tr_b16 a[204:205], v228 offset:24320
    ds_read_b64_tr_b16 a[206:207], v228 offset:25856
    v_accvgpr_read_b32 v167, a103
    v_max3_u32 v168, v164, v165, v168
    v_max3_u32 v168, v166, v167, v168
    s_waitcnt vmcnt(7)
    v_accvgpr_read_b32 v160, a104
    s_waitcnt lgkmcnt(8)
    v_mfma_f32_32x32x16_bf16 v[192:207], a[176:179], a[84:87], v[192:207]
    ds_read_b64_tr_b16 a[160:161], v228 offset:27648
    ds_read_b64_tr_b16 a[162:163], v228 offset:29184
    v_accvgpr_read_b32 v161, a105
    v_accvgpr_read_b32 v162, a106
    v_accvgpr_read_b32 v163, a107
    v_max3_u32 v168, v160, v161, v168
    v_mfma_f32_32x32x16_bf16 v[208:223], a[180:183], a[84:87], v[208:223]
    ds_read_b64_tr_b16 a[164:165], v228 offset:27712
    ds_read_b64_tr_b16 a[166:167], v228 offset:29248
    v_max3_u32 v168, v162, v163, v168
    s_waitcnt vmcnt(6)
    v_accvgpr_read_b32 v164, a108
    v_accvgpr_read_b32 v165, a109
    v_accvgpr_read_b32 v166, a110
    v_mfma_f32_32x32x16_bf16 v[176:191], a[184:187], a[88:91], v[176:191]
    ds_read_b64_tr_b16 a[168:169], v228 offset:27776
    ds_read_b64_tr_b16 a[170:171], v228 offset:29312
    v_accvgpr_read_b32 v167, a111
    v_max3_u32 v168, v164, v165, v168
    v_max3_u32 v168, v166, v167, v168
    v_mfma_f32_32x32x16_bf16 v[192:207], a[188:191], a[88:91], v[192:207]
    ds_read_b64_tr_b16 a[172:173], v228 offset:31104
    ds_read_b64_tr_b16 a[174:175], v228 offset:32640
    s_waitcnt vmcnt(5)
    v_accvgpr_read_b32 v160, a112
    v_accvgpr_read_b32 v161, a113
    v_accvgpr_read_b32 v162, a114
    v_accvgpr_read_b32 v163, a115
    s_waitcnt lgkmcnt(8)
    v_mfma_f32_32x32x16_bf16 v[208:223], a[192:195], a[88:91], v[208:223]
    ds_read_b64_tr_b16 a[176:177], v228 offset:31168
    ds_read_b64_tr_b16 a[178:179], v228 offset:32704
    v_max3_u32 v168, v160, v161, v168
    v_max3_u32 v168, v162, v163, v168
    s_waitcnt vmcnt(4)
    v_accvgpr_read_b32 v164, a116
    v_accvgpr_read_b32 v165, a117
    v_mfma_f32_32x32x16_bf16 v[176:191], a[196:199], a[92:95], v[176:191]
    ds_read_b64_tr_b16 a[180:181], v228 offset:31232
    ds_read_b64_tr_b16 a[182:183], v228 offset:32768
    v_accvgpr_read_b32 v166, a118
    v_accvgpr_read_b32 v167, a119
    v_max3_u32 v168, v164, v165, v168
    v_max3_u32 v168, v166, v167, v168
    v_mfma_f32_32x32x16_bf16 v[192:207], a[200:203], a[92:95], v[192:207]
    ds_read_b64_tr_b16 a[184:185], v228 offset:34560
    ds_read_b64_tr_b16 a[186:187], v228 offset:36096
    s_waitcnt vmcnt(3)
    v_accvgpr_read_b32 v160, a120
    v_accvgpr_read_b32 v161, a121
    v_accvgpr_read_b32 v162, a122
    v_mfma_f32_32x32x16_bf16 v[208:223], a[204:207], a[92:95], v[208:223]
    ds_read_b64_tr_b16 a[188:189], v228 offset:34624
    ds_read_b64_tr_b16 a[190:191], v228 offset:36160
    v_accvgpr_read_b32 v163, a123
    v_max3_u32 v168, v160, v161, v168
    v_max3_u32 v168, v162, v163, v168
    s_waitcnt vmcnt(2)
    v_accvgpr_read_b32 v164, a124
    s_waitcnt lgkmcnt(8)
    v_mfma_f32_32x32x16_bf16 v[176:191], a[160:163], a[96:99], v[176:191]
    ds_read_b64_tr_b16 a[192:193], v228 offset:34688
    ds_read_b64_tr_b16 a[194:195], v228 offset:36224
    v_accvgpr_read_b32 v165, a125
    v_accvgpr_read_b32 v166, a126
    v_accvgpr_read_b32 v167, a127
    v_max3_u32 v168, v164, v165, v168
    v_mfma_f32_32x32x16_bf16 v[192:207], a[164:167], a[96:99], v[192:207]
    ds_read_b64_tr_b16 a[196:197], v228 offset:38016
    ds_read_b64_tr_b16 a[198:199], v228 offset:39552
    v_max3_u32 v168, v166, v167, v168
    s_waitcnt vmcnt(1)
    v_accvgpr_read_b32 v160, a128
    v_accvgpr_read_b32 v161, a129
    v_accvgpr_read_b32 v162, a130
    v_mfma_f32_32x32x16_bf16 v[208:223], a[168:171], a[96:99], v[208:223]
    ds_read_b64_tr_b16 a[200:201], v228 offset:38080
    ds_read_b64_tr_b16 a[202:203], v228 offset:39616
    v_accvgpr_read_b32 v163, a131
    v_max3_u32 v168, v160, v161, v168
    v_max3_u32 v168, v162, v163, v168
    v_mfma_f32_32x32x16_bf16 v[176:191], a[172:175], a[100:103], v[176:191]
    ds_read_b64_tr_b16 a[204:205], v228 offset:38144
    ds_read_b64_tr_b16 a[206:207], v228 offset:39680
    s_waitcnt vmcnt(0)
    v_accvgpr_read_b32 v164, a132
    v_accvgpr_read_b32 v165, a133
    v_accvgpr_read_b32 v166, a134
    v_accvgpr_read_b32 v167, a135
    s_waitcnt lgkmcnt(8)
    v_mfma_f32_32x32x16_bf16 v[192:207], a[176:179], a[100:103], v[192:207]
    ds_read_b64_tr_b16 a[160:161], v228 offset:41472
    ds_read_b64_tr_b16 a[162:163], v228 offset:43008
    v_max3_u32 v168, v164, v165, v168
    v_max3_u32 v168, v166, v167, v168
    v_cmp_eq_u32 vcc, -1, v168
    v_mfma_f32_32x32x16_bf16 v[208:223], a[180:183], a[100:103], v[208:223]
    ds_read_b64_tr_b16 a[164:165], v228 offset:41536
    ds_read_b64_tr_b16 a[166:167], v228 offset:43072
    v_mfma_f32_32x32x16_bf16 v[176:191], a[184:187], a[104:107], v[176:191]
    ds_read_b64_tr_b16 a[168:169], v228 offset:41600
    ds_read_b64_tr_b16 a[170:171], v228 offset:43136
    v_mfma_f32_32x32x16_bf16 v[192:207], a[188:191], a[104:107], v[192:207]
    ds_read_b64_tr_b16 a[172:173], v228 offset:44928
    ds_read_b64_tr_b16 a[174:175], v228 offset:46464
    s_waitcnt lgkmcnt(8)
    v_mfma_f32_32x32x16_bf16 v[208:223], a[192:195], a[104:107], v[208:223]
    ds_read_b64_tr_b16 a[176:177], v228 offset:44992
    ds_read_b64_tr_b16 a[178:179], v228 offset:46528
    v_mfma_f32_32x32x16_bf16 v[176:191], a[196:199], a[108:111], v[176:191]
    ds_read_b64_tr_b16 a[180:181], v228 offset:45056
    ds_read_b64_tr_b16 a[182:183], v228 offset:46592
    v_mfma_f32_32x32x16_bf16 v[192:207], a[200:203], a[108:111], v[192:207]
    ds_read_b64_tr_b16 a[184:185], v228 offset:48384
    ds_read_b64_tr_b16 a[186:187], v228 offset:49920
    v_mfma_f32_32x32x16_bf16 v[208:223], a[204:207], a[108:111], v[208:223]
    ds_read_b64_tr_b16 a[188:189], v228 offset:48448
    ds_read_b64_tr_b16 a[190:191], v228 offset:49984
    s_waitcnt lgkmcnt(8)
    v_mfma_f32_32x32x16_bf16 v[176:191], a[160:163], a[112:115], v[176:191]
    ds_read_b64_tr_b16 a[192:193], v228 offset:48512
    ds_read_b64_tr_b16 a[194:195], v228 offset:50048
    v_mfma_f32_32x32x16_bf16 v[192:207], a[164:167], a[112:115], v[192:207]
    ds_read_b64_tr_b16 a[196:197], v228 offset:51840
    ds_read_b64_tr_b16 a[198:199], v228 offset:53376
    v_mfma_f32_32x32x16_bf16 v[208:223], a[168:171], a[112:115], v[208:223]
    ds_read_b64_tr_b16 a[200:201], v228 offset:51904
    ds_read_b64_tr_b16 a[202:203], v228 offset:53440
    v_mfma_f32_32x32x16_bf16 v[176:191], a[172:175], a[116:119], v[176:191]
    ds_read_b64_tr_b16 a[204:205], v228 offset:51968
    ds_read_b64_tr_b16 a[206:207], v228 offset:53504
    s_waitcnt lgkmcnt(8)
    v_mfma_f32_32x32x16_bf16 v[192:207], a[176:179], a[116:119], v[192:207]
    ds_read_b64_tr_b16 a[160:161], v228 offset:55296
    ds_read_b64_tr_b16 a[162:163], v228 offset:56832
    v_mfma_f32_32x32x16_bf16 v[208:223], a[180:183], a[116:119], v[208:223]
    ds_read_b64_tr_b16 a[164:165], v228 offset:55360
    ds_read_b64_tr_b16 a[166:167], v228 offset:56896
    v_mfma_f32_32x32x16_bf16 v[176:191], a[184:187], a[120:123], v[176:191]
    ds_read_b64_tr_b16 a[168:169], v228 offset:55424
    ds_read_b64_tr_b16 a[170:171], v228 offset:56960
    v_mfma_f32_32x32x16_bf16 v[192:207], a[188:191], a[120:123], v[192:207]
    ds_read_b64_tr_b16 a[172:173], v228 offset:58752
    ds_read_b64_tr_b16 a[174:175], v228 offset:60288
    s_waitcnt lgkmcnt(8)
    v_mfma_f32_32x32x16_bf16 v[208:223], a[192:195], a[120:123], v[208:223]
    ds_read_b64_tr_b16 a[176:177], v228 offset:58816
    ds_read_b64_tr_b16 a[178:179], v228 offset:60352
    v_mfma_f32_32x32x16_bf16 v[176:191], a[196:199], a[124:127], v[176:191]
    ds_read_b64_tr_b16 a[180:181], v228 offset:58880
    ds_read_b64_tr_b16 a[182:183], v228 offset:60416
    v_mfma_f32_32x32x16_bf16 v[192:207], a[200:203], a[124:127], v[192:207]
    v_mfma_f32_32x32x16_bf16 v[208:223], a[204:207], a[124:127], v[208:223]
    s_waitcnt lgkmcnt(4)
    v_mfma_f32_32x32x16_bf16 v[176:191], a[160:163], a[128:131], v[176:191]
    v_mfma_f32_32x32x16_bf16 v[192:207], a[164:167], a[128:131], v[192:207]
    v_mfma_f32_32x32x16_bf16 v[208:223], a[168:171], a[128:131], v[208:223]
    v_mfma_f32_32x32x16_bf16 v[176:191], a[172:175], a[132:135], v[176:191]
    s_waitcnt lgkmcnt(0)
    v_mfma_f32_32x32x16_bf16 v[192:207], a[176:179], a[132:135], v[192:207]
    s_nop 9
    v_mul_f32 v176, v176, v224
    v_mfma_f32_32x32x16_bf16 v[208:223], a[180:183], a[132:135], v[208:223]
    v_mul_f32 v177, v177, v224
    v_mul_f32 v178, v178, v224
    v_mul_f32 v179, v179, v224
    v_mul_f32 v180, v180, v224
    v_mul_f32 v181, v181, v224
    v_mul_f32 v182, v182, v224
    v_mul_f32 v183, v183, v224
    v_mul_f32 v184, v184, v224
    v_mul_f32 v185, v185, v224
    v_mul_f32 v186, v186, v224
    v_mul_f32 v187, v187, v224
    v_mul_f32 v188, v188, v224
    v_mul_f32 v189, v189, v224
    v_mul_f32 v190, v190, v224
    v_mul_f32 v191, v191, v224
    v_mul_f32 v192, v192, v224
    v_mul_f32 v193, v193, v224
    v_mul_f32 v194, v194, v224
    v_mul_f32 v195, v195, v224
    v_mul_f32 v196, v196, v224
    v_mul_f32 v197, v197, v224
    v_mul_f32 v198, v198, v224
    v_mul_f32 v199, v199, v224
    v_mul_f32 v200, v200, v224
    v_mul_f32 v201, v201, v224
    v_mul_f32 v202, v202, v224
    v_mul_f32 v203, v203, v224
    v_mul_f32 v204, v204, v224
    v_mul_f32 v205, v205, v224
    v_mul_f32 v206, v206, v224
    v_mul_f32 v207, v207, v224
    v_mul_f32 v208, v208, v224
    v_mul_f32 v209, v209, v224
    v_mul_f32 v210, v210, v224
    v_mul_f32 v211, v211, v224
    v_mul_f32 v212, v212, v224
    v_mul_f32 v213, v213, v224
    v_mul_f32 v214, v214, v224
    v_mul_f32 v215, v215, v224
    v_mul_f32 v216, v216, v224
    v_mul_f32 v217, v217, v224
    v_mul_f32 v218, v218, v224
    v_mul_f32 v219, v219, v224
    v_mul_f32 v220, v220, v224
    v_mul_f32 v221, v221, v224
    v_mul_f32 v222, v222, v224
    v_mul_f32 v223, v223, v224
    s_cmp_eq_u64 vcc, 0
    s_cselect_b32 s53, 1, 0
    s_cmp_lt_u32 s51, 20000
    s_cselect_b32 s53, s53, 1
    s_or_b32 s50, s50, s53
Q1_21:
    s_cmp_eq_u32 s50, 3
    s_cbranch_scc0 Q1_19
    v_add_f32 v16, v16, v176
    v_add_f32 v17, v17, v177
    v_add_f32 v18, v18, v178
    v_add_f32 v19, v19, v179
    v_add_f32 v20, v20, v180
    v_add_f32 v21, v21, v181
    v_add_f32 v22, v22, v182
    v_add_f32 v23, v23, v183
    v_add_f32 v24, v24, v184
    v_add_f32 v25, v25, v185
    v_add_f32 v26, v26, v186
    v_add_f32 v27, v27, v187
    v_add_f32 v28, v28, v188
    v_add_f32 v29, v29, v189
    v_add_f32 v30, v30, v190
    v_add_f32 v31, v31, v191
    v_add_f32 v32, v32, v192
    v_add_f32 v33, v33, v193
    v_add_f32 v34, v34, v194
    v_add_f32 v35, v35, v195
    v_add_f32 v36, v36, v196
    v_add_f32 v37, v37, v197
    v_add_f32 v38, v38, v198
    v_add_f32 v39, v39, v199
    v_add_f32 v40, v40, v200
    v_add_f32 v41, v41, v201
    v_add_f32 v42, v42, v202
    v_add_f32 v43, v43, v203
    v_add_f32 v44, v44, v204
    v_add_f32 v45, v45, v205
    v_add_f32 v46, v46, v206
    v_add_f32 v47, v47, v207
    v_add_f32 v48, v48, v208
    v_add_f32 v49, v49, v209
    v_add_f32 v50, v50, v210
    v_add_f32 v51, v51, v211
    v_add_f32 v52, v52, v212
    v_add_f32 v53, v53, v213
    v_add_f32 v54, v54, v214
    v_add_f32 v55, v55, v215
    v_add_f32 v56, v56, v216
    v_add_f32 v57, v57, v217
    v_add_f32 v58, v58, v218
    v_add_f32 v59, v59, v219
    v_add_f32 v60, v60, v220
    v_add_f32 v61, v61, v221
    v_add_f32 v62, v62, v222
    v_add_f32 v63, v63, v223
    s_waitcnt lgkmcnt(0)
    s_barrier
    ds_read_b128 v[176:179], v232 offset:0
    ds_read_b128 v[180:183], v232 offset:1024
    ds_read_b128 v[184:187], v232 offset:2048
    ds_read_b128 v[188:191], v232 offset:3072
    ds_read_b128 v[192:195], v232 offset:4096
    ds_read_b128 v[196:199], v232 offset:5120
    ds_read_b128 v[200:203], v232 offset:6144
    ds_read_b128 v[204:207], v232 offset:7168
    ds_read_b128 v[208:211], v232 offset:8192
    ds_read_b128 v[212:215], v232 offset:9216
    ds_read_b128 v[216:219], v232 offset:10240
    ds_read_b128 v[220:223], v232 offset:11264
    s_waitcnt lgkmcnt(8)
    v_add_f32 v16, v16, v176
    v_add_f32 v17, v17, v177
    v_add_f32 v18, v18, v178
    v_add_f32 v19, v19, v179
    v_add_f32 v20, v20, v180
    v_add_f32 v21, v21, v181
    v_add_f32 v22, v22, v182
    v_add_f32 v23, v23, v183
    v_add_f32 v24, v24, v184
    v_add_f32 v25, v25, v185
    v_add_f32 v26, v26, v186
    v_add_f32 v27, v27, v187
    v_add_f32 v28, v28, v188
    v_add_f32 v29, v29, v189
    v_add_f32 v30, v30, v190
    v_add_f32 v31, v31, v191
    v_cvt_pk_bf16_f32 v112, v16, v17
    v_cvt_pk_bf16_f32 v113, v18, v19
    v_cvt_pk_bf16_f32 v114, v20, v21
    v_cvt_pk_bf16_f32 v115, v22, v23
    v_cvt_pk_bf16_f32 v116, v24, v25
    v_cvt_pk_bf16_f32 v117, v26, v27
    v_cvt_pk_bf16_f32 v118, v28, v29
    v_cvt_pk_bf16_f32 v119, v30, v31
    buffer_store_dwordx4 v[112:115], v234, s[20:23], s63 offen offset:0
    buffer_store_dwordx4 v[116:119], v234, s[20:23], s63 offen offset:32
    s_waitcnt lgkmcnt(4)
    v_add_f32 v32, v32, v192
    v_add_f32 v33, v33, v193
    v_add_f32 v34, v34, v194
    v_add_f32 v35, v35, v195
    v_add_f32 v36, v36, v196
    v_add_f32 v37, v37, v197
    v_add_f32 v38, v38, v198
    v_add_f32 v39, v39, v199
    v_add_f32 v40, v40, v200
    v_add_f32 v41, v41, v201
    v_add_f32 v42, v42, v202
    v_add_f32 v43, v43, v203
    v_add_f32 v44, v44, v204
    v_add_f32 v45, v45, v205
    v_add_f32 v46, v46, v206
    v_add_f32 v47, v47, v207
    v_cvt_pk_bf16_f32 v120, v32, v33
    v_cvt_pk_bf16_f32 v121, v34, v35
    v_cvt_pk_bf16_f32 v122, v36, v37
    v_cvt_pk_bf16_f32 v123, v38, v39
    v_cvt_pk_bf16_f32 v124, v40, v41
    v_cvt_pk_bf16_f32 v125, v42, v43
    v_cvt_pk_bf16_f32 v126, v44, v45
    v_cvt_pk_bf16_f32 v127, v46, v47
    buffer_store_dwordx4 v[120:123], v234, s[20:23], s63 offen offset:64
    buffer_store_dwordx4 v[124:127], v234, s[20:23], s63 offen offset:96
    s_waitcnt lgkmcnt(0)
    v_add_f32 v48, v48, v208
    v_add_f32 v49, v49, v209
    v_add_f32 v50, v50, v210
    v_add_f32 v51, v51, v211
    v_add_f32 v52, v52, v212
    v_add_f32 v53, v53, v213
    v_add_f32 v54, v54, v214
    v_add_f32 v55, v55, v215
    v_add_f32 v56, v56, v216
    v_add_f32 v57, v57, v217
    v_add_f32 v58, v58, v218
    v_add_f32 v59, v59, v219
    v_add_f32 v60, v60, v220
    v_add_f32 v61, v61, v221
    v_add_f32 v62, v62, v222
    v_add_f32 v63, v63, v223
    v_cvt_pk_bf16_f32 v128, v48, v49
    v_cvt_pk_bf16_f32 v129, v50, v51
    v_cvt_pk_bf16_f32 v130, v52, v53
    v_cvt_pk_bf16_f32 v131, v54, v55
    v_cvt_pk_bf16_f32 v132, v56, v57
    v_cvt_pk_bf16_f32 v133, v58, v59
    v_cvt_pk_bf16_f32 v134, v60, v61
    v_cvt_pk_bf16_f32 v135, v62, v63
    buffer_store_dwordx4 v[128:131], v234, s[20:23], s63 offen offset:128
    buffer_store_dwordx4 v[132:135], v234, s[20:23], s63 offen offset:160
    s_endpgm
F_P3_2:
    s_waitcnt vmcnt(40) lgkmcnt(15)
    s_mov_b32 s20, s6
    s_and_b32 s21, s7, 0xffff
    s_mov_b32 s22, 0x240000
    s_mov_b32 s23, 0x00020000
    v_mul_f32 v64, v64, v225
    v_mul_f32 v65, v65, v225
    v_mul_f32 v66, v66, v225
    v_mul_f32 v67, v67, v225
    v_mul_f32 v68, v68, v225
    v_mul_f32 v69, v69, v225
    v_mul_f32 v70, v70, v225
    v_mul_f32 v71, v71, v225
    v_mul_f32 v72, v72, v225
    v_mul_f32 v73, v73, v225
    v_mul_f32 v74, v74, v225
    v_mul_f32 v75, v75, v225
    v_mul_f32 v76, v76, v225
    v_mul_f32 v77, v77, v225
    v_mul_f32 v78, v78, v225
    v_mul_f32 v79, v79, v225
    v_mul_f32 v80, v80, v225
    v_mul_f32 v81, v81, v225
    v_mul_f32 v82, v82, v225
    v_mul_f32 v83, v83, v225
    v_mul_f32 v84, v84, v225
    v_mul_f32 v85, v85, v225
    v_mul_f32 v86, v86, v225
    v_mul_f32 v87, v87, v225
    v_mul_f32 v88, v88, v225
    v_mul_f32 v89, v89, v225
    v_mul_f32 v90, v90, v225
    v_mul_f32 v91, v91, v225
    v_mul_f32 v92, v92, v225
    v_mul_f32 v93, v93, v225
    v_mul_f32 v94, v94, v225
    v_mul_f32 v95, v95, v225
    v_mul_f32 v96, v96, v225
    v_mul_f32 v97, v97, v225
    v_mul_f32 v98, v98, v225
    v_mul_f32 v99, v99, v225
    v_mul_f32 v100, v100, v225
    v_mul_f32 v101, v101, v225
    v_mul_f32 v102, v102, v225
    v_mul_f32 v103, v103, v225
    v_mul_f32 v104, v104, v225
    v_mul_f32 v105, v105, v225
    v_mul_f32 v106, v106, v225
    v_mul_f32 v107, v107, v225
    v_mul_f32 v108, v108, v225
    v_mul_f32 v109, v109, v225
    v_mul_f32 v110, v110, v225
    v_mul_f32 v111, v111, v225
    s_waitcnt vmcnt(0)
    s_barrier
    s_mov_b32 s50, 2
    s_mov_b32 s51, 0
Q2_26:
    buffer_load_dword v238, v233, s[24:27], 0 offen sc0 sc1
    s_waitcnt vmcnt(0)
    v_cmp_eq_u32 vcc, v243, v238
    s_add_u32 s51, s51, 1
    s_nop 0
    s_cmp_eq_u32 vcc_lo, 0
    s_cselect_b32 s54, 1, 0
    s_and_b32 s53, vcc_hi, 7
    s_cmp_eq_u32 s53, 7
    s_cselect_b32 s53, 2, 0
    s_or_b32 s54, s54, s53
    s_cmp_lt_u32 s51, 20000
    s_cselect_b32 s54, s54, 3
    s_andn2_b32 s54, s54, s50
    s_cbranch_scc1 Q2_30
    s_sleep 4
    s_branch Q2_26
Q2_30:
    s_bitcmp1_b32 s54, 0
    s_cbranch_scc0 Q2_28
    s_add_u32 s46, s62, 0
    buffer_load_dwordx4 a[64:67], v229, s[24:27], s46 offen offset:0 sc0 sc1
    buffer_load_dwordx4 a[68:71], v229, s[24:27], s46 offen offset:1024 sc0 sc1
    buffer_load_dwordx4 a[72:75], v229, s[24:27], s46 offen offset:2048 sc0 sc1
    buffer_load_dwordx4 a[76:79], v229, s[24:27], s46 offen offset:3072 sc0 sc1
    s_add_u32 s47, s62, 4096
    buffer_load_dwordx4 a[80:83], v229, s[24:27], s47 offen offset:0 sc0 sc1
    buffer_load_dwordx4 a[84:87], v229, s[24:27], s47 offen offset:1024 sc0 sc1
    buffer_load_dwordx4 a[88:91], v229, s[24:27], s47 offen offset:2048 sc0 sc1
    buffer_load_dwordx4 a[92:95], v229, s[24:27], s47 offen offset:3072 sc0 sc1
    s_add_u32 s46, s62, 8192
    buffer_load_dwordx4 a[96:99], v229, s[24:27], s46 offen offset:0 sc0 sc1
    buffer_load_dwordx4 a[100:103], v229, s[24:27], s46 offen offset:1024 sc0 sc1
    buffer_load_dwordx4 a[104:107], v229, s[24:27], s46 offen offset:2048 sc0 sc1
    buffer_load_dwordx4 a[108:111], v229, s[24:27], s46 offen offset:3072 sc0 sc1
    s_add_u32 s47, s62, 12288
    buffer_load_dwordx4 a[112:115], v229, s[24:27], s47 offen offset:0 sc0 sc1
    buffer_load_dwordx4 a[116:119], v229, s[24:27], s47 offen offset:1024 sc0 sc1
    buffer_load_dwordx4 a[120:123], v229, s[24:27], s47 offen offset:2048 sc0 sc1
    buffer_load_dwordx4 a[124:127], v229, s[24:27], s47 offen offset:3072 sc0 sc1
    s_add_u32 s46, s62, 16384
    buffer_load_dwordx4 a[128:131], v229, s[24:27], s46 offen offset:0 sc0 sc1
    buffer_load_dwordx4 a[132:135], v229, s[24:27], s46 offen offset:1024 sc0 sc1
Q2_32:
    ds_read_b64_tr_b16 a[160:161], v228 offset:0
    ds_read_b64_tr_b16 a[162:163], v228 offset:1536
    ds_read_b64_tr_b16 a[164:165], v228 offset:64
    ds_read_b64_tr_b16 a[166:167], v228 offset:1600
    ds_read_b64_tr_b16 a[168:169], v228 offset:128
    ds_read_b64_tr_b16 a[170:171], v228 offset:1664
    ds_read_b64_tr_b16 a[172:173], v228 offset:3456
    ds_read_b64_tr_b16 a[174:175], v228 offset:4992
    ds_read_b64_tr_b16 a[176:177], v228 offset:3520
    ds_read_b64_tr_b16 a[178:179], v228 offset:5056
    ds_read_b64_tr_b16 a[180:181], v228 offset:3584
    ds_read_b64_tr_b16 a[182:183], v228 offset:5120
    ds_read_b64_tr_b16 a[184:185], v228 offset:6912
    ds_read_b64_tr_b16 a[186:187], v228 offset:8448
    ds_read_b64_tr_b16 a[188:189], v228 offset:6976
    ds_read_b64_tr_b16 a[190:191], v228 offset:8512
    s_waitcnt vmcnt(17)
    v_accvgpr_read_b32 v160, a64
    s_waitcnt lgkmcnt(8)
    v_mfma_f32_32x32x16_bf16 v[176:191], a[160:163], a[64:67], 0
    ds_read_b64_tr_b16 a[192:193], v228 offset:7040
    ds_read_b64_tr_b16 a[194:195], v228 offset:8576
    v_accvgpr_read_b32 v161, a65
    v_accvgpr_read_b32 v162, a66
    v_accvgpr_read_b32 v163, a67
    v_mfma_f32_32x32x16_bf16 v[192:207], a[164:167], a[64:67], 0
    ds_read_b64_tr_b16 a[196:197], v228 offset:10368
    ds_read_b64_tr_b16 a[198:199], v228 offset:11904
    v_max_u32 v168, v160, v161
    v_max3_u32 v168, v162, v163, v168
    s_waitcnt vmcnt(16)
    v_accvgpr_read_b32 v164, a68
    v_accvgpr_read_b32 v165, a69
    v_mfma_f32_32x32x16_bf16 v[208:223], a[168:171], a[64:67], 0
    ds_read_b64_tr_b16 a[200:201], v228 offset:10432
    ds_read_b64_tr_b16 a[202:203], v228 offset:11968
    v_accvgpr_read_b32 v166, a70
    v_accvgpr_read_b32 v167, a71
    v_max3_u32 v168, v164, v165, v168
    v_max3_u32 v168, v166, v167, v168
    v_mfma_f32_32x32x16_bf16 v[176:191], a[172:175], a[68:71], v[176:191]
    ds_read_b64_tr_b16 a[204:205], v228 offset:10496
    ds_read_b64_tr_b16 a[206:207], v228 offset:12032
    s_waitcnt vmcnt(15)
    v_accvgpr_read_b32 v160, a72
    v_accvgpr_read_b32 v161, a73
    v_accvgpr_read_b32 v162, a74
    v_accvgpr_read_b32 v163, a75
    s_waitcnt lgkmcnt(8)
    v_mfma_f32_32x32x16_bf16 v[192:207], a[176:179], a[68:71], v[192:207]
    ds_read_b64_tr_b16 a[160:161], v228 offset:13824
    ds_read_b64_tr_b16 a[162:163], v228 offset:15360
    v_max3_u32 v168, v160, v161, v168
    v_max3_u32 v168, v162, v163, v168
    s_waitcnt vmcnt(14)
    v_accvgpr_read_b32 v164, a76
    v_accvgpr_read_b32 v165, a77
    v_mfma_f32_32x32x16_bf16 v[208:223], a[180:183], a[68:71], v[208:223]
    ds_read_b64_tr_b16 a[164:165], v228 offset:13888
    ds_read_b64_tr_b16 a[166:167], v228 offset:15424
    v_accvgpr_read_b32 v166, a78
    v_accvgpr_read_b32 v167, a79
    v_max3_u32 v168, v164, v165, v168
    v_max3_u32 v168, v166, v167, v168
    v_mfma_f32_32x32x16_bf16 v[176:191], a[184:187], a[72:75], v[176:191]
    ds_read_b64_tr_b16 a[168:169], v228 offset:13952
    ds_read_b64_tr_b16 a[170:171], v228 offset:15488
    s_waitcnt vmcnt(13)
    v_accvgpr_read_b32 v160, a80
    v_accvgpr_read_b32 v161, a81
    v_accvgpr_read_b32 v162, a82
    v_mfma_f32_32x32x16_bf16 v[192:207], a[188:191], a[72:75], v[192:207]
    ds_read_b64_tr_b16 a[172:173], v228 offset:17280
    ds_read_b64_tr_b16 a[174:175], v228 offset:18816
    v_accvgpr_read_b32 v163, a83
    v_max3_u32 v168, v160, v161, v168
    v_max3_u32 v168, v162, v163, v168
    s_waitcnt vmcnt(12)
    v_accvgpr_read_b32 v164, a84
    s_waitcnt lgkmcnt(8)
    v_mfma_f32_32x32x16_bf16 v[208:223], a[192:195], a[72:75], v[208:223]
    ds_read_b64_tr_b16 a[176:177], v228 offset:17344
    ds_read_b64_tr_b16 a[178:179], v228 offset:18880
    v_accvgpr_read_b32 v165, a85
    v_accvgpr_read_b32 v166, a86
    v_accvgpr_read_b32 v167, a87
    v_max3_u32 v168, v164, v165, v168
    v_mfma_f32_32x32x16_bf16 v[176:191], a[196:199], a[76:79], v[176:191]
    ds_read_b64_tr_b16 a[180:181], v228 offset:17408
    ds_read_b64_tr_b16 a[182:183], v228 offset:18944
    v_max3_u32 v168, v166, v167, v168
    s_waitcnt vmcnt(11)
    v_accvgpr_read_b32 v160, a88
    v_accvgpr_read_b32 v161, a89
    v_accvgpr_read_b32 v162, a90
    v_mfma_f32_32x32x16_bf16 v[192:207], a[200:203], a[76:79], v[192:207]
    ds_read_b64_tr_b16 a[184:185], v228 offset:20736
    ds_read_b64_tr_b16 a[186:187], v228 offset:22272
    v_accvgpr_read_b32 v163, a91
    v_max3_u32 v168, v160, v161, v168
    v_max3_u32 v168, v162, v163, v168
    v_mfma_f32_32x32x16_bf16 v[208:223], a[204:207], a[76:79], v[208:223]
    ds_read_b64_tr_b16 a[188:189], v228 offset:20800
    ds_read_b64_tr_b16 a[190:191], v228 offset:22336
    s_waitcnt vmcnt(10)
    v_accvgpr_read_b32 v164, a92
    v_accvgpr_read_b32 v165, a93
    v_accvgpr_read_b32 v166, a94
    v_accvgpr_read_b32 v167, a95
    s_waitcnt lgkmcnt(8)
    v_mfma_f32_32x32x16_bf16 v[176:191], a[160:163], a[80:83], v[176:191]
    ds_read_b64_tr_b16 a[192:193], v228 offset:20864
    ds_read_b64_tr_b16 a[194:195], v228 offset:22400
    v_max3_u32 v168, v164, v165, v168
    v_max3_u32 v168, v166, v167, v168
    s_waitcnt vmcnt(9)
    v_accvgpr_read_b32 v160, a96
    v_accvgpr_read_b32 v161, a97
    v_mfma_f32_32x32x16_bf16 v[192:207], a[164:167], a[80:83], v[192:207]
    ds_read_b64_tr_b16 a[196:197], v228 offset:24192
    ds_read_b64_tr_b16 a[198:199], v228 offset:25728
    v_accvgpr_read_b32 v162, a98
    v_accvgpr_read_b32 v163, a99
    v_max3_u32 v168, v160, v161, v168
    v_max3_u32 v168, v162, v163, v168
    v_mfma_f32_32x32x16_bf16 v[208:223], a[168:171], a[80:83], v[208:223]
    ds_read_b64_tr_b16 a[200:201], v228 offset:24256
    ds_read_b64_tr_b16 a[202:203], v228 offset:25792
    s_waitcnt vmcnt(8)
    v_accvgpr_read_b32 v164, a100
    v_accvgpr_read_b32 v165, a101
    v_accvgpr_read_b32 v166, a102
    v_mfma_f32_32x32x16_bf16 v[176:191], a[172:175], a[84:87], v[176:191]
    ds_read_b64_tr_b16 a[204:205], v228 offset:24320
    ds_read_b64_tr_b16 a[206:207], v228 offset:25856
    v_accvgpr_read_b32 v167, a103
    v_max3_u32 v168, v164, v165, v168
    v_max3_u32 v168, v166, v167, v168
    s_waitcnt vmcnt(7)
    v_accvgpr_read_b32 v160, a104
    s_waitcnt lgkmcnt(8)
    v_mfma_f32_32x32x16_bf16 v[192:207], a[176:179], a[84:87], v[192:207]
    ds_read_b64_tr_b16 a[160:161], v228 offset:27648
    ds_read_b64_tr_b16 a[162:163], v228 offset:29184
    v_accvgpr_read_b32 v161, a105
    v_accvgpr_read_b32 v162, a106
    v_accvgpr_read_b32 v163, a107
    v_max3_u32 v168, v160, v161, v168
    v_mfma_f32_32x32x16_bf16 v[208:223], a[180:183], a[84:87], v[208:223]
    ds_read_b64_tr_b16 a[164:165], v228 offset:27712
    ds_read_b64_tr_b16 a[166:167], v228 offset:29248
    v_max3_u32 v168, v162, v163, v168
    s_waitcnt vmcnt(6)
    v_accvgpr_read_b32 v164, a108
    v_accvgpr_read_b32 v165, a109
    v_accvgpr_read_b32 v166, a110
    v_mfma_f32_32x32x16_bf16 v[176:191], a[184:187], a[88:91], v[176:191]
    ds_read_b64_tr_b16 a[168:169], v228 offset:27776
    ds_read_b64_tr_b16 a[170:171], v228 offset:29312
    v_accvgpr_read_b32 v167, a111
    v_max3_u32 v168, v164, v165, v168
    v_max3_u32 v168, v166, v167, v168
    v_mfma_f32_32x32x16_bf16 v[192:207], a[188:191], a[88:91], v[192:207]
    ds_read_b64_tr_b16 a[172:173], v228 offset:31104
    ds_read_b64_tr_b16 a[174:175], v228 offset:32640
    s_waitcnt vmcnt(5)
    v_accvgpr_read_b32 v160, a112
    v_accvgpr_read_b32 v161, a113
    v_accvgpr_read_b32 v162, a114
    v_accvgpr_read_b32 v163, a115
    s_waitcnt lgkmcnt(8)
    v_mfma_f32_32x32x16_bf16 v[208:223], a[192:195], a[88:91], v[208:223]
    ds_read_b64_tr_b16 a[176:177], v228 offset:31168
    ds_read_b64_tr_b16 a[178:179], v228 offset:32704
    v_max3_u32 v168, v160, v161, v168
    v_max3_u32 v168, v162, v163, v168
    s_waitcnt vmcnt(4)
    v_accvgpr_read_b32 v164, a116
    v_accvgpr_read_b32 v165, a117
    v_mfma_f32_32x32x16_bf16 v[176:191], a[196:199], a[92:95], v[176:191]
    ds_read_b64_tr_b16 a[180:181], v228 offset:31232
    ds_read_b64_tr_b16 a[182:183], v228 offset:32768
    v_accvgpr_read_b32 v166, a118
    v_accvgpr_read_b32 v167, a119
    v_max3_u32 v168, v164, v165, v168
    v_max3_u32 v168, v166, v167, v168
    v_mfma_f32_32x32x16_bf16 v[192:207], a[200:203], a[92:95], v[192:207]
    ds_read_b64_tr_b16 a[184:185], v228 offset:34560
    ds_read_b64_tr_b16 a[186:187], v228 offset:36096
    s_waitcnt vmcnt(3)
    v_accvgpr_read_b32 v160, a120
    v_accvgpr_read_b32 v161, a121
    v_accvgpr_read_b32 v162, a122
    v_mfma_f32_32x32x16_bf16 v[208:223], a[204:207], a[92:95], v[208:223]
    ds_read_b64_tr_b16 a[188:189], v228 offset:34624
    ds_read_b64_tr_b16 a[190:191], v228 offset:36160
    v_accvgpr_read_b32 v163, a123
    v_max3_u32 v168, v160, v161, v168
    v_max3_u32 v168, v162, v163, v168
    s_waitcnt vmcnt(2)
    v_accvgpr_read_b32 v164, a124
    s_waitcnt lgkmcnt(8)
    v_mfma_f32_32x32x16_bf16 v[176:191], a[160:163], a[96:99], v[176:191]
    ds_read_b64_tr_b16 a[192:193], v228 offset:34688
    ds_read_b64_tr_b16 a[194:195], v228 offset:36224
    v_accvgpr_read_b32 v165, a125
    v_accvgpr_read_b32 v166, a126
    v_accvgpr_read_b32 v167, a127
    v_max3_u32 v168, v164, v165, v168
    v_mfma_f32_32x32x16_bf16 v[192:207], a[164:167], a[96:99], v[192:207]
    ds_read_b64_tr_b16 a[196:197], v228 offset:38016
    ds_read_b64_tr_b16 a[198:199], v228 offset:39552
    v_max3_u32 v168, v166, v167, v168
    s_waitcnt vmcnt(1)
    v_accvgpr_read_b32 v160, a128
    v_accvgpr_read_b32 v161, a129
    v_accvgpr_read_b32 v162, a130
    v_mfma_f32_32x32x16_bf16 v[208:223], a[168:171], a[96:99], v[208:223]
    ds_read_b64_tr_b16 a[200:201], v228 offset:38080
    ds_read_b64_tr_b16 a[202:203], v228 offset:39616
    v_accvgpr_read_b32 v163, a131
    v_max3_u32 v168, v160, v161, v168
    v_max3_u32 v168, v162, v163, v168
    v_mfma_f32_32x32x16_bf16 v[176:191], a[172:175], a[100:103], v[176:191]
    ds_read_b64_tr_b16 a[204:205], v228 offset:38144
    ds_read_b64_tr_b16 a[206:207], v228 offset:39680
    s_waitcnt vmcnt(0)
    v_accvgpr_read_b32 v164, a132
    v_accvgpr_read_b32 v165, a133
    v_accvgpr_read_b32 v166, a134
    v_accvgpr_read_b32 v167, a135
    s_waitcnt lgkmcnt(8)
    v_mfma_f32_32x32x16_bf16 v[192:207], a[176:179], a[100:103], v[192:207]
    ds_read_b64_tr_b16 a[160:161], v228 offset:41472
    ds_read_b64_tr_b16 a[162:163], v228 offset:43008
    v_max3_u32 v168, v164, v165, v168
    v_max3_u32 v168, v166, v167, v168
    v_cmp_eq_u32 vcc, -1, v168
    v_mfma_f32_32x32x16_bf16 v[208:223], a[180:183], a[100:103], v[208:223]
    ds_read_b64_tr_b16 a[164:165], v228 offset:41536
    ds_read_b64_tr_b16 a[166:167], v228 offset:43072
    v_mfma_f32_32x32x16_bf16 v[176:191], a[184:187], a[104:107], v[176:191]
    ds_read_b64_tr_b16 a[168:169], v228 offset:41600
    ds_read_b64_tr_b16 a[170:171], v228 offset:43136
    v_mfma_f32_32x32x16_bf16 v[192:207], a[188:191], a[104:107], v[192:207]
    ds_read_b64_tr_b16 a[172:173], v228 offset:44928
    ds_read_b64_tr_b16 a[174:175], v228 offset:46464
    s_waitcnt lgkmcnt(8)
    v_mfma_f32_32x32x16_bf16 v[208:223], a[192:195], a[104:107], v[208:223]
    ds_read_b64_tr_b16 a[176:177], v228 offset:44992
    ds_read_b64_tr_b16 a[178:179], v228 offset:46528
    v_mfma_f32_32x32x16_bf16 v[176:191], a[196:199], a[108:111], v[176:191]
    ds_read_b64_tr_b16 a[180:181], v228 offset:45056
    ds_read_b64_tr_b16 a[182:183], v228 offset:46592
    v_mfma_f32_32x32x16_bf16 v[192:207], a[200:203], a[108:111], v[192:207]
    ds_read_b64_tr_b16 a[184:185], v228 offset:48384
    ds_read_b64_tr_b16 a[186:187], v228 offset:49920
    v_mfma_f32_32x32x16_bf16 v[208:223], a[204:207], a[108:111], v[208:223]
    ds_read_b64_tr_b16 a[188:189], v228 offset:48448
    ds_read_b64_tr_b16 a[190:191], v228 offset:49984
    s_waitcnt lgkmcnt(8)
    v_mfma_f32_32x32x16_bf16 v[176:191], a[160:163], a[112:115], v[176:191]
    ds_read_b64_tr_b16 a[192:193], v228 offset:48512
    ds_read_b64_tr_b16 a[194:195], v228 offset:50048
    v_mfma_f32_32x32x16_bf16 v[192:207], a[164:167], a[112:115], v[192:207]
    ds_read_b64_tr_b16 a[196:197], v228 offset:51840
    ds_read_b64_tr_b16 a[198:199], v228 offset:53376
    v_mfma_f32_32x32x16_bf16 v[208:223], a[168:171], a[112:115], v[208:223]
    ds_read_b64_tr_b16 a[200:201], v228 offset:51904
    ds_read_b64_tr_b16 a[202:203], v228 offset:53440
    v_mfma_f32_32x32x16_bf16 v[176:191], a[172:175], a[116:119], v[176:191]
    ds_read_b64_tr_b16 a[204:205], v228 offset:51968
    ds_read_b64_tr_b16 a[206:207], v228 offset:53504
    s_waitcnt lgkmcnt(8)
    v_mfma_f32_32x32x16_bf16 v[192:207], a[176:179], a[116:119], v[192:207]
    ds_read_b64_tr_b16 a[160:161], v228 offset:55296
    ds_read_b64_tr_b16 a[162:163], v228 offset:56832
    v_mfma_f32_32x32x16_bf16 v[208:223], a[180:183], a[116:119], v[208:223]
    ds_read_b64_tr_b16 a[164:165], v228 offset:55360
    ds_read_b64_tr_b16 a[166:167], v228 offset:56896
    v_mfma_f32_32x32x16_bf16 v[176:191], a[184:187], a[120:123], v[176:191]
    ds_read_b64_tr_b16 a[168:169], v228 offset:55424
    ds_read_b64_tr_b16 a[170:171], v228 offset:56960
    v_mfma_f32_32x32x16_bf16 v[192:207], a[188:191], a[120:123], v[192:207]
    ds_read_b64_tr_b16 a[172:173], v228 offset:58752
    ds_read_b64_tr_b16 a[174:175], v228 offset:60288
    s_waitcnt lgkmcnt(8)
    v_mfma_f32_32x32x16_bf16 v[208:223], a[192:195], a[120:123], v[208:223]
    ds_read_b64_tr_b16 a[176:177], v228 offset:58816
    ds_read_b64_tr_b16 a[178:179], v228 offset:60352
    v_mfma_f32_32x32x16_bf16 v[176:191], a[196:199], a[124:127], v[176:191]
    ds_read_b64_tr_b16 a[180:181], v228 offset:58880
    ds_read_b64_tr_b16 a[182:183], v228 offset:60416
    v_mfma_f32_32x32x16_bf16 v[192:207], a[200:203], a[124:127], v[192:207]
    v_mfma_f32_32x32x16_bf16 v[208:223], a[204:207], a[124:127], v[208:223]
    s_waitcnt lgkmcnt(4)
    v_mfma_f32_32x32x16_bf16 v[176:191], a[160:163], a[128:131], v[176:191]
    v_mfma_f32_32x32x16_bf16 v[192:207], a[164:167], a[128:131], v[192:207]
    v_mfma_f32_32x32x16_bf16 v[208:223], a[168:171], a[128:131], v[208:223]
    v_mfma_f32_32x32x16_bf16 v[176:191], a[172:175], a[132:135], v[176:191]
    s_waitcnt lgkmcnt(0)
    v_mfma_f32_32x32x16_bf16 v[192:207], a[176:179], a[132:135], v[192:207]
    s_nop 9
    v_mul_f32 v176, v176, v224
    v_mfma_f32_32x32x16_bf16 v[208:223], a[180:183], a[132:135], v[208:223]
    v_mul_f32 v177, v177, v224
    v_mul_f32 v178, v178, v224
    v_mul_f32 v179, v179, v224
    v_mul_f32 v180, v180, v224
    v_mul_f32 v181, v181, v224
    v_mul_f32 v182, v182, v224
    v_mul_f32 v183, v183, v224
    v_mul_f32 v184, v184, v224
    v_mul_f32 v185, v185, v224
    v_mul_f32 v186, v186, v224
    v_mul_f32 v187, v187, v224
    v_mul_f32 v188, v188, v224
    v_mul_f32 v189, v189, v224
    v_mul_f32 v190, v190, v224
    v_mul_f32 v191, v191, v224
    v_mul_f32 v192, v192, v224
    v_mul_f32 v193, v193, v224
    v_mul_f32 v194, v194, v224
    v_mul_f32 v195, v195, v224
    v_mul_f32 v196, v196, v224
    v_mul_f32 v197, v197, v224
    v_mul_f32 v198, v198, v224
    v_mul_f32 v199, v199, v224
    v_mul_f32 v200, v200, v224
    v_mul_f32 v201, v201, v224
    v_mul_f32 v202, v202, v224
    v_mul_f32 v203, v203, v224
    v_mul_f32 v204, v204, v224
    v_mul_f32 v205, v205, v224
    v_mul_f32 v206, v206, v224
    v_mul_f32 v207, v207, v224
    v_mul_f32 v208, v208, v224
    v_mul_f32 v209, v209, v224
    v_mul_f32 v210, v210, v224
    v_mul_f32 v211, v211, v224
    v_mul_f32 v212, v212, v224
    v_mul_f32 v213, v213, v224
    v_mul_f32 v214, v214, v224
    v_mul_f32 v215, v215, v224
    v_mul_f32 v216, v216, v224
    v_mul_f32 v217, v217, v224
    v_mul_f32 v218, v218, v224
    v_mul_f32 v219, v219, v224
    v_mul_f32 v220, v220, v224
    v_mul_f32 v221, v221, v224
    v_mul_f32 v222, v222, v224
    v_mul_f32 v223, v223, v224
    s_cmp_eq_u64 vcc, 0
    s_cselect_b32 s53, 1, 0
    s_cmp_lt_u32 s51, 20000
    s_cselect_b32 s53, s53, 1
    s_or_b32 s50, s50, s53
Q2_28:
    s_cmp_eq_u32 s50, 3
    s_cbranch_scc0 Q2_26
    v_add_f32 v64, v64, v176
    v_add_f32 v65, v65, v177
    v_add_f32 v66, v66, v178
    v_add_f32 v67, v67, v179
    v_add_f32 v68, v68, v180
    v_add_f32 v69, v69, v181
    v_add_f32 v70, v70, v182
    v_add_f32 v71, v71, v183
    v_add_f32 v72, v72, v184
    v_add_f32 v73, v73, v185
    v_add_f32 v74, v74, v186
    v_add_f32 v75, v75, v187
    v_add_f32 v76, v76, v188
    v_add_f32 v77, v77, v189
    v_add_f32 v78, v78, v190
    v_add_f32 v79, v79, v191
    v_add_f32 v80, v80, v192
    v_add_f32 v81, v81, v193
    v_add_f32 v82, v82, v194
    v_add_f32 v83, v83, v195
    v_add_f32 v84, v84, v196
    v_add_f32 v85, v85, v197
    v_add_f32 v86, v86, v198
    v_add_f32 v87, v87, v199
    v_add_f32 v88, v88, v200
    v_add_f32 v89, v89, v201
    v_add_f32 v90, v90, v202
    v_add_f32 v91, v91, v203
    v_add_f32 v92, v92, v204
    v_add_f32 v93, v93, v205
    v_add_f32 v94, v94, v206
    v_add_f32 v95, v95, v207
    v_add_f32 v96, v96, v208
    v_add_f32 v97, v97, v209
    v_add_f32 v98, v98, v210
    v_add_f32 v99, v99, v211
    v_add_f32 v100, v100, v212
    v_add_f32 v101, v101, v213
    v_add_f32 v102, v102, v214
    v_add_f32 v103, v103, v215
    v_add_f32 v104, v104, v216
    v_add_f32 v105, v105, v217
    v_add_f32 v106, v106, v218
    v_add_f32 v107, v107, v219
    v_add_f32 v108, v108, v220
    v_add_f32 v109, v109, v221
    v_add_f32 v110, v110, v222
    v_add_f32 v111, v111, v223
    s_waitcnt lgkmcnt(0)
    s_barrier
    ds_read_b128 v[176:179], v232 offset:0
    ds_read_b128 v[180:183], v232 offset:1024
    ds_read_b128 v[184:187], v232 offset:2048
    ds_read_b128 v[188:191], v232 offset:3072
    ds_read_b128 v[192:195], v232 offset:4096
    ds_read_b128 v[196:199], v232 offset:5120
    ds_read_b128 v[200:203], v232 offset:6144
    ds_read_b128 v[204:207], v232 offset:7168
    ds_read_b128 v[208:211], v232 offset:8192
    ds_read_b128 v[212:215], v232 offset:9216
    ds_read_b128 v[216:219], v232 offset:10240
    ds_read_b128 v[220:223], v232 offset:11264
    s_waitcnt lgkmcnt(8)
    v_add_f32 v64, v64, v176
    v_add_f32 v65, v65, v177
    v_add_f32 v66, v66, v178
    v_add_f32 v67, v67, v179
    v_add_f32 v68, v68, v180
    v_add_f32 v69, v69, v181
    v_add_f32 v70, v70, v182
    v_add_f32 v71, v71, v183
    v_add_f32 v72, v72, v184
    v_add_f32 v73, v73, v185
    v_add_f32 v74, v74, v186
    v_add_f32 v75, v75, v187
    v_add_f32 v76, v76, v188
    v_add_f32 v77, v77, v189
    v_add_f32 v78, v78, v190
    v_add_f32 v79, v79, v191
    v_cvt_pk_bf16_f32 v112, v64, v65
    v_cvt_pk_bf16_f32 v113, v66, v67
    v_cvt_pk_bf16_f32 v114, v68, v69
    v_cvt_pk_bf16_f32 v115, v70, v71
    v_cvt_pk_bf16_f32 v116, v72, v73
    v_cvt_pk_bf16_f32 v117, v74, v75
    v_cvt_pk_bf16_f32 v118, v76, v77
    v_cvt_pk_bf16_f32 v119, v78, v79
    buffer_store_dwordx4 v[112:115], v234, s[20:23], s63 offen offset:0
    buffer_store_dwordx4 v[116:119], v234, s[20:23], s63 offen offset:32
    s_waitcnt lgkmcnt(4)
    v_add_f32 v80, v80, v192
    v_add_f32 v81, v81, v193
    v_add_f32 v82, v82, v194
    v_add_f32 v83, v83, v195
    v_add_f32 v84, v84, v196
    v_add_f32 v85, v85, v197
    v_add_f32 v86, v86, v198
    v_add_f32 v87, v87, v199
    v_add_f32 v88, v88, v200
    v_add_f32 v89, v89, v201
    v_add_f32 v90, v90, v202
    v_add_f32 v91, v91, v203
    v_add_f32 v92, v92, v204
    v_add_f32 v93, v93, v205
    v_add_f32 v94, v94, v206
    v_add_f32 v95, v95, v207
    v_cvt_pk_bf16_f32 v120, v80, v81
    v_cvt_pk_bf16_f32 v121, v82, v83
    v_cvt_pk_bf16_f32 v122, v84, v85
    v_cvt_pk_bf16_f32 v123, v86, v87
    v_cvt_pk_bf16_f32 v124, v88, v89
    v_cvt_pk_bf16_f32 v125, v90, v91
    v_cvt_pk_bf16_f32 v126, v92, v93
    v_cvt_pk_bf16_f32 v127, v94, v95
    buffer_store_dwordx4 v[120:123], v234, s[20:23], s63 offen offset:64
    buffer_store_dwordx4 v[124:127], v234, s[20:23], s63 offen offset:96
    s_waitcnt lgkmcnt(0)
    v_add_f32 v96, v96, v208
    v_add_f32 v97, v97, v209
    v_add_f32 v98, v98, v210
    v_add_f32 v99, v99, v211
    v_add_f32 v100, v100, v212
    v_add_f32 v101, v101, v213
    v_add_f32 v102, v102, v214
    v_add_f32 v103, v103, v215
    v_add_f32 v104, v104, v216
    v_add_f32 v105, v105, v217
    v_add_f32 v106, v106, v218
    v_add_f32 v107, v107, v219
    v_add_f32 v108, v108, v220
    v_add_f32 v109, v109, v221
    v_add_f32 v110, v110, v222
    v_add_f32 v111, v111, v223
    v_cvt_pk_bf16_f32 v128, v96, v97
    v_cvt_pk_bf16_f32 v129, v98, v99
    v_cvt_pk_bf16_f32 v130, v100, v101
    v_cvt_pk_bf16_f32 v131, v102, v103
    v_cvt_pk_bf16_f32 v132, v104, v105
    v_cvt_pk_bf16_f32 v133, v106, v107
    v_cvt_pk_bf16_f32 v134, v108, v109
    v_cvt_pk_bf16_f32 v135, v110, v111
    buffer_store_dwordx4 v[128:131], v234, s[20:23], s63 offen offset:128
    buffer_store_dwordx4 v[132:135], v234, s[20:23], s63 offen offset:160
    s_endpgm
K1_QKV:
    s_and_b32 s33, s2, 3
    s_lshl_b32 s33, s33, 1
    s_bfe_u32 s45, s2, 0x10003
    s_add_u32 s33, s33, s45
    s_bfe_u32 s34, s2, 0x20004
    s_and_b32 s45, s2, 4
    s_add_u32 s34, s34, s45
    s_lshl_b32 s38, s34, 3
    s_add_u32 s38, s38, s33
    s_lshl_b32 s38, s38, 9
    s_add_u32 s38, s38, 28393856
    s_lshl_b32 s39, s34, 3
    s_lshl_b32 s45, s32, 1
    s_add_u32 s39, s39, s45
    s_mul_i32 s40, s39, 36864
    s_lshl_b32 s54, s32, 13
    s_add_u32 s59, s54, 73728
    s_lshl_b32 s54, s32, 12
    s_add_u32 s54, s54, 110848
    s_mov_b32 s42, 0
    s_mov_b32 s43, 0
    v_lshrrev_b32 v12, 2, v0
    v_mul_u32_u24 v12, 1152, v12
    v_bfe_u32 v13, v0, 4, 2
    v_and_b32 v14, 3, v0
    v_xor_b32 v13, v13, v14
    v_lshl_add_u32 v1, v13, 4, v12
    v_add_u32 v2, 17408, v1
    v_add_u32 v3, 34816, v1
    v_add_u32 v4, 52224, v1
    s_add_u32 m0, s59, 0
    s_nop 0
    buffer_load_dwordx4 v1, s[16:19], s40 offen offset:0 lds
    buffer_load_dwordx4 v2, s[16:19], s40 offen offset:1024 lds
    buffer_load_dwordx4 v3, s[16:19], s40 offen offset:2048 lds
    buffer_load_dwordx4 v4, s[16:19], s40 offen offset:3072 lds
    s_add_u32 s40, s40, 64
    s_add_u32 m0, s59, 4096
    s_nop 0
    buffer_load_dwordx4 v1, s[16:19], s40 offen offset:0 lds
    buffer_load_dwordx4 v2, s[16:19], s40 offen offset:1024 lds
    buffer_load_dwordx4 v3, s[16:19], s40 offen offset:2048 lds
    buffer_load_dwordx4 v4, s[16:19], s40 offen offset:3072 lds
    s_add_u32 s40, s40, 64
    s_mov_b32 s20, s66
    s_and_b32 s21, s67, 0xffff
    s_mov_b32 s22, 0x1e6000
    s_mov_b32 s23, 0x00020000
    s_mul_i32 s36, s33, 144
    s_and_b32 s35, s36, 63
    s_sub_u32 s48, s36, s35
    s_add_u32 s60, s48, 442368
    s_mul_i32 s52, s32, 55296
    s_add_u32 s48, s48, s52
    s_mul_i32 s49, s32, 9216
    s_add_u32 s50, s49, 36864
    s_add_u32 s51, s49, 73728
    s_mov_b32 s52, 58255
    s_mov_b32 s53, 43691
    v_add_u32 v12, 0, v0
    v_mul_lo_u32 v13, v12, s52
    v_lshrrev_b32 v13, 21, v13
    v_mul_u32_u24 v14, 36, v13
    v_sub_u32 v14, v12, v14
    v_mul_u32_u24 v15, 43, v14
    v_lshrrev_b32 v15, 9, v15
    v_mul_u32_u24 v13, 3456, v13
    v_mul_u32_u24 v15, 960, v15
    v_lshl_add_u32 v13, v14, 4, v13
    v_add_u32 v240, v13, v15
    s_add_u32 m0, s49, 0
    s_nop 0
    buffer_load_dwordx4 v240, s[20:23], s48 offen offset:0  lds
    v_add_u32 v12, 64, v0
    v_mul_lo_u32 v13, v12, s52
    v_lshrrev_b32 v13, 21, v13
    v_mul_u32_u24 v14, 36, v13
    v_sub_u32 v14, v12, v14
    v_mul_u32_u24 v15, 43, v14
    v_lshrrev_b32 v15, 9, v15
    v_mul_u32_u24 v13, 3456, v13
    v_mul_u32_u24 v15, 960, v15
    v_lshl_add_u32 v13, v14, 4, v13
    v_subrev_u32 v13, 1024, v13
    v_add_u32 v241, v13, v15
    buffer_load_dwordx4 v241, s[20:23], s48 offen offset:1024  lds
    v_add_u32 v12, 128, v0
    v_mul_lo_u32 v13, v12, s52
    v_lshrrev_b32 v13, 21, v13
    v_mul_u32_u24 v14, 36, v13
    v_sub_u32 v14, v12, v14
    v_mul_u32_u24 v15, 43, v14
    v_lshrrev_b32 v15, 9, v15
    v_mul_u32_u24 v13, 3456, v13
    v_mul_u32_u24 v15, 960, v15
    v_lshl_add_u32 v13, v14, 4, v13
    v_subrev_u32 v13, 2048, v13
    v_add_u32 v242, v13, v15
    buffer_load_dwordx4 v242, s[20:23], s48 offen offset:2048  lds
    v_add_u32 v12, 192, v0
    v_mul_lo_u32 v13, v12, s52
    v_lshrrev_b32 v13, 21, v13
    v_mul_u32_u24 v14, 36, v13
    v_sub_u32 v14, v12, v14
    v_mul_u32_u24 v15, 43, v14
    v_lshrrev_b32 v15, 9, v15
    v_mul_u32_u24 v13, 3456, v13
    v_mul_u32_u24 v15, 960, v15
    v_lshl_add_u32 v13, v14, 4, v13
    v_add_u32 v243, v13, v15
    s_add_u32 m0, s49, 3072
    s_nop 0
    buffer_load_dwordx4 v243, s[20:23], s48 offen offset:0  lds
    v_add_u32 v12, 256, v0
    v_mul_lo_u32 v13, v12, s52
    v_lshrrev_b32 v13, 21, v13
    v_mul_u32_u24 v14, 36, v13
    v_sub_u32 v14, v12, v14
    v_mul_u32_u24 v15, 43, v14
    v_lshrrev_b32 v15, 9, v15
    v_mul_u32_u24 v13, 3456, v13
    v_mul_u32_u24 v15, 960, v15
    v_lshl_add_u32 v13, v14, 4, v13
    v_subrev_u32 v13, 1024, v13
    v_add_u32 v244, v13, v15
    buffer_load_dwordx4 v244, s[20:23], s48 offen offset:1024  lds
    v_add_u32 v12, 320, v0
    v_mul_lo_u32 v13, v12, s52
    v_lshrrev_b32 v13, 21, v13
    v_mul_u32_u24 v14, 36, v13
    v_sub_u32 v14, v12, v14
    v_mul_u32_u24 v15, 43, v14
    v_lshrrev_b32 v15, 9, v15
    v_mul_u32_u24 v13, 3456, v13
    v_mul_u32_u24 v15, 960, v15
    v_lshl_add_u32 v13, v14, 4, v13
    v_subrev_u32 v13, 2048, v13
    v_add_u32 v245, v13, v15
    buffer_load_dwordx4 v245, s[20:23], s48 offen offset:2048  lds
    v_add_u32 v12, 384, v0
    v_mul_lo_u32 v13, v12, s52
    v_lshrrev_b32 v13, 21, v13
    v_mul_u32_u24 v14, 36, v13
    v_sub_u32 v14, v12, v14
    v_mul_u32_u24 v15, 43, v14
    v_lshrrev_b32 v15, 9, v15
    v_mul_u32_u24 v13, 3456, v13
    v_mul_u32_u24 v15, 960, v15
    v_lshl_add_u32 v13, v14, 4, v13
    v_add_u32 v246, v13, v15
    s_add_u32 m0, s49, 6144
    s_nop 0
    buffer_load_dwordx4 v246, s[20:23], s48 offen offset:0  lds
    v_add_u32 v12, 448, v0
    v_mul_lo_u32 v13, v12, s52
    v_lshrrev_b32 v13, 21, v13
    v_mul_u32_u24 v14, 36, v13
    v_sub_u32 v14, v12, v14
    v_mul_u32_u24 v15, 43, v14
    v_lshrrev_b32 v15, 9, v15
    v_mul_u32_u24 v13, 3456, v13
    v_mul_u32_u24 v15, 960, v15
    v_lshl_add_u32 v13, v14, 4, v13
    v_subrev_u32 v13, 1024, v13
    v_add_u32 v247, v13, v15
    buffer_load_dwordx4 v247, s[20:23], s48 offen offset:1024  lds
    v_add_u32 v12, 512, v0
    v_mul_lo_u32 v13, v12, s52
    v_lshrrev_b32 v13, 21, v13
    v_mul_u32_u24 v14, 36, v13
    v_sub_u32 v14, v12, v14
    v_mul_u32_u24 v15, 43, v14
    v_lshrrev_b32 v15, 9, v15
    v_mul_u32_u24 v13, 3456, v13
    v_mul_u32_u24 v15, 960, v15
    v_lshl_add_u32 v13, v14, 4, v13
    v_subrev_u32 v13, 2048, v13
    v_add_u32 v248, v13, v15
    buffer_load_dwordx4 v248, s[20:23], s48 offen offset:2048  lds
    s_add_u32 s48, s48, 221184
    s_add_u32 m0, s54, s42
    s_nop 0
    buffer_load_dwordx4 v1, s[16:19], s40 offen offset:0 lds
    buffer_load_dwordx4 v2, s[16:19], s40 offen offset:1024 lds
    buffer_load_dwordx4 v3, s[16:19], s40 offen offset:2048 lds
    buffer_load_dwordx4 v4, s[16:19], s40 offen offset:3072 lds
    s_add_u32 s40, s40, 64
    s_add_u32 s42, s42, 16384
    s_cmp_eq_u32 s42, 49152
    s_cselect_b32 s42, 0, s42
    s_add_u32 m0, s54, s42
    s_nop 0
    buffer_load_dwordx4 v1, s[16:19], s40 offen offset:0 lds
    buffer_load_dwordx4 v2, s[16:19], s40 offen offset:1024 lds
    buffer_load_dwordx4 v3, s[16:19], s40 offen offset:2048 lds
    buffer_load_dwordx4 v4, s[16:19], s40 offen offset:3072 lds
    s_add_u32 s40, s40, 64
    s_add_u32 s42, s42, 16384
    s_cmp_eq_u32 s42, 49152
    s_cselect_b32 s42, 0, s42
    s_add_u32 m0, s50, 0
    s_nop 0
    buffer_load_dwordx4 v240, s[20:23], s48 offen offset:0  lds
    buffer_load_dwordx4 v241, s[20:23], s48 offen offset:1024  lds
    buffer_load_dwordx4 v242, s[20:23], s48 offen offset:2048  lds
    s_add_u32 m0, s50, 3072
    s_nop 0
    buffer_load_dwordx4 v243, s[20:23], s48 offen offset:0  lds
    buffer_load_dwordx4 v244, s[20:23], s48 offen offset:1024  lds
    buffer_load_dwordx4 v245, s[20:23], s48 offen offset:2048  lds
    s_add_u32 m0, s50, 6144
    s_nop 0
    buffer_load_dwordx4 v246, s[20:23], s48 offen offset:0  lds
    v_mov_b32 v15, 0
    buffer_load_dword v14, v15, s[12:15], 0 offen
    v_and_b32 v12, 31, v0
    v_lshrrev_b32 v13, 5, v0
    v_bfe_u32 v11, v0, 2, 2
    v_xor_b32 v10, v13, v11
    v_lshlrev_b32 v10, 4, v10
    v_lshl_add_u32 v10, v12, 6, v10
    v_add_u32 v5, s59, v10
    v_xor_b32 v6, 32, v5
    v_lshl_add_u32 v7, v13, 3, v11
    v_mul_u32_u24 v7, 576, v7
    v_add_u32 v7, s35, v7
    v_bfe_u32 v12, v0, 4, 1
    v_lshlrev_b32 v12, 2, v12
    v_and_b32 v13, 3, v0
    v_add_u32 v11, v12, v13
    v_lshl_add_u32 v11, v11, 3, v7
    v_add_u32 v251, 384, v11
    v_and_b32 v13, 1, v0
    v_lshl_add_u32 v12, v13, 1, v12
    v_bfe_u32 v13, v0, 1, 1
    v_add_u32 v12, v12, v13
    v_lshrrev_b32 v13, 2, v12
    v_add_u32 v13, v13, v12
    v_lshl_add_u32 v249, v13, 3, v7
    v_and_b32 v13, 1, v12
    v_mul_u32_u24 v11, 72, v13
    v_bfe_u32 v8, v12, 1, 1
    v_mul_u32_u24 v8, 192, v8
    v_add3_u32 v11, v11, v8, 32
    v_lshlrev_b32 v13, 3, v13
    v_add_u32 v13, 512, v13
    v_cmp_gt_u32 vcc, 4, v12
    s_nop 1
    v_cndmask_b32 v11, v13, v11, vcc
    v_add_u32 v250, v11, v7
    s_mov_b32 s55, 0
    s_mov_b32 s57, 0
    s_mov_b32 s58, 36864
    s_waitcnt vmcnt(25)
    ds_read_b128 a[0:3], v5 offset:0
    ds_read_b128 a[16:19], v5 offset:2048
    ds_read_b128 a[4:7], v6 offset:0
    ds_read_b128 a[20:23], v6 offset:2048
    ds_read_b128 a[8:11], v5 offset:4096
    ds_read_b128 a[24:27], v5 offset:6144
    ds_read_b128 a[12:15], v6 offset:4096
    ds_read_b128 a[28:31], v6 offset:6144
    v_add_u32 v252, s54, v10
    v_add_u32 v5, s54, v10
    v_xor_b32 v6, 32, v5
    s_waitcnt vmcnt(16)
    s_barrier
    ds_read_b64_tr_b16 a[32:33], v249 offset:0
    ds_read_b64_tr_b16 a[34:35], v249 offset:2304
    ds_read_b64_tr_b16 a[36:37], v249 offset:72
    ds_read_b64_tr_b16 a[38:39], v249 offset:2376
    ds_read_b64_tr_b16 a[40:41], v249 offset:192
    ds_read_b64_tr_b16 a[42:43], v249 offset:2496
    ds_read_b64_tr_b16 a[44:45], v249 offset:264
    ds_read_b64_tr_b16 a[46:47], v249 offset:2568
    ds_read_b64_tr_b16 a[48:49], v250 offset:0
    ds_read_b64_tr_b16 a[50:51], v250 offset:2304
    ds_read_b64_tr_b16 a[52:53], v251 offset:0
    ds_read_b64_tr_b16 a[54:55], v251 offset:2304
    ds_read_b64_tr_b16 a[56:57], v251 offset:64
    ds_read_b64_tr_b16 a[58:59], v251 offset:2368
    ds_read_b64_tr_b16 a[60:61], v249 offset:9216
    ds_read_b64_tr_b16 a[62:63], v249 offset:11520
    s_waitcnt lgkmcnt(0)
    v_mfma_f32_32x32x16_bf16 v[16:31], a[32:35], a[0:3], 0
    ds_read_b64_tr_b16 a[64:65], v249 offset:9288
    ds_read_b64_tr_b16 a[66:67], v249 offset:11592
    s_lshl_b32 s66, s33, 2
    s_add_u32 s66, s66, s32
    s_mul_i32 s61, s34, 294912
    s_add_u32 s61, s61, 25952256
    v_mfma_f32_32x32x16_bf16 v[32:47], a[32:35], a[16:19], 0
    s_lshr_b32 s62, s66, 3
    s_lshl_b32 s62, s62, 10
    s_add_u32 s62, s62, s61
    s_bfe_u32 s63, s66, 0x10002
    s_lshl_b32 s63, s63, 9
    s_add_u32 s62, s62, s63
    v_mfma_f32_32x32x16_bf16 v[48:63], a[36:39], a[0:3], 0
    ds_read_b64_tr_b16 a[68:69], v249 offset:9408
    ds_read_b64_tr_b16 a[70:71], v249 offset:11712
    s_lshl_b32 s63, s32, 2
    s_add_u32 s62, s62, s63
    s_add_u32 s62, s62, 32768
    s_lshl_b32 s66, s66, 10
    v_mfma_f32_32x32x16_bf16 v[64:79], a[36:39], a[16:19], 0
    s_add_u32 s61, s61, s66
    s_add_u32 m0, s50, 6144
    s_nop 0
    buffer_load_dwordx4 v247, s[20:23], s48 offen offset:1024  lds
    buffer_load_dwordx4 v248, s[20:23], s48 offen offset:2048  lds
    s_mov_b32 s65, 43691
    s_mov_b32 s53, s49
    v_mfma_f32_32x32x16_bf16 v[80:95], a[40:43], a[0:3], 0
    ds_read_b64_tr_b16 a[72:73], v249 offset:9480
    ds_read_b64_tr_b16 a[74:75], v249 offset:11784
    s_add_u32 s48, s48, 221184
    s_cmp_lt_u32 s55, 7
    s_cselect_b32 s18, 0x240000, 0
    s_mov_b32 s49, s50
    v_mfma_f32_32x32x16_bf16 v[96:111], a[40:43], a[16:19], 0
    v_add_u32 v253, 0, v0
    v_min_u32 v253, 83, v253
    v_mov_b32 v10, -1
    v_mov_b32 v11, -1
    v_mov_b32 v12, -1
    v_mov_b32 v13, -1
    v_mfma_f32_32x32x16_bf16 v[112:127], a[44:47], a[0:3], 0
    ds_read_b64_tr_b16 a[76:77], v250 offset:9216
    ds_read_b64_tr_b16 a[78:79], v250 offset:11520
    v_mov_b32 v9, 0x3f803f80
    v_accvgpr_write_b32 a160, v9
    v_accvgpr_write_b32 a161, v9
    v_accvgpr_write_b32 a162, v9
    v_mfma_f32_32x32x16_bf16 v[128:143], a[44:47], a[16:19], 0
    v_accvgpr_write_b32 a163, v9
    v_accvgpr_write_b32 a164, v9
    v_accvgpr_write_b32 a165, v9
    v_accvgpr_write_b32 a166, v9
    v_accvgpr_write_b32 a167, v9
    v_accvgpr_write_b32 a168, v9
    v_mfma_f32_32x32x16_bf16 v[144:159], a[48:51], a[0:3], 0
    ds_read_b64_tr_b16 a[80:81], v251 offset:9216
    ds_read_b64_tr_b16 a[82:83], v251 offset:11520
    v_accvgpr_write_b32 a169, v9
    v_accvgpr_write_b32 a170, v9
    v_accvgpr_write_b32 a171, v9
    v_accvgpr_write_b32 a172, v9
    v_mfma_f32_32x32x16_bf16 v[160:175], a[48:51], a[16:19], 0
    v_accvgpr_write_b32 a173, v9
    v_accvgpr_write_b32 a174, v9
    v_accvgpr_write_b32 a175, v9
    v_accvgpr_write_b32 a176, v9
    v_accvgpr_write_b32 a177, v9
    v_mfma_f32_32x32x16_bf16 v[176:191], a[0:3], a[52:55], 0
    ds_read_b64_tr_b16 a[84:85], v251 offset:9280
    ds_read_b64_tr_b16 a[86:87], v251 offset:11584
    v_accvgpr_write_b32 a178, v9
    v_accvgpr_write_b32 a179, v9
    v_accvgpr_write_b32 a180, v9
    v_mfma_f32_32x32x16_bf16 v[192:207], a[16:19], a[52:55], 0
    v_accvgpr_write_b32 a181, v9
    v_accvgpr_write_b32 a182, v9
    v_accvgpr_write_b32 a183, v9
    v_accvgpr_write_b32 a184, v9
    v_accvgpr_write_b32 a185, v9
    v_accvgpr_write_b32 a186, v9
    v_mfma_f32_32x32x16_bf16 v[208:223], a[0:3], a[56:59], 0
    ds_read_b64_tr_b16 a[88:89], v249 offset:18432
    ds_read_b64_tr_b16 a[90:91], v249 offset:20736
    s_waitcnt vmcnt(14)
    ds_read_b128 a[0:3], v5 offset:0
    s_add_u32 m0, s54, s42
    s_nop 0
    buffer_load_dwordx4 v1, s[16:19], s40 offen offset:0 lds
    v_accvgpr_write_b32 a187, v9
    v_mfma_f32_32x32x16_bf16 v[224:239], a[16:19], a[56:59], 0
    ds_read_b128 a[16:19], v5 offset:2048
    v_accvgpr_write_b32 a188, v9
    v_accvgpr_write_b32 a189, v9
    v_accvgpr_write_b32 a190, v9
    v_accvgpr_write_b32 a191, v9
    v_accvgpr_write_b32 a192, v9
    v_mfma_f32_32x32x16_bf16 v[16:31], a[60:63], a[4:7], v[16:31]
    ds_read_b64_tr_b16 a[92:93], v249 offset:18504
    ds_read_b64_tr_b16 a[94:95], v249 offset:20808
    v_accvgpr_write_b32 a193, v9
    v_accvgpr_write_b32 a194, v9
    v_accvgpr_write_b32 a195, v9
    v_accvgpr_write_b32 a196, v9
    v_mfma_f32_32x32x16_bf16 v[32:47], a[60:63], a[20:23], v[32:47]
    buffer_load_dwordx4 v2, s[16:19], s40 offen offset:1024 lds
    v_accvgpr_write_b32 a197, v9
    v_accvgpr_write_b32 a198, v9
    v_accvgpr_write_b32 a199, v9
    v_accvgpr_write_b32 a200, v9
    v_accvgpr_write_b32 a201, v9
    s_waitcnt lgkmcnt(10)
    v_mfma_f32_32x32x16_bf16 v[48:63], a[64:67], a[4:7], v[48:63]
    ds_read_b64_tr_b16 a[96:97], v249 offset:18624
    ds_read_b64_tr_b16 a[98:99], v249 offset:20928
    v_accvgpr_write_b32 a202, v9
    v_accvgpr_write_b32 a203, v9
    v_accvgpr_write_b32 a204, v9
    v_accvgpr_write_b32 a205, v9
    v_mfma_f32_32x32x16_bf16 v[64:79], a[64:67], a[20:23], v[64:79]
    v_accvgpr_write_b32 a206, v9
    v_accvgpr_write_b32 a207, v9
    v_accvgpr_write_b32 a208, v9
    v_accvgpr_write_b32 a209, v9
    v_accvgpr_write_b32 a210, v9
    v_mfma_f32_32x32x16_bf16 v[80:95], a[68:71], a[4:7], v[80:95]
    ds_read_b64_tr_b16 a[100:101], v249 offset:18696
    ds_read_b64_tr_b16 a[102:103], v249 offset:21000
    buffer_load_dwordx4 v3, s[16:19], s40 offen offset:2048 lds
    v_accvgpr_write_b32 a211, v9
    v_accvgpr_write_b32 a212, v9
    v_accvgpr_write_b32 a213, v9
    v_mfma_f32_32x32x16_bf16 v[96:111], a[68:71], a[20:23], v[96:111]
    v_accvgpr_write_b32 a214, v9
    v_accvgpr_write_b32 a215, v9
    v_accvgpr_write_b32 a216, v9
    v_accvgpr_write_b32 a217, v9
    v_accvgpr_write_b32 a218, v9
    v_accvgpr_write_b32 a219, v9
    v_mfma_f32_32x32x16_bf16 v[112:127], a[72:75], a[4:7], v[112:127]
    ds_read_b64_tr_b16 a[104:105], v250 offset:18432
    ds_read_b64_tr_b16 a[106:107], v250 offset:20736
    v_accvgpr_write_b32 a220, v9
    v_accvgpr_write_b32 a221, v9
    v_accvgpr_write_b32 a222, v9
    v_accvgpr_write_b32 a223, v9
    v_mfma_f32_32x32x16_bf16 v[128:143], a[72:75], a[20:23], v[128:143]
    buffer_load_dwordx4 v4, s[16:19], s40 offen offset:3072 lds
    v_accvgpr_write_b32 a224, v9
    v_accvgpr_write_b32 a225, v9
    s_add_u32 s40, s40, 64
    s_add_u32 s42, s42, 16384
    s_cmp_eq_u32 s42, 49152
    v_mfma_f32_32x32x16_bf16 v[144:159], a[76:79], a[4:7], v[144:159]
    ds_read_b64_tr_b16 a[108:109], v251 offset:18432
    ds_read_b64_tr_b16 a[110:111], v251 offset:20736
    s_cselect_b32 s42, 0, s42
    v_accvgpr_write_b32 a226, v9
    v_accvgpr_write_b32 a227, v9
    v_accvgpr_write_b32 a228, v9
    v_mfma_f32_32x32x16_bf16 v[160:175], a[76:79], a[20:23], v[160:175]
    v_accvgpr_write_b32 a229, v9
    v_accvgpr_write_b32 a230, v9
    v_accvgpr_write_b32 a231, v9
    v_accvgpr_write_b32 a232, v9
    v_accvgpr_write_b32 a233, v9
    v_accvgpr_write_b32 a234, v9
    s_waitcnt lgkmcnt(8)
    v_mfma_f32_32x32x16_bf16 v[176:191], a[4:7], a[80:83], v[176:191]
    ds_read_b64_tr_b16 a[112:113], v251 offset:18496
    ds_read_b64_tr_b16 a[114:115], v251 offset:20800
    s_waitcnt vmcnt(6)
    v_readfirstlane_b32 s3, v14
    s_nop 1
    s_cmp_eq_u32 s3, 0
    s_cbranch_scc1 TG_33
TGR_34:
    s_cmp_lg_u32 s32, 0
    s_cbranch_scc1 PUB_35
    s_or_b32 s101, s3, s37
    s_or_b32 s101, s101, 16
    v_mov_b32 v14, s101
    buffer_store_dword v14, v15, s[24:27], s38 offen sc0 sc1
PUB_35:
    v_mfma_f32_32x32x16_bf16 v[192:207], a[20:23], a[80:83], v[192:207]
    s_add_u32 s43, s43, 16384
    s_cmp_eq_u32 s43, 49152
    s_cselect_b32 s43, 0, s43
    v_add_u32 v5, s43, v252
    v_accvgpr_write_b32 a235, v9
    v_mfma_f32_32x32x16_bf16 v[208:223], a[4:7], a[84:87], v[208:223]
    ds_read_b64_tr_b16 a[116:117], v249 offset:27648
    ds_read_b64_tr_b16 a[118:119], v249 offset:29952
    ds_read_b128 a[4:7], v6 offset:0
    v_accvgpr_write_b32 a236, v9
    v_accvgpr_write_b32 a237, v9
    v_accvgpr_write_b32 a238, v9
    v_mfma_f32_32x32x16_bf16 v[224:239], a[20:23], a[84:87], v[224:239]
    ds_read_b128 a[20:23], v6 offset:2048
    v_xor_b32 v6, 32, v5
    v_accvgpr_write_b32 a239, v9
    v_accvgpr_write_b32 a240, v9
    v_accvgpr_write_b32 a241, v9
    v_accvgpr_write_b32 a242, v9
    v_mfma_f32_32x32x16_bf16 v[16:31], a[88:91], a[8:11], v[16:31]
    ds_read_b64_tr_b16 a[120:121], v249 offset:27720
    ds_read_b64_tr_b16 a[122:123], v249 offset:30024
    v_accvgpr_write_b32 a243, v9
    v_accvgpr_write_b32 a244, v9
    v_accvgpr_write_b32 a245, v9
    v_accvgpr_write_b32 a246, v9
    v_mfma_f32_32x32x16_bf16 v[32:47], a[88:91], a[24:27], v[32:47]
    v_accvgpr_write_b32 a247, v9
    v_accvgpr_write_b32 a248, v9
    v_accvgpr_write_b32 a249, v9
    v_accvgpr_write_b32 a250, v9
    v_accvgpr_write_b32 a251, v9
    v_accvgpr_write_b32 a252, v9
    v_mfma_f32_32x32x16_bf16 v[48:63], a[92:95], a[8:11], v[48:63]
    ds_read_b64_tr_b16 a[124:125], v249 offset:27840
    ds_read_b64_tr_b16 a[126:127], v249 offset:30144
    v_accvgpr_write_b32 a253, v9
    v_accvgpr_write_b32 a254, v9
    v_accvgpr_write_b32 a255, v9
    v_mfma_f32_32x32x16_bf16 v[64:79], a[92:95], a[24:27], v[64:79]
    s_add_u32 m0, s54, s42
    s_waitcnt lgkmcnt(4)
    buffer_load_dwordx4 v1, s[16:19], s40 offen offset:0 lds
    s_cmp_lt_u32 s55, 7
    s_cselect_b32 s22, 0x1e6000, 0
    s_cselect_b32 s51, s51, 0x30000
    s_add_u32 s57, s57, 1
    s_waitcnt lgkmcnt(10)
    v_mfma_f32_32x32x16_bf16 v[80:95], a[96:99], a[8:11], v[80:95]
    ds_read_b64_tr_b16 a[128:129], v249 offset:27912
    ds_read_b64_tr_b16 a[130:131], v249 offset:30216
    s_cmp_eq_u32 s57, 3
    s_cselect_b32 s56, 0xfffee000, s58
    s_cselect_b32 s57, 0, s57
    s_mov_b32 s50, s51
    v_mfma_f32_32x32x16_bf16 v[96:111], a[96:99], a[24:27], v[96:111]
    v_add_u32 v249, s56, v249
    v_mfma_f32_32x32x16_bf16 v[112:127], a[100:103], a[8:11], v[112:127]
    buffer_load_dwordx4 v2, s[16:19], s40 offen offset:1024 lds
    ds_read_b64_tr_b16 a[132:133], v250 offset:27648
    ds_read_b64_tr_b16 a[134:135], v250 offset:29952
    v_add_u32 v250, s56, v250
    v_mfma_f32_32x32x16_bf16 v[128:143], a[100:103], a[24:27], v[128:143]
    v_mfma_f32_32x32x16_bf16 v[144:159], a[104:107], a[8:11], v[144:159]
    ds_read_b64_tr_b16 a[136:137], v251 offset:27648
    ds_read_b64_tr_b16 a[138:139], v251 offset:29952
    v_mfma_f32_32x32x16_bf16 v[160:175], a[104:107], a[24:27], v[160:175]
    buffer_load_dwordx4 v3, s[16:19], s40 offen offset:2048 lds
    v_mfma_f32_32x32x16_bf16 v[176:191], a[8:11], a[108:111], v[176:191]
    ds_read_b64_tr_b16 a[140:141], v251 offset:27712
    ds_read_b64_tr_b16 a[142:143], v251 offset:30016
    v_add_u32 v251, s56, v251
    v_mfma_f32_32x32x16_bf16 v[192:207], a[24:27], a[108:111], v[192:207]
    s_waitcnt lgkmcnt(8)
    v_mfma_f32_32x32x16_bf16 v[208:223], a[8:11], a[112:115], v[208:223]
    buffer_load_dwordx4 v4, s[16:19], s40 offen offset:3072 lds
    s_waitcnt vmcnt(8)
    s_barrier
    ds_read_b64_tr_b16 a[32:33], v249 offset:0
    ds_read_b64_tr_b16 a[34:35], v249 offset:2304
    s_waitcnt vmcnt(0)
    ds_read_b128 a[8:11], v5 offset:0
    v_mfma_f32_32x32x16_bf16 v[224:239], a[24:27], a[112:115], v[224:239]
    ds_read_b128 a[24:27], v5 offset:2048
    s_add_u32 s40, s40, 64
    s_add_u32 s42, s42, 16384
    s_cmp_eq_u32 s42, 49152
    s_cselect_b32 s42, 0, s42
    s_add_u32 m0, s51, 0
    v_mfma_f32_32x32x16_bf16 v[16:31], a[116:119], a[12:15], v[16:31]
    buffer_load_dwordx4 v240, s[20:23], s48 offen offset:0  lds
    ds_read_b64_tr_b16 a[36:37], v249 offset:72
    ds_read_b64_tr_b16 a[38:39], v249 offset:2376
    s_lshr_b32 s64, s39, 1
    s_mul_i32 s64, s64, 84
    v_mfma_f32_32x32x16_bf16 v[32:47], a[116:119], a[28:31], v[32:47]
    v_add_u32 v253, s64, v253
    v_mul_lo_u32 v254, v253, s65
    v_lshrrev_b32 v254, 18, v254
    v_mul_u32_u24 v7, 6, v254
    v_sub_u32 v7, v253, v7
    v_lshrrev_b32 v8, 1, v7
    v_mfma_f32_32x32x16_bf16 v[48:63], a[120:123], a[12:15], v[48:63]
    ds_read_b64_tr_b16 a[40:41], v249 offset:192
    ds_read_b64_tr_b16 a[42:43], v249 offset:2496
    v_and_b32 v7, 1, v7
    v_mul_u32_u24 v8, 1152, v8
    v_mul_u32_u24 v7, 188, v7
    v_mul_u32_u24 v254, 3456, v254
    v_mfma_f32_32x32x16_bf16 v[64:79], a[120:123], a[28:31], v[64:79]
    v_add3_u32 v254, v254, v7, v8
    v_add_u32 v253, 64, v0
    v_min_u32 v253, 83, v253
    v_add_u32 v253, s64, v253
    buffer_load_dword v255, v254, s[20:23], s60 offen
    v_mfma_f32_32x32x16_bf16 v[80:95], a[124:127], a[12:15], v[80:95]
    ds_read_b64_tr_b16 a[44:45], v249 offset:264
    ds_read_b64_tr_b16 a[46:47], v249 offset:2568
    v_mul_lo_u32 v254, v253, s65
    v_lshrrev_b32 v254, 18, v254
    v_mul_u32_u24 v7, 6, v254
    v_sub_u32 v7, v253, v7
    v_mfma_f32_32x32x16_bf16 v[96:111], a[124:127], a[28:31], v[96:111]
    v_lshrrev_b32 v8, 1, v7
    v_and_b32 v7, 1, v7
    v_mul_u32_u24 v8, 1152, v8
    v_mul_u32_u24 v7, 188, v7
    v_mul_u32_u24 v254, 3456, v254
    v_add3_u32 v254, v254, v7, v8
    s_waitcnt lgkmcnt(10)
    v_mfma_f32_32x32x16_bf16 v[112:127], a[128:131], a[12:15], v[112:127]
    buffer_load_dword v255, v254, s[20:23], s60 offen
    buffer_load_dwordx4 v241, s[20:23], s48 offen offset:1024  lds
    ds_read_b64_tr_b16 a[48:49], v250 offset:0
    ds_read_b64_tr_b16 a[50:51], v250 offset:2304
    v_lshlrev_b32 v8, 4, v0
    v_and_b32 v7, 0x1f0, v8
    v_mfma_f32_32x32x16_bf16 v[128:143], a[128:131], a[28:31], v[128:143]
    buffer_store_dwordx4 v[10:13], v8, s[24:27], s61 offen sc0 sc1
    buffer_store_dword v10, v7, s[24:27], s62 offen sc0 sc1
    buffer_load_dwordx4 v242, s[20:23], s48 offen offset:2048  lds
    s_add_u32 s61, s61, 36864
    buffer_store_dwordx4 v[10:13], v8, s[24:27], s61 offen sc0 sc1
    s_add_u32 s62, s62, 36864
    v_mfma_f32_32x32x16_bf16 v[144:159], a[132:135], a[12:15], v[144:159]
    buffer_store_dword v10, v7, s[24:27], s62 offen sc0 sc1
    ds_read_b64_tr_b16 a[52:53], v251 offset:0
    ds_read_b64_tr_b16 a[54:55], v251 offset:2304
    s_add_u32 s61, s61, 36864
    s_add_u32 s62, s62, 36864
    s_add_u32 m0, s51, 3072
    v_mfma_f32_32x32x16_bf16 v[160:175], a[132:135], a[28:31], v[160:175]
    buffer_load_dwordx4 v243, s[20:23], s48 offen offset:0  lds
    buffer_store_dwordx4 v[10:13], v8, s[24:27], s61 offen sc0 sc1
    buffer_store_dword v10, v7, s[24:27], s62 offen sc0 sc1
    buffer_load_dwordx4 v244, s[20:23], s48 offen offset:1024  lds
    s_add_u32 s61, s61, 36864
    buffer_store_dwordx4 v[10:13], v8, s[24:27], s61 offen sc0 sc1
    v_mfma_f32_32x32x16_bf16 v[176:191], a[12:15], a[136:139], v[176:191]
    ds_read_b64_tr_b16 a[56:57], v251 offset:64
    ds_read_b64_tr_b16 a[58:59], v251 offset:2368
    s_add_u32 s62, s62, 36864
    buffer_store_dword v10, v7, s[24:27], s62 offen sc0 sc1
    buffer_load_dwordx4 v245, s[20:23], s48 offen offset:2048  lds
    s_add_u32 s61, s61, 36864
    v_mfma_f32_32x32x16_bf16 v[192:207], a[28:31], a[136:139], v[192:207]
    buffer_store_dwordx4 v[10:13], v8, s[24:27], s61 offen sc0 sc1
    s_add_u32 s62, s62, 36864
    buffer_store_dword v10, v7, s[24:27], s62 offen sc0 sc1
    s_add_u32 s61, s61, 36864
    s_add_u32 s62, s62, 36864
    v_mfma_f32_32x32x16_bf16 v[208:223], a[12:15], a[140:143], v[208:223]
    ds_read_b64_tr_b16 a[60:61], v249 offset:9216
    ds_read_b64_tr_b16 a[62:63], v249 offset:11520
    ds_read_b128 a[12:15], v6 offset:0
    s_add_u32 m0, s51, 6144
    s_nop 0
    buffer_load_dwordx4 v246, s[20:23], s48 offen offset:0  lds
    buffer_store_dwordx4 v[10:13], v8, s[24:27], s61 offen sc0 sc1
    v_mfma_f32_32x32x16_bf16 v[224:239], a[28:31], a[140:143], v[224:239]
    buffer_store_dword v10, v7, s[24:27], s62 offen sc0 sc1
    ds_read_b128 a[28:31], v6 offset:2048
    s_add_u32 s61, s61, 36864
    buffer_store_dwordx4 v[10:13], v8, s[24:27], s61 offen sc0 sc1
    s_add_u32 s62, s62, 36864
    buffer_store_dword v10, v7, s[24:27], s62 offen sc0 sc1
    s_add_u32 s61, s61, 36864
    buffer_store_dwordx4 v[10:13], v8, s[24:27], s61 offen sc0 sc1
    s_add_u32 s62, s62, 36864
    buffer_store_dword v10, v7, s[24:27], s62 offen sc0 sc1
    s_add_u32 s43, s43, 16384
    s_cmp_eq_u32 s43, 49152
    s_cselect_b32 s43, 0, s43
    s_add_u32 s61, s61, 36864
    s_add_u32 s62, s62, 36864
    s_mov_b32 s51, s53
    s_add_u32 s55, s55, 1
    v_add_u32 v5, s43, v252
    v_xor_b32 v6, 32, v5
.p2align 6
F_QLOOP:
    s_waitcnt lgkmcnt(10)
    v_mfma_f32_32x32x16_bf16 v[16:31], a[32:35], a[0:3], v[16:31]
    ds_read_b64_tr_b16 a[64:65], v249 offset:9288
    ds_read_b64_tr_b16 a[66:67], v249 offset:11592
    s_waitcnt lgkmcnt(15)
    v_mfma_f32_32x32x16_bf16 v[32:47], a[32:35], a[16:19], v[32:47]
    s_add_u32 m0, s50, 6144
    s_nop 0
    buffer_load_dwordx4 v247, s[20:23], s48 offen offset:1024  lds
    s_mov_b32 s53, s49
    s_mov_b32 s49, s50
    v_mfma_f32_32x32x16_bf16 v[48:63], a[36:39], a[0:3], v[48:63]
    ds_read_b64_tr_b16 a[68:69], v249 offset:9408
    ds_read_b64_tr_b16 a[70:71], v249 offset:11712
    v_mfma_f32_32x32x16_bf16 v[64:79], a[36:39], a[16:19], v[64:79]
    buffer_load_dwordx4 v248, s[20:23], s48 offen offset:2048  lds
    s_add_u32 s48, s48, 221184
    s_cmp_lt_u32 s55, 7
    s_cselect_b32 s18, 0x240000, 0
    v_mfma_f32_32x32x16_bf16 v[80:95], a[40:43], a[0:3], v[80:95]
    ds_read_b64_tr_b16 a[72:73], v249 offset:9480
    ds_read_b64_tr_b16 a[74:75], v249 offset:11784
    v_mfma_f32_32x32x16_bf16 v[96:111], a[40:43], a[16:19], v[96:111]
    v_mfma_f32_32x32x16_bf16 v[112:127], a[44:47], a[0:3], v[112:127]
    ds_read_b64_tr_b16 a[76:77], v250 offset:9216
    ds_read_b64_tr_b16 a[78:79], v250 offset:11520
    v_mfma_f32_32x32x16_bf16 v[128:143], a[44:47], a[16:19], v[128:143]
    s_waitcnt lgkmcnt(10)
    v_mfma_f32_32x32x16_bf16 v[144:159], a[48:51], a[0:3], v[144:159]
    ds_read_b64_tr_b16 a[80:81], v251 offset:9216
    ds_read_b64_tr_b16 a[82:83], v251 offset:11520
    v_mfma_f32_32x32x16_bf16 v[160:175], a[48:51], a[16:19], v[160:175]
    v_mfma_f32_32x32x16_bf16 v[176:191], a[0:3], a[52:55], v[176:191]
    ds_read_b64_tr_b16 a[84:85], v251 offset:9280
    ds_read_b64_tr_b16 a[86:87], v251 offset:11584
    v_mfma_f32_32x32x16_bf16 v[192:207], a[16:19], a[52:55], v[192:207]
    v_mfma_f32_32x32x16_bf16 v[208:223], a[0:3], a[56:59], v[208:223]
    ds_read_b64_tr_b16 a[88:89], v249 offset:18432
    ds_read_b64_tr_b16 a[90:91], v249 offset:20736
    s_waitcnt vmcnt(13)
    ds_read_b128 a[0:3], v5 offset:0
    s_add_u32 m0, s54, s42
    s_waitcnt lgkmcnt(15)
    buffer_load_dwordx4 v1, s[16:19], s40 offen offset:0 lds
    v_mfma_f32_32x32x16_bf16 v[224:239], a[16:19], a[56:59], v[224:239]
    ds_read_b128 a[16:19], v5 offset:2048
    s_waitcnt lgkmcnt(15)
    v_mfma_f32_32x32x16_bf16 v[16:31], a[60:63], a[4:7], v[16:31]
    ds_read_b64_tr_b16 a[92:93], v249 offset:18504
    ds_read_b64_tr_b16 a[94:95], v249 offset:20808
    s_waitcnt lgkmcnt(15)
    v_mfma_f32_32x32x16_bf16 v[32:47], a[60:63], a[20:23], v[32:47]
    buffer_load_dwordx4 v2, s[16:19], s40 offen offset:1024 lds
    s_waitcnt lgkmcnt(10)
    v_mfma_f32_32x32x16_bf16 v[48:63], a[64:67], a[4:7], v[48:63]
    ds_read_b64_tr_b16 a[96:97], v249 offset:18624
    ds_read_b64_tr_b16 a[98:99], v249 offset:20928
    v_mfma_f32_32x32x16_bf16 v[64:79], a[64:67], a[20:23], v[64:79]
    v_mfma_f32_32x32x16_bf16 v[80:95], a[68:71], a[4:7], v[80:95]
    ds_read_b64_tr_b16 a[100:101], v249 offset:18696
    ds_read_b64_tr_b16 a[102:103], v249 offset:21000
    buffer_load_dwordx4 v3, s[16:19], s40 offen offset:2048 lds
    v_mfma_f32_32x32x16_bf16 v[96:111], a[68:71], a[20:23], v[96:111]
    v_mfma_f32_32x32x16_bf16 v[112:127], a[72:75], a[4:7], v[112:127]
    ds_read_b64_tr_b16 a[104:105], v250 offset:18432
    ds_read_b64_tr_b16 a[106:107], v250 offset:20736
    v_mfma_f32_32x32x16_bf16 v[128:143], a[72:75], a[20:23], v[128:143]
    buffer_load_dwordx4 v4, s[16:19], s40 offen offset:3072 lds
    s_add_u32 s40, s40, 64
    s_add_u32 s42, s42, 16384
    s_cmp_eq_u32 s42, 49152
    v_mfma_f32_32x32x16_bf16 v[144:159], a[76:79], a[4:7], v[144:159]
    ds_read_b64_tr_b16 a[108:109], v251 offset:18432
    ds_read_b64_tr_b16 a[110:111], v251 offset:20736
    s_cselect_b32 s42, 0, s42
    s_add_u32 s43, s43, 16384
    s_cmp_eq_u32 s43, 49152
    s_cselect_b32 s43, 0, s43
    v_mfma_f32_32x32x16_bf16 v[160:175], a[76:79], a[20:23], v[160:175]
    v_add_u32 v5, s43, v252
    s_waitcnt lgkmcnt(8)
    v_mfma_f32_32x32x16_bf16 v[176:191], a[4:7], a[80:83], v[176:191]
    ds_read_b64_tr_b16 a[112:113], v251 offset:18496
    ds_read_b64_tr_b16 a[114:115], v251 offset:20800
    v_mfma_f32_32x32x16_bf16 v[192:207], a[20:23], a[80:83], v[192:207]
    v_mfma_f32_32x32x16_bf16 v[208:223], a[4:7], a[84:87], v[208:223]
    ds_read_b64_tr_b16 a[116:117], v249 offset:27648
    ds_read_b64_tr_b16 a[118:119], v249 offset:29952
    ds_read_b128 a[4:7], v6 offset:0
    v_mfma_f32_32x32x16_bf16 v[224:239], a[20:23], a[84:87], v[224:239]
    ds_read_b128 a[20:23], v6 offset:2048
    v_xor_b32 v6, 32, v5
    s_waitcnt lgkmcnt(15)
    v_mfma_f32_32x32x16_bf16 v[16:31], a[88:91], a[8:11], v[16:31]
    ds_read_b64_tr_b16 a[120:121], v249 offset:27720
    ds_read_b64_tr_b16 a[122:123], v249 offset:30024
    s_waitcnt lgkmcnt(15)
    v_mfma_f32_32x32x16_bf16 v[32:47], a[88:91], a[24:27], v[32:47]
    v_mfma_f32_32x32x16_bf16 v[48:63], a[92:95], a[8:11], v[48:63]
    ds_read_b64_tr_b16 a[124:125], v249 offset:27840
    ds_read_b64_tr_b16 a[126:127], v249 offset:30144
    v_mfma_f32_32x32x16_bf16 v[64:79], a[92:95], a[24:27], v[64:79]
    s_add_u32 m0, s54, s42
    s_waitcnt lgkmcnt(4)
    buffer_load_dwordx4 v1, s[16:19], s40 offen offset:0 lds
    s_cmp_lt_u32 s55, 7
    s_cselect_b32 s22, 0x1e6000, 0
    s_cselect_b32 s51, s51, 0x30000
    s_add_u32 s57, s57, 1
    s_waitcnt lgkmcnt(10)
    v_mfma_f32_32x32x16_bf16 v[80:95], a[96:99], a[8:11], v[80:95]
    ds_read_b64_tr_b16 a[128:129], v249 offset:27912
    ds_read_b64_tr_b16 a[130:131], v249 offset:30216
    s_cmp_eq_u32 s57, 3
    s_cselect_b32 s56, 0xfffee000, s58
    s_cselect_b32 s57, 0, s57
    s_mov_b32 s50, s51
    v_mfma_f32_32x32x16_bf16 v[96:111], a[96:99], a[24:27], v[96:111]
    v_add_u32 v249, s56, v249
    v_mfma_f32_32x32x16_bf16 v[112:127], a[100:103], a[8:11], v[112:127]
    ds_read_b64_tr_b16 a[132:133], v250 offset:27648
    ds_read_b64_tr_b16 a[134:135], v250 offset:29952
    buffer_load_dwordx4 v2, s[16:19], s40 offen offset:1024 lds
    v_add_u32 v250, s56, v250
    v_mfma_f32_32x32x16_bf16 v[128:143], a[100:103], a[24:27], v[128:143]
    v_mfma_f32_32x32x16_bf16 v[144:159], a[104:107], a[8:11], v[144:159]
    ds_read_b64_tr_b16 a[136:137], v251 offset:27648
    ds_read_b64_tr_b16 a[138:139], v251 offset:29952
    v_mfma_f32_32x32x16_bf16 v[160:175], a[104:107], a[24:27], v[160:175]
    buffer_load_dwordx4 v3, s[16:19], s40 offen offset:2048 lds
    v_mfma_f32_32x32x16_bf16 v[176:191], a[8:11], a[108:111], v[176:191]
    ds_read_b64_tr_b16 a[140:141], v251 offset:27712
    ds_read_b64_tr_b16 a[142:143], v251 offset:30016
    v_add_u32 v251, s56, v251
    v_mfma_f32_32x32x16_bf16 v[192:207], a[24:27], a[108:111], v[192:207]
    s_waitcnt lgkmcnt(8)
    v_mfma_f32_32x32x16_bf16 v[208:223], a[8:11], a[112:115], v[208:223]
    buffer_load_dwordx4 v4, s[16:19], s40 offen offset:3072 lds
    s_add_u32 s40, s40, 64
    s_waitcnt vmcnt(8)
    s_barrier
    v_mfma_f32_32x32x16_bf16 v[224:239], a[24:27], a[112:115], v[224:239]
    ds_read_b64_tr_b16 a[32:33], v249 offset:0
    ds_read_b64_tr_b16 a[34:35], v249 offset:2304
    s_waitcnt vmcnt(17)
    ds_read_b128 a[8:11], v5 offset:0
    ds_read_b128 a[24:27], v5 offset:2048
    s_add_u32 s42, s42, 16384
    s_waitcnt lgkmcnt(15)
    v_mfma_f32_32x32x16_bf16 v[16:31], a[116:119], a[12:15], v[16:31]
    ds_read_b64_tr_b16 a[36:37], v249 offset:72
    ds_read_b64_tr_b16 a[38:39], v249 offset:2376
    s_cmp_eq_u32 s42, 49152
    s_cselect_b32 s42, 0, s42
    s_add_u32 m0, s51, 0
    s_nop 0
    buffer_load_dwordx4 v240, s[20:23], s48 offen offset:0  lds
    s_waitcnt lgkmcnt(15)
    v_mfma_f32_32x32x16_bf16 v[32:47], a[116:119], a[28:31], v[32:47]
    buffer_load_dwordx4 v241, s[20:23], s48 offen offset:1024  lds
    v_mfma_f32_32x32x16_bf16 v[48:63], a[120:123], a[12:15], v[48:63]
    ds_read_b64_tr_b16 a[40:41], v249 offset:192
    ds_read_b64_tr_b16 a[42:43], v249 offset:2496
    v_mfma_f32_32x32x16_bf16 v[64:79], a[120:123], a[28:31], v[64:79]
    buffer_load_dwordx4 v242, s[20:23], s48 offen offset:2048  lds
    v_mfma_f32_32x32x16_bf16 v[80:95], a[124:127], a[12:15], v[80:95]
    ds_read_b64_tr_b16 a[44:45], v249 offset:264
    ds_read_b64_tr_b16 a[46:47], v249 offset:2568
    v_mfma_f32_32x32x16_bf16 v[96:111], a[124:127], a[28:31], v[96:111]
    s_add_u32 m0, s51, 3072
    s_nop 0
    buffer_load_dwordx4 v243, s[20:23], s48 offen offset:0  lds
    s_waitcnt lgkmcnt(10)
    v_mfma_f32_32x32x16_bf16 v[112:127], a[128:131], a[12:15], v[112:127]
    ds_read_b64_tr_b16 a[48:49], v250 offset:0
    ds_read_b64_tr_b16 a[50:51], v250 offset:2304
    v_mfma_f32_32x32x16_bf16 v[128:143], a[128:131], a[28:31], v[128:143]
    buffer_load_dwordx4 v244, s[20:23], s48 offen offset:1024  lds
    v_mfma_f32_32x32x16_bf16 v[144:159], a[132:135], a[12:15], v[144:159]
    ds_read_b64_tr_b16 a[52:53], v251 offset:0
    ds_read_b64_tr_b16 a[54:55], v251 offset:2304
    v_mfma_f32_32x32x16_bf16 v[160:175], a[132:135], a[28:31], v[160:175]
    buffer_load_dwordx4 v245, s[20:23], s48 offen offset:2048  lds
    v_mfma_f32_32x32x16_bf16 v[176:191], a[12:15], a[136:139], v[176:191]
    ds_read_b64_tr_b16 a[56:57], v251 offset:64
    ds_read_b64_tr_b16 a[58:59], v251 offset:2368
    v_mfma_f32_32x32x16_bf16 v[192:207], a[28:31], a[136:139], v[192:207]
    s_add_u32 m0, s51, 6144
    s_nop 0
    buffer_load_dwordx4 v246, s[20:23], s48 offen offset:0  lds
    s_add_u32 s43, s43, 16384
    s_cmp_eq_u32 s43, 49152
    s_cselect_b32 s43, 0, s43
    s_mov_b32 s51, s53
    v_mfma_f32_32x32x16_bf16 v[208:223], a[12:15], a[140:143], v[208:223]
    ds_read_b64_tr_b16 a[60:61], v249 offset:9216
    ds_read_b64_tr_b16 a[62:63], v249 offset:11520
    ds_read_b128 a[12:15], v6 offset:0
    s_add_u32 s55, s55, 1
    v_add_u32 v5, s43, v252
    v_mfma_f32_32x32x16_bf16 v[224:239], a[28:31], a[140:143], v[224:239]
    ds_read_b128 a[28:31], v6 offset:2048
    v_xor_b32 v6, 32, v5
    s_cmp_lt_u32 s55, 9
    s_cbranch_scc1 F_QLOOP
    s_add_u32 s40, s38, 4096
    s_cmp_eq_u32 s34, 7
    s_cselect_b32 s40, s38, s40
    s_cmp_eq_u32 s34, 3
    s_cselect_b32 s40, s38, s40
    buffer_load_dword v14, v15, s[24:27], s40 offen sc0 sc1
    v_lshlrev_b32 v1, 4, v0
    s_lshl_b32 s40, s32, 11
    v_add_u32 v2, s40, v1
    s_mul_i32 s40, s32, 2080
    s_add_u32 s40, s40, 65536
    v_add_u32 v3, s40, v1
    v_mov_b32 v7, s40
    v_and_b32 v12, 31, v0
    v_lshrrev_b32 v13, 5, v0
    v_mul_u32_u24 v5, 1152, v13
    v_lshl_add_u32 v5, v12, 4, v5
    s_mul_i32 s40, s32, 9216
    s_add_u32 s40, s40, 73856
    v_add_u32 v5, s40, v5
    v_mul_u32_u24 v6, 9216, v13
    v_lshl_add_u32 v6, v12, 4, v6
    v_mov_b32 v8, 0x3eae1a93
    v_cmp_gt_u32 vcc, 32, v0
    s_nop 1
    v_cndmask_b32 v9, 1.0, v8, vcc
    v_bfe_u32 v10, v0, 4, 1
    v_mul_u32_u24 v10, 2304, v10
    v_bfe_u32 v11, v0, 2, 1
    v_mul_u32_u24 v11, 1152, v11
    v_add3_u32 v10, v10, v11, s40
    v_bfe_u32 v11, v0, 3, 1
    v_lshl_add_u32 v10, v11, 3, v10
    v_and_b32 v11, 3, v0
    v_lshl_add_u32 v10, v11, 1, v10
    v_mov_b32 v11, 111232
    v_cndmask_b32 v10, v11, v10, vcc
    v_bfe_u32 v11, v0, 3, 3
    v_mul_u32_u24 v4, 1152, v11
    v_and_b32 v12, 7, v0
    v_lshlrev_b32 v12, 4, v12
    v_add3_u32 v4, v4, v12, s40
    v_mul_u32_u24 v11, 9216, v11
    v_add_u32 v11, v11, v12
    s_lshl_b32 s41, s39, 10
    s_lshl_b32 s42, s33, 18
    s_add_u32 s42, s42, s41
    s_add_u32 s42, s42, 20971520
    s_lshl_b32 s43, s33, 16
    s_add_u32 s43, s43, s41
    s_add_u32 s43, s43, 23068672
    s_mul_i32 s44, s39, 36864
    s_mul_i32 s45, s33, 1152
    s_add_u32 s44, s44, s45
    s_add_u32 s44, s44, 23592960
    s_waitcnt lgkmcnt(0)
    s_barrier
    s_cmp_eq_u32 s34, 3
    s_cbranch_scc1 F_QEPI_SC
    v_mul_f32 v144, v144, v9
    v_mul_f32 v145, v145, v9
    v_mul_f32 v146, v146, v9
    v_mul_f32 v147, v147, v9
    v_mul_f32 v148, v148, v9
    v_mul_f32 v149, v149, v9
    v_mul_f32 v150, v150, v9
    v_mul_f32 v151, v151, v9
    v_cvt_pk_bf16_f32 v144, v144, v145
    v_cvt_pk_bf16_f32 v145, v146, v147
    v_cvt_pk_bf16_f32 v146, v148, v149
    v_cvt_pk_bf16_f32 v147, v150, v151
    v_cvt_pk_bf16_f32 v152, v152, v153
    v_cvt_pk_bf16_f32 v153, v154, v155
    v_cvt_pk_bf16_f32 v154, v156, v157
    v_cvt_pk_bf16_f32 v155, v158, v159
    v_mul_f32 v160, v160, v9
    v_mul_f32 v161, v161, v9
    v_mul_f32 v162, v162, v9
    v_mul_f32 v163, v163, v9
    v_mul_f32 v164, v164, v9
    v_mul_f32 v165, v165, v9
    v_mul_f32 v166, v166, v9
    v_mul_f32 v167, v167, v9
    v_cvt_pk_bf16_f32 v160, v160, v161
    v_cvt_pk_bf16_f32 v161, v162, v163
    v_cvt_pk_bf16_f32 v162, v164, v165
    v_cvt_pk_bf16_f32 v163, v166, v167
    v_cvt_pk_bf16_f32 v168, v168, v169
    v_cvt_pk_bf16_f32 v169, v170, v171
    v_cvt_pk_bf16_f32 v170, v172, v173
    v_cvt_pk_bf16_f32 v171, v174, v175
    ds_write_b16 v10, v152 offset:1024
    ds_write_b16_d16_hi v10, v152 offset:1040
    ds_write_b16 v10, v153 offset:1056
    ds_write_b16_d16_hi v10, v153 offset:1072
    ds_write_b16 v10, v154 offset:1088
    ds_write_b16_d16_hi v10, v154 offset:1104
    ds_write_b16 v10, v155 offset:1120
    ds_write_b16_d16_hi v10, v155 offset:1136
    s_add_u32 s46, s43, 0
    buffer_store_dwordx4 v[144:147], v1, s[24:27], s46 offen
    ds_write_b128 v3, v[144:147] offset:0
    ds_write_b16 v10, v168 offset:5632
    ds_write_b16_d16_hi v10, v168 offset:5648
    ds_write_b16 v10, v169 offset:5664
    ds_write_b16_d16_hi v10, v169 offset:5680
    ds_write_b16 v10, v170 offset:5696
    ds_write_b16_d16_hi v10, v170 offset:5712
    ds_write_b16 v10, v171 offset:5728
    ds_write_b16_d16_hi v10, v171 offset:5744
    s_add_u32 s47, s43, 1024
    buffer_store_dwordx4 v[160:163], v1, s[24:27], s47 offen
    ds_write_b128 v3, v[160:163] offset:1040
    ds_read_b128 v[240:243], v4 offset:1024
    v_cvt_pk_bf16_f32 v96, v96, v97
    v_cvt_pk_bf16_f32 v97, v98, v99
    v_cvt_pk_bf16_f32 v98, v100, v101
    v_cvt_pk_bf16_f32 v99, v102, v103
    v_cvt_pk_bf16_f32 v104, v104, v105
    v_cvt_pk_bf16_f32 v105, v106, v107
    v_cvt_pk_bf16_f32 v106, v108, v109
    v_cvt_pk_bf16_f32 v107, v110, v111
    v_cvt_pk_bf16_f32 v128, v128, v129
    v_cvt_pk_bf16_f32 v129, v130, v131
    v_cvt_pk_bf16_f32 v130, v132, v133
    v_cvt_pk_bf16_f32 v131, v134, v135
    v_cvt_pk_bf16_f32 v136, v136, v137
    v_cvt_pk_bf16_f32 v137, v138, v139
    v_cvt_pk_bf16_f32 v138, v140, v141
    v_cvt_pk_bf16_f32 v139, v142, v143
    s_add_u32 s48, s42, 1024
    buffer_store_dwordx4 v[96:99], v1, s[24:27], s48 offen
    ds_write_b128 v2, v[96:99] offset:33792
    s_add_u32 s49, s42, 66560
    buffer_store_dwordx4 v[104:107], v1, s[24:27], s49 offen
    ds_write_b128 v2, v[104:107] offset:41984
    s_add_u32 s50, s42, 132096
    buffer_store_dwordx4 v[128:131], v1, s[24:27], s50 offen
    ds_write_b128 v2, v[128:131] offset:50176
    s_add_u32 s51, s42, 197632
    buffer_store_dwordx4 v[136:139], v1, s[24:27], s51 offen
    ds_write_b128 v2, v[136:139] offset:58368
    v_cvt_pk_bf16_f32 v192, v192, v193
    v_cvt_pk_bf16_f32 v193, v194, v195
    v_cvt_pk_bf16_f32 v194, v196, v197
    v_cvt_pk_bf16_f32 v195, v198, v199
    v_cvt_pk_bf16_f32 v200, v200, v201
    v_cvt_pk_bf16_f32 v201, v202, v203
    v_cvt_pk_bf16_f32 v202, v204, v205
    v_cvt_pk_bf16_f32 v203, v206, v207
    v_cvt_pk_bf16_f32 v224, v224, v225
    v_cvt_pk_bf16_f32 v225, v226, v227
    v_cvt_pk_bf16_f32 v226, v228, v229
    v_cvt_pk_bf16_f32 v227, v230, v231
    v_cvt_pk_bf16_f32 v232, v232, v233
    v_cvt_pk_bf16_f32 v233, v234, v235
    v_cvt_pk_bf16_f32 v234, v236, v237
    v_cvt_pk_bf16_f32 v235, v238, v239
    s_add_u32 s52, s44, 36864
    buffer_store_dwordx4 v[192:195], v6, s[24:27], s52 offen
    ds_write_b128 v5, v[192:195] offset:4608
    s_add_u32 s53, s44, 55296
    buffer_store_dwordx4 v[200:203], v6, s[24:27], s53 offen
    ds_write_b128 v5, v[200:203] offset:6912
    s_add_u32 s46, s44, 37376
    buffer_store_dwordx4 v[224:227], v6, s[24:27], s46 offen
    ds_write_b128 v5, v[224:227] offset:5120
    s_add_u32 s47, s44, 55808
    buffer_store_dwordx4 v[232:235], v6, s[24:27], s47 offen
    ds_write_b128 v5, v[232:235] offset:7424
    s_waitcnt lgkmcnt(8)
    buffer_store_dwordx4 v[240:243], v11, s[24:27], s44 offen offset:1024
    v_cvt_pk_bf16_f32 v80, v80, v81
    v_cvt_pk_bf16_f32 v81, v82, v83
    v_cvt_pk_bf16_f32 v82, v84, v85
    v_cvt_pk_bf16_f32 v83, v86, v87
    v_cvt_pk_bf16_f32 v88, v88, v89
    v_cvt_pk_bf16_f32 v89, v90, v91
    v_cvt_pk_bf16_f32 v90, v92, v93
    v_cvt_pk_bf16_f32 v91, v94, v95
    v_cvt_pk_bf16_f32 v112, v112, v113
    v_cvt_pk_bf16_f32 v113, v114, v115
    v_cvt_pk_bf16_f32 v114, v116, v117
    v_cvt_pk_bf16_f32 v115, v118, v119
    v_cvt_pk_bf16_f32 v120, v120, v121
    v_cvt_pk_bf16_f32 v121, v122, v123
    v_cvt_pk_bf16_f32 v122, v124, v125
    v_cvt_pk_bf16_f32 v123, v126, v127
    s_add_u32 s48, s42, 0
    buffer_store_dwordx4 v[80:83], v1, s[24:27], s48 offen
    ds_write_b128 v2, v[80:83] offset:32768
    s_add_u32 s49, s42, 65536
    buffer_store_dwordx4 v[88:91], v1, s[24:27], s49 offen
    ds_write_b128 v2, v[88:91] offset:40960
    s_add_u32 s50, s42, 131072
    buffer_store_dwordx4 v[112:115], v1, s[24:27], s50 offen
    ds_write_b128 v2, v[112:115] offset:49152
    s_add_u32 s51, s42, 196608
    buffer_store_dwordx4 v[120:123], v1, s[24:27], s51 offen
    ds_write_b128 v2, v[120:123] offset:57344
    v_cvt_pk_bf16_f32 v176, v176, v177
    v_cvt_pk_bf16_f32 v177, v178, v179
    v_cvt_pk_bf16_f32 v178, v180, v181
    v_cvt_pk_bf16_f32 v179, v182, v183
    v_cvt_pk_bf16_f32 v184, v184, v185
    v_cvt_pk_bf16_f32 v185, v186, v187
    v_cvt_pk_bf16_f32 v186, v188, v189
    v_cvt_pk_bf16_f32 v187, v190, v191
    v_cvt_pk_bf16_f32 v208, v208, v209
    v_cvt_pk_bf16_f32 v209, v210, v211
    v_cvt_pk_bf16_f32 v210, v212, v213
    v_cvt_pk_bf16_f32 v211, v214, v215
    v_cvt_pk_bf16_f32 v216, v216, v217
    v_cvt_pk_bf16_f32 v217, v218, v219
    v_cvt_pk_bf16_f32 v218, v220, v221
    v_cvt_pk_bf16_f32 v219, v222, v223
    s_add_u32 s52, s44, 0
    buffer_store_dwordx4 v[176:179], v6, s[24:27], s52 offen
    ds_write_b128 v5, v[176:179] offset:0
    s_add_u32 s53, s44, 18432
    buffer_store_dwordx4 v[184:187], v6, s[24:27], s53 offen
    ds_write_b128 v5, v[184:187] offset:2304
    s_add_u32 s46, s44, 512
    buffer_store_dwordx4 v[208:211], v6, s[24:27], s46 offen
    ds_write_b128 v5, v[208:211] offset:512
    s_add_u32 s47, s44, 18944
    buffer_store_dwordx4 v[216:219], v6, s[24:27], s47 offen
    ds_write_b128 v5, v[216:219] offset:2816
    v_mul_f32 v16, v16, v8
    v_mul_f32 v17, v17, v8
    v_mul_f32 v18, v18, v8
    v_mul_f32 v19, v19, v8
    v_mul_f32 v20, v20, v8
    v_mul_f32 v21, v21, v8
    v_mul_f32 v22, v22, v8
    v_mul_f32 v23, v23, v8
    v_cvt_pk_bf16_f32 v16, v16, v17
    v_cvt_pk_bf16_f32 v17, v18, v19
    v_cvt_pk_bf16_f32 v18, v20, v21
    v_cvt_pk_bf16_f32 v19, v22, v23
    v_mul_f32 v24, v24, v8
    v_mul_f32 v25, v25, v8
    v_mul_f32 v26, v26, v8
    v_mul_f32 v27, v27, v8
    v_mul_f32 v28, v28, v8
    v_mul_f32 v29, v29, v8
    v_mul_f32 v30, v30, v8
    v_mul_f32 v31, v31, v8
    v_cvt_pk_bf16_f32 v24, v24, v25
    v_cvt_pk_bf16_f32 v25, v26, v27
    v_cvt_pk_bf16_f32 v26, v28, v29
    v_cvt_pk_bf16_f32 v27, v30, v31
    v_mul_f32 v48, v48, v8
    v_mul_f32 v49, v49, v8
    v_mul_f32 v50, v50, v8
    v_mul_f32 v51, v51, v8
    v_mul_f32 v52, v52, v8
    v_mul_f32 v53, v53, v8
    v_mul_f32 v54, v54, v8
    v_mul_f32 v55, v55, v8
    v_cvt_pk_bf16_f32 v48, v48, v49
    v_cvt_pk_bf16_f32 v49, v50, v51
    v_cvt_pk_bf16_f32 v50, v52, v53
    v_cvt_pk_bf16_f32 v51, v54, v55
    v_mul_f32 v56, v56, v8
    v_mul_f32 v57, v57, v8
    v_mul_f32 v58, v58, v8
    v_mul_f32 v59, v59, v8
    v_mul_f32 v60, v60, v8
    v_mul_f32 v61, v61, v8
    v_mul_f32 v62, v62, v8
    v_mul_f32 v63, v63, v8
    v_cvt_pk_bf16_f32 v56, v56, v57
    v_cvt_pk_bf16_f32 v57, v58, v59
    v_cvt_pk_bf16_f32 v58, v60, v61
    v_cvt_pk_bf16_f32 v59, v62, v63
    ds_write_b128 v2, v[16:19] offset:0
    ds_write_b128 v2, v[24:27] offset:8192
    ds_write_b128 v2, v[48:51] offset:16384
    ds_write_b128 v2, v[56:59] offset:24576
    v_mul_f32 v32, v32, v8
    v_mul_f32 v33, v33, v8
    v_mul_f32 v34, v34, v8
    v_mul_f32 v35, v35, v8
    v_mul_f32 v36, v36, v8
    v_mul_f32 v37, v37, v8
    v_mul_f32 v38, v38, v8
    v_mul_f32 v39, v39, v8
    v_cvt_pk_bf16_f32 v32, v32, v33
    v_cvt_pk_bf16_f32 v33, v34, v35
    v_cvt_pk_bf16_f32 v34, v36, v37
    v_cvt_pk_bf16_f32 v35, v38, v39
    v_mul_f32 v40, v40, v8
    v_mul_f32 v41, v41, v8
    v_mul_f32 v42, v42, v8
    v_mul_f32 v43, v43, v8
    v_mul_f32 v44, v44, v8
    v_mul_f32 v45, v45, v8
    v_mul_f32 v46, v46, v8
    v_mul_f32 v47, v47, v8
    v_cvt_pk_bf16_f32 v40, v40, v41
    v_cvt_pk_bf16_f32 v41, v42, v43
    v_cvt_pk_bf16_f32 v42, v44, v45
    v_cvt_pk_bf16_f32 v43, v46, v47
    v_mul_f32 v64, v64, v8
    v_mul_f32 v65, v65, v8
    v_mul_f32 v66, v66, v8
    v_mul_f32 v67, v67, v8
    v_mul_f32 v68, v68, v8
    v_mul_f32 v69, v69, v8
    v_mul_f32 v70, v70, v8
    v_mul_f32 v71, v71, v8
    v_cvt_pk_bf16_f32 v64, v64, v65
    v_cvt_pk_bf16_f32 v65, v66, v67
    v_cvt_pk_bf16_f32 v66, v68, v69
    v_cvt_pk_bf16_f32 v67, v70, v71
    v_mul_f32 v72, v72, v8
    v_mul_f32 v73, v73, v8
    v_mul_f32 v74, v74, v8
    v_mul_f32 v75, v75, v8
    v_mul_f32 v76, v76, v8
    v_mul_f32 v77, v77, v8
    v_mul_f32 v78, v78, v8
    v_mul_f32 v79, v79, v8
    v_cvt_pk_bf16_f32 v72, v72, v73
    v_cvt_pk_bf16_f32 v73, v74, v75
    v_cvt_pk_bf16_f32 v74, v76, v77
    v_cvt_pk_bf16_f32 v75, v78, v79
    ds_write_b128 v2, v[32:35] offset:1024
    ds_write_b128 v2, v[40:43] offset:9216
    ds_write_b128 v2, v[64:67] offset:17408
    ds_write_b128 v2, v[72:75] offset:25600
    v_mov_b32 v244, 0
    v_mov_b32 v245, 0
    v_mov_b32 v246, 0
    v_mov_b32 v247, 0
    ds_write_b128 v7, v[244:247] offset:1024
    ds_write_b128 v7, v[244:247] offset:2064
F_QEPI_DONE:
    s_lshl_b32 s4, s33, 2
    s_add_u32 s4, s4, s32
    v_and_b32 v2, 31, v0
    v_lshrrev_b32 v3, 5, v0
    v_lshlrev_b32 v4, 4, v0
    v_lshlrev_b32 v5, 4, v2
    v_mul_u32_u24 v6, 9216, v3
    v_add_u32 v6, v6, v5
    v_cmp_gt_u32 vcc, 32, v0
    v_mov_b32 v8, 0x7ff00000
    s_nop 0
    v_cndmask_b32 v7, v8, v5, vcc
    s_lshl_b32 s5, s34, 3
    s_sub_u32 s5, s5, 8
    s_lshl_b32 s73, s4, 6
    s_add_u32 s73, s73, s5
    s_lshl_b32 s73, s73, 10
    s_add_u32 s73, s73, 20971520
    s_lshl_b32 s75, s33, 6
    s_add_u32 s75, s75, s5
    s_lshl_b32 s75, s75, 10
    s_lshl_b32 s8, s32, 2
    s_add_u32 s75, s75, s8
    s_add_u32 s75, s75, 23069184
    s_mul_i32 s76, s5, 36864
    s_mul_i32 s77, s4, 288
    s_add_u32 s76, s76, s77
    s_add_u32 s76, s76, 23592960
    s_bfe_u32 s6, s4, 0x10002
    s_lshl_b32 s6, s6, 9
    s_add_u32 s6, s6, s8
    s_mul_i32 s77, s5, 36864
    s_add_u32 s77, s77, 25952256
    s_lshr_b32 s7, s4, 3
    s_add_u32 s7, s7, 32
    s_lshl_b32 s7, s7, 10
    s_add_u32 s7, s7, s6
    s_add_u32 s7, s7, s77
    s_lshl_b32 s9, s4, 10
    s_add_u32 s77, s77, s9
    s_mov_b32 s78, 0x0003ffff
    s_mov_b32 s79, 0x0003ffff
    s_lshl_b32 s9, s32, 13
    v_add_u32 v1, s9, v4
    s_add_u32 s9, s8, 65536
    v_add_u32 v11, s9, v5
    v_mov_b32 v10, 66560
    v_cndmask_b32 v10, v10, v11, vcc
    v_add_u32 v11, 512, v11
    v_mul_u32_u24 v12, 1152, v3
    v_add_u32 v12, v12, v5
    s_mul_i32 s9, s32, 288
    s_add_u32 s9, s9, 73856
    v_add_u32 v12, s9, v12
    v_accvgpr_write_b32 a121, 0
    v_accvgpr_write_b32 a122, 0
    v_accvgpr_write_b32 a123, 0
    v_accvgpr_write_b32 a125, 0
    v_accvgpr_write_b32 a126, 0
    v_accvgpr_write_b32 a127, 0
    v_mov_b32 v9, 0x3f803f80
    v_lshlrev_b32 v13, 2, v3
    v_sub_u32 v13, v2, v13
    v_cmp_gt_i32 s[40:41], 0, v13
    v_cmp_gt_i32 s[42:43], 1, v13
    v_cmp_gt_i32 s[44:45], 2, v13
    v_cmp_gt_i32 s[46:47], 3, v13
    v_cmp_gt_i32 s[48:49], 8, v13
    v_cmp_gt_i32 s[50:51], 9, v13
    v_cmp_gt_i32 s[52:53], 10, v13
    v_cmp_gt_i32 s[54:55], 11, v13
    v_cmp_gt_i32 s[56:57], 16, v13
    v_cmp_gt_i32 s[58:59], 17, v13
    v_cmp_gt_i32 s[60:61], 18, v13
    v_cmp_gt_i32 s[62:63], 19, v13
    v_cmp_gt_i32 s[64:65], 24, v13
    v_cmp_gt_i32 s[66:67], 25, v13
    v_cmp_gt_i32 s[68:69], 26, v13
    v_cmp_gt_i32 s[70:71], 27, v13
    v_mov_b32 v240, 0xffff
    v_mov_b32 v241, 0xffff0000
    v_cndmask_b32 v242, 0, v240, s[40:41]
    v_cndmask_b32 v243, 0, v241, s[42:43]
    v_or_b32 v232, v242, v243
    v_cndmask_b32 v242, 0, v240, s[44:45]
    v_cndmask_b32 v243, 0, v241, s[46:47]
    v_or_b32 v233, v242, v243
    v_cndmask_b32 v242, 0, v240, s[48:49]
    v_cndmask_b32 v243, 0, v241, s[50:51]
    v_or_b32 v234, v242, v243
    v_cndmask_b32 v242, 0, v240, s[52:53]
    v_cndmask_b32 v243, 0, v241, s[54:55]
    v_or_b32 v235, v242, v243
    v_cndmask_b32 v242, 0, v240, s[56:57]
    v_cndmask_b32 v243, 0, v241, s[58:59]
    v_or_b32 v236, v242, v243
    v_cndmask_b32 v242, 0, v240, s[60:61]
    v_cndmask_b32 v243, 0, v241, s[62:63]
    v_or_b32 v237, v242, v243
    v_cndmask_b32 v242, 0, v240, s[64:65]
    v_cndmask_b32 v243, 0, v241, s[66:67]
    v_or_b32 v238, v242, v243
    v_cndmask_b32 v242, 0, v240, s[68:69]
    v_cndmask_b32 v243, 0, v241, s[70:71]
    v_or_b32 v239, v242, v243
    v_cndmask_b32 v228, 0, v9, vcc
    v_mov_b32 v229, 0
    v_mov_b32 v225, 0
    v_mov_b32 v230, 0
    v_mov_b32 v226, 0
    v_mov_b32 v231, 0
    v_mov_b32 v227, 0
    v_mov_b32 v13, 0xf149f2ca
    s_sub_u32 s9, s38, 4096
    s_or_b32 s8, s3, s37
    s_or_b32 s8, s8, 0x30
    s_waitcnt vmcnt(0) lgkmcnt(0)
    s_barrier
    s_cmp_lg_u32 s32, 0
    s_cbranch_scc1 PUB_37
    v_readfirstlane_b32 s100, v14
    s_nop 1
    s_xor_b32 s100, s100, s8
    s_and_b32 s100, s100, 0xffffffcf
    s_cmp_eq_u32 s100, 0
    s_cbranch_scc1 WB_36
    buffer_wbl2 sc1
    s_waitcnt vmcnt(0)
WB_36:
    s_or_b32 s101, s3, s37
    s_or_b32 s101, s101, 32
    v_mov_b32 v14, s101
    buffer_store_dword v14, v15, s[24:27], s38 offen sc0 sc1
PUB_37:
    s_cmp_eq_u32 s34, 0
    s_cbranch_scc1 F_ATT_FIRST
    ds_read_b128 a[116:119], v1 offset:7168
    ds_read_b32 a124, v10 offset:7280
    ds_read_b128 a[12:15], v1 offset:39936
    ds_read_b32 a76, v11 offset:7280
    ds_read_b128 a[8:11], v1 offset:38912
    ds_read_b32 a72, v11 offset:6240
    ds_read_b128 a[4:7], v1 offset:37888
    ds_read_b32 a68, v11 offset:5200
    ds_read_b128 a[0:3], v1 offset:36864
    ds_read_b32 a64, v11 offset:4160
    ds_read_b128 a[44:47], v1 offset:35840
    ds_read_b32 a108, v11 offset:3120
    ds_read_b128 a[40:43], v1 offset:34816
    ds_read_b32 a104, v11 offset:2080
    ds_read_b128 a[36:39], v1 offset:33792
    ds_read_b32 a100, v11 offset:1040
    ds_read_b128 a[32:35], v1 offset:32768
    ds_read_b32 a96, v11 offset:0
    s_mov_b64 exec, s[78:79]
    ds_read_b128 a[184:187], v12 offset:32256
    ds_read_b128 a[188:191], v12 offset:34560
    s_mov_b64 exec, -1
    s_mov_b64 exec, s[78:79]
    ds_read_b128 a[176:179], v12 offset:27648
    ds_read_b128 a[180:183], v12 offset:29952
    s_mov_b64 exec, -1
    s_mov_b64 exec, s[78:79]
    ds_read_b128 a[168:171], v12 offset:23040
    ds_read_b128 a[172:175], v12 offset:25344
    s_mov_b64 exec, -1
    s_mov_b64 exec, s[78:79]
    ds_read_b128 a[160:163], v12 offset:18432
    ds_read_b128 a[164:167], v12 offset:20736
    s_mov_b64 exec, -1
    s_mov_b64 exec, s[78:79]
    ds_read_b128 a[248:251], v12 offset:13824
    ds_read_b128 a[252:255], v12 offset:16128
    s_mov_b64 exec, -1
    s_mov_b64 exec, s[78:79]
    ds_read_b128 a[240:243], v12 offset:9216
    ds_read_b128 a[244:247], v12 offset:11520
    s_mov_b64 exec, -1
    s_mov_b64 exec, s[78:79]
    ds_read_b128 a[232:235], v12 offset:4608
    ds_read_b128 a[236:239], v12 offset:6912
    s_mov_b64 exec, -1
    s_mov_b64 exec, s[78:79]
    ds_read_b128 a[224:227], v12 offset:0
    ds_read_b128 a[228:231], v12 offset:2304
    s_mov_b64 exec, -1
    ds_read_b128 a[112:115], v1 offset:6144
    ds_read_b32 a120, v10 offset:6240
    s_waitcnt lgkmcnt(15)
    v_mfma_f32_32x32x16_bf16 v[16:31], a[12:15], a[116:119], 0
    s_waitcnt lgkmcnt(15)
    v_mfma_f32_32x32x16_bf16 v[32:47], a[32:35], a[116:119], 0
    v_mfma_f32_32x32x16_bf16 v[16:31], a[76:79], a[124:127], v[16:31]
    s_waitcnt lgkmcnt(15)
    v_mfma_f32_32x32x16_bf16 v[48:63], a[36:39], a[116:119], 0
    s_nop 9
    v_cndmask_b32 v16, v16, v13, s[40:41]
    v_mfma_f32_32x32x16_bf16 v[32:47], a[96:99], a[124:127], v[32:47]
    v_cndmask_b32 v17, v17, v13, s[42:43]
    v_cndmask_b32 v18, v18, v13, s[44:45]
    v_cndmask_b32 v19, v19, v13, s[46:47]
    v_cndmask_b32 v20, v20, v13, s[48:49]
    v_cndmask_b32 v21, v21, v13, s[50:51]
    v_cndmask_b32 v22, v22, v13, s[52:53]
    s_waitcnt lgkmcnt(15)
    v_mfma_f32_32x32x16_bf16 v[64:79], a[40:43], a[116:119], 0
    v_cndmask_b32 v23, v23, v13, s[54:55]
    v_max_f32 v242, v16, v17
    v_max_f32 v243, v18, v19
    v_cndmask_b32 v24, v24, v13, s[56:57]
    v_cndmask_b32 v25, v25, v13, s[58:59]
    v_cndmask_b32 v26, v26, v13, s[60:61]
    v_mfma_f32_32x32x16_bf16 v[48:63], a[100:103], a[124:127], v[48:63]
    v_cndmask_b32 v27, v27, v13, s[62:63]
    v_max3_f32 v242, v20, v21, v242
    v_max3_f32 v243, v22, v23, v243
    v_cndmask_b32 v28, v28, v13, s[64:65]
    v_cndmask_b32 v29, v29, v13, s[66:67]
    v_cndmask_b32 v30, v30, v13, s[68:69]
    s_waitcnt lgkmcnt(15)
    v_mfma_f32_32x32x16_bf16 v[80:95], a[44:47], a[116:119], 0
    v_cndmask_b32 v31, v31, v13, s[70:71]
    v_max3_f32 v242, v24, v25, v242
    v_max3_f32 v243, v26, v27, v243
    v_max3_f32 v242, v28, v29, v242
    v_max3_f32 v243, v30, v31, v243
    v_max3_f32 v242, v32, v33, v242
    v_mfma_f32_32x32x16_bf16 v[64:79], a[104:107], a[124:127], v[64:79]
    v_max3_f32 v243, v34, v35, v243
    v_max3_f32 v242, v36, v37, v242
    v_max3_f32 v243, v38, v39, v243
    v_max3_f32 v242, v40, v41, v242
    v_max3_f32 v243, v42, v43, v243
    v_max3_f32 v242, v44, v45, v242
    s_waitcnt lgkmcnt(15)
    v_mfma_f32_32x32x16_bf16 v[96:111], a[0:3], a[116:119], 0
    v_max3_f32 v243, v46, v47, v243
    v_max3_f32 v242, v48, v49, v242
    v_max3_f32 v243, v50, v51, v243
    v_max3_f32 v242, v52, v53, v242
    v_max3_f32 v243, v54, v55, v243
    v_max3_f32 v242, v56, v57, v242
    v_mfma_f32_32x32x16_bf16 v[80:95], a[108:111], a[124:127], v[80:95]
    v_max3_f32 v243, v58, v59, v243
    v_max3_f32 v242, v60, v61, v242
    v_max3_f32 v243, v62, v63, v243
    v_max3_f32 v242, v64, v65, v242
    v_max3_f32 v243, v66, v67, v243
    v_max3_f32 v242, v68, v69, v242
    s_waitcnt lgkmcnt(15)
    v_mfma_f32_32x32x16_bf16 v[112:127], a[4:7], a[116:119], 0
    v_max3_f32 v243, v70, v71, v243
    v_max3_f32 v242, v72, v73, v242
    v_max3_f32 v243, v74, v75, v243
    v_max3_f32 v242, v76, v77, v242
    v_max3_f32 v243, v78, v79, v243
    v_max3_f32 v242, v80, v81, v242
    v_mfma_f32_32x32x16_bf16 v[96:111], a[64:67], a[124:127], v[96:111]
    v_max3_f32 v243, v82, v83, v243
    v_max3_f32 v242, v84, v85, v242
    v_max3_f32 v243, v86, v87, v243
    v_max3_f32 v242, v88, v89, v242
    v_max3_f32 v243, v90, v91, v243
    v_max3_f32 v242, v92, v93, v242
    s_waitcnt lgkmcnt(15)
    v_mfma_f32_32x32x16_bf16 v[128:143], a[8:11], a[116:119], 0
    v_max3_f32 v243, v94, v95, v243
    s_nop 2
    v_max3_f32 v242, v96, v97, v242
    v_mfma_f32_32x32x16_bf16 v[112:127], a[68:71], a[124:127], v[112:127]
    v_max3_f32 v243, v98, v99, v243
    v_max3_f32 v242, v100, v101, v242
    v_max3_f32 v243, v102, v103, v243
    v_max3_f32 v242, v104, v105, v242
    v_max3_f32 v243, v106, v107, v243
    v_max3_f32 v242, v108, v109, v242
    v_mfma_f32_32x32x16_bf16 v[128:143], a[72:75], a[124:127], v[128:143]
    v_max3_f32 v243, v110, v111, v243
    s_nop 3
    v_max3_f32 v242, v112, v113, v242
    v_max3_f32 v243, v114, v115, v243
    v_max3_f32 v242, v116, v117, v242
    v_max3_f32 v243, v118, v119, v243
    v_max3_f32 v242, v120, v121, v242
    v_max3_f32 v243, v122, v123, v243
    v_max3_f32 v242, v124, v125, v242
    v_max3_f32 v243, v126, v127, v243
    v_max3_f32 v242, v128, v129, v242
    v_max3_f32 v243, v130, v131, v243
    v_max3_f32 v242, v132, v133, v242
    v_max3_f32 v243, v134, v135, v243
    v_max3_f32 v242, v136, v137, v242
    v_max3_f32 v243, v138, v139, v243
    v_max3_f32 v242, v140, v141, v242
    v_max3_f32 v243, v142, v143, v243
    v_max_f32 v242, v242, v243
    v_mov_b32 v243, v242
    s_nop 1
    v_permlane32_swap_b32 v242, v243
    v_max_f32 v242, v242, v243
    v_cvt_pk_bf16_f32 v244, v242, v242
    v_and_b32 v244, 0xffff0000, v244
    v_sub_f32 v243, v244, v242
    v_cvt_pk_bf16_f32 v224, -v244, v243
    v_lshlrev_b32 v247, 16, v224
    v_and_b32 v246, 0xffff0000, v224
    v_mfma_f32_32x32x16_bf16 v[16:31], v[228:231], v[224:227], v[16:31]
    v_add_f32 v247, v247, v246
    v_mfma_f32_32x32x16_bf16 v[64:79], v[228:231], v[224:227], v[64:79]
    s_nop 9
    v_exp_f32 v30, v30
    v_mfma_f32_32x32x16_bf16 v[32:47], v[228:231], v[224:227], v[32:47]
    v_exp_f32 v31, v31
    v_exp_f32 v16, v16
    v_cvt_pk_bf16_f32 v199, v30, v31
    v_exp_f32 v78, v78
    v_mfma_f32_32x32x16_bf16 v[48:63], v[228:231], v[224:227], v[48:63]
    buffer_load_dword v14, v15, s[24:27], s9 offen sc0 sc1
    v_exp_f32 v79, v79
    v_exp_f32 v17, v17
    v_cvt_pk_bf16_f32 v223, v78, v79
    v_mfma_f32_32x32x16_bf16 v[80:95], v[228:231], v[224:227], v[80:95]
    v_exp_f32 v18, v18
    v_exp_f32 v19, v19
    v_exp_f32 v20, v20
    v_mfma_f32_32x32x16_bf16 v[96:111], v[228:231], v[224:227], v[96:111]
    v_exp_f32 v21, v21
    v_exp_f32 v22, v22
    v_exp_f32 v23, v23
    v_mfma_f32_32x32x16_bf16 v[112:127], v[228:231], v[224:227], v[112:127]
    v_cvt_pk_bf16_f32 v192, v16, v17
    v_cvt_pk_bf16_f32 v193, v18, v19
    v_cvt_pk_bf16_f32 v194, v20, v21
    v_cvt_pk_bf16_f32 v195, v22, v23
    v_exp_f32 v24, v24
    s_waitcnt lgkmcnt(15)
    v_mfma_f32_32x32x16_bf16 v[176:191], a[184:187], v[192:195], 0
    v_exp_f32 v25, v25
    v_exp_f32 v26, v26
    v_exp_f32 v27, v27
    v_mfma_f32_32x32x16_bf16 v[128:143], v[228:231], v[224:227], v[128:143]
    v_exp_f32 v28, v28
    v_exp_f32 v29, v29
    v_cvt_pk_bf16_f32 v196, v24, v25
    v_cvt_pk_bf16_f32 v197, v26, v27
    v_cvt_pk_bf16_f32 v198, v28, v29
    s_waitcnt lgkmcnt(0)
    v_mfma_f32_32x32x16_bf16 v[16:31], a[8:11], a[112:115], 0
    v_exp_f32 v32, v32
    v_exp_f32 v33, v33
    v_exp_f32 v34, v34
    v_mfma_f32_32x32x16_bf16 v[176:191], a[188:191], v[196:199], v[176:191]
    v_exp_f32 v35, v35
    v_exp_f32 v36, v36
    v_exp_f32 v37, v37
    v_mfma_f32_32x32x16_bf16 v[16:31], a[72:75], a[120:123], v[16:31]
    v_exp_f32 v38, v38
    v_exp_f32 v39, v39
    v_cvt_pk_bf16_f32 v200, v32, v33
    v_cvt_pk_bf16_f32 v201, v34, v35
    v_cvt_pk_bf16_f32 v202, v36, v37
    v_cvt_pk_bf16_f32 v203, v38, v39
    v_exp_f32 v40, v40
    s_waitcnt lgkmcnt(2)
    v_mfma_f32_32x32x16_bf16 v[176:191], a[224:227], v[200:203], v[176:191]
    v_exp_f32 v41, v41
    v_exp_f32 v42, v42
    v_exp_f32 v43, v43
    v_exp_f32 v44, v44
    v_exp_f32 v45, v45
    v_exp_f32 v46, v46
    v_exp_f32 v47, v47
    v_cvt_pk_bf16_f32 v204, v40, v41
    v_cvt_pk_bf16_f32 v205, v42, v43
    v_cvt_pk_bf16_f32 v206, v44, v45
    v_cvt_pk_bf16_f32 v207, v46, v47
    v_mfma_f32_32x32x16_bf16 v[32:47], a[4:7], a[112:115], 0
    v_exp_f32 v48, v48
    v_exp_f32 v49, v49
    v_exp_f32 v50, v50
    v_mfma_f32_32x32x16_bf16 v[176:191], a[228:231], v[204:207], v[176:191]
    v_exp_f32 v51, v51
    v_exp_f32 v52, v52
    v_exp_f32 v53, v53
    v_mfma_f32_32x32x16_bf16 v[32:47], a[68:71], a[120:123], v[32:47]
    v_exp_f32 v54, v54
    v_exp_f32 v55, v55
    v_cvt_pk_bf16_f32 v208, v48, v49
    v_cvt_pk_bf16_f32 v209, v50, v51
    v_cvt_pk_bf16_f32 v210, v52, v53
    v_cvt_pk_bf16_f32 v211, v54, v55
    v_exp_f32 v56, v56
    s_waitcnt lgkmcnt(4)
    v_mfma_f32_32x32x16_bf16 v[176:191], a[232:235], v[208:211], v[176:191]
    v_exp_f32 v57, v57
    v_exp_f32 v58, v58
    v_exp_f32 v59, v59
    v_exp_f32 v60, v60
    v_exp_f32 v61, v61
    v_exp_f32 v62, v62
    v_exp_f32 v63, v63
    v_cvt_pk_bf16_f32 v212, v56, v57
    v_cvt_pk_bf16_f32 v213, v58, v59
    v_cvt_pk_bf16_f32 v214, v60, v61
    v_cvt_pk_bf16_f32 v215, v62, v63
    v_mfma_f32_32x32x16_bf16 v[48:63], a[0:3], a[112:115], 0
    v_exp_f32 v64, v64
    v_exp_f32 v65, v65
    v_exp_f32 v66, v66
    v_mfma_f32_32x32x16_bf16 v[176:191], a[236:239], v[212:215], v[176:191]
    v_exp_f32 v67, v67
    v_exp_f32 v68, v68
    v_exp_f32 v69, v69
    v_mfma_f32_32x32x16_bf16 v[48:63], a[64:67], a[120:123], v[48:63]
    v_exp_f32 v70, v70
    v_exp_f32 v71, v71
    v_cvt_pk_bf16_f32 v216, v64, v65
    v_cvt_pk_bf16_f32 v217, v66, v67
    v_cvt_pk_bf16_f32 v218, v68, v69
    v_cvt_pk_bf16_f32 v219, v70, v71
    v_exp_f32 v72, v72
    s_waitcnt lgkmcnt(6)
    v_mfma_f32_32x32x16_bf16 v[176:191], a[240:243], v[216:219], v[176:191]
    v_exp_f32 v73, v73
    s_waitcnt vmcnt(0)
    v_readfirstlane_b32 s101, v14
    s_nop 1
    s_xor_b32 s101, s101, s8
    s_and_b32 s101, s101, 0xffffffef
    s_cmp_lg_u32 s101, 0
    s_cbranch_scc1 HC_38
HCR_39:
    s_add_u32 s16, s73, 4096
    buffer_load_dwordx4 a[28:31], v4, s[24:27], s16 offen offset:3072
    s_add_u32 s17, s75, 4096
    buffer_load_dword a92, v5, s[24:27], s17 offen offset:3072
    s_add_u32 s18, s73, 4096
    buffer_load_dwordx4 a[24:27], v4, s[24:27], s18 offen offset:2048
    s_add_u32 s19, s75, 4096
    buffer_load_dword a88, v5, s[24:27], s19 offen offset:2048
    s_add_u32 s20, s76, 258048
    s_add_u32 s21, s76, 276480
    s_mov_b64 exec, s[78:79]
    buffer_load_dwordx4 a[216:219], v6, s[24:27], s20 offen
    buffer_load_dwordx4 a[220:223], v6, s[24:27], s21 offen
    s_mov_b64 exec, -1
    s_add_u32 s22, s76, 221184
    s_add_u32 s23, s76, 239616
    s_mov_b64 exec, s[78:79]
    buffer_load_dwordx4 a[208:211], v6, s[24:27], s22 offen
    buffer_load_dwordx4 a[212:215], v6, s[24:27], s23 offen
    s_mov_b64 exec, -1
    s_add_u32 s16, s73, 4096
    buffer_load_dwordx4 a[20:23], v4, s[24:27], s16 offen offset:1024
    s_add_u32 s17, s75, 4096
    buffer_load_dword a84, v5, s[24:27], s17 offen offset:1024
    s_add_u32 s18, s76, 184320
    s_add_u32 s19, s76, 202752
    s_mov_b64 exec, s[78:79]
    buffer_load_dwordx4 a[200:203], v6, s[24:27], s18 offen
    buffer_load_dwordx4 a[204:207], v6, s[24:27], s19 offen
    s_mov_b64 exec, -1
    s_add_u32 s20, s73, 4096
    buffer_load_dwordx4 a[16:19], v4, s[24:27], s20 offen offset:0
    s_add_u32 s21, s75, 4096
    buffer_load_dword a80, v5, s[24:27], s21 offen offset:0
    s_add_u32 s22, s76, 147456
    s_add_u32 s23, s76, 165888
    s_mov_b64 exec, s[78:79]
    buffer_load_dwordx4 a[192:195], v6, s[24:27], s22 offen
    buffer_load_dwordx4 a[196:199], v6, s[24:27], s23 offen
    s_mov_b64 exec, -1
    s_add_u32 s16, s77, 552960
    s_add_u32 s17, s7, 552960
    s_add_u32 s18, s73, 0
    s_add_u32 s19, s75, 0
    s_add_u32 s20, s76, 110592
    s_add_u32 s21, s76, 129024
    s_add_u32 s22, s77, 516096
    s_add_u32 s23, s7, 516096
    v_exp_f32 v74, v74
    v_exp_f32 v75, v75
    v_exp_f32 v76, v76
    v_exp_f32 v77, v77
    v_cvt_pk_bf16_f32 v220, v72, v73
    v_cvt_pk_bf16_f32 v221, v74, v75
    v_cvt_pk_bf16_f32 v222, v76, v77
    v_mfma_f32_32x32x16_bf16 v[64:79], a[44:47], a[112:115], 0
    v_exp_f32 v80, v80
    v_exp_f32 v81, v81
    v_exp_f32 v82, v82
    v_mfma_f32_32x32x16_bf16 v[176:191], a[244:247], v[220:223], v[176:191]
    v_exp_f32 v83, v83
    v_exp_f32 v84, v84
    v_exp_f32 v85, v85
    v_mfma_f32_32x32x16_bf16 v[64:79], a[108:111], a[120:123], v[64:79]
    v_exp_f32 v86, v86
    v_exp_f32 v87, v87
    v_cvt_pk_bf16_f32 v192, v80, v81
    v_cvt_pk_bf16_f32 v193, v82, v83
    v_cvt_pk_bf16_f32 v194, v84, v85
    v_cvt_pk_bf16_f32 v195, v86, v87
    v_exp_f32 v88, v88
    s_waitcnt lgkmcnt(8)
    v_mfma_f32_32x32x16_bf16 v[176:191], a[248:251], v[192:195], v[176:191]
    v_exp_f32 v89, v89
    v_exp_f32 v90, v90
    v_exp_f32 v91, v91
    v_exp_f32 v92, v92
    v_exp_f32 v93, v93
    v_exp_f32 v94, v94
    v_exp_f32 v95, v95
    v_cvt_pk_bf16_f32 v196, v88, v89
    v_cvt_pk_bf16_f32 v197, v90, v91
    v_cvt_pk_bf16_f32 v198, v92, v93
    v_cvt_pk_bf16_f32 v199, v94, v95
    v_mfma_f32_32x32x16_bf16 v[80:95], a[40:43], a[112:115], 0
    v_exp_f32 v96, v96
    v_exp_f32 v97, v97
    v_exp_f32 v98, v98
    v_mfma_f32_32x32x16_bf16 v[176:191], a[252:255], v[196:199], v[176:191]
    v_exp_f32 v99, v99
    v_exp_f32 v100, v100
    v_exp_f32 v101, v101
    v_mfma_f32_32x32x16_bf16 v[80:95], a[104:107], a[120:123], v[80:95]
    v_exp_f32 v102, v102
    v_exp_f32 v103, v103
    v_cvt_pk_bf16_f32 v200, v96, v97
    v_cvt_pk_bf16_f32 v201, v98, v99
    v_cvt_pk_bf16_f32 v202, v100, v101
    v_cvt_pk_bf16_f32 v203, v102, v103
    v_exp_f32 v104, v104
    s_waitcnt lgkmcnt(10)
    v_mfma_f32_32x32x16_bf16 v[176:191], a[160:163], v[200:203], v[176:191]
    v_exp_f32 v105, v105
    v_exp_f32 v106, v106
    v_exp_f32 v107, v107
    v_exp_f32 v108, v108
    v_exp_f32 v109, v109
    v_exp_f32 v110, v110
    v_exp_f32 v111, v111
    v_cvt_pk_bf16_f32 v204, v104, v105
    v_cvt_pk_bf16_f32 v205, v106, v107
    v_cvt_pk_bf16_f32 v206, v108, v109
    v_cvt_pk_bf16_f32 v207, v110, v111
    v_mfma_f32_32x32x16_bf16 v[96:111], a[36:39], a[112:115], 0
    v_exp_f32 v112, v112
    v_exp_f32 v113, v113
    v_exp_f32 v114, v114
    v_mfma_f32_32x32x16_bf16 v[176:191], a[164:167], v[204:207], v[176:191]
    v_exp_f32 v115, v115
    v_exp_f32 v116, v116
    v_exp_f32 v117, v117
    v_mfma_f32_32x32x16_bf16 v[96:111], a[100:103], a[120:123], v[96:111]
    v_exp_f32 v118, v118
    v_exp_f32 v119, v119
    v_cvt_pk_bf16_f32 v208, v112, v113
    v_cvt_pk_bf16_f32 v209, v114, v115
    v_cvt_pk_bf16_f32 v210, v116, v117
    v_cvt_pk_bf16_f32 v211, v118, v119
    v_exp_f32 v120, v120
    s_waitcnt lgkmcnt(12)
    v_mfma_f32_32x32x16_bf16 v[176:191], a[168:171], v[208:211], v[176:191]
    v_exp_f32 v121, v121
    v_exp_f32 v122, v122
    v_exp_f32 v123, v123
    v_exp_f32 v124, v124
    v_exp_f32 v125, v125
    v_exp_f32 v126, v126
    v_exp_f32 v127, v127
    v_cvt_pk_bf16_f32 v212, v120, v121
    v_cvt_pk_bf16_f32 v213, v122, v123
    v_cvt_pk_bf16_f32 v214, v124, v125
    v_cvt_pk_bf16_f32 v215, v126, v127
    v_mfma_f32_32x32x16_bf16 v[112:127], a[32:35], a[112:115], 0
    v_exp_f32 v128, v128
    v_exp_f32 v129, v129
    v_exp_f32 v130, v130
    v_mfma_f32_32x32x16_bf16 v[176:191], a[172:175], v[212:215], v[176:191]
    v_exp_f32 v131, v131
    v_exp_f32 v132, v132
    v_exp_f32 v133, v133
    v_mfma_f32_32x32x16_bf16 v[112:127], a[96:99], a[120:123], v[112:127]
    v_exp_f32 v134, v134
    v_exp_f32 v135, v135
    v_exp_f32 v136, v136
    v_exp_f32 v137, v137
    v_exp_f32 v138, v138
    v_exp_f32 v139, v139
    v_exp_f32 v140, v140
    v_exp_f32 v141, v141
    v_exp_f32 v142, v142
    v_exp_f32 v143, v143
    v_cvt_pk_bf16_f32 v216, v128, v129
    v_cvt_pk_bf16_f32 v217, v130, v131
    v_cvt_pk_bf16_f32 v218, v132, v133
    v_cvt_pk_bf16_f32 v219, v134, v135
    v_cvt_pk_bf16_f32 v220, v136, v137
    v_cvt_pk_bf16_f32 v221, v138, v139
    s_waitcnt lgkmcnt(14)
    v_mfma_f32_32x32x16_bf16 v[176:191], a[176:179], v[216:219], v[176:191]
    v_cvt_pk_bf16_f32 v222, v140, v141
    v_cvt_pk_bf16_f32 v223, v142, v143
    s_nop 1
    v_mfma_f32_32x32x16_bf16 v[176:191], a[180:183], v[220:223], v[176:191]
    s_waitcnt vmcnt(14)
    v_mfma_f32_32x32x16_bf16 v[144:159], a[28:31], a[116:119], 0
    ds_read_b128 a[116:119], v1 offset:5120
    s_waitcnt vmcnt(12)
    v_mfma_f32_32x32x16_bf16 v[160:175], a[24:27], a[112:115], 0
    v_mfma_f32_32x32x16_bf16 v[144:159], a[92:95], a[124:127], v[144:159]
    ds_read_b32 a124, v10 offset:5200
    v_mfma_f32_32x32x16_bf16 v[160:175], a[88:91], a[120:123], v[160:175]
    s_nop 9
    v_cndmask_b32 v144, v13, v144, s[40:41]
    v_mfma_f32_32x32x16_bf16 v[128:143], a[28:31], a[112:115], 0
    ds_read_b128 a[112:115], v1 offset:4096
    v_cndmask_b32 v145, v13, v145, s[42:43]
    v_cndmask_b32 v146, v13, v146, s[44:45]
    v_cndmask_b32 v147, v13, v147, s[46:47]
    v_max3_f32 v242, v144, v145, v242
    v_mfma_f32_32x32x16_bf16 v[128:143], a[92:95], a[120:123], v[128:143]
    ds_read_b32 a120, v10 offset:4160
    v_cndmask_b32 v148, v13, v148, s[48:49]
    v_cndmask_b32 v149, v13, v149, s[50:51]
    v_max3_f32 v242, v146, v147, v242
    v_cndmask_b32 v16, v16, v160, s[40:41]
    v_cndmask_b32 v17, v17, v161, s[42:43]
    v_cndmask_b32 v18, v18, v162, s[44:45]
    v_cndmask_b32 v19, v19, v163, s[46:47]
    v_cndmask_b32 v150, v13, v150, s[52:53]
    v_cndmask_b32 v151, v13, v151, s[54:55]
    v_max3_f32 v242, v148, v149, v242
    v_cndmask_b32 v20, v20, v164, s[48:49]
    v_cndmask_b32 v21, v21, v165, s[50:51]
    v_cndmask_b32 v22, v22, v166, s[52:53]
    v_cndmask_b32 v23, v23, v167, s[54:55]
    v_max_f32 v240, v16, v17
    v_max_f32 v241, v18, v19
    v_cndmask_b32 v152, v13, v152, s[56:57]
    v_cndmask_b32 v153, v13, v153, s[58:59]
    v_max3_f32 v242, v150, v151, v242
    v_cndmask_b32 v24, v24, v168, s[56:57]
    v_cndmask_b32 v25, v25, v169, s[58:59]
    v_cndmask_b32 v26, v26, v170, s[60:61]
    v_cndmask_b32 v27, v27, v171, s[62:63]
    v_max3_f32 v240, v20, v21, v240
    v_max3_f32 v241, v22, v23, v241
    v_cndmask_b32 v154, v13, v154, s[60:61]
    v_cndmask_b32 v155, v13, v155, s[62:63]
    v_max3_f32 v242, v152, v153, v242
    v_cndmask_b32 v28, v28, v172, s[64:65]
    v_cndmask_b32 v29, v29, v173, s[66:67]
    v_cndmask_b32 v30, v30, v174, s[68:69]
    v_cndmask_b32 v31, v31, v175, s[70:71]
    s_waitcnt lgkmcnt(2)
    v_mfma_f32_32x32x16_bf16 v[160:175], a[4:7], a[116:119], 0
    v_max3_f32 v240, v24, v25, v240
    v_max3_f32 v241, v26, v27, v241
    v_cndmask_b32 v156, v13, v156, s[64:65]
    v_cndmask_b32 v157, v13, v157, s[66:67]
    v_max3_f32 v242, v154, v155, v242
    v_max3_f32 v240, v28, v29, v240
    v_mfma_f32_32x32x16_bf16 v[160:175], a[68:71], a[124:127], v[160:175]
    v_max3_f32 v241, v30, v31, v241
    v_cndmask_b32 v158, v13, v158, s[68:69]
    v_cndmask_b32 v159, v13, v159, s[70:71]
    v_max3_f32 v242, v156, v157, v242
    v_max3_f32 v240, v32, v33, v240
    v_max3_f32 v241, v34, v35, v241
    v_max3_f32 v242, v158, v159, v242
    v_max3_f32 v240, v36, v37, v240
    v_max3_f32 v241, v38, v39, v241
    v_mov_b32 v243, v242
    v_max3_f32 v240, v40, v41, v240
    v_max3_f32 v241, v42, v43, v241
    v_permlane32_swap_b32 v242, v243
    v_max3_f32 v240, v44, v45, v240
    v_max3_f32 v241, v46, v47, v241
    v_max_f32 v242, v242, v243
    v_max3_f32 v240, v48, v49, v240
    v_max3_f32 v241, v50, v51, v241
    v_cvt_pk_bf16_f32 v244, v242, v242
    v_max3_f32 v240, v52, v53, v240
    v_max3_f32 v241, v54, v55, v241
    v_and_b32 v244, 0xffff0000, v244
    v_max3_f32 v240, v56, v57, v240
    v_max3_f32 v241, v58, v59, v241
    v_sub_f32 v243, v244, v242
    v_max3_f32 v240, v60, v61, v240
    v_max3_f32 v241, v62, v63, v241
    v_cvt_pk_bf16_f32 v224, -v244, v243
    v_max3_f32 v240, v64, v65, v240
    v_max3_f32 v241, v66, v67, v241
    v_mfma_f32_32x32x16_bf16 v[144:159], v[228:231], v[224:227], v[144:159]
    v_max3_f32 v240, v68, v69, v240
    v_max3_f32 v241, v70, v71, v241
    v_max3_f32 v240, v72, v73, v240
    v_max3_f32 v241, v74, v75, v241
    v_max3_f32 v240, v76, v77, v240
    v_max3_f32 v241, v78, v79, v241
    v_max3_f32 v240, v80, v81, v240
    v_max3_f32 v241, v82, v83, v241
    v_max3_f32 v240, v84, v85, v240
    v_max3_f32 v241, v86, v87, v241
    v_max3_f32 v240, v88, v89, v240
    v_max3_f32 v241, v90, v91, v241
    v_max3_f32 v240, v92, v93, v240
    v_max3_f32 v241, v94, v95, v241
    v_max3_f32 v240, v96, v97, v240
    v_max3_f32 v241, v98, v99, v241
    v_max3_f32 v240, v100, v101, v240
    v_max3_f32 v241, v102, v103, v241
    v_max3_f32 v240, v104, v105, v240
    v_max3_f32 v241, v106, v107, v241
    v_max3_f32 v240, v108, v109, v240
    v_max3_f32 v241, v110, v111, v241
    v_max3_f32 v240, v112, v113, v240
    v_max3_f32 v241, v114, v115, v241
    v_max3_f32 v240, v116, v117, v240
    v_max3_f32 v241, v118, v119, v241
    v_max3_f32 v240, v120, v121, v240
    v_max3_f32 v241, v122, v123, v241
    v_lshlrev_b32 v243, 16, v224
    v_and_b32 v246, 0xffff0000, v224
    v_max3_f32 v240, v124, v125, v240
    v_max3_f32 v241, v126, v127, v241
    v_add_f32 v246, v246, v243
    v_max3_f32 v240, v128, v129, v240
    v_max3_f32 v241, v130, v131, v241
    v_sub_f32 v246, v246, v247
    v_max3_f32 v240, v132, v133, v240
    v_max3_f32 v241, v134, v135, v241
    v_exp_f32 v246, v246
    v_exp_f32 v144, v144
    v_exp_f32 v145, v145
    v_exp_f32 v146, v146
    v_exp_f32 v147, v147
    v_exp_f32 v148, v148
    v_exp_f32 v149, v149
    v_exp_f32 v150, v150
    v_exp_f32 v151, v151
    v_max3_f32 v240, v136, v137, v240
    v_max3_f32 v241, v138, v139, v241
    v_max3_f32 v240, v140, v141, v240
    v_max3_f32 v241, v142, v143, v241
    v_max_f32 v240, v240, v241
    v_mul_f32 v176, v176, v246
    v_mul_f32 v177, v177, v246
    v_mul_f32 v178, v178, v246
    v_mul_f32 v179, v179, v246
    v_mul_f32 v180, v180, v246
    v_mul_f32 v181, v181, v246
    v_mul_f32 v182, v182, v246
    v_mul_f32 v183, v183, v246
    v_mul_f32 v184, v184, v246
    v_mul_f32 v185, v185, v246
    v_mul_f32 v186, v186, v246
    v_cvt_pk_bf16_f32 v192, v144, v145
    v_cvt_pk_bf16_f32 v193, v146, v147
    v_cvt_pk_bf16_f32 v194, v148, v149
    v_cvt_pk_bf16_f32 v195, v150, v151
    v_mov_b32 v241, v240
    s_nop 1
    v_permlane32_swap_b32 v240, v241
    s_waitcnt vmcnt(10)
    v_mfma_f32_32x32x16_bf16 v[176:191], a[216:219], v[192:195], v[176:191]
    v_max_f32 v240, v240, v241
    v_cvt_pk_bf16_f32 v244, v240, v240
    v_and_b32 v244, 0xffff0000, v244
    v_exp_f32 v152, v152
    v_exp_f32 v153, v153
    v_exp_f32 v154, v154
    v_exp_f32 v155, v155
    v_exp_f32 v156, v156
    v_exp_f32 v157, v157
    v_exp_f32 v158, v158
    v_exp_f32 v159, v159
    v_sub_f32 v241, v244, v240
    v_cvt_pk_bf16_f32 v224, -v244, v241
    v_cvt_pk_bf16_f32 v196, v152, v153
    v_cvt_pk_bf16_f32 v197, v154, v155
    v_mfma_f32_32x32x16_bf16 v[16:31], v[228:231], v[224:227], v[16:31]
    v_cvt_pk_bf16_f32 v198, v156, v157
    v_cvt_pk_bf16_f32 v199, v158, v159
    s_nop 1
    v_mfma_f32_32x32x16_bf16 v[176:191], a[220:223], v[196:199], v[176:191]
    s_nop 6
    v_exp_f32 v16, v16
    v_mfma_f32_32x32x16_bf16 v[32:47], v[228:231], v[224:227], v[32:47]
    v_exp_f32 v17, v17
    v_exp_f32 v18, v18
    v_exp_f32 v19, v19
    v_mfma_f32_32x32x16_bf16 v[48:63], v[228:231], v[224:227], v[48:63]
    v_exp_f32 v20, v20
    v_exp_f32 v21, v21
    v_exp_f32 v22, v22
    v_mfma_f32_32x32x16_bf16 v[64:79], v[228:231], v[224:227], v[64:79]
    v_exp_f32 v23, v23
    v_rcp_f32 v246, v186
    v_cvt_pk_bf16_f32 v200, v16, v17
    v_cvt_pk_bf16_f32 v201, v18, v19
    v_mfma_f32_32x32x16_bf16 v[80:95], v[228:231], v[224:227], v[80:95]
    v_cvt_pk_bf16_f32 v202, v20, v21
    v_cvt_pk_bf16_f32 v203, v22, v23
    v_and_b32 v208, v200, v232
    v_and_b32 v209, v201, v233
    v_and_b32 v210, v202, v234
    v_and_b32 v211, v203, v235
    s_waitcnt vmcnt(6)
    v_mfma_f32_32x32x16_bf16 v[144:159], a[20:23], a[116:119], 0
    v_mul_f32 v176, v176, v246
    v_mul_f32 v177, v177, v246
    v_mul_f32 v178, v178, v246
    v_mul_f32 v179, v179, v246
    v_mul_f32 v180, v180, v246
    v_mul_f32 v181, v181, v246
    v_mfma_f32_32x32x16_bf16 v[96:111], v[228:231], v[224:227], v[96:111]
    v_mul_f32 v182, v182, v246
    v_mul_f32 v183, v183, v246
    v_mul_f32 v184, v184, v246
    v_mul_f32 v185, v185, v246
    v_cvt_pk_bf16_f32 v248, v176, v177
    v_cvt_pk_bf16_f32 v249, v178, v179
    v_mfma_f32_32x32x16_bf16 v[144:159], a[84:87], a[124:127], v[144:159]
    v_cvt_pk_bf16_f32 v250, v180, v181
    v_cvt_pk_bf16_f32 v251, v182, v183
    v_cvt_pk_bf16_f32 v252, v184, v185
    v_exp_f32 v24, v24
    v_exp_f32 v25, v25
    s_waitcnt vmcnt(8)
    v_mfma_f32_32x32x16_bf16 v[176:191], a[208:211], v[208:211], 0
    buffer_store_dwordx4 v[248:251], v4, s[24:27], s16 offen sc0 sc1
    buffer_store_dword v252, v7, s[24:27], s17 offen sc0 sc1
    buffer_load_dwordx4 a[12:15], v4, s[24:27], s18 offen offset:3072
    buffer_load_dword a76, v5, s[24:27], s19 offen offset:3072
    s_mov_b64 exec, s[78:79]
    buffer_load_dwordx4 a[184:187], v6, s[24:27], s20 offen
    buffer_load_dwordx4 a[188:191], v6, s[24:27], s21 offen
    s_mov_b64 exec, -1
    s_nop 0
    v_mfma_f32_32x32x16_bf16 v[112:127], v[228:231], v[224:227], v[112:127]
    s_add_u32 s16, s73, 0
    s_add_u32 s17, s75, 0
    s_add_u32 s18, s76, 73728
    s_add_u32 s19, s76, 92160
    s_add_u32 s20, s77, 479232
    s_add_u32 s21, s7, 479232
    v_mfma_f32_32x32x16_bf16 v[128:143], v[228:231], v[224:227], v[128:143]
    v_exp_f32 v26, v26
    v_exp_f32 v27, v27
    v_exp_f32 v28, v28
    v_exp_f32 v29, v29
    v_exp_f32 v30, v30
    v_exp_f32 v31, v31
    v_cvt_pk_bf16_f32 v204, v24, v25
    v_cvt_pk_bf16_f32 v205, v26, v27
    v_cvt_pk_bf16_f32 v206, v28, v29
    v_cvt_pk_bf16_f32 v207, v30, v31
    v_mfma_f32_32x32x16_bf16 v[16:31], a[0:3], a[116:119], 0
    v_and_b32 v212, v204, v236
    v_and_b32 v213, v205, v237
    v_and_b32 v214, v206, v238
    v_and_b32 v215, v207, v239
    v_xor_b32 v200, v200, v208
    v_xor_b32 v201, v201, v209
    v_mfma_f32_32x32x16_bf16 v[176:191], a[212:215], v[212:215], v[176:191]
    v_xor_b32 v202, v202, v210
    v_xor_b32 v203, v203, v211
    v_xor_b32 v204, v204, v212
    v_xor_b32 v205, v205, v213
    v_xor_b32 v206, v206, v214
    v_xor_b32 v207, v207, v215
    v_mfma_f32_32x32x16_bf16 v[176:191], a[176:179], v[200:203], v[176:191]
    v_exp_f32 v32, v32
    v_exp_f32 v33, v33
    v_exp_f32 v34, v34
    v_mfma_f32_32x32x16_bf16 v[176:191], a[180:183], v[204:207], v[176:191]
    v_exp_f32 v35, v35
    v_exp_f32 v36, v36
    v_exp_f32 v37, v37
    v_mfma_f32_32x32x16_bf16 v[16:31], a[64:67], a[124:127], v[16:31]
    v_exp_f32 v38, v38
    v_exp_f32 v39, v39
    v_cvt_pk_bf16_f32 v216, v32, v33
    v_cvt_pk_bf16_f32 v217, v34, v35
    v_cvt_pk_bf16_f32 v218, v36, v37
    v_cvt_pk_bf16_f32 v219, v38, v39
    v_exp_f32 v40, v40
    s_nop 0
    v_mfma_f32_32x32x16_bf16 v[176:191], a[168:171], v[216:219], v[176:191]
    v_exp_f32 v41, v41
    v_exp_f32 v42, v42
    v_exp_f32 v43, v43
    v_exp_f32 v44, v44
    v_exp_f32 v45, v45
    v_exp_f32 v46, v46
    v_exp_f32 v47, v47
    v_cvt_pk_bf16_f32 v220, v40, v41
    v_cvt_pk_bf16_f32 v221, v42, v43
    v_cvt_pk_bf16_f32 v222, v44, v45
    v_cvt_pk_bf16_f32 v223, v46, v47
    v_mfma_f32_32x32x16_bf16 v[32:47], a[44:47], a[116:119], 0
    v_exp_f32 v48, v48
    v_exp_f32 v49, v49
    v_exp_f32 v50, v50
    v_mfma_f32_32x32x16_bf16 v[176:191], a[172:175], v[220:223], v[176:191]
    v_exp_f32 v51, v51
    v_exp_f32 v52, v52
    v_exp_f32 v53, v53
    v_mfma_f32_32x32x16_bf16 v[32:47], a[108:111], a[124:127], v[32:47]
    v_exp_f32 v54, v54
    v_exp_f32 v55, v55
    v_cvt_pk_bf16_f32 v192, v48, v49
    v_cvt_pk_bf16_f32 v193, v50, v51
    v_cvt_pk_bf16_f32 v194, v52, v53
    v_cvt_pk_bf16_f32 v195, v54, v55
    v_exp_f32 v56, v56
    s_nop 0
    v_mfma_f32_32x32x16_bf16 v[176:191], a[160:163], v[192:195], v[176:191]
    v_exp_f32 v57, v57
    v_exp_f32 v58, v58
    v_exp_f32 v59, v59
    v_exp_f32 v60, v60
    v_exp_f32 v61, v61
    v_exp_f32 v62, v62
    v_exp_f32 v63, v63
    v_cvt_pk_bf16_f32 v196, v56, v57
    v_cvt_pk_bf16_f32 v197, v58, v59
    v_cvt_pk_bf16_f32 v198, v60, v61
    v_cvt_pk_bf16_f32 v199, v62, v63
    v_mfma_f32_32x32x16_bf16 v[48:63], a[40:43], a[116:119], 0
    v_exp_f32 v64, v64
    v_exp_f32 v65, v65
    v_exp_f32 v66, v66
    v_mfma_f32_32x32x16_bf16 v[176:191], a[164:167], v[196:199], v[176:191]
    v_exp_f32 v67, v67
    v_exp_f32 v68, v68
    v_exp_f32 v69, v69
    v_mfma_f32_32x32x16_bf16 v[48:63], a[104:107], a[124:127], v[48:63]
    v_exp_f32 v70, v70
    v_exp_f32 v71, v71
    v_cvt_pk_bf16_f32 v208, v64, v65
    v_cvt_pk_bf16_f32 v209, v66, v67
    v_cvt_pk_bf16_f32 v210, v68, v69
    v_cvt_pk_bf16_f32 v211, v70, v71
    v_exp_f32 v72, v72
    s_nop 0
    v_mfma_f32_32x32x16_bf16 v[176:191], a[248:251], v[208:211], v[176:191]
    v_exp_f32 v73, v73
    v_exp_f32 v74, v74
    v_exp_f32 v75, v75
    v_exp_f32 v76, v76
    v_exp_f32 v77, v77
    v_exp_f32 v78, v78
    v_exp_f32 v79, v79
    v_cvt_pk_bf16_f32 v212, v72, v73
    v_cvt_pk_bf16_f32 v213, v74, v75
    v_cvt_pk_bf16_f32 v214, v76, v77
    v_cvt_pk_bf16_f32 v215, v78, v79
    v_mfma_f32_32x32x16_bf16 v[64:79], a[36:39], a[116:119], 0
    v_exp_f32 v80, v80
    v_exp_f32 v81, v81
    v_exp_f32 v82, v82
    v_mfma_f32_32x32x16_bf16 v[176:191], a[252:255], v[212:215], v[176:191]
    v_exp_f32 v83, v83
    v_exp_f32 v84, v84
    v_exp_f32 v85, v85
    v_mfma_f32_32x32x16_bf16 v[64:79], a[100:103], a[124:127], v[64:79]
    v_exp_f32 v86, v86
    v_exp_f32 v87, v87
    v_cvt_pk_bf16_f32 v200, v80, v81
    v_cvt_pk_bf16_f32 v201, v82, v83
    v_cvt_pk_bf16_f32 v202, v84, v85
    v_cvt_pk_bf16_f32 v203, v86, v87
    v_exp_f32 v88, v88
    s_nop 0
    v_mfma_f32_32x32x16_bf16 v[176:191], a[240:243], v[200:203], v[176:191]
    v_exp_f32 v89, v89
    v_exp_f32 v90, v90
    v_exp_f32 v91, v91
    v_exp_f32 v92, v92
    v_exp_f32 v93, v93
    v_exp_f32 v94, v94
    v_exp_f32 v95, v95
    v_cvt_pk_bf16_f32 v204, v88, v89
    v_cvt_pk_bf16_f32 v205, v90, v91
    v_cvt_pk_bf16_f32 v206, v92, v93
    v_cvt_pk_bf16_f32 v207, v94, v95
    v_mfma_f32_32x32x16_bf16 v[80:95], a[32:35], a[116:119], 0
    v_exp_f32 v96, v96
    v_exp_f32 v97, v97
    v_exp_f32 v98, v98
    v_mfma_f32_32x32x16_bf16 v[176:191], a[244:247], v[204:207], v[176:191]
    v_exp_f32 v99, v99
    v_exp_f32 v100, v100
    v_exp_f32 v101, v101
    v_mfma_f32_32x32x16_bf16 v[80:95], a[96:99], a[124:127], v[80:95]
    v_exp_f32 v102, v102
    v_exp_f32 v103, v103
    v_exp_f32 v104, v104
    v_exp_f32 v105, v105
    v_exp_f32 v106, v106
    v_exp_f32 v107, v107
    v_exp_f32 v108, v108
    v_exp_f32 v109, v109
    v_exp_f32 v110, v110
    v_exp_f32 v111, v111
    v_cndmask_b32 v160, v160, v144, s[40:41]
    v_cndmask_b32 v161, v161, v145, s[42:43]
    v_cndmask_b32 v162, v162, v146, s[44:45]
    v_cndmask_b32 v163, v163, v147, s[46:47]
    v_cvt_pk_bf16_f32 v216, v96, v97
    v_cvt_pk_bf16_f32 v217, v98, v99
    v_cvt_pk_bf16_f32 v218, v100, v101
    v_cvt_pk_bf16_f32 v219, v102, v103
    v_cvt_pk_bf16_f32 v220, v104, v105
    v_cvt_pk_bf16_f32 v221, v106, v107
    v_mfma_f32_32x32x16_bf16 v[176:191], a[232:235], v[216:219], v[176:191]
    v_cvt_pk_bf16_f32 v222, v108, v109
    v_cvt_pk_bf16_f32 v223, v110, v111
    v_cndmask_b32 v164, v164, v148, s[48:49]
    v_cndmask_b32 v165, v165, v149, s[50:51]
    v_cndmask_b32 v166, v166, v150, s[52:53]
    v_cndmask_b32 v167, v167, v151, s[54:55]
    v_mfma_f32_32x32x16_bf16 v[96:111], a[28:31], a[116:119], 0
    v_max_f32 v242, v160, v161
    v_max_f32 v243, v162, v163
    v_exp_f32 v112, v112
    v_exp_f32 v113, v113
    v_mfma_f32_32x32x16_bf16 v[96:111], a[92:95], a[124:127], v[96:111]
    v_exp_f32 v114, v114
    v_exp_f32 v115, v115
    v_exp_f32 v116, v116
    v_mfma_f32_32x32x16_bf16 v[176:191], a[236:239], v[220:223], v[176:191]
    v_exp_f32 v117, v117
    v_exp_f32 v118, v118
    v_exp_f32 v119, v119
    v_exp_f32 v120, v120
    v_exp_f32 v121, v121
    v_exp_f32 v122, v122
    v_exp_f32 v123, v123
    v_exp_f32 v124, v124
    v_exp_f32 v125, v125
    v_exp_f32 v126, v126
    v_exp_f32 v127, v127
    v_cndmask_b32 v168, v168, v152, s[56:57]
    v_cndmask_b32 v169, v169, v153, s[58:59]
    v_cndmask_b32 v170, v170, v154, s[60:61]
    v_cndmask_b32 v171, v171, v155, s[62:63]
    v_max3_f32 v242, v164, v165, v242
    v_max3_f32 v243, v166, v167, v243
    v_cndmask_b32 v172, v172, v156, s[64:65]
    v_cndmask_b32 v173, v173, v157, s[66:67]
    v_cndmask_b32 v174, v174, v158, s[68:69]
    v_cndmask_b32 v175, v175, v159, s[70:71]
    s_waitcnt lgkmcnt(0)
    v_mfma_f32_32x32x16_bf16 v[144:159], a[0:3], a[112:115], 0
    v_max3_f32 v242, v168, v169, v242
    v_max3_f32 v243, v170, v171, v243
    v_max3_f32 v242, v172, v173, v242
    v_max3_f32 v243, v174, v175, v243
    v_cvt_pk_bf16_f32 v192, v112, v113
    v_cvt_pk_bf16_f32 v193, v114, v115
    v_mfma_f32_32x32x16_bf16 v[144:159], a[64:67], a[120:123], v[144:159]
    v_cvt_pk_bf16_f32 v194, v116, v117
    v_cvt_pk_bf16_f32 v195, v118, v119
    v_cvt_pk_bf16_f32 v196, v120, v121
    v_cvt_pk_bf16_f32 v197, v122, v123
    v_cvt_pk_bf16_f32 v198, v124, v125
    v_cvt_pk_bf16_f32 v199, v126, v127
    v_mfma_f32_32x32x16_bf16 v[112:127], a[24:27], a[116:119], 0
    ds_read_b128 a[116:119], v1 offset:3072
    v_max3_f32 v242, v16, v17, v242
    v_max3_f32 v243, v18, v19, v243
    v_max3_f32 v242, v20, v21, v242
    v_max3_f32 v243, v22, v23, v243
    v_max3_f32 v242, v24, v25, v242
    v_mfma_f32_32x32x16_bf16 v[112:127], a[88:91], a[124:127], v[112:127]
    ds_read_b32 a124, v10 offset:3120
    v_max3_f32 v243, v26, v27, v243
    v_max3_f32 v242, v28, v29, v242
    v_max3_f32 v243, v30, v31, v243
    v_mfma_f32_32x32x16_bf16 v[176:191], a[224:227], v[192:195], v[176:191]
    v_max3_f32 v242, v32, v33, v242
    v_max3_f32 v243, v34, v35, v243
    v_max3_f32 v242, v36, v37, v242
    v_max3_f32 v243, v38, v39, v243
    v_max3_f32 v242, v40, v41, v242
    v_max3_f32 v243, v42, v43, v243
    v_mfma_f32_32x32x16_bf16 v[176:191], a[228:231], v[196:199], v[176:191]
    v_max3_f32 v242, v44, v45, v242
    v_max3_f32 v243, v46, v47, v243
    v_max3_f32 v242, v48, v49, v242
    v_max3_f32 v243, v50, v51, v243
    v_max3_f32 v242, v52, v53, v242
    v_max3_f32 v243, v54, v55, v243
    v_max3_f32 v242, v56, v57, v242
    v_max3_f32 v243, v58, v59, v243
    v_max3_f32 v242, v60, v61, v242
    v_max3_f32 v243, v62, v63, v243
    v_max3_f32 v242, v64, v65, v242
    v_max3_f32 v243, v66, v67, v243
    v_max3_f32 v242, v68, v69, v242
    v_max3_f32 v243, v70, v71, v243
    v_max3_f32 v242, v72, v73, v242
    v_max3_f32 v243, v74, v75, v243
    v_max3_f32 v242, v76, v77, v242
    v_max3_f32 v243, v78, v79, v243
    v_max3_f32 v242, v80, v81, v242
    v_max3_f32 v243, v82, v83, v243
    v_max3_f32 v242, v84, v85, v242
    v_max3_f32 v243, v86, v87, v243
    v_max3_f32 v242, v88, v89, v242
    v_max3_f32 v243, v90, v91, v243
    v_max3_f32 v242, v92, v93, v242
    v_max3_f32 v243, v94, v95, v243
    v_max3_f32 v242, v96, v97, v242
    v_max3_f32 v243, v98, v99, v243
    v_max3_f32 v242, v100, v101, v242
    v_max3_f32 v243, v102, v103, v243
    v_max3_f32 v242, v104, v105, v242
    v_max3_f32 v243, v106, v107, v243
    v_max3_f32 v242, v108, v109, v242
    v_max3_f32 v243, v110, v111, v243
    v_max3_f32 v242, v112, v113, v242
    v_max3_f32 v243, v114, v115, v243
    v_max3_f32 v242, v116, v117, v242
    v_max3_f32 v243, v118, v119, v243
    v_exp_f32 v128, v128
    v_exp_f32 v129, v129
    v_exp_f32 v130, v130
    v_exp_f32 v131, v131
    v_exp_f32 v132, v132
    v_exp_f32 v133, v133
    v_exp_f32 v134, v134
    v_exp_f32 v135, v135
    v_max3_f32 v242, v120, v121, v242
    v_max3_f32 v243, v122, v123, v243
    v_max3_f32 v242, v124, v125, v242
    v_max3_f32 v243, v126, v127, v243
    v_max_f32 v242, v242, v243
    v_cvt_pk_bf16_f32 v208, v128, v129
    v_cvt_pk_bf16_f32 v209, v130, v131
    v_cvt_pk_bf16_f32 v210, v132, v133
    v_cvt_pk_bf16_f32 v211, v134, v135
    v_mov_b32 v243, v242
    s_nop 1
    v_permlane32_swap_b32 v242, v243
    v_mfma_f32_32x32x16_bf16 v[176:191], a[216:219], v[208:211], v[176:191]
    v_max_f32 v242, v242, v243
    v_cvt_pk_bf16_f32 v244, v242, v242
    v_and_b32 v244, 0xffff0000, v244
    v_exp_f32 v136, v136
    v_exp_f32 v137, v137
    v_exp_f32 v138, v138
    v_exp_f32 v139, v139
    v_exp_f32 v140, v140
    v_exp_f32 v141, v141
    v_exp_f32 v142, v142
    v_exp_f32 v143, v143
    v_sub_f32 v243, v244, v242
    v_cvt_pk_bf16_f32 v224, -v244, v243
    v_cvt_pk_bf16_f32 v212, v136, v137
    v_cvt_pk_bf16_f32 v213, v138, v139
    v_mfma_f32_32x32x16_bf16 v[160:175], v[228:231], v[224:227], v[160:175]
    v_cvt_pk_bf16_f32 v214, v140, v141
    v_cvt_pk_bf16_f32 v215, v142, v143
    s_nop 1
    v_mfma_f32_32x32x16_bf16 v[176:191], a[220:223], v[212:215], v[176:191]
    s_nop 6
    v_exp_f32 v160, v160
    v_mfma_f32_32x32x16_bf16 v[16:31], v[228:231], v[224:227], v[16:31]
    v_exp_f32 v161, v161
    v_exp_f32 v162, v162
    v_exp_f32 v163, v163
    v_mfma_f32_32x32x16_bf16 v[32:47], v[228:231], v[224:227], v[32:47]
    v_exp_f32 v164, v164
    v_exp_f32 v165, v165
    v_exp_f32 v166, v166
    v_mfma_f32_32x32x16_bf16 v[48:63], v[228:231], v[224:227], v[48:63]
    v_exp_f32 v167, v167
    v_rcp_f32 v246, v186
    v_cvt_pk_bf16_f32 v200, v160, v161
    v_cvt_pk_bf16_f32 v201, v162, v163
    v_mfma_f32_32x32x16_bf16 v[64:79], v[228:231], v[224:227], v[64:79]
    v_cvt_pk_bf16_f32 v202, v164, v165
    v_cvt_pk_bf16_f32 v203, v166, v167
    v_and_b32 v216, v200, v232
    v_and_b32 v217, v201, v233
    v_and_b32 v218, v202, v234
    v_and_b32 v219, v203, v235
    s_waitcnt vmcnt(8)
    v_mfma_f32_32x32x16_bf16 v[128:143], a[16:19], a[112:115], 0
    v_mul_f32 v176, v176, v246
    v_mul_f32 v177, v177, v246
    v_mul_f32 v178, v178, v246
    v_mul_f32 v179, v179, v246
    v_mul_f32 v180, v180, v246
    v_mul_f32 v181, v181, v246
    v_mfma_f32_32x32x16_bf16 v[80:95], v[228:231], v[224:227], v[80:95]
    v_mul_f32 v182, v182, v246
    v_mul_f32 v183, v183, v246
    v_mul_f32 v184, v184, v246
    v_mul_f32 v185, v185, v246
    v_cvt_pk_bf16_f32 v248, v176, v177
    v_cvt_pk_bf16_f32 v249, v178, v179
    v_mfma_f32_32x32x16_bf16 v[128:143], a[80:83], a[120:123], v[128:143]
    v_cvt_pk_bf16_f32 v250, v180, v181
    v_cvt_pk_bf16_f32 v251, v182, v183
    v_cvt_pk_bf16_f32 v252, v184, v185
    v_exp_f32 v168, v168
    v_exp_f32 v169, v169
    s_waitcnt vmcnt(10)
    v_mfma_f32_32x32x16_bf16 v[176:191], a[200:203], v[216:219], 0
    buffer_store_dwordx4 v[248:251], v4, s[24:27], s22 offen sc0 sc1
    buffer_store_dword v252, v7, s[24:27], s23 offen sc0 sc1
    buffer_load_dwordx4 a[8:11], v4, s[24:27], s16 offen offset:2048
    buffer_load_dword a72, v5, s[24:27], s17 offen offset:2048
    s_mov_b64 exec, s[78:79]
    buffer_load_dwordx4 a[176:179], v6, s[24:27], s18 offen
    buffer_load_dwordx4 a[180:183], v6, s[24:27], s19 offen
    s_mov_b64 exec, -1
    s_nop 0
    v_mfma_f32_32x32x16_bf16 v[96:111], v[228:231], v[224:227], v[96:111]
    s_add_u32 s22, s73, 0
    s_add_u32 s23, s75, 0
    s_add_u32 s16, s76, 36864
    s_add_u32 s17, s76, 55296
    s_add_u32 s18, s77, 442368
    s_add_u32 s19, s7, 442368
    v_mfma_f32_32x32x16_bf16 v[112:127], v[228:231], v[224:227], v[112:127]
    v_exp_f32 v170, v170
    v_exp_f32 v171, v171
    v_exp_f32 v172, v172
    v_exp_f32 v173, v173
    v_exp_f32 v174, v174
    v_exp_f32 v175, v175
    v_cvt_pk_bf16_f32 v204, v168, v169
    v_cvt_pk_bf16_f32 v205, v170, v171
    v_cvt_pk_bf16_f32 v206, v172, v173
    v_cvt_pk_bf16_f32 v207, v174, v175
    v_mfma_f32_32x32x16_bf16 v[160:175], a[44:47], a[112:115], 0
    v_and_b32 v220, v204, v236
    v_and_b32 v221, v205, v237
    v_and_b32 v222, v206, v238
    v_and_b32 v223, v207, v239
    v_xor_b32 v200, v200, v216
    v_xor_b32 v201, v201, v217
    v_mfma_f32_32x32x16_bf16 v[176:191], a[204:207], v[220:223], v[176:191]
    v_xor_b32 v202, v202, v218
    v_xor_b32 v203, v203, v219
    v_xor_b32 v204, v204, v220
    v_xor_b32 v205, v205, v221
    v_xor_b32 v206, v206, v222
    v_xor_b32 v207, v207, v223
    v_mfma_f32_32x32x16_bf16 v[176:191], a[168:171], v[200:203], v[176:191]
    v_exp_f32 v16, v16
    v_exp_f32 v17, v17
    v_exp_f32 v18, v18
    v_mfma_f32_32x32x16_bf16 v[176:191], a[172:175], v[204:207], v[176:191]
    v_exp_f32 v19, v19
    v_exp_f32 v20, v20
    v_exp_f32 v21, v21
    v_mfma_f32_32x32x16_bf16 v[160:175], a[108:111], a[120:123], v[160:175]
    v_exp_f32 v22, v22
    v_exp_f32 v23, v23
    v_cvt_pk_bf16_f32 v192, v16, v17
    v_cvt_pk_bf16_f32 v193, v18, v19
    v_cvt_pk_bf16_f32 v194, v20, v21
    v_cvt_pk_bf16_f32 v195, v22, v23
    v_exp_f32 v24, v24
    s_nop 0
    v_mfma_f32_32x32x16_bf16 v[176:191], a[160:163], v[192:195], v[176:191]
    v_exp_f32 v25, v25
    v_exp_f32 v26, v26
    v_exp_f32 v27, v27
    v_exp_f32 v28, v28
    v_exp_f32 v29, v29
    v_exp_f32 v30, v30
    v_exp_f32 v31, v31
    v_cvt_pk_bf16_f32 v196, v24, v25
    v_cvt_pk_bf16_f32 v197, v26, v27
    v_cvt_pk_bf16_f32 v198, v28, v29
    v_cvt_pk_bf16_f32 v199, v30, v31
    v_mfma_f32_32x32x16_bf16 v[16:31], a[40:43], a[112:115], 0
    v_exp_f32 v32, v32
    v_exp_f32 v33, v33
    v_exp_f32 v34, v34
    v_mfma_f32_32x32x16_bf16 v[176:191], a[164:167], v[196:199], v[176:191]
    v_exp_f32 v35, v35
    v_exp_f32 v36, v36
    v_exp_f32 v37, v37
    v_mfma_f32_32x32x16_bf16 v[16:31], a[104:107], a[120:123], v[16:31]
    v_exp_f32 v38, v38
    v_exp_f32 v39, v39
    v_cvt_pk_bf16_f32 v208, v32, v33
    v_cvt_pk_bf16_f32 v209, v34, v35
    v_cvt_pk_bf16_f32 v210, v36, v37
    v_cvt_pk_bf16_f32 v211, v38, v39
    v_exp_f32 v40, v40
    s_nop 0
    v_mfma_f32_32x32x16_bf16 v[176:191], a[248:251], v[208:211], v[176:191]
    v_exp_f32 v41, v41
    v_exp_f32 v42, v42
    v_exp_f32 v43, v43
    v_exp_f32 v44, v44
    v_exp_f32 v45, v45
    v_exp_f32 v46, v46
    v_exp_f32 v47, v47
    v_cvt_pk_bf16_f32 v212, v40, v41
    v_cvt_pk_bf16_f32 v213, v42, v43
    v_cvt_pk_bf16_f32 v214, v44, v45
    v_cvt_pk_bf16_f32 v215, v46, v47
    v_mfma_f32_32x32x16_bf16 v[32:47], a[36:39], a[112:115], 0
    v_exp_f32 v48, v48
    v_exp_f32 v49, v49
    v_exp_f32 v50, v50
    v_mfma_f32_32x32x16_bf16 v[176:191], a[252:255], v[212:215], v[176:191]
    v_exp_f32 v51, v51
    v_exp_f32 v52, v52
    v_exp_f32 v53, v53
    v_mfma_f32_32x32x16_bf16 v[32:47], a[100:103], a[120:123], v[32:47]
    v_exp_f32 v54, v54
    v_exp_f32 v55, v55
    v_cvt_pk_bf16_f32 v216, v48, v49
    v_cvt_pk_bf16_f32 v217, v50, v51
    v_cvt_pk_bf16_f32 v218, v52, v53
    v_cvt_pk_bf16_f32 v219, v54, v55
    v_exp_f32 v56, v56
    s_nop 0
    v_mfma_f32_32x32x16_bf16 v[176:191], a[240:243], v[216:219], v[176:191]
    v_exp_f32 v57, v57
    v_exp_f32 v58, v58
    v_exp_f32 v59, v59
    v_exp_f32 v60, v60
    v_exp_f32 v61, v61
    v_exp_f32 v62, v62
    v_exp_f32 v63, v63
    v_cvt_pk_bf16_f32 v220, v56, v57
    v_cvt_pk_bf16_f32 v221, v58, v59
    v_cvt_pk_bf16_f32 v222, v60, v61
    v_cvt_pk_bf16_f32 v223, v62, v63
    v_mfma_f32_32x32x16_bf16 v[48:63], a[32:35], a[112:115], 0
    v_exp_f32 v64, v64
    v_exp_f32 v65, v65
    v_exp_f32 v66, v66
    v_mfma_f32_32x32x16_bf16 v[176:191], a[244:247], v[220:223], v[176:191]
    v_exp_f32 v67, v67
    v_exp_f32 v68, v68
    v_exp_f32 v69, v69
    v_mfma_f32_32x32x16_bf16 v[48:63], a[96:99], a[120:123], v[48:63]
    v_exp_f32 v70, v70
    v_exp_f32 v71, v71
    v_cvt_pk_bf16_f32 v200, v64, v65
    v_cvt_pk_bf16_f32 v201, v66, v67
    v_cvt_pk_bf16_f32 v202, v68, v69
    v_cvt_pk_bf16_f32 v203, v70, v71
    v_exp_f32 v72, v72
    s_nop 0
    v_mfma_f32_32x32x16_bf16 v[176:191], a[232:235], v[200:203], v[176:191]
    v_exp_f32 v73, v73
    v_exp_f32 v74, v74
    v_exp_f32 v75, v75
    v_exp_f32 v76, v76
    v_exp_f32 v77, v77
    v_exp_f32 v78, v78
    v_exp_f32 v79, v79
    v_cvt_pk_bf16_f32 v204, v72, v73
    v_cvt_pk_bf16_f32 v205, v74, v75
    v_cvt_pk_bf16_f32 v206, v76, v77
    v_cvt_pk_bf16_f32 v207, v78, v79
    v_mfma_f32_32x32x16_bf16 v[64:79], a[28:31], a[112:115], 0
    v_exp_f32 v80, v80
    v_exp_f32 v81, v81
    v_exp_f32 v82, v82
    v_mfma_f32_32x32x16_bf16 v[176:191], a[236:239], v[204:207], v[176:191]
    v_exp_f32 v83, v83
    v_exp_f32 v84, v84
    v_exp_f32 v85, v85
    v_mfma_f32_32x32x16_bf16 v[64:79], a[92:95], a[120:123], v[64:79]
    v_exp_f32 v86, v86
    v_exp_f32 v87, v87
    v_exp_f32 v88, v88
    v_exp_f32 v89, v89
    v_exp_f32 v90, v90
    v_exp_f32 v91, v91
    v_exp_f32 v92, v92
    v_exp_f32 v93, v93
    v_exp_f32 v94, v94
    v_exp_f32 v95, v95
    v_cndmask_b32 v144, v144, v128, s[40:41]
    v_cndmask_b32 v145, v145, v129, s[42:43]
    v_cndmask_b32 v146, v146, v130, s[44:45]
    v_cndmask_b32 v147, v147, v131, s[46:47]
    v_cvt_pk_bf16_f32 v192, v80, v81
    v_cvt_pk_bf16_f32 v193, v82, v83
    v_cvt_pk_bf16_f32 v194, v84, v85
    v_cvt_pk_bf16_f32 v195, v86, v87
    v_cvt_pk_bf16_f32 v196, v88, v89
    v_cvt_pk_bf16_f32 v197, v90, v91
    v_mfma_f32_32x32x16_bf16 v[176:191], a[224:227], v[192:195], v[176:191]
    v_cvt_pk_bf16_f32 v198, v92, v93
    v_cvt_pk_bf16_f32 v199, v94, v95
    v_cndmask_b32 v148, v148, v132, s[48:49]
    v_cndmask_b32 v149, v149, v133, s[50:51]
    v_cndmask_b32 v150, v150, v134, s[52:53]
    v_cndmask_b32 v151, v151, v135, s[54:55]
    v_mfma_f32_32x32x16_bf16 v[80:95], a[24:27], a[112:115], 0
    v_max_f32 v240, v144, v145
    v_max_f32 v241, v146, v147
    v_exp_f32 v96, v96
    v_exp_f32 v97, v97
    v_mfma_f32_32x32x16_bf16 v[80:95], a[88:91], a[120:123], v[80:95]
    v_exp_f32 v98, v98
    v_exp_f32 v99, v99
    v_exp_f32 v100, v100
    v_mfma_f32_32x32x16_bf16 v[176:191], a[228:231], v[196:199], v[176:191]
    v_exp_f32 v101, v101
    v_exp_f32 v102, v102
    v_exp_f32 v103, v103
    v_exp_f32 v104, v104
    v_exp_f32 v105, v105
    v_exp_f32 v106, v106
    v_exp_f32 v107, v107
    v_exp_f32 v108, v108
    v_exp_f32 v109, v109
    v_exp_f32 v110, v110
    v_exp_f32 v111, v111
    v_cndmask_b32 v152, v152, v136, s[56:57]
    v_cndmask_b32 v153, v153, v137, s[58:59]
    v_cndmask_b32 v154, v154, v138, s[60:61]
    v_cndmask_b32 v155, v155, v139, s[62:63]
    v_max3_f32 v240, v148, v149, v240
    v_max3_f32 v241, v150, v151, v241
    v_cndmask_b32 v156, v156, v140, s[64:65]
    v_cndmask_b32 v157, v157, v141, s[66:67]
    v_cndmask_b32 v158, v158, v142, s[68:69]
    v_cndmask_b32 v159, v159, v143, s[70:71]
    s_waitcnt lgkmcnt(0)
    v_mfma_f32_32x32x16_bf16 v[128:143], a[44:47], a[116:119], 0
    v_max3_f32 v240, v152, v153, v240
    v_max3_f32 v241, v154, v155, v241
    v_max3_f32 v240, v156, v157, v240
    v_max3_f32 v241, v158, v159, v241
    v_cvt_pk_bf16_f32 v208, v96, v97
    v_cvt_pk_bf16_f32 v209, v98, v99
    v_mfma_f32_32x32x16_bf16 v[128:143], a[108:111], a[124:127], v[128:143]
    v_cvt_pk_bf16_f32 v210, v100, v101
    v_cvt_pk_bf16_f32 v211, v102, v103
    v_cvt_pk_bf16_f32 v212, v104, v105
    v_cvt_pk_bf16_f32 v213, v106, v107
    v_cvt_pk_bf16_f32 v214, v108, v109
    v_cvt_pk_bf16_f32 v215, v110, v111
    v_mfma_f32_32x32x16_bf16 v[96:111], a[20:23], a[112:115], 0
    ds_read_b128 a[112:115], v1 offset:2048
    v_max3_f32 v240, v160, v161, v240
    v_max3_f32 v241, v162, v163, v241
    v_max3_f32 v240, v164, v165, v240
    v_max3_f32 v241, v166, v167, v241
    v_max3_f32 v240, v168, v169, v240
    v_mfma_f32_32x32x16_bf16 v[96:111], a[84:87], a[120:123], v[96:111]
    ds_read_b32 a120, v10 offset:2080
    v_max3_f32 v241, v170, v171, v241
    v_max3_f32 v240, v172, v173, v240
    v_max3_f32 v241, v174, v175, v241
    v_mfma_f32_32x32x16_bf16 v[176:191], a[216:219], v[208:211], v[176:191]
    v_max3_f32 v240, v16, v17, v240
    v_max3_f32 v241, v18, v19, v241
    v_max3_f32 v240, v20, v21, v240
    v_max3_f32 v241, v22, v23, v241
    v_max3_f32 v240, v24, v25, v240
    v_max3_f32 v241, v26, v27, v241
    v_mfma_f32_32x32x16_bf16 v[176:191], a[220:223], v[212:215], v[176:191]
    v_max3_f32 v240, v28, v29, v240
    v_max3_f32 v241, v30, v31, v241
    v_max3_f32 v240, v32, v33, v240
    v_max3_f32 v241, v34, v35, v241
    v_max3_f32 v240, v36, v37, v240
    v_max3_f32 v241, v38, v39, v241
    v_max3_f32 v240, v40, v41, v240
    v_max3_f32 v241, v42, v43, v241
    v_max3_f32 v240, v44, v45, v240
    v_max3_f32 v241, v46, v47, v241
    v_max3_f32 v240, v48, v49, v240
    v_max3_f32 v241, v50, v51, v241
    v_max3_f32 v240, v52, v53, v240
    v_max3_f32 v241, v54, v55, v241
    v_max3_f32 v240, v56, v57, v240
    v_max3_f32 v241, v58, v59, v241
    v_max3_f32 v240, v60, v61, v240
    v_max3_f32 v241, v62, v63, v241
    v_max3_f32 v240, v64, v65, v240
    v_max3_f32 v241, v66, v67, v241
    v_max3_f32 v240, v68, v69, v240
    v_max3_f32 v241, v70, v71, v241
    v_max3_f32 v240, v72, v73, v240
    v_max3_f32 v241, v74, v75, v241
    v_max3_f32 v240, v76, v77, v240
    v_max3_f32 v241, v78, v79, v241
    v_max3_f32 v240, v80, v81, v240
    v_max3_f32 v241, v82, v83, v241
    v_max3_f32 v240, v84, v85, v240
    v_max3_f32 v241, v86, v87, v241
    v_max3_f32 v240, v88, v89, v240
    v_max3_f32 v241, v90, v91, v241
    v_max3_f32 v240, v92, v93, v240
    v_max3_f32 v241, v94, v95, v241
    v_max3_f32 v240, v96, v97, v240
    v_max3_f32 v241, v98, v99, v241
    v_max3_f32 v240, v100, v101, v240
    v_max3_f32 v241, v102, v103, v241
    v_exp_f32 v112, v112
    v_exp_f32 v113, v113
    v_exp_f32 v114, v114
    v_exp_f32 v115, v115
    v_exp_f32 v116, v116
    v_exp_f32 v117, v117
    v_exp_f32 v118, v118
    v_exp_f32 v119, v119
    v_max3_f32 v240, v104, v105, v240
    v_max3_f32 v241, v106, v107, v241
    v_max3_f32 v240, v108, v109, v240
    v_max3_f32 v241, v110, v111, v241
    v_max_f32 v240, v240, v241
    v_cvt_pk_bf16_f32 v216, v112, v113
    v_cvt_pk_bf16_f32 v217, v114, v115
    v_cvt_pk_bf16_f32 v218, v116, v117
    v_cvt_pk_bf16_f32 v219, v118, v119
    v_mov_b32 v241, v240
    s_nop 1
    v_permlane32_swap_b32 v240, v241
    v_mfma_f32_32x32x16_bf16 v[176:191], a[208:211], v[216:219], v[176:191]
    v_max_f32 v240, v240, v241
    v_cvt_pk_bf16_f32 v244, v240, v240
    v_and_b32 v244, 0xffff0000, v244
    v_exp_f32 v120, v120
    v_exp_f32 v121, v121
    v_exp_f32 v122, v122
    v_exp_f32 v123, v123
    v_exp_f32 v124, v124
    v_exp_f32 v125, v125
    v_exp_f32 v126, v126
    v_exp_f32 v127, v127
    v_sub_f32 v241, v244, v240
    v_cvt_pk_bf16_f32 v224, -v244, v241
    v_cvt_pk_bf16_f32 v220, v120, v121
    v_cvt_pk_bf16_f32 v221, v122, v123
    v_mfma_f32_32x32x16_bf16 v[144:159], v[228:231], v[224:227], v[144:159]
    v_cvt_pk_bf16_f32 v222, v124, v125
    v_cvt_pk_bf16_f32 v223, v126, v127
    s_nop 1
    v_mfma_f32_32x32x16_bf16 v[176:191], a[212:215], v[220:223], v[176:191]
    s_nop 6
    v_exp_f32 v144, v144
    v_mfma_f32_32x32x16_bf16 v[160:175], v[228:231], v[224:227], v[160:175]
    v_exp_f32 v145, v145
    v_exp_f32 v146, v146
    v_exp_f32 v147, v147
    v_mfma_f32_32x32x16_bf16 v[16:31], v[228:231], v[224:227], v[16:31]
    v_exp_f32 v148, v148
    v_exp_f32 v149, v149
    v_exp_f32 v150, v150
    v_mfma_f32_32x32x16_bf16 v[32:47], v[228:231], v[224:227], v[32:47]
    v_exp_f32 v151, v151
    v_rcp_f32 v246, v186
    v_cvt_pk_bf16_f32 v200, v144, v145
    v_cvt_pk_bf16_f32 v201, v146, v147
    v_mfma_f32_32x32x16_bf16 v[48:63], v[228:231], v[224:227], v[48:63]
    v_cvt_pk_bf16_f32 v202, v148, v149
    v_cvt_pk_bf16_f32 v203, v150, v151
    v_and_b32 v192, v200, v232
    v_and_b32 v193, v201, v233
    v_and_b32 v194, v202, v234
    v_and_b32 v195, v203, v235
    s_waitcnt vmcnt(8)
    v_mfma_f32_32x32x16_bf16 v[112:127], a[12:15], a[116:119], 0
    v_mul_f32 v176, v176, v246
    v_mul_f32 v177, v177, v246
    v_mul_f32 v178, v178, v246
    v_mul_f32 v179, v179, v246
    v_mul_f32 v180, v180, v246
    v_mul_f32 v181, v181, v246
    v_mfma_f32_32x32x16_bf16 v[64:79], v[228:231], v[224:227], v[64:79]
    v_mul_f32 v182, v182, v246
    v_mul_f32 v183, v183, v246
    v_mul_f32 v184, v184, v246
    v_mul_f32 v185, v185, v246
    v_cvt_pk_bf16_f32 v248, v176, v177
    v_cvt_pk_bf16_f32 v249, v178, v179
    v_mfma_f32_32x32x16_bf16 v[112:127], a[76:79], a[124:127], v[112:127]
    v_cvt_pk_bf16_f32 v250, v180, v181
    v_cvt_pk_bf16_f32 v251, v182, v183
    v_cvt_pk_bf16_f32 v252, v184, v185
    v_exp_f32 v152, v152
    v_exp_f32 v153, v153
    s_waitcnt vmcnt(12)
    v_mfma_f32_32x32x16_bf16 v[176:191], a[192:195], v[192:195], 0
    buffer_store_dwordx4 v[248:251], v4, s[24:27], s20 offen sc0 sc1
    buffer_store_dword v252, v7, s[24:27], s21 offen sc0 sc1
    buffer_load_dwordx4 a[4:7], v4, s[24:27], s22 offen offset:1024
    buffer_load_dword a68, v5, s[24:27], s23 offen offset:1024
    s_mov_b64 exec, s[78:79]
    buffer_load_dwordx4 a[168:171], v6, s[24:27], s16 offen
    buffer_load_dwordx4 a[172:175], v6, s[24:27], s17 offen
    s_mov_b64 exec, -1
    s_nop 0
    v_mfma_f32_32x32x16_bf16 v[80:95], v[228:231], v[224:227], v[80:95]
    s_add_u32 s20, s73, 0
    s_add_u32 s21, s75, 0
    s_add_u32 s22, s76, 0
    s_add_u32 s23, s76, 18432
    s_add_u32 s16, s77, 405504
    s_add_u32 s17, s7, 405504
    v_mfma_f32_32x32x16_bf16 v[96:111], v[228:231], v[224:227], v[96:111]
    v_exp_f32 v154, v154
    v_exp_f32 v155, v155
    v_exp_f32 v156, v156
    v_exp_f32 v157, v157
    v_exp_f32 v158, v158
    v_exp_f32 v159, v159
    v_cvt_pk_bf16_f32 v204, v152, v153
    v_cvt_pk_bf16_f32 v205, v154, v155
    v_cvt_pk_bf16_f32 v206, v156, v157
    v_cvt_pk_bf16_f32 v207, v158, v159
    v_mfma_f32_32x32x16_bf16 v[144:159], a[40:43], a[116:119], 0
    v_and_b32 v196, v204, v236
    v_and_b32 v197, v205, v237
    v_and_b32 v198, v206, v238
    v_and_b32 v199, v207, v239
    v_xor_b32 v200, v200, v192
    v_xor_b32 v201, v201, v193
    v_mfma_f32_32x32x16_bf16 v[176:191], a[196:199], v[196:199], v[176:191]
    v_xor_b32 v202, v202, v194
    v_xor_b32 v203, v203, v195
    v_xor_b32 v204, v204, v196
    v_xor_b32 v205, v205, v197
    v_xor_b32 v206, v206, v198
    v_xor_b32 v207, v207, v199
    v_mfma_f32_32x32x16_bf16 v[176:191], a[160:163], v[200:203], v[176:191]
    v_exp_f32 v160, v160
    v_exp_f32 v161, v161
    v_exp_f32 v162, v162
    v_mfma_f32_32x32x16_bf16 v[176:191], a[164:167], v[204:207], v[176:191]
    v_exp_f32 v163, v163
    v_exp_f32 v164, v164
    v_exp_f32 v165, v165
    v_mfma_f32_32x32x16_bf16 v[144:159], a[104:107], a[124:127], v[144:159]
    v_exp_f32 v166, v166
    v_exp_f32 v167, v167
    v_cvt_pk_bf16_f32 v208, v160, v161
    v_cvt_pk_bf16_f32 v209, v162, v163
    v_cvt_pk_bf16_f32 v210, v164, v165
    v_cvt_pk_bf16_f32 v211, v166, v167
    v_exp_f32 v168, v168
    s_nop 0
    v_mfma_f32_32x32x16_bf16 v[176:191], a[248:251], v[208:211], v[176:191]
    v_exp_f32 v169, v169
    v_exp_f32 v170, v170
    v_exp_f32 v171, v171
    v_exp_f32 v172, v172
    v_exp_f32 v173, v173
    v_exp_f32 v174, v174
    v_exp_f32 v175, v175
    v_cvt_pk_bf16_f32 v212, v168, v169
    v_cvt_pk_bf16_f32 v213, v170, v171
    v_cvt_pk_bf16_f32 v214, v172, v173
    v_cvt_pk_bf16_f32 v215, v174, v175
    v_mfma_f32_32x32x16_bf16 v[160:175], a[36:39], a[116:119], 0
    v_exp_f32 v16, v16
    v_exp_f32 v17, v17
    v_exp_f32 v18, v18
    v_mfma_f32_32x32x16_bf16 v[176:191], a[252:255], v[212:215], v[176:191]
    v_exp_f32 v19, v19
    v_exp_f32 v20, v20
    v_exp_f32 v21, v21
    v_mfma_f32_32x32x16_bf16 v[160:175], a[100:103], a[124:127], v[160:175]
    v_exp_f32 v22, v22
    v_exp_f32 v23, v23
    v_cvt_pk_bf16_f32 v216, v16, v17
    v_cvt_pk_bf16_f32 v217, v18, v19
    v_cvt_pk_bf16_f32 v218, v20, v21
    v_cvt_pk_bf16_f32 v219, v22, v23
    v_exp_f32 v24, v24
    s_nop 0
    v_mfma_f32_32x32x16_bf16 v[176:191], a[240:243], v[216:219], v[176:191]
    v_exp_f32 v25, v25
    v_exp_f32 v26, v26
    v_exp_f32 v27, v27
    v_exp_f32 v28, v28
    v_exp_f32 v29, v29
    v_exp_f32 v30, v30
    v_exp_f32 v31, v31
    v_cvt_pk_bf16_f32 v220, v24, v25
    v_cvt_pk_bf16_f32 v221, v26, v27
    v_cvt_pk_bf16_f32 v222, v28, v29
    v_cvt_pk_bf16_f32 v223, v30, v31
    v_mfma_f32_32x32x16_bf16 v[16:31], a[32:35], a[116:119], 0
    v_exp_f32 v32, v32
    v_exp_f32 v33, v33
    v_exp_f32 v34, v34
    v_mfma_f32_32x32x16_bf16 v[176:191], a[244:247], v[220:223], v[176:191]
    v_exp_f32 v35, v35
    v_exp_f32 v36, v36
    v_exp_f32 v37, v37
    v_mfma_f32_32x32x16_bf16 v[16:31], a[96:99], a[124:127], v[16:31]
    v_exp_f32 v38, v38
    v_exp_f32 v39, v39
    v_cvt_pk_bf16_f32 v192, v32, v33
    v_cvt_pk_bf16_f32 v193, v34, v35
    v_cvt_pk_bf16_f32 v194, v36, v37
    v_cvt_pk_bf16_f32 v195, v38, v39
    v_exp_f32 v40, v40
    s_nop 0
    v_mfma_f32_32x32x16_bf16 v[176:191], a[232:235], v[192:195], v[176:191]
    v_exp_f32 v41, v41
    v_exp_f32 v42, v42
    v_exp_f32 v43, v43
    v_exp_f32 v44, v44
    v_exp_f32 v45, v45
    v_exp_f32 v46, v46
    v_exp_f32 v47, v47
    v_cvt_pk_bf16_f32 v196, v40, v41
    v_cvt_pk_bf16_f32 v197, v42, v43
    v_cvt_pk_bf16_f32 v198, v44, v45
    v_cvt_pk_bf16_f32 v199, v46, v47
    v_mfma_f32_32x32x16_bf16 v[32:47], a[28:31], a[116:119], 0
    v_exp_f32 v48, v48
    v_exp_f32 v49, v49
    v_exp_f32 v50, v50
    v_mfma_f32_32x32x16_bf16 v[176:191], a[236:239], v[196:199], v[176:191]
    v_exp_f32 v51, v51
    v_exp_f32 v52, v52
    v_exp_f32 v53, v53
    v_mfma_f32_32x32x16_bf16 v[32:47], a[92:95], a[124:127], v[32:47]
    v_exp_f32 v54, v54
    v_exp_f32 v55, v55
    v_cvt_pk_bf16_f32 v200, v48, v49
    v_cvt_pk_bf16_f32 v201, v50, v51
    v_cvt_pk_bf16_f32 v202, v52, v53
    v_cvt_pk_bf16_f32 v203, v54, v55
    v_exp_f32 v56, v56
    s_nop 0
    v_mfma_f32_32x32x16_bf16 v[176:191], a[224:227], v[200:203], v[176:191]
    v_exp_f32 v57, v57
    v_exp_f32 v58, v58
    v_exp_f32 v59, v59
    v_exp_f32 v60, v60
    v_exp_f32 v61, v61
    v_exp_f32 v62, v62
    v_exp_f32 v63, v63
    v_cvt_pk_bf16_f32 v204, v56, v57
    v_cvt_pk_bf16_f32 v205, v58, v59
    v_cvt_pk_bf16_f32 v206, v60, v61
    v_cvt_pk_bf16_f32 v207, v62, v63
    v_mfma_f32_32x32x16_bf16 v[48:63], a[24:27], a[116:119], 0
    v_exp_f32 v64, v64
    v_exp_f32 v65, v65
    v_exp_f32 v66, v66
    v_mfma_f32_32x32x16_bf16 v[176:191], a[228:231], v[204:207], v[176:191]
    v_exp_f32 v67, v67
    v_exp_f32 v68, v68
    v_exp_f32 v69, v69
    v_mfma_f32_32x32x16_bf16 v[48:63], a[88:91], a[124:127], v[48:63]
    v_exp_f32 v70, v70
    v_exp_f32 v71, v71
    v_exp_f32 v72, v72
    v_exp_f32 v73, v73
    v_exp_f32 v74, v74
    v_exp_f32 v75, v75
    v_exp_f32 v76, v76
    v_exp_f32 v77, v77
    v_exp_f32 v78, v78
    v_exp_f32 v79, v79
    v_cndmask_b32 v128, v128, v112, s[40:41]
    v_cndmask_b32 v129, v129, v113, s[42:43]
    v_cndmask_b32 v130, v130, v114, s[44:45]
    v_cndmask_b32 v131, v131, v115, s[46:47]
    v_cvt_pk_bf16_f32 v208, v64, v65
    v_cvt_pk_bf16_f32 v209, v66, v67
    v_cvt_pk_bf16_f32 v210, v68, v69
    v_cvt_pk_bf16_f32 v211, v70, v71
    v_cvt_pk_bf16_f32 v212, v72, v73
    v_cvt_pk_bf16_f32 v213, v74, v75
    v_mfma_f32_32x32x16_bf16 v[176:191], a[216:219], v[208:211], v[176:191]
    v_cvt_pk_bf16_f32 v214, v76, v77
    v_cvt_pk_bf16_f32 v215, v78, v79
    v_cndmask_b32 v132, v132, v116, s[48:49]
    v_cndmask_b32 v133, v133, v117, s[50:51]
    v_cndmask_b32 v134, v134, v118, s[52:53]
    v_cndmask_b32 v135, v135, v119, s[54:55]
    v_mfma_f32_32x32x16_bf16 v[64:79], a[20:23], a[116:119], 0
    v_max_f32 v242, v128, v129
    v_max_f32 v243, v130, v131
    v_exp_f32 v80, v80
    v_exp_f32 v81, v81
    v_mfma_f32_32x32x16_bf16 v[64:79], a[84:87], a[124:127], v[64:79]
    v_exp_f32 v82, v82
    v_exp_f32 v83, v83
    v_exp_f32 v84, v84
    v_mfma_f32_32x32x16_bf16 v[176:191], a[220:223], v[212:215], v[176:191]
    v_exp_f32 v85, v85
    v_exp_f32 v86, v86
    v_exp_f32 v87, v87
    v_exp_f32 v88, v88
    v_exp_f32 v89, v89
    v_exp_f32 v90, v90
    v_exp_f32 v91, v91
    v_exp_f32 v92, v92
    v_exp_f32 v93, v93
    v_exp_f32 v94, v94
    v_exp_f32 v95, v95
    v_cndmask_b32 v136, v136, v120, s[56:57]
    v_cndmask_b32 v137, v137, v121, s[58:59]
    v_cndmask_b32 v138, v138, v122, s[60:61]
    v_cndmask_b32 v139, v139, v123, s[62:63]
    v_max3_f32 v242, v132, v133, v242
    v_max3_f32 v243, v134, v135, v243
    v_cndmask_b32 v140, v140, v124, s[64:65]
    v_cndmask_b32 v141, v141, v125, s[66:67]
    v_cndmask_b32 v142, v142, v126, s[68:69]
    v_cndmask_b32 v143, v143, v127, s[70:71]
    s_waitcnt lgkmcnt(0)
    v_mfma_f32_32x32x16_bf16 v[112:127], a[40:43], a[112:115], 0
    v_max3_f32 v242, v136, v137, v242
    v_max3_f32 v243, v138, v139, v243
    v_max3_f32 v242, v140, v141, v242
    v_max3_f32 v243, v142, v143, v243
    v_cvt_pk_bf16_f32 v216, v80, v81
    v_cvt_pk_bf16_f32 v217, v82, v83
    v_mfma_f32_32x32x16_bf16 v[112:127], a[104:107], a[120:123], v[112:127]
    v_cvt_pk_bf16_f32 v218, v84, v85
    v_cvt_pk_bf16_f32 v219, v86, v87
    v_cvt_pk_bf16_f32 v220, v88, v89
    v_cvt_pk_bf16_f32 v221, v90, v91
    v_cvt_pk_bf16_f32 v222, v92, v93
    v_cvt_pk_bf16_f32 v223, v94, v95
    v_mfma_f32_32x32x16_bf16 v[80:95], a[16:19], a[116:119], 0
    ds_read_b128 a[116:119], v1 offset:1024
    v_max3_f32 v242, v144, v145, v242
    v_max3_f32 v243, v146, v147, v243
    v_max3_f32 v242, v148, v149, v242
    v_max3_f32 v243, v150, v151, v243
    v_max3_f32 v242, v152, v153, v242
    v_mfma_f32_32x32x16_bf16 v[80:95], a[80:83], a[124:127], v[80:95]
    ds_read_b32 a124, v10 offset:1040
    v_max3_f32 v243, v154, v155, v243
    v_max3_f32 v242, v156, v157, v242
    v_max3_f32 v243, v158, v159, v243
    v_mfma_f32_32x32x16_bf16 v[176:191], a[208:211], v[216:219], v[176:191]
    v_max3_f32 v242, v160, v161, v242
    v_max3_f32 v243, v162, v163, v243
    v_max3_f32 v242, v164, v165, v242
    v_max3_f32 v243, v166, v167, v243
    v_max3_f32 v242, v168, v169, v242
    v_max3_f32 v243, v170, v171, v243
    v_mfma_f32_32x32x16_bf16 v[176:191], a[212:215], v[220:223], v[176:191]
    v_max3_f32 v242, v172, v173, v242
    v_max3_f32 v243, v174, v175, v243
    v_max3_f32 v242, v16, v17, v242
    v_max3_f32 v243, v18, v19, v243
    v_max3_f32 v242, v20, v21, v242
    v_max3_f32 v243, v22, v23, v243
    v_max3_f32 v242, v24, v25, v242
    v_max3_f32 v243, v26, v27, v243
    v_max3_f32 v242, v28, v29, v242
    v_max3_f32 v243, v30, v31, v243
    v_max3_f32 v242, v32, v33, v242
    v_max3_f32 v243, v34, v35, v243
    v_max3_f32 v242, v36, v37, v242
    v_max3_f32 v243, v38, v39, v243
    v_max3_f32 v242, v40, v41, v242
    v_max3_f32 v243, v42, v43, v243
    v_max3_f32 v242, v44, v45, v242
    v_max3_f32 v243, v46, v47, v243
    v_max3_f32 v242, v48, v49, v242
    v_max3_f32 v243, v50, v51, v243
    v_max3_f32 v242, v52, v53, v242
    v_max3_f32 v243, v54, v55, v243
    v_max3_f32 v242, v56, v57, v242
    v_max3_f32 v243, v58, v59, v243
    v_max3_f32 v242, v60, v61, v242
    v_max3_f32 v243, v62, v63, v243
    v_max3_f32 v242, v64, v65, v242
    v_max3_f32 v243, v66, v67, v243
    v_max3_f32 v242, v68, v69, v242
    v_max3_f32 v243, v70, v71, v243
    v_max3_f32 v242, v72, v73, v242
    v_max3_f32 v243, v74, v75, v243
    v_max3_f32 v242, v76, v77, v242
    v_max3_f32 v243, v78, v79, v243
    v_max3_f32 v242, v80, v81, v242
    v_max3_f32 v243, v82, v83, v243
    v_max3_f32 v242, v84, v85, v242
    v_max3_f32 v243, v86, v87, v243
    v_exp_f32 v96, v96
    v_exp_f32 v97, v97
    v_exp_f32 v98, v98
    v_exp_f32 v99, v99
    v_exp_f32 v100, v100
    v_exp_f32 v101, v101
    v_exp_f32 v102, v102
    v_exp_f32 v103, v103
    v_max3_f32 v242, v88, v89, v242
    v_max3_f32 v243, v90, v91, v243
    v_max3_f32 v242, v92, v93, v242
    v_max3_f32 v243, v94, v95, v243
    v_max_f32 v242, v242, v243
    v_cvt_pk_bf16_f32 v192, v96, v97
    v_cvt_pk_bf16_f32 v193, v98, v99
    v_cvt_pk_bf16_f32 v194, v100, v101
    v_cvt_pk_bf16_f32 v195, v102, v103
    v_mov_b32 v243, v242
    s_nop 1
    v_permlane32_swap_b32 v242, v243
    v_mfma_f32_32x32x16_bf16 v[176:191], a[200:203], v[192:195], v[176:191]
    v_max_f32 v242, v242, v243
    v_cvt_pk_bf16_f32 v244, v242, v242
    v_and_b32 v244, 0xffff0000, v244
    v_exp_f32 v104, v104
    v_exp_f32 v105, v105
    v_exp_f32 v106, v106
    v_exp_f32 v107, v107
    v_exp_f32 v108, v108
    v_exp_f32 v109, v109
    v_exp_f32 v110, v110
    v_exp_f32 v111, v111
    v_sub_f32 v243, v244, v242
    v_cvt_pk_bf16_f32 v224, -v244, v243
    v_cvt_pk_bf16_f32 v196, v104, v105
    v_cvt_pk_bf16_f32 v197, v106, v107
    v_mfma_f32_32x32x16_bf16 v[128:143], v[228:231], v[224:227], v[128:143]
    v_cvt_pk_bf16_f32 v198, v108, v109
    v_cvt_pk_bf16_f32 v199, v110, v111
    s_nop 1
    v_mfma_f32_32x32x16_bf16 v[176:191], a[204:207], v[196:199], v[176:191]
    s_nop 6
    v_exp_f32 v128, v128
    v_mfma_f32_32x32x16_bf16 v[144:159], v[228:231], v[224:227], v[144:159]
    v_exp_f32 v129, v129
    v_exp_f32 v130, v130
    v_exp_f32 v131, v131
    v_mfma_f32_32x32x16_bf16 v[160:175], v[228:231], v[224:227], v[160:175]
    v_exp_f32 v132, v132
    v_exp_f32 v133, v133
    v_exp_f32 v134, v134
    v_mfma_f32_32x32x16_bf16 v[16:31], v[228:231], v[224:227], v[16:31]
    v_exp_f32 v135, v135
    v_rcp_f32 v246, v186
    v_cvt_pk_bf16_f32 v200, v128, v129
    v_cvt_pk_bf16_f32 v201, v130, v131
    v_mfma_f32_32x32x16_bf16 v[32:47], v[228:231], v[224:227], v[32:47]
    v_cvt_pk_bf16_f32 v202, v132, v133
    v_cvt_pk_bf16_f32 v203, v134, v135
    v_and_b32 v208, v200, v232
    v_and_b32 v209, v201, v233
    v_and_b32 v210, v202, v234
    v_and_b32 v211, v203, v235
    s_waitcnt vmcnt(8)
    v_mfma_f32_32x32x16_bf16 v[96:111], a[8:11], a[112:115], 0
    v_mul_f32 v176, v176, v246
    v_mul_f32 v177, v177, v246
    v_mul_f32 v178, v178, v246
    v_mul_f32 v179, v179, v246
    v_mul_f32 v180, v180, v246
    v_mul_f32 v181, v181, v246
    v_mfma_f32_32x32x16_bf16 v[48:63], v[228:231], v[224:227], v[48:63]
    v_mul_f32 v182, v182, v246
    v_mul_f32 v183, v183, v246
    v_mul_f32 v184, v184, v246
    v_mul_f32 v185, v185, v246
    v_cvt_pk_bf16_f32 v248, v176, v177
    v_cvt_pk_bf16_f32 v249, v178, v179
    v_mfma_f32_32x32x16_bf16 v[96:111], a[72:75], a[120:123], v[96:111]
    v_cvt_pk_bf16_f32 v250, v180, v181
    v_cvt_pk_bf16_f32 v251, v182, v183
    v_cvt_pk_bf16_f32 v252, v184, v185
    v_exp_f32 v136, v136
    v_exp_f32 v137, v137
    s_waitcnt vmcnt(12)
    v_mfma_f32_32x32x16_bf16 v[176:191], a[184:187], v[208:211], 0
    buffer_store_dwordx4 v[248:251], v4, s[24:27], s18 offen sc0 sc1
    buffer_store_dword v252, v7, s[24:27], s19 offen sc0 sc1
    buffer_load_dwordx4 a[0:3], v4, s[24:27], s20 offen offset:0
    buffer_load_dword a64, v5, s[24:27], s21 offen offset:0
    s_mov_b64 exec, s[78:79]
    buffer_load_dwordx4 a[160:163], v6, s[24:27], s22 offen
    buffer_load_dwordx4 a[164:167], v6, s[24:27], s23 offen
    s_mov_b64 exec, -1
    s_nop 0
    v_mfma_f32_32x32x16_bf16 v[64:79], v[228:231], v[224:227], v[64:79]
    s_add_u32 s18, s77, 368640
    s_add_u32 s19, s7, 368640
    s_add_u32 s20, s77, 331776
    s_add_u32 s21, s7, 331776
    s_add_u32 s22, s77, 294912
    s_add_u32 s23, s7, 294912
    v_mfma_f32_32x32x16_bf16 v[80:95], v[228:231], v[224:227], v[80:95]
    v_exp_f32 v138, v138
    v_exp_f32 v139, v139
    v_exp_f32 v140, v140
    v_exp_f32 v141, v141
    v_exp_f32 v142, v142
    v_exp_f32 v143, v143
    v_cvt_pk_bf16_f32 v204, v136, v137
    v_cvt_pk_bf16_f32 v205, v138, v139
    v_cvt_pk_bf16_f32 v206, v140, v141
    v_cvt_pk_bf16_f32 v207, v142, v143
    v_mfma_f32_32x32x16_bf16 v[128:143], a[36:39], a[112:115], 0
    v_and_b32 v212, v204, v236
    v_and_b32 v213, v205, v237
    v_and_b32 v214, v206, v238
    v_and_b32 v215, v207, v239
    v_xor_b32 v200, v200, v208
    v_xor_b32 v201, v201, v209
    v_mfma_f32_32x32x16_bf16 v[176:191], a[188:191], v[212:215], v[176:191]
    v_xor_b32 v202, v202, v210
    v_xor_b32 v203, v203, v211
    v_xor_b32 v204, v204, v212
    v_xor_b32 v205, v205, v213
    v_xor_b32 v206, v206, v214
    v_xor_b32 v207, v207, v215
    v_mfma_f32_32x32x16_bf16 v[176:191], a[248:251], v[200:203], v[176:191]
    v_exp_f32 v144, v144
    v_exp_f32 v145, v145
    v_exp_f32 v146, v146
    v_mfma_f32_32x32x16_bf16 v[176:191], a[252:255], v[204:207], v[176:191]
    v_exp_f32 v147, v147
    v_exp_f32 v148, v148
    v_exp_f32 v149, v149
    v_mfma_f32_32x32x16_bf16 v[128:143], a[100:103], a[120:123], v[128:143]
    v_exp_f32 v150, v150
    v_exp_f32 v151, v151
    v_cvt_pk_bf16_f32 v216, v144, v145
    v_cvt_pk_bf16_f32 v217, v146, v147
    v_cvt_pk_bf16_f32 v218, v148, v149
    v_cvt_pk_bf16_f32 v219, v150, v151
    v_exp_f32 v152, v152
    s_nop 0
    v_mfma_f32_32x32x16_bf16 v[176:191], a[240:243], v[216:219], v[176:191]
    v_exp_f32 v153, v153
    v_exp_f32 v154, v154
    v_exp_f32 v155, v155
    v_exp_f32 v156, v156
    v_exp_f32 v157, v157
    v_exp_f32 v158, v158
    v_exp_f32 v159, v159
    v_cvt_pk_bf16_f32 v220, v152, v153
    v_cvt_pk_bf16_f32 v221, v154, v155
    v_cvt_pk_bf16_f32 v222, v156, v157
    v_cvt_pk_bf16_f32 v223, v158, v159
    v_mfma_f32_32x32x16_bf16 v[144:159], a[32:35], a[112:115], 0
    v_exp_f32 v160, v160
    v_exp_f32 v161, v161
    v_exp_f32 v162, v162
    v_mfma_f32_32x32x16_bf16 v[176:191], a[244:247], v[220:223], v[176:191]
    v_exp_f32 v163, v163
    v_exp_f32 v164, v164
    v_exp_f32 v165, v165
    v_mfma_f32_32x32x16_bf16 v[144:159], a[96:99], a[120:123], v[144:159]
    v_exp_f32 v166, v166
    v_exp_f32 v167, v167
    v_cvt_pk_bf16_f32 v192, v160, v161
    v_cvt_pk_bf16_f32 v193, v162, v163
    v_cvt_pk_bf16_f32 v194, v164, v165
    v_cvt_pk_bf16_f32 v195, v166, v167
    v_exp_f32 v168, v168
    s_nop 0
    v_mfma_f32_32x32x16_bf16 v[176:191], a[232:235], v[192:195], v[176:191]
    v_exp_f32 v169, v169
    v_exp_f32 v170, v170
    v_exp_f32 v171, v171
    v_exp_f32 v172, v172
    v_exp_f32 v173, v173
    v_exp_f32 v174, v174
    v_exp_f32 v175, v175
    v_cvt_pk_bf16_f32 v196, v168, v169
    v_cvt_pk_bf16_f32 v197, v170, v171
    v_cvt_pk_bf16_f32 v198, v172, v173
    v_cvt_pk_bf16_f32 v199, v174, v175
    v_mfma_f32_32x32x16_bf16 v[160:175], a[28:31], a[112:115], 0
    v_exp_f32 v16, v16
    v_exp_f32 v17, v17
    v_exp_f32 v18, v18
    v_mfma_f32_32x32x16_bf16 v[176:191], a[236:239], v[196:199], v[176:191]
    v_exp_f32 v19, v19
    v_exp_f32 v20, v20
    v_exp_f32 v21, v21
    v_mfma_f32_32x32x16_bf16 v[160:175], a[92:95], a[120:123], v[160:175]
    v_exp_f32 v22, v22
    v_exp_f32 v23, v23
    v_cvt_pk_bf16_f32 v208, v16, v17
    v_cvt_pk_bf16_f32 v209, v18, v19
    v_cvt_pk_bf16_f32 v210, v20, v21
    v_cvt_pk_bf16_f32 v211, v22, v23
    v_exp_f32 v24, v24
    s_nop 0
    v_mfma_f32_32x32x16_bf16 v[176:191], a[224:227], v[208:211], v[176:191]
    v_exp_f32 v25, v25
    v_exp_f32 v26, v26
    v_exp_f32 v27, v27
    v_exp_f32 v28, v28
    v_exp_f32 v29, v29
    v_exp_f32 v30, v30
    v_exp_f32 v31, v31
    v_cvt_pk_bf16_f32 v212, v24, v25
    v_cvt_pk_bf16_f32 v213, v26, v27
    v_cvt_pk_bf16_f32 v214, v28, v29
    v_cvt_pk_bf16_f32 v215, v30, v31
    v_mfma_f32_32x32x16_bf16 v[16:31], a[24:27], a[112:115], 0
    v_exp_f32 v32, v32
    v_exp_f32 v33, v33
    v_exp_f32 v34, v34
    v_mfma_f32_32x32x16_bf16 v[176:191], a[228:231], v[212:215], v[176:191]
    v_exp_f32 v35, v35
    v_exp_f32 v36, v36
    v_exp_f32 v37, v37
    v_mfma_f32_32x32x16_bf16 v[16:31], a[88:91], a[120:123], v[16:31]
    v_exp_f32 v38, v38
    v_exp_f32 v39, v39
    v_cvt_pk_bf16_f32 v200, v32, v33
    v_cvt_pk_bf16_f32 v201, v34, v35
    v_cvt_pk_bf16_f32 v202, v36, v37
    v_cvt_pk_bf16_f32 v203, v38, v39
    v_exp_f32 v40, v40
    s_nop 0
    v_mfma_f32_32x32x16_bf16 v[176:191], a[216:219], v[200:203], v[176:191]
    v_exp_f32 v41, v41
    v_exp_f32 v42, v42
    v_exp_f32 v43, v43
    v_exp_f32 v44, v44
    v_exp_f32 v45, v45
    v_exp_f32 v46, v46
    v_exp_f32 v47, v47
    v_cvt_pk_bf16_f32 v204, v40, v41
    v_cvt_pk_bf16_f32 v205, v42, v43
    v_cvt_pk_bf16_f32 v206, v44, v45
    v_cvt_pk_bf16_f32 v207, v46, v47
    v_mfma_f32_32x32x16_bf16 v[32:47], a[20:23], a[112:115], 0
    v_exp_f32 v48, v48
    v_exp_f32 v49, v49
    v_exp_f32 v50, v50
    v_mfma_f32_32x32x16_bf16 v[176:191], a[220:223], v[204:207], v[176:191]
    v_exp_f32 v51, v51
    v_exp_f32 v52, v52
    v_exp_f32 v53, v53
    v_mfma_f32_32x32x16_bf16 v[32:47], a[84:87], a[120:123], v[32:47]
    v_exp_f32 v54, v54
    v_exp_f32 v55, v55
    v_exp_f32 v56, v56
    v_exp_f32 v57, v57
    v_exp_f32 v58, v58
    v_exp_f32 v59, v59
    v_exp_f32 v60, v60
    v_exp_f32 v61, v61
    v_exp_f32 v62, v62
    v_exp_f32 v63, v63
    v_cndmask_b32 v112, v112, v96, s[40:41]
    v_cndmask_b32 v113, v113, v97, s[42:43]
    v_cndmask_b32 v114, v114, v98, s[44:45]
    v_cndmask_b32 v115, v115, v99, s[46:47]
    v_cvt_pk_bf16_f32 v216, v48, v49
    v_cvt_pk_bf16_f32 v217, v50, v51
    v_cvt_pk_bf16_f32 v218, v52, v53
    v_cvt_pk_bf16_f32 v219, v54, v55
    v_cvt_pk_bf16_f32 v220, v56, v57
    v_cvt_pk_bf16_f32 v221, v58, v59
    v_mfma_f32_32x32x16_bf16 v[176:191], a[208:211], v[216:219], v[176:191]
    v_cvt_pk_bf16_f32 v222, v60, v61
    v_cvt_pk_bf16_f32 v223, v62, v63
    v_cndmask_b32 v116, v116, v100, s[48:49]
    v_cndmask_b32 v117, v117, v101, s[50:51]
    v_cndmask_b32 v118, v118, v102, s[52:53]
    v_cndmask_b32 v119, v119, v103, s[54:55]
    v_mfma_f32_32x32x16_bf16 v[48:63], a[16:19], a[112:115], 0
    v_max_f32 v240, v112, v113
    v_max_f32 v241, v114, v115
    v_exp_f32 v64, v64
    v_exp_f32 v65, v65
    v_mfma_f32_32x32x16_bf16 v[48:63], a[80:83], a[120:123], v[48:63]
    v_exp_f32 v66, v66
    v_exp_f32 v67, v67
    v_exp_f32 v68, v68
    v_mfma_f32_32x32x16_bf16 v[176:191], a[212:215], v[220:223], v[176:191]
    v_exp_f32 v69, v69
    v_exp_f32 v70, v70
    v_exp_f32 v71, v71
    v_exp_f32 v72, v72
    v_exp_f32 v73, v73
    v_exp_f32 v74, v74
    v_exp_f32 v75, v75
    v_exp_f32 v76, v76
    v_exp_f32 v77, v77
    v_exp_f32 v78, v78
    v_exp_f32 v79, v79
    v_cndmask_b32 v120, v120, v104, s[56:57]
    v_cndmask_b32 v121, v121, v105, s[58:59]
    v_cndmask_b32 v122, v122, v106, s[60:61]
    v_cndmask_b32 v123, v123, v107, s[62:63]
    v_max3_f32 v240, v116, v117, v240
    v_max3_f32 v241, v118, v119, v241
    v_cndmask_b32 v124, v124, v108, s[64:65]
    v_cndmask_b32 v125, v125, v109, s[66:67]
    v_cndmask_b32 v126, v126, v110, s[68:69]
    v_cndmask_b32 v127, v127, v111, s[70:71]
    s_waitcnt lgkmcnt(0)
    v_mfma_f32_32x32x16_bf16 v[96:111], a[36:39], a[116:119], 0
    v_max3_f32 v240, v120, v121, v240
    v_max3_f32 v241, v122, v123, v241
    v_max3_f32 v240, v124, v125, v240
    v_max3_f32 v241, v126, v127, v241
    v_cvt_pk_bf16_f32 v192, v64, v65
    v_cvt_pk_bf16_f32 v193, v66, v67
    v_mfma_f32_32x32x16_bf16 v[96:111], a[100:103], a[124:127], v[96:111]
    v_cvt_pk_bf16_f32 v194, v68, v69
    v_cvt_pk_bf16_f32 v195, v70, v71
    v_cvt_pk_bf16_f32 v196, v72, v73
    v_cvt_pk_bf16_f32 v197, v74, v75
    v_cvt_pk_bf16_f32 v198, v76, v77
    v_cvt_pk_bf16_f32 v199, v78, v79
    v_mfma_f32_32x32x16_bf16 v[64:79], a[12:15], a[112:115], 0
    ds_read_b128 a[112:115], v1 offset:0
    v_max3_f32 v240, v128, v129, v240
    v_max3_f32 v241, v130, v131, v241
    v_max3_f32 v240, v132, v133, v240
    v_max3_f32 v241, v134, v135, v241
    v_max3_f32 v240, v136, v137, v240
    v_mfma_f32_32x32x16_bf16 v[64:79], a[76:79], a[120:123], v[64:79]
    ds_read_b32 a120, v10 offset:0
    v_max3_f32 v241, v138, v139, v241
    v_max3_f32 v240, v140, v141, v240
    v_max3_f32 v241, v142, v143, v241
    v_mfma_f32_32x32x16_bf16 v[176:191], a[200:203], v[192:195], v[176:191]
    v_max3_f32 v240, v144, v145, v240
    v_max3_f32 v241, v146, v147, v241
    v_max3_f32 v240, v148, v149, v240
    v_max3_f32 v241, v150, v151, v241
    v_max3_f32 v240, v152, v153, v240
    v_max3_f32 v241, v154, v155, v241
    v_mfma_f32_32x32x16_bf16 v[176:191], a[204:207], v[196:199], v[176:191]
    v_max3_f32 v240, v156, v157, v240
    v_max3_f32 v241, v158, v159, v241
    v_max3_f32 v240, v160, v161, v240
    v_max3_f32 v241, v162, v163, v241
    v_max3_f32 v240, v164, v165, v240
    v_max3_f32 v241, v166, v167, v241
    v_max3_f32 v240, v168, v169, v240
    v_max3_f32 v241, v170, v171, v241
    v_max3_f32 v240, v172, v173, v240
    v_max3_f32 v241, v174, v175, v241
    v_max3_f32 v240, v16, v17, v240
    v_max3_f32 v241, v18, v19, v241
    v_max3_f32 v240, v20, v21, v240
    v_max3_f32 v241, v22, v23, v241
    v_max3_f32 v240, v24, v25, v240
    v_max3_f32 v241, v26, v27, v241
    v_max3_f32 v240, v28, v29, v240
    v_max3_f32 v241, v30, v31, v241
    v_max3_f32 v240, v32, v33, v240
    v_max3_f32 v241, v34, v35, v241
    v_max3_f32 v240, v36, v37, v240
    v_max3_f32 v241, v38, v39, v241
    v_max3_f32 v240, v40, v41, v240
    v_max3_f32 v241, v42, v43, v241
    v_max3_f32 v240, v44, v45, v240
    v_max3_f32 v241, v46, v47, v241
    v_max3_f32 v240, v48, v49, v240
    v_max3_f32 v241, v50, v51, v241
    v_max3_f32 v240, v52, v53, v240
    v_max3_f32 v241, v54, v55, v241
    v_max3_f32 v240, v56, v57, v240
    v_max3_f32 v241, v58, v59, v241
    v_max3_f32 v240, v60, v61, v240
    v_max3_f32 v241, v62, v63, v241
    v_max3_f32 v240, v64, v65, v240
    v_max3_f32 v241, v66, v67, v241
    v_max3_f32 v240, v68, v69, v240
    v_max3_f32 v241, v70, v71, v241
    v_exp_f32 v80, v80
    v_exp_f32 v81, v81
    v_exp_f32 v82, v82
    v_exp_f32 v83, v83
    v_exp_f32 v84, v84
    v_exp_f32 v85, v85
    v_exp_f32 v86, v86
    v_exp_f32 v87, v87
    v_max3_f32 v240, v72, v73, v240
    v_max3_f32 v241, v74, v75, v241
    v_max3_f32 v240, v76, v77, v240
    v_max3_f32 v241, v78, v79, v241
    v_max_f32 v240, v240, v241
    v_cvt_pk_bf16_f32 v208, v80, v81
    v_cvt_pk_bf16_f32 v209, v82, v83
    v_cvt_pk_bf16_f32 v210, v84, v85
    v_cvt_pk_bf16_f32 v211, v86, v87
    v_mov_b32 v241, v240
    s_nop 1
    v_permlane32_swap_b32 v240, v241
    v_mfma_f32_32x32x16_bf16 v[176:191], a[192:195], v[208:211], v[176:191]
    v_max_f32 v240, v240, v241
    v_cvt_pk_bf16_f32 v244, v240, v240
    v_and_b32 v244, 0xffff0000, v244
    v_exp_f32 v88, v88
    v_exp_f32 v89, v89
    v_exp_f32 v90, v90
    v_exp_f32 v91, v91
    v_exp_f32 v92, v92
    v_exp_f32 v93, v93
    v_exp_f32 v94, v94
    v_exp_f32 v95, v95
    v_sub_f32 v241, v244, v240
    v_cvt_pk_bf16_f32 v224, -v244, v241
    v_cvt_pk_bf16_f32 v212, v88, v89
    v_cvt_pk_bf16_f32 v213, v90, v91
    v_mfma_f32_32x32x16_bf16 v[112:127], v[228:231], v[224:227], v[112:127]
    v_cvt_pk_bf16_f32 v214, v92, v93
    v_cvt_pk_bf16_f32 v215, v94, v95
    s_nop 1
    v_mfma_f32_32x32x16_bf16 v[176:191], a[196:199], v[212:215], v[176:191]
    s_nop 6
    v_exp_f32 v112, v112
    v_mfma_f32_32x32x16_bf16 v[128:143], v[228:231], v[224:227], v[128:143]
    v_exp_f32 v113, v113
    v_exp_f32 v114, v114
    v_exp_f32 v115, v115
    v_mfma_f32_32x32x16_bf16 v[144:159], v[228:231], v[224:227], v[144:159]
    v_exp_f32 v116, v116
    v_exp_f32 v117, v117
    v_exp_f32 v118, v118
    v_mfma_f32_32x32x16_bf16 v[160:175], v[228:231], v[224:227], v[160:175]
    v_exp_f32 v119, v119
    v_rcp_f32 v246, v186
    v_cvt_pk_bf16_f32 v200, v112, v113
    v_cvt_pk_bf16_f32 v201, v114, v115
    v_mfma_f32_32x32x16_bf16 v[16:31], v[228:231], v[224:227], v[16:31]
    v_cvt_pk_bf16_f32 v202, v116, v117
    v_cvt_pk_bf16_f32 v203, v118, v119
    v_and_b32 v216, v200, v232
    v_and_b32 v217, v201, v233
    v_and_b32 v218, v202, v234
    v_and_b32 v219, v203, v235
    s_waitcnt vmcnt(8)
    v_mfma_f32_32x32x16_bf16 v[80:95], a[4:7], a[116:119], 0
    v_mul_f32 v176, v176, v246
    v_mul_f32 v177, v177, v246
    v_mul_f32 v178, v178, v246
    v_mul_f32 v179, v179, v246
    v_mul_f32 v180, v180, v246
    v_mul_f32 v181, v181, v246
    v_mfma_f32_32x32x16_bf16 v[32:47], v[228:231], v[224:227], v[32:47]
    v_mul_f32 v182, v182, v246
    v_mul_f32 v183, v183, v246
    v_mul_f32 v184, v184, v246
    v_mul_f32 v185, v185, v246
    v_cvt_pk_bf16_f32 v248, v176, v177
    v_cvt_pk_bf16_f32 v249, v178, v179
    v_mfma_f32_32x32x16_bf16 v[80:95], a[68:71], a[124:127], v[80:95]
    v_cvt_pk_bf16_f32 v250, v180, v181
    v_cvt_pk_bf16_f32 v251, v182, v183
    v_cvt_pk_bf16_f32 v252, v184, v185
    v_exp_f32 v120, v120
    v_exp_f32 v121, v121
    s_waitcnt vmcnt(12)
    v_mfma_f32_32x32x16_bf16 v[176:191], a[176:179], v[216:219], 0
    buffer_store_dwordx4 v[248:251], v4, s[24:27], s16 offen sc0 sc1
    buffer_store_dword v252, v7, s[24:27], s17 offen sc0 sc1
    v_exp_f32 v122, v122
    v_exp_f32 v123, v123
    v_mfma_f32_32x32x16_bf16 v[48:63], v[228:231], v[224:227], v[48:63]
    v_exp_f32 v124, v124
    v_exp_f32 v125, v125
    v_exp_f32 v126, v126
    v_mfma_f32_32x32x16_bf16 v[64:79], v[228:231], v[224:227], v[64:79]
    v_exp_f32 v127, v127
    v_cvt_pk_bf16_f32 v204, v120, v121
    v_cvt_pk_bf16_f32 v205, v122, v123
    v_cvt_pk_bf16_f32 v206, v124, v125
    v_cvt_pk_bf16_f32 v207, v126, v127
    v_mfma_f32_32x32x16_bf16 v[112:127], a[32:35], a[116:119], 0
    v_and_b32 v220, v204, v236
    v_and_b32 v221, v205, v237
    v_and_b32 v222, v206, v238
    v_and_b32 v223, v207, v239
    v_xor_b32 v200, v200, v216
    v_xor_b32 v201, v201, v217
    v_mfma_f32_32x32x16_bf16 v[176:191], a[180:183], v[220:223], v[176:191]
    v_xor_b32 v202, v202, v218
    v_xor_b32 v203, v203, v219
    v_xor_b32 v204, v204, v220
    v_xor_b32 v205, v205, v221
    v_xor_b32 v206, v206, v222
    v_xor_b32 v207, v207, v223
    v_mfma_f32_32x32x16_bf16 v[176:191], a[240:243], v[200:203], v[176:191]
    v_exp_f32 v128, v128
    v_exp_f32 v129, v129
    v_exp_f32 v130, v130
    v_mfma_f32_32x32x16_bf16 v[176:191], a[244:247], v[204:207], v[176:191]
    v_exp_f32 v131, v131
    v_exp_f32 v132, v132
    v_exp_f32 v133, v133
    v_mfma_f32_32x32x16_bf16 v[112:127], a[96:99], a[124:127], v[112:127]
    v_exp_f32 v134, v134
    v_exp_f32 v135, v135
    v_cvt_pk_bf16_f32 v192, v128, v129
    v_cvt_pk_bf16_f32 v193, v130, v131
    v_cvt_pk_bf16_f32 v194, v132, v133
    v_cvt_pk_bf16_f32 v195, v134, v135
    v_exp_f32 v136, v136
    s_nop 0
    v_mfma_f32_32x32x16_bf16 v[176:191], a[232:235], v[192:195], v[176:191]
    v_exp_f32 v137, v137
    v_exp_f32 v138, v138
    v_exp_f32 v139, v139
    v_exp_f32 v140, v140
    v_exp_f32 v141, v141
    v_exp_f32 v142, v142
    v_exp_f32 v143, v143
    v_cvt_pk_bf16_f32 v196, v136, v137
    v_cvt_pk_bf16_f32 v197, v138, v139
    v_cvt_pk_bf16_f32 v198, v140, v141
    v_cvt_pk_bf16_f32 v199, v142, v143
    v_mfma_f32_32x32x16_bf16 v[128:143], a[28:31], a[116:119], 0
    v_exp_f32 v144, v144
    v_exp_f32 v145, v145
    v_exp_f32 v146, v146
    v_mfma_f32_32x32x16_bf16 v[176:191], a[236:239], v[196:199], v[176:191]
    v_exp_f32 v147, v147
    v_exp_f32 v148, v148
    v_exp_f32 v149, v149
    v_mfma_f32_32x32x16_bf16 v[128:143], a[92:95], a[124:127], v[128:143]
    v_exp_f32 v150, v150
    v_exp_f32 v151, v151
    v_cvt_pk_bf16_f32 v208, v144, v145
    v_cvt_pk_bf16_f32 v209, v146, v147
    v_cvt_pk_bf16_f32 v210, v148, v149
    v_cvt_pk_bf16_f32 v211, v150, v151
    v_exp_f32 v152, v152
    s_nop 0
    v_mfma_f32_32x32x16_bf16 v[176:191], a[224:227], v[208:211], v[176:191]
    v_exp_f32 v153, v153
    v_exp_f32 v154, v154
    v_exp_f32 v155, v155
    v_exp_f32 v156, v156
    v_exp_f32 v157, v157
    v_exp_f32 v158, v158
    v_exp_f32 v159, v159
    v_cvt_pk_bf16_f32 v212, v152, v153
    v_cvt_pk_bf16_f32 v213, v154, v155
    v_cvt_pk_bf16_f32 v214, v156, v157
    v_cvt_pk_bf16_f32 v215, v158, v159
    v_mfma_f32_32x32x16_bf16 v[144:159], a[24:27], a[116:119], 0
    v_exp_f32 v160, v160
    v_exp_f32 v161, v161
    v_exp_f32 v162, v162
    v_mfma_f32_32x32x16_bf16 v[176:191], a[228:231], v[212:215], v[176:191]
    v_exp_f32 v163, v163
    v_exp_f32 v164, v164
    v_exp_f32 v165, v165
    v_mfma_f32_32x32x16_bf16 v[144:159], a[88:91], a[124:127], v[144:159]
    v_exp_f32 v166, v166
    v_exp_f32 v167, v167
    v_cvt_pk_bf16_f32 v216, v160, v161
    v_cvt_pk_bf16_f32 v217, v162, v163
    v_cvt_pk_bf16_f32 v218, v164, v165
    v_cvt_pk_bf16_f32 v219, v166, v167
    v_exp_f32 v168, v168
    s_nop 0
    v_mfma_f32_32x32x16_bf16 v[176:191], a[216:219], v[216:219], v[176:191]
    v_exp_f32 v169, v169
    v_exp_f32 v170, v170
    v_exp_f32 v171, v171
    v_exp_f32 v172, v172
    v_exp_f32 v173, v173
    v_exp_f32 v174, v174
    v_exp_f32 v175, v175
    v_cvt_pk_bf16_f32 v220, v168, v169
    v_cvt_pk_bf16_f32 v221, v170, v171
    v_cvt_pk_bf16_f32 v222, v172, v173
    v_cvt_pk_bf16_f32 v223, v174, v175
    v_mfma_f32_32x32x16_bf16 v[160:175], a[20:23], a[116:119], 0
    v_exp_f32 v16, v16
    v_exp_f32 v17, v17
    v_exp_f32 v18, v18
    v_mfma_f32_32x32x16_bf16 v[176:191], a[220:223], v[220:223], v[176:191]
    v_exp_f32 v19, v19
    v_exp_f32 v20, v20
    v_exp_f32 v21, v21
    v_mfma_f32_32x32x16_bf16 v[160:175], a[84:87], a[124:127], v[160:175]
    v_exp_f32 v22, v22
    v_exp_f32 v23, v23
    v_cvt_pk_bf16_f32 v200, v16, v17
    v_cvt_pk_bf16_f32 v201, v18, v19
    v_cvt_pk_bf16_f32 v202, v20, v21
    v_cvt_pk_bf16_f32 v203, v22, v23
    v_exp_f32 v24, v24
    s_nop 0
    v_mfma_f32_32x32x16_bf16 v[176:191], a[208:211], v[200:203], v[176:191]
    v_exp_f32 v25, v25
    v_exp_f32 v26, v26
    v_exp_f32 v27, v27
    v_exp_f32 v28, v28
    v_exp_f32 v29, v29
    v_exp_f32 v30, v30
    v_exp_f32 v31, v31
    v_cvt_pk_bf16_f32 v204, v24, v25
    v_cvt_pk_bf16_f32 v205, v26, v27
    v_cvt_pk_bf16_f32 v206, v28, v29
    v_cvt_pk_bf16_f32 v207, v30, v31
    v_mfma_f32_32x32x16_bf16 v[16:31], a[16:19], a[116:119], 0
    v_exp_f32 v32, v32
    v_exp_f32 v33, v33
    v_exp_f32 v34, v34
    v_mfma_f32_32x32x16_bf16 v[176:191], a[212:215], v[204:207], v[176:191]
    v_exp_f32 v35, v35
    v_exp_f32 v36, v36
    v_exp_f32 v37, v37
    v_mfma_f32_32x32x16_bf16 v[16:31], a[80:83], a[124:127], v[16:31]
    v_exp_f32 v38, v38
    v_exp_f32 v39, v39
    v_exp_f32 v40, v40
    v_exp_f32 v41, v41
    v_exp_f32 v42, v42
    v_exp_f32 v43, v43
    v_exp_f32 v44, v44
    v_exp_f32 v45, v45
    v_exp_f32 v46, v46
    v_exp_f32 v47, v47
    v_cndmask_b32 v96, v96, v80, s[40:41]
    v_cndmask_b32 v97, v97, v81, s[42:43]
    v_cndmask_b32 v98, v98, v82, s[44:45]
    v_cndmask_b32 v99, v99, v83, s[46:47]
    v_cvt_pk_bf16_f32 v192, v32, v33
    v_cvt_pk_bf16_f32 v193, v34, v35
    v_cvt_pk_bf16_f32 v194, v36, v37
    v_cvt_pk_bf16_f32 v195, v38, v39
    v_cvt_pk_bf16_f32 v196, v40, v41
    v_cvt_pk_bf16_f32 v197, v42, v43
    v_mfma_f32_32x32x16_bf16 v[176:191], a[200:203], v[192:195], v[176:191]
    v_cvt_pk_bf16_f32 v198, v44, v45
    v_cvt_pk_bf16_f32 v199, v46, v47
    v_cndmask_b32 v100, v100, v84, s[48:49]
    v_cndmask_b32 v101, v101, v85, s[50:51]
    v_cndmask_b32 v102, v102, v86, s[52:53]
    v_cndmask_b32 v103, v103, v87, s[54:55]
    v_mfma_f32_32x32x16_bf16 v[32:47], a[12:15], a[116:119], 0
    v_max_f32 v242, v96, v97
    v_max_f32 v243, v98, v99
    v_exp_f32 v48, v48
    v_exp_f32 v49, v49
    v_mfma_f32_32x32x16_bf16 v[32:47], a[76:79], a[124:127], v[32:47]
    v_exp_f32 v50, v50
    v_exp_f32 v51, v51
    v_exp_f32 v52, v52
    v_mfma_f32_32x32x16_bf16 v[176:191], a[204:207], v[196:199], v[176:191]
    v_exp_f32 v53, v53
    v_exp_f32 v54, v54
    v_exp_f32 v55, v55
    v_exp_f32 v56, v56
    v_exp_f32 v57, v57
    v_exp_f32 v58, v58
    v_exp_f32 v59, v59
    v_exp_f32 v60, v60
    v_exp_f32 v61, v61
    v_exp_f32 v62, v62
    v_exp_f32 v63, v63
    v_cndmask_b32 v104, v104, v88, s[56:57]
    v_cndmask_b32 v105, v105, v89, s[58:59]
    v_cndmask_b32 v106, v106, v90, s[60:61]
    v_cndmask_b32 v107, v107, v91, s[62:63]
    v_max3_f32 v242, v100, v101, v242
    v_max3_f32 v243, v102, v103, v243
    v_cndmask_b32 v108, v108, v92, s[64:65]
    v_cndmask_b32 v109, v109, v93, s[66:67]
    v_cndmask_b32 v110, v110, v94, s[68:69]
    v_cndmask_b32 v111, v111, v95, s[70:71]
    s_waitcnt lgkmcnt(0)
    v_mfma_f32_32x32x16_bf16 v[80:95], a[32:35], a[112:115], 0
    v_max3_f32 v242, v104, v105, v242
    v_max3_f32 v243, v106, v107, v243
    v_max3_f32 v242, v108, v109, v242
    v_max3_f32 v243, v110, v111, v243
    v_cvt_pk_bf16_f32 v208, v48, v49
    v_cvt_pk_bf16_f32 v209, v50, v51
    v_mfma_f32_32x32x16_bf16 v[80:95], a[96:99], a[120:123], v[80:95]
    v_cvt_pk_bf16_f32 v210, v52, v53
    v_cvt_pk_bf16_f32 v211, v54, v55
    v_cvt_pk_bf16_f32 v212, v56, v57
    v_cvt_pk_bf16_f32 v213, v58, v59
    v_cvt_pk_bf16_f32 v214, v60, v61
    v_cvt_pk_bf16_f32 v215, v62, v63
    v_mfma_f32_32x32x16_bf16 v[48:63], a[8:11], a[116:119], 0
    v_max3_f32 v242, v112, v113, v242
    v_max3_f32 v243, v114, v115, v243
    v_max3_f32 v242, v116, v117, v242
    v_max3_f32 v243, v118, v119, v243
    v_max3_f32 v242, v120, v121, v242
    v_max3_f32 v243, v122, v123, v243
    v_mfma_f32_32x32x16_bf16 v[48:63], a[72:75], a[124:127], v[48:63]
    v_max3_f32 v242, v124, v125, v242
    v_max3_f32 v243, v126, v127, v243
    v_max3_f32 v242, v128, v129, v242
    v_max3_f32 v243, v130, v131, v243
    v_max3_f32 v242, v132, v133, v242
    v_max3_f32 v243, v134, v135, v243
    v_mfma_f32_32x32x16_bf16 v[176:191], a[192:195], v[208:211], v[176:191]
    v_max3_f32 v242, v136, v137, v242
    v_max3_f32 v243, v138, v139, v243
    v_max3_f32 v242, v140, v141, v242
    v_max3_f32 v243, v142, v143, v243
    v_max3_f32 v242, v144, v145, v242
    v_max3_f32 v243, v146, v147, v243
    v_mfma_f32_32x32x16_bf16 v[176:191], a[196:199], v[212:215], v[176:191]
    v_max3_f32 v242, v148, v149, v242
    v_max3_f32 v243, v150, v151, v243
    v_max3_f32 v242, v152, v153, v242
    v_max3_f32 v243, v154, v155, v243
    v_max3_f32 v242, v156, v157, v242
    v_max3_f32 v243, v158, v159, v243
    v_max3_f32 v242, v160, v161, v242
    v_max3_f32 v243, v162, v163, v243
    v_max3_f32 v242, v164, v165, v242
    v_max3_f32 v243, v166, v167, v243
    v_max3_f32 v242, v168, v169, v242
    v_max3_f32 v243, v170, v171, v243
    v_max3_f32 v242, v172, v173, v242
    v_max3_f32 v243, v174, v175, v243
    v_max3_f32 v242, v16, v17, v242
    v_max3_f32 v243, v18, v19, v243
    v_max3_f32 v242, v20, v21, v242
    v_max3_f32 v243, v22, v23, v243
    v_max3_f32 v242, v24, v25, v242
    v_max3_f32 v243, v26, v27, v243
    v_max3_f32 v242, v28, v29, v242
    v_max3_f32 v243, v30, v31, v243
    v_max3_f32 v242, v32, v33, v242
    v_max3_f32 v243, v34, v35, v243
    v_max3_f32 v242, v36, v37, v242
    v_max3_f32 v243, v38, v39, v243
    v_max3_f32 v242, v40, v41, v242
    v_max3_f32 v243, v42, v43, v243
    v_max3_f32 v242, v44, v45, v242
    v_max3_f32 v243, v46, v47, v243
    v_max3_f32 v242, v48, v49, v242
    v_max3_f32 v243, v50, v51, v243
    v_max3_f32 v242, v52, v53, v242
    v_max3_f32 v243, v54, v55, v243
    v_exp_f32 v64, v64
    v_exp_f32 v65, v65
    v_exp_f32 v66, v66
    v_exp_f32 v67, v67
    v_exp_f32 v68, v68
    v_exp_f32 v69, v69
    v_exp_f32 v70, v70
    v_exp_f32 v71, v71
    v_max3_f32 v242, v56, v57, v242
    v_max3_f32 v243, v58, v59, v243
    v_max3_f32 v242, v60, v61, v242
    v_max3_f32 v243, v62, v63, v243
    v_max_f32 v242, v242, v243
    v_cvt_pk_bf16_f32 v216, v64, v65
    v_cvt_pk_bf16_f32 v217, v66, v67
    v_cvt_pk_bf16_f32 v218, v68, v69
    v_cvt_pk_bf16_f32 v219, v70, v71
    v_mov_b32 v243, v242
    s_nop 1
    v_permlane32_swap_b32 v242, v243
    v_mfma_f32_32x32x16_bf16 v[176:191], a[184:187], v[216:219], v[176:191]
    v_max_f32 v242, v242, v243
    v_cvt_pk_bf16_f32 v244, v242, v242
    v_and_b32 v244, 0xffff0000, v244
    v_exp_f32 v72, v72
    v_exp_f32 v73, v73
    v_exp_f32 v74, v74
    v_exp_f32 v75, v75
    v_exp_f32 v76, v76
    v_exp_f32 v77, v77
    v_exp_f32 v78, v78
    v_exp_f32 v79, v79
    v_sub_f32 v243, v244, v242
    v_cvt_pk_bf16_f32 v224, -v244, v243
    v_cvt_pk_bf16_f32 v220, v72, v73
    v_cvt_pk_bf16_f32 v221, v74, v75
    v_mfma_f32_32x32x16_bf16 v[96:111], v[228:231], v[224:227], v[96:111]
    v_cvt_pk_bf16_f32 v222, v76, v77
    v_cvt_pk_bf16_f32 v223, v78, v79
    s_nop 1
    v_mfma_f32_32x32x16_bf16 v[176:191], a[188:191], v[220:223], v[176:191]
    s_nop 6
    v_exp_f32 v96, v96
    v_mfma_f32_32x32x16_bf16 v[112:127], v[228:231], v[224:227], v[112:127]
    v_exp_f32 v97, v97
    v_exp_f32 v98, v98
    v_exp_f32 v99, v99
    v_mfma_f32_32x32x16_bf16 v[128:143], v[228:231], v[224:227], v[128:143]
    v_exp_f32 v100, v100
    v_exp_f32 v101, v101
    v_exp_f32 v102, v102
    v_mfma_f32_32x32x16_bf16 v[144:159], v[228:231], v[224:227], v[144:159]
    v_exp_f32 v103, v103
    v_rcp_f32 v246, v186
    v_cvt_pk_bf16_f32 v200, v96, v97
    v_cvt_pk_bf16_f32 v201, v98, v99
    v_mfma_f32_32x32x16_bf16 v[160:175], v[228:231], v[224:227], v[160:175]
    v_cvt_pk_bf16_f32 v202, v100, v101
    v_cvt_pk_bf16_f32 v203, v102, v103
    v_and_b32 v192, v200, v232
    v_and_b32 v193, v201, v233
    v_and_b32 v194, v202, v234
    v_and_b32 v195, v203, v235
    s_waitcnt vmcnt(4)
    v_mfma_f32_32x32x16_bf16 v[64:79], a[0:3], a[112:115], 0
    v_mul_f32 v176, v176, v246
    v_mul_f32 v177, v177, v246
    v_mul_f32 v178, v178, v246
    v_mul_f32 v179, v179, v246
    v_mul_f32 v180, v180, v246
    v_mul_f32 v181, v181, v246
    v_mfma_f32_32x32x16_bf16 v[16:31], v[228:231], v[224:227], v[16:31]
    v_mul_f32 v182, v182, v246
    v_mul_f32 v183, v183, v246
    v_mul_f32 v184, v184, v246
    v_mul_f32 v185, v185, v246
    v_cvt_pk_bf16_f32 v248, v176, v177
    v_cvt_pk_bf16_f32 v249, v178, v179
    v_mfma_f32_32x32x16_bf16 v[64:79], a[64:67], a[120:123], v[64:79]
    v_cvt_pk_bf16_f32 v250, v180, v181
    v_cvt_pk_bf16_f32 v251, v182, v183
    v_cvt_pk_bf16_f32 v252, v184, v185
    v_exp_f32 v104, v104
    v_exp_f32 v105, v105
    s_waitcnt vmcnt(8)
    v_mfma_f32_32x32x16_bf16 v[176:191], a[168:171], v[192:195], 0
    buffer_store_dwordx4 v[248:251], v4, s[24:27], s18 offen sc0 sc1
    buffer_store_dword v252, v7, s[24:27], s19 offen sc0 sc1
    v_exp_f32 v106, v106
    v_exp_f32 v107, v107
    v_mfma_f32_32x32x16_bf16 v[32:47], v[228:231], v[224:227], v[32:47]
    v_exp_f32 v108, v108
    v_exp_f32 v109, v109
    v_exp_f32 v110, v110
    v_mfma_f32_32x32x16_bf16 v[48:63], v[228:231], v[224:227], v[48:63]
    v_exp_f32 v111, v111
    v_cvt_pk_bf16_f32 v204, v104, v105
    v_cvt_pk_bf16_f32 v205, v106, v107
    v_cvt_pk_bf16_f32 v206, v108, v109
    v_cvt_pk_bf16_f32 v207, v110, v111
    v_mfma_f32_32x32x16_bf16 v[96:111], a[28:31], a[112:115], 0
    v_and_b32 v196, v204, v236
    v_and_b32 v197, v205, v237
    v_and_b32 v198, v206, v238
    v_and_b32 v199, v207, v239
    v_xor_b32 v200, v200, v192
    v_xor_b32 v201, v201, v193
    v_mfma_f32_32x32x16_bf16 v[176:191], a[172:175], v[196:199], v[176:191]
    v_xor_b32 v202, v202, v194
    v_xor_b32 v203, v203, v195
    v_xor_b32 v204, v204, v196
    v_xor_b32 v205, v205, v197
    v_xor_b32 v206, v206, v198
    v_xor_b32 v207, v207, v199
    v_mfma_f32_32x32x16_bf16 v[176:191], a[232:235], v[200:203], v[176:191]
    v_exp_f32 v112, v112
    v_exp_f32 v113, v113
    v_exp_f32 v114, v114
    v_mfma_f32_32x32x16_bf16 v[176:191], a[236:239], v[204:207], v[176:191]
    v_exp_f32 v115, v115
    v_exp_f32 v116, v116
    v_exp_f32 v117, v117
    v_mfma_f32_32x32x16_bf16 v[96:111], a[92:95], a[120:123], v[96:111]
    v_exp_f32 v118, v118
    v_exp_f32 v119, v119
    v_cvt_pk_bf16_f32 v208, v112, v113
    v_cvt_pk_bf16_f32 v209, v114, v115
    v_cvt_pk_bf16_f32 v210, v116, v117
    v_cvt_pk_bf16_f32 v211, v118, v119
    v_exp_f32 v120, v120
    s_nop 0
    v_mfma_f32_32x32x16_bf16 v[176:191], a[224:227], v[208:211], v[176:191]
    v_exp_f32 v121, v121
    v_exp_f32 v122, v122
    v_exp_f32 v123, v123
    v_exp_f32 v124, v124
    v_exp_f32 v125, v125
    v_exp_f32 v126, v126
    v_exp_f32 v127, v127
    v_cvt_pk_bf16_f32 v212, v120, v121
    v_cvt_pk_bf16_f32 v213, v122, v123
    v_cvt_pk_bf16_f32 v214, v124, v125
    v_cvt_pk_bf16_f32 v215, v126, v127
    v_mfma_f32_32x32x16_bf16 v[112:127], a[24:27], a[112:115], 0
    v_exp_f32 v128, v128
    v_exp_f32 v129, v129
    v_exp_f32 v130, v130
    v_mfma_f32_32x32x16_bf16 v[176:191], a[228:231], v[212:215], v[176:191]
    v_exp_f32 v131, v131
    v_exp_f32 v132, v132
    v_exp_f32 v133, v133
    v_mfma_f32_32x32x16_bf16 v[112:127], a[88:91], a[120:123], v[112:127]
    v_exp_f32 v134, v134
    v_exp_f32 v135, v135
    v_cvt_pk_bf16_f32 v216, v128, v129
    v_cvt_pk_bf16_f32 v217, v130, v131
    v_cvt_pk_bf16_f32 v218, v132, v133
    v_cvt_pk_bf16_f32 v219, v134, v135
    v_exp_f32 v136, v136
    s_nop 0
    v_mfma_f32_32x32x16_bf16 v[176:191], a[216:219], v[216:219], v[176:191]
    v_exp_f32 v137, v137
    v_exp_f32 v138, v138
    v_exp_f32 v139, v139
    v_exp_f32 v140, v140
    v_exp_f32 v141, v141
    v_exp_f32 v142, v142
    v_exp_f32 v143, v143
    v_cvt_pk_bf16_f32 v220, v136, v137
    v_cvt_pk_bf16_f32 v221, v138, v139
    v_cvt_pk_bf16_f32 v222, v140, v141
    v_cvt_pk_bf16_f32 v223, v142, v143
    v_mfma_f32_32x32x16_bf16 v[128:143], a[20:23], a[112:115], 0
    v_exp_f32 v144, v144
    v_exp_f32 v145, v145
    v_exp_f32 v146, v146
    v_mfma_f32_32x32x16_bf16 v[176:191], a[220:223], v[220:223], v[176:191]
    v_exp_f32 v147, v147
    v_exp_f32 v148, v148
    v_exp_f32 v149, v149
    v_mfma_f32_32x32x16_bf16 v[128:143], a[84:87], a[120:123], v[128:143]
    v_exp_f32 v150, v150
    v_exp_f32 v151, v151
    v_cvt_pk_bf16_f32 v192, v144, v145
    v_cvt_pk_bf16_f32 v193, v146, v147
    v_cvt_pk_bf16_f32 v194, v148, v149
    v_cvt_pk_bf16_f32 v195, v150, v151
    v_exp_f32 v152, v152
    s_nop 0
    v_mfma_f32_32x32x16_bf16 v[176:191], a[208:211], v[192:195], v[176:191]
    v_exp_f32 v153, v153
    v_exp_f32 v154, v154
    v_exp_f32 v155, v155
    v_exp_f32 v156, v156
    v_exp_f32 v157, v157
    v_exp_f32 v158, v158
    v_exp_f32 v159, v159
    v_cvt_pk_bf16_f32 v196, v152, v153
    v_cvt_pk_bf16_f32 v197, v154, v155
    v_cvt_pk_bf16_f32 v198, v156, v157
    v_cvt_pk_bf16_f32 v199, v158, v159
    v_mfma_f32_32x32x16_bf16 v[144:159], a[16:19], a[112:115], 0
    v_exp_f32 v160, v160
    v_exp_f32 v161, v161
    v_exp_f32 v162, v162
    v_mfma_f32_32x32x16_bf16 v[176:191], a[212:215], v[196:199], v[176:191]
    v_exp_f32 v163, v163
    v_exp_f32 v164, v164
    v_exp_f32 v165, v165
    v_mfma_f32_32x32x16_bf16 v[144:159], a[80:83], a[120:123], v[144:159]
    v_exp_f32 v166, v166
    v_exp_f32 v167, v167
    v_cvt_pk_bf16_f32 v200, v160, v161
    v_cvt_pk_bf16_f32 v201, v162, v163
    v_cvt_pk_bf16_f32 v202, v164, v165
    v_cvt_pk_bf16_f32 v203, v166, v167
    v_exp_f32 v168, v168
    s_nop 0
    v_mfma_f32_32x32x16_bf16 v[176:191], a[200:203], v[200:203], v[176:191]
    v_exp_f32 v169, v169
    v_exp_f32 v170, v170
    v_exp_f32 v171, v171
    v_exp_f32 v172, v172
    v_exp_f32 v173, v173
    v_exp_f32 v174, v174
    v_exp_f32 v175, v175
    v_cvt_pk_bf16_f32 v204, v168, v169
    v_cvt_pk_bf16_f32 v205, v170, v171
    v_cvt_pk_bf16_f32 v206, v172, v173
    v_cvt_pk_bf16_f32 v207, v174, v175
    v_mfma_f32_32x32x16_bf16 v[160:175], a[12:15], a[112:115], 0
    v_exp_f32 v16, v16
    v_exp_f32 v17, v17
    v_exp_f32 v18, v18
    v_mfma_f32_32x32x16_bf16 v[176:191], a[204:207], v[204:207], v[176:191]
    v_exp_f32 v19, v19
    v_exp_f32 v20, v20
    v_exp_f32 v21, v21
    v_mfma_f32_32x32x16_bf16 v[160:175], a[76:79], a[120:123], v[160:175]
    v_exp_f32 v22, v22
    v_exp_f32 v23, v23
    v_exp_f32 v24, v24
    v_exp_f32 v25, v25
    v_exp_f32 v26, v26
    v_exp_f32 v27, v27
    v_exp_f32 v28, v28
    v_exp_f32 v29, v29
    v_exp_f32 v30, v30
    v_exp_f32 v31, v31
    v_cndmask_b32 v80, v80, v64, s[40:41]
    v_cndmask_b32 v81, v81, v65, s[42:43]
    v_cndmask_b32 v82, v82, v66, s[44:45]
    v_cndmask_b32 v83, v83, v67, s[46:47]
    v_cvt_pk_bf16_f32 v208, v16, v17
    v_cvt_pk_bf16_f32 v209, v18, v19
    v_cvt_pk_bf16_f32 v210, v20, v21
    v_cvt_pk_bf16_f32 v211, v22, v23
    v_cvt_pk_bf16_f32 v212, v24, v25
    v_cvt_pk_bf16_f32 v213, v26, v27
    v_mfma_f32_32x32x16_bf16 v[176:191], a[192:195], v[208:211], v[176:191]
    v_cvt_pk_bf16_f32 v214, v28, v29
    v_cvt_pk_bf16_f32 v215, v30, v31
    v_cndmask_b32 v84, v84, v68, s[48:49]
    v_cndmask_b32 v85, v85, v69, s[50:51]
    v_cndmask_b32 v86, v86, v70, s[52:53]
    v_cndmask_b32 v87, v87, v71, s[54:55]
    v_mfma_f32_32x32x16_bf16 v[16:31], a[8:11], a[112:115], 0
    v_max_f32 v240, v80, v81
    v_max_f32 v241, v82, v83
    v_exp_f32 v32, v32
    v_exp_f32 v33, v33
    v_mfma_f32_32x32x16_bf16 v[16:31], a[72:75], a[120:123], v[16:31]
    v_exp_f32 v34, v34
    v_exp_f32 v35, v35
    v_exp_f32 v36, v36
    v_mfma_f32_32x32x16_bf16 v[176:191], a[196:199], v[212:215], v[176:191]
    v_exp_f32 v37, v37
    v_exp_f32 v38, v38
    v_exp_f32 v39, v39
    v_exp_f32 v40, v40
    v_exp_f32 v41, v41
    v_exp_f32 v42, v42
    v_exp_f32 v43, v43
    v_exp_f32 v44, v44
    v_exp_f32 v45, v45
    v_exp_f32 v46, v46
    v_exp_f32 v47, v47
    v_cndmask_b32 v88, v88, v72, s[56:57]
    v_cndmask_b32 v89, v89, v73, s[58:59]
    v_cndmask_b32 v90, v90, v74, s[60:61]
    v_cndmask_b32 v91, v91, v75, s[62:63]
    v_max3_f32 v240, v84, v85, v240
    v_max3_f32 v241, v86, v87, v241
    v_cndmask_b32 v92, v92, v76, s[64:65]
    v_cndmask_b32 v93, v93, v77, s[66:67]
    v_cndmask_b32 v94, v94, v78, s[68:69]
    v_cndmask_b32 v95, v95, v79, s[70:71]
    v_max3_f32 v240, v88, v89, v240
    v_max3_f32 v241, v90, v91, v241
    v_max3_f32 v240, v92, v93, v240
    v_max3_f32 v241, v94, v95, v241
    v_cvt_pk_bf16_f32 v216, v32, v33
    v_cvt_pk_bf16_f32 v217, v34, v35
    v_cvt_pk_bf16_f32 v218, v36, v37
    v_cvt_pk_bf16_f32 v219, v38, v39
    v_cvt_pk_bf16_f32 v220, v40, v41
    v_cvt_pk_bf16_f32 v221, v42, v43
    v_mfma_f32_32x32x16_bf16 v[176:191], a[184:187], v[216:219], v[176:191]
    v_cvt_pk_bf16_f32 v222, v44, v45
    v_cvt_pk_bf16_f32 v223, v46, v47
    v_max3_f32 v240, v96, v97, v240
    v_max3_f32 v241, v98, v99, v241
    v_max3_f32 v240, v100, v101, v240
    v_max3_f32 v241, v102, v103, v241
    v_mfma_f32_32x32x16_bf16 v[32:47], a[4:7], a[112:115], 0
    v_max3_f32 v240, v104, v105, v240
    v_max3_f32 v241, v106, v107, v241
    v_max3_f32 v240, v108, v109, v240
    v_max3_f32 v241, v110, v111, v241
    v_max3_f32 v240, v112, v113, v240
    v_max3_f32 v241, v114, v115, v241
    v_mfma_f32_32x32x16_bf16 v[32:47], a[68:71], a[120:123], v[32:47]
    v_max3_f32 v240, v116, v117, v240
    v_max3_f32 v241, v118, v119, v241
    v_max3_f32 v240, v120, v121, v240
    v_max3_f32 v241, v122, v123, v241
    v_max3_f32 v240, v124, v125, v240
    v_max3_f32 v241, v126, v127, v241
    v_mfma_f32_32x32x16_bf16 v[176:191], a[188:191], v[220:223], v[176:191]
    v_max3_f32 v240, v128, v129, v240
    v_max3_f32 v241, v130, v131, v241
    v_max3_f32 v240, v132, v133, v240
    v_max3_f32 v241, v134, v135, v241
    v_max3_f32 v240, v136, v137, v240
    v_max3_f32 v241, v138, v139, v241
    v_max3_f32 v240, v140, v141, v240
    v_max3_f32 v241, v142, v143, v241
    v_max3_f32 v240, v144, v145, v240
    v_max3_f32 v241, v146, v147, v241
    v_max3_f32 v240, v148, v149, v240
    v_max3_f32 v241, v150, v151, v241
    v_max3_f32 v240, v152, v153, v240
    v_max3_f32 v241, v154, v155, v241
    v_max3_f32 v240, v156, v157, v240
    v_max3_f32 v241, v158, v159, v241
    v_max3_f32 v240, v160, v161, v240
    v_max3_f32 v241, v162, v163, v241
    v_max3_f32 v240, v164, v165, v240
    v_max3_f32 v241, v166, v167, v241
    v_max3_f32 v240, v168, v169, v240
    v_max3_f32 v241, v170, v171, v241
    v_max3_f32 v240, v172, v173, v240
    v_max3_f32 v241, v174, v175, v241
    v_max3_f32 v240, v16, v17, v240
    v_max3_f32 v241, v18, v19, v241
    v_max3_f32 v240, v20, v21, v240
    v_max3_f32 v241, v22, v23, v241
    v_max3_f32 v240, v24, v25, v240
    v_max3_f32 v241, v26, v27, v241
    v_max3_f32 v240, v28, v29, v240
    v_max3_f32 v241, v30, v31, v241
    v_max3_f32 v240, v32, v33, v240
    v_max3_f32 v241, v34, v35, v241
    v_max3_f32 v240, v36, v37, v240
    v_max3_f32 v241, v38, v39, v241
    v_exp_f32 v48, v48
    v_exp_f32 v49, v49
    v_exp_f32 v50, v50
    v_exp_f32 v51, v51
    v_exp_f32 v52, v52
    v_exp_f32 v53, v53
    v_exp_f32 v54, v54
    v_exp_f32 v55, v55
    v_max3_f32 v240, v40, v41, v240
    v_max3_f32 v241, v42, v43, v241
    v_max3_f32 v240, v44, v45, v240
    v_max3_f32 v241, v46, v47, v241
    v_max_f32 v240, v240, v241
    v_cvt_pk_bf16_f32 v192, v48, v49
    v_cvt_pk_bf16_f32 v193, v50, v51
    v_cvt_pk_bf16_f32 v194, v52, v53
    v_cvt_pk_bf16_f32 v195, v54, v55
    v_mov_b32 v241, v240
    s_nop 1
    v_permlane32_swap_b32 v240, v241
    v_mfma_f32_32x32x16_bf16 v[176:191], a[176:179], v[192:195], v[176:191]
    v_max_f32 v240, v240, v241
    v_cvt_pk_bf16_f32 v244, v240, v240
    v_and_b32 v244, 0xffff0000, v244
    v_exp_f32 v56, v56
    v_exp_f32 v57, v57
    v_exp_f32 v58, v58
    v_exp_f32 v59, v59
    v_exp_f32 v60, v60
    v_exp_f32 v61, v61
    v_exp_f32 v62, v62
    v_exp_f32 v63, v63
    v_sub_f32 v241, v244, v240
    v_cvt_pk_bf16_f32 v224, -v244, v241
    v_cvt_pk_bf16_f32 v196, v56, v57
    v_cvt_pk_bf16_f32 v197, v58, v59
    v_mfma_f32_32x32x16_bf16 v[80:95], v[228:231], v[224:227], v[80:95]
    v_cvt_pk_bf16_f32 v198, v60, v61
    v_cvt_pk_bf16_f32 v199, v62, v63
    s_nop 1
    v_mfma_f32_32x32x16_bf16 v[176:191], a[180:183], v[196:199], v[176:191]
    s_nop 6
    v_exp_f32 v80, v80
    v_mfma_f32_32x32x16_bf16 v[96:111], v[228:231], v[224:227], v[96:111]
    v_exp_f32 v81, v81
    v_exp_f32 v82, v82
    v_exp_f32 v83, v83
    v_mfma_f32_32x32x16_bf16 v[112:127], v[228:231], v[224:227], v[112:127]
    v_exp_f32 v84, v84
    v_exp_f32 v85, v85
    v_exp_f32 v86, v86
    v_mfma_f32_32x32x16_bf16 v[128:143], v[228:231], v[224:227], v[128:143]
    v_exp_f32 v87, v87
    v_rcp_f32 v246, v186
    v_cvt_pk_bf16_f32 v200, v80, v81
    v_cvt_pk_bf16_f32 v201, v82, v83
    v_mfma_f32_32x32x16_bf16 v[144:159], v[228:231], v[224:227], v[144:159]
    v_cvt_pk_bf16_f32 v202, v84, v85
    v_cvt_pk_bf16_f32 v203, v86, v87
    v_and_b32 v208, v200, v232
    v_and_b32 v209, v201, v233
    v_and_b32 v210, v202, v234
    v_and_b32 v211, v203, v235
    v_mfma_f32_32x32x16_bf16 v[160:175], v[228:231], v[224:227], v[160:175]
    v_mul_f32 v176, v176, v246
    v_mul_f32 v177, v177, v246
    v_mul_f32 v178, v178, v246
    v_mul_f32 v179, v179, v246
    v_mul_f32 v180, v180, v246
    v_mul_f32 v181, v181, v246
    v_mfma_f32_32x32x16_bf16 v[16:31], v[228:231], v[224:227], v[16:31]
    v_mul_f32 v182, v182, v246
    v_mul_f32 v183, v183, v246
    v_mul_f32 v184, v184, v246
    v_mul_f32 v185, v185, v246
    v_cvt_pk_bf16_f32 v248, v176, v177
    v_cvt_pk_bf16_f32 v249, v178, v179
    v_mfma_f32_32x32x16_bf16 v[32:47], v[228:231], v[224:227], v[32:47]
    v_cvt_pk_bf16_f32 v250, v180, v181
    v_cvt_pk_bf16_f32 v251, v182, v183
    v_cvt_pk_bf16_f32 v252, v184, v185
    v_exp_f32 v88, v88
    v_exp_f32 v89, v89
    s_waitcnt vmcnt(4)
    v_mfma_f32_32x32x16_bf16 v[176:191], a[160:163], v[208:211], 0
    buffer_store_dwordx4 v[248:251], v4, s[24:27], s20 offen sc0 sc1
    buffer_store_dword v252, v7, s[24:27], s21 offen sc0 sc1
    v_exp_f32 v90, v90
    v_exp_f32 v91, v91
    v_exp_f32 v92, v92
    v_exp_f32 v93, v93
    v_exp_f32 v94, v94
    v_exp_f32 v95, v95
    v_cvt_pk_bf16_f32 v204, v88, v89
    v_cvt_pk_bf16_f32 v205, v90, v91
    v_cvt_pk_bf16_f32 v206, v92, v93
    v_cvt_pk_bf16_f32 v207, v94, v95
    v_and_b32 v212, v204, v236
    v_and_b32 v213, v205, v237
    v_and_b32 v214, v206, v238
    v_and_b32 v215, v207, v239
    v_xor_b32 v200, v200, v208
    v_xor_b32 v201, v201, v209
    v_mfma_f32_32x32x16_bf16 v[176:191], a[164:167], v[212:215], v[176:191]
    v_xor_b32 v202, v202, v210
    v_xor_b32 v203, v203, v211
    v_xor_b32 v204, v204, v212
    v_xor_b32 v205, v205, v213
    v_xor_b32 v206, v206, v214
    v_xor_b32 v207, v207, v215
    v_mfma_f32_32x32x16_bf16 v[176:191], a[224:227], v[200:203], v[176:191]
    v_exp_f32 v96, v96
    v_exp_f32 v97, v97
    v_exp_f32 v98, v98
    v_mfma_f32_32x32x16_bf16 v[176:191], a[228:231], v[204:207], v[176:191]
    v_exp_f32 v99, v99
    v_exp_f32 v100, v100
    v_exp_f32 v101, v101
    v_exp_f32 v102, v102
    v_exp_f32 v103, v103
    v_cvt_pk_bf16_f32 v216, v96, v97
    v_cvt_pk_bf16_f32 v217, v98, v99
    v_cvt_pk_bf16_f32 v218, v100, v101
    v_cvt_pk_bf16_f32 v219, v102, v103
    v_exp_f32 v104, v104
    s_nop 0
    v_mfma_f32_32x32x16_bf16 v[176:191], a[216:219], v[216:219], v[176:191]
    v_exp_f32 v105, v105
    v_exp_f32 v106, v106
    v_exp_f32 v107, v107
    v_exp_f32 v108, v108
    v_exp_f32 v109, v109
    v_exp_f32 v110, v110
    v_exp_f32 v111, v111
    v_cvt_pk_bf16_f32 v220, v104, v105
    v_cvt_pk_bf16_f32 v221, v106, v107
    v_cvt_pk_bf16_f32 v222, v108, v109
    v_cvt_pk_bf16_f32 v223, v110, v111
    v_exp_f32 v112, v112
    s_nop 0
    v_mfma_f32_32x32x16_bf16 v[176:191], a[220:223], v[220:223], v[176:191]
    v_exp_f32 v113, v113
    v_exp_f32 v114, v114
    v_exp_f32 v115, v115
    v_exp_f32 v116, v116
    v_exp_f32 v117, v117
    v_exp_f32 v118, v118
    v_exp_f32 v119, v119
    v_cvt_pk_bf16_f32 v192, v112, v113
    v_cvt_pk_bf16_f32 v193, v114, v115
    v_cvt_pk_bf16_f32 v194, v116, v117
    v_cvt_pk_bf16_f32 v195, v118, v119
    v_exp_f32 v120, v120
    s_nop 0
    v_mfma_f32_32x32x16_bf16 v[176:191], a[208:211], v[192:195], v[176:191]
    v_exp_f32 v121, v121
    v_exp_f32 v122, v122
    v_exp_f32 v123, v123
    v_exp_f32 v124, v124
    v_exp_f32 v125, v125
    v_exp_f32 v126, v126
    v_exp_f32 v127, v127
    v_cvt_pk_bf16_f32 v196, v120, v121
    v_cvt_pk_bf16_f32 v197, v122, v123
    v_cvt_pk_bf16_f32 v198, v124, v125
    v_cvt_pk_bf16_f32 v199, v126, v127
    v_exp_f32 v128, v128
    s_nop 0
    v_mfma_f32_32x32x16_bf16 v[176:191], a[212:215], v[196:199], v[176:191]
    v_exp_f32 v129, v129
    v_exp_f32 v130, v130
    v_exp_f32 v131, v131
    v_exp_f32 v132, v132
    v_exp_f32 v133, v133
    v_exp_f32 v134, v134
    v_exp_f32 v135, v135
    v_cvt_pk_bf16_f32 v208, v128, v129
    v_cvt_pk_bf16_f32 v209, v130, v131
    v_cvt_pk_bf16_f32 v210, v132, v133
    v_cvt_pk_bf16_f32 v211, v134, v135
    v_exp_f32 v136, v136
    s_nop 0
    v_mfma_f32_32x32x16_bf16 v[176:191], a[200:203], v[208:211], v[176:191]
    v_exp_f32 v137, v137
    v_exp_f32 v138, v138
    v_exp_f32 v139, v139
    v_exp_f32 v140, v140
    v_exp_f32 v141, v141
    v_exp_f32 v142, v142
    v_exp_f32 v143, v143
    v_cvt_pk_bf16_f32 v212, v136, v137
    v_cvt_pk_bf16_f32 v213, v138, v139
    v_cvt_pk_bf16_f32 v214, v140, v141
    v_cvt_pk_bf16_f32 v215, v142, v143
    v_exp_f32 v144, v144
    s_nop 0
    v_mfma_f32_32x32x16_bf16 v[176:191], a[204:207], v[212:215], v[176:191]
    v_exp_f32 v145, v145
    v_exp_f32 v146, v146
    v_exp_f32 v147, v147
    v_exp_f32 v148, v148
    v_exp_f32 v149, v149
    v_exp_f32 v150, v150
    v_exp_f32 v151, v151
    v_cvt_pk_bf16_f32 v200, v144, v145
    v_cvt_pk_bf16_f32 v201, v146, v147
    v_cvt_pk_bf16_f32 v202, v148, v149
    v_cvt_pk_bf16_f32 v203, v150, v151
    v_exp_f32 v152, v152
    s_nop 0
    v_mfma_f32_32x32x16_bf16 v[176:191], a[192:195], v[200:203], v[176:191]
    v_exp_f32 v153, v153
    v_exp_f32 v154, v154
    v_exp_f32 v155, v155
    v_exp_f32 v156, v156
    v_exp_f32 v157, v157
    v_exp_f32 v158, v158
    v_exp_f32 v159, v159
    v_cvt_pk_bf16_f32 v204, v152, v153
    v_cvt_pk_bf16_f32 v205, v154, v155
    v_cvt_pk_bf16_f32 v206, v156, v157
    v_cvt_pk_bf16_f32 v207, v158, v159
    v_exp_f32 v160, v160
    s_nop 0
    v_mfma_f32_32x32x16_bf16 v[176:191], a[196:199], v[204:207], v[176:191]
    v_exp_f32 v161, v161
    v_exp_f32 v162, v162
    v_exp_f32 v163, v163
    v_exp_f32 v164, v164
    v_exp_f32 v165, v165
    v_exp_f32 v166, v166
    v_exp_f32 v167, v167
    v_cvt_pk_bf16_f32 v216, v160, v161
    v_cvt_pk_bf16_f32 v217, v162, v163
    v_cvt_pk_bf16_f32 v218, v164, v165
    v_cvt_pk_bf16_f32 v219, v166, v167
    v_exp_f32 v168, v168
    s_nop 0
    v_mfma_f32_32x32x16_bf16 v[176:191], a[184:187], v[216:219], v[176:191]
    v_exp_f32 v169, v169
    v_exp_f32 v170, v170
    v_exp_f32 v171, v171
    v_exp_f32 v172, v172
    v_exp_f32 v173, v173
    v_exp_f32 v174, v174
    v_exp_f32 v175, v175
    v_cvt_pk_bf16_f32 v220, v168, v169
    v_cvt_pk_bf16_f32 v221, v170, v171
    v_cvt_pk_bf16_f32 v222, v172, v173
    v_cvt_pk_bf16_f32 v223, v174, v175
    v_exp_f32 v16, v16
    s_nop 0
    v_mfma_f32_32x32x16_bf16 v[176:191], a[188:191], v[220:223], v[176:191]
    v_exp_f32 v17, v17
    v_exp_f32 v18, v18
    v_exp_f32 v19, v19
    v_exp_f32 v20, v20
    v_exp_f32 v21, v21
    v_exp_f32 v22, v22
    v_exp_f32 v23, v23
    v_cvt_pk_bf16_f32 v192, v16, v17
    v_cvt_pk_bf16_f32 v193, v18, v19
    v_cvt_pk_bf16_f32 v194, v20, v21
    v_cvt_pk_bf16_f32 v195, v22, v23
    v_exp_f32 v24, v24
    s_nop 0
    v_mfma_f32_32x32x16_bf16 v[176:191], a[176:179], v[192:195], v[176:191]
    v_exp_f32 v25, v25
    v_exp_f32 v26, v26
    v_exp_f32 v27, v27
    v_exp_f32 v28, v28
    v_exp_f32 v29, v29
    v_exp_f32 v30, v30
    v_exp_f32 v31, v31
    v_cvt_pk_bf16_f32 v196, v24, v25
    v_cvt_pk_bf16_f32 v197, v26, v27
    v_cvt_pk_bf16_f32 v198, v28, v29
    v_cvt_pk_bf16_f32 v199, v30, v31
    v_exp_f32 v32, v32
    s_nop 0
    v_mfma_f32_32x32x16_bf16 v[176:191], a[180:183], v[196:199], v[176:191]
    v_exp_f32 v33, v33
    v_exp_f32 v34, v34
    v_exp_f32 v35, v35
    v_exp_f32 v36, v36
    v_exp_f32 v37, v37
    v_exp_f32 v38, v38
    v_exp_f32 v39, v39
    v_cvt_pk_bf16_f32 v208, v32, v33
    v_cvt_pk_bf16_f32 v209, v34, v35
    v_cvt_pk_bf16_f32 v210, v36, v37
    v_cvt_pk_bf16_f32 v211, v38, v39
    v_exp_f32 v40, v40
    s_nop 0
    v_mfma_f32_32x32x16_bf16 v[176:191], a[168:171], v[208:211], v[176:191]
    v_exp_f32 v41, v41
    v_exp_f32 v42, v42
    v_exp_f32 v43, v43
    v_exp_f32 v44, v44
    v_exp_f32 v45, v45
    v_exp_f32 v46, v46
    v_exp_f32 v47, v47
    v_cvt_pk_bf16_f32 v212, v40, v41
    v_cvt_pk_bf16_f32 v213, v42, v43
    v_cvt_pk_bf16_f32 v214, v44, v45
    v_cvt_pk_bf16_f32 v215, v46, v47
    s_nop 1
    v_mfma_f32_32x32x16_bf16 v[176:191], a[172:175], v[212:215], v[176:191]
    s_nop 11
    v_rcp_f32 v246, v186
    s_nop 0
    v_mul_f32 v176, v176, v246
    v_mul_f32 v177, v177, v246
    v_mul_f32 v178, v178, v246
    v_mul_f32 v179, v179, v246
    v_mul_f32 v180, v180, v246
    v_mul_f32 v181, v181, v246
    v_mul_f32 v182, v182, v246
    v_mul_f32 v183, v183, v246
    v_mul_f32 v184, v184, v246
    v_mul_f32 v185, v185, v246
    v_cvt_pk_bf16_f32 v248, v176, v177
    v_cvt_pk_bf16_f32 v249, v178, v179
    v_cvt_pk_bf16_f32 v250, v180, v181
    v_cvt_pk_bf16_f32 v251, v182, v183
    v_cvt_pk_bf16_f32 v252, v184, v185
    buffer_store_dwordx4 v[248:251], v4, s[24:27], s22 offen sc0 sc1
    buffer_store_dword v252, v7, s[24:27], s23 offen sc0 sc1
    s_endpgm
F_ATT_FIRST:
    ds_read_b128 a[116:119], v1 offset:7168
    ds_read_b32 a124, v10 offset:7280
    ds_read_b128 a[12:15], v1 offset:39936
    ds_read_b32 a76, v11 offset:7280
    ds_read_b128 a[8:11], v1 offset:38912
    ds_read_b32 a72, v11 offset:6240
    ds_read_b128 a[4:7], v1 offset:37888
    ds_read_b32 a68, v11 offset:5200
    ds_read_b128 a[0:3], v1 offset:36864
    ds_read_b32 a64, v11 offset:4160
    ds_read_b128 a[44:47], v1 offset:35840
    ds_read_b32 a108, v11 offset:3120
    ds_read_b128 a[40:43], v1 offset:34816
    ds_read_b32 a104, v11 offset:2080
    ds_read_b128 a[36:39], v1 offset:33792
    ds_read_b32 a100, v11 offset:1040
    ds_read_b128 a[32:35], v1 offset:32768
    ds_read_b32 a96, v11 offset:0
    s_mov_b64 exec, s[78:79]
    ds_read_b128 a[184:187], v12 offset:32256
    ds_read_b128 a[188:191], v12 offset:34560
    s_mov_b64 exec, -1
    s_mov_b64 exec, s[78:79]
    ds_read_b128 a[176:179], v12 offset:27648
    ds_read_b128 a[180:183], v12 offset:29952
    s_mov_b64 exec, -1
    s_mov_b64 exec, s[78:79]
    ds_read_b128 a[168:171], v12 offset:23040
    ds_read_b128 a[172:175], v12 offset:25344
    s_mov_b64 exec, -1
    s_mov_b64 exec, s[78:79]
    ds_read_b128 a[160:163], v12 offset:18432
    ds_read_b128 a[164:167], v12 offset:20736
    s_mov_b64 exec, -1
    s_mov_b64 exec, s[78:79]
    ds_read_b128 a[248:251], v12 offset:13824
    ds_read_b128 a[252:255], v12 offset:16128
    s_mov_b64 exec, -1
    s_mov_b64 exec, s[78:79]
    ds_read_b128 a[240:243], v12 offset:9216
    ds_read_b128 a[244:247], v12 offset:11520
    s_mov_b64 exec, -1
    s_mov_b64 exec, s[78:79]
    ds_read_b128 a[232:235], v12 offset:4608
    ds_read_b128 a[236:239], v12 offset:6912
    s_mov_b64 exec, -1
    s_mov_b64 exec, s[78:79]
    ds_read_b128 a[224:227], v12 offset:0
    ds_read_b128 a[228:231], v12 offset:2304
    s_mov_b64 exec, -1
    ds_read_b128 a[112:115], v1 offset:6144
    ds_read_b32 a120, v10 offset:6240
    s_waitcnt lgkmcnt(15)
    v_mfma_f32_32x32x16_bf16 v[16:31], a[12:15], a[116:119], 0
    s_waitcnt lgkmcnt(15)
    v_mfma_f32_32x32x16_bf16 v[32:47], a[32:35], a[116:119], 0
    v_mfma_f32_32x32x16_bf16 v[16:31], a[76:79], a[124:127], v[16:31]
    s_add_u32 s16, s77, 552960
    s_add_u32 s17, s7, 552960
    s_add_u32 s18, s77, 516096
    s_add_u32 s19, s7, 516096
    s_waitcnt lgkmcnt(15)
    v_mfma_f32_32x32x16_bf16 v[48:63], a[36:39], a[116:119], 0
    s_add_u32 s20, s77, 479232
    s_add_u32 s21, s7, 479232
    s_add_u32 s22, s77, 442368
    s_add_u32 s23, s7, 442368
    v_mfma_f32_32x32x16_bf16 v[32:47], a[96:99], a[124:127], v[32:47]
    s_nop 0
    v_cndmask_b32 v16, v16, v13, s[40:41]
    v_cndmask_b32 v17, v17, v13, s[42:43]
    v_cndmask_b32 v18, v18, v13, s[44:45]
    v_cndmask_b32 v19, v19, v13, s[46:47]
    v_cndmask_b32 v20, v20, v13, s[48:49]
    v_cndmask_b32 v21, v21, v13, s[50:51]
    s_waitcnt lgkmcnt(15)
    v_mfma_f32_32x32x16_bf16 v[64:79], a[40:43], a[116:119], 0
    v_cndmask_b32 v22, v22, v13, s[52:53]
    v_cndmask_b32 v23, v23, v13, s[54:55]
    v_max_f32 v242, v16, v17
    v_max_f32 v243, v18, v19
    v_cndmask_b32 v24, v24, v13, s[56:57]
    v_cndmask_b32 v25, v25, v13, s[58:59]
    v_mfma_f32_32x32x16_bf16 v[48:63], a[100:103], a[124:127], v[48:63]
    v_cndmask_b32 v26, v26, v13, s[60:61]
    v_cndmask_b32 v27, v27, v13, s[62:63]
    v_max3_f32 v242, v20, v21, v242
    v_max3_f32 v243, v22, v23, v243
    v_cndmask_b32 v28, v28, v13, s[64:65]
    v_cndmask_b32 v29, v29, v13, s[66:67]
    s_waitcnt lgkmcnt(15)
    v_mfma_f32_32x32x16_bf16 v[80:95], a[44:47], a[116:119], 0
    v_cndmask_b32 v30, v30, v13, s[68:69]
    v_cndmask_b32 v31, v31, v13, s[70:71]
    v_max3_f32 v242, v24, v25, v242
    v_max3_f32 v243, v26, v27, v243
    v_max3_f32 v242, v28, v29, v242
    v_max3_f32 v243, v30, v31, v243
    v_mfma_f32_32x32x16_bf16 v[64:79], a[104:107], a[124:127], v[64:79]
    v_max3_f32 v242, v32, v33, v242
    v_max3_f32 v243, v34, v35, v243
    v_max3_f32 v242, v36, v37, v242
    v_max3_f32 v243, v38, v39, v243
    v_max3_f32 v242, v40, v41, v242
    v_max3_f32 v243, v42, v43, v243
    s_waitcnt lgkmcnt(15)
    v_mfma_f32_32x32x16_bf16 v[96:111], a[0:3], a[116:119], 0
    v_max3_f32 v242, v44, v45, v242
    v_max3_f32 v243, v46, v47, v243
    v_max3_f32 v242, v48, v49, v242
    v_max3_f32 v243, v50, v51, v243
    v_max3_f32 v242, v52, v53, v242
    v_max3_f32 v243, v54, v55, v243
    v_mfma_f32_32x32x16_bf16 v[80:95], a[108:111], a[124:127], v[80:95]
    v_max3_f32 v242, v56, v57, v242
    v_max3_f32 v243, v58, v59, v243
    v_max3_f32 v242, v60, v61, v242
    v_max3_f32 v243, v62, v63, v243
    v_max3_f32 v242, v64, v65, v242
    v_max3_f32 v243, v66, v67, v243
    s_waitcnt lgkmcnt(15)
    v_mfma_f32_32x32x16_bf16 v[112:127], a[4:7], a[116:119], 0
    v_max3_f32 v242, v68, v69, v242
    v_max3_f32 v243, v70, v71, v243
    v_max3_f32 v242, v72, v73, v242
    v_max3_f32 v243, v74, v75, v243
    v_max3_f32 v242, v76, v77, v242
    v_max3_f32 v243, v78, v79, v243
    v_mfma_f32_32x32x16_bf16 v[96:111], a[64:67], a[124:127], v[96:111]
    v_max3_f32 v242, v80, v81, v242
    v_max3_f32 v243, v82, v83, v243
    v_max3_f32 v242, v84, v85, v242
    v_max3_f32 v243, v86, v87, v243
    v_max3_f32 v242, v88, v89, v242
    v_max3_f32 v243, v90, v91, v243
    s_waitcnt lgkmcnt(15)
    v_mfma_f32_32x32x16_bf16 v[128:143], a[8:11], a[116:119], 0
    ds_read_b128 a[116:119], v1 offset:5120
    v_max3_f32 v242, v92, v93, v242
    v_max3_f32 v243, v94, v95, v243
    s_nop 0
    v_max3_f32 v242, v96, v97, v242
    v_mfma_f32_32x32x16_bf16 v[112:127], a[68:71], a[124:127], v[112:127]
    v_max3_f32 v243, v98, v99, v243
    v_max3_f32 v242, v100, v101, v242
    v_max3_f32 v243, v102, v103, v243
    v_max3_f32 v242, v104, v105, v242
    v_max3_f32 v243, v106, v107, v243
    v_max3_f32 v242, v108, v109, v242
    v_mfma_f32_32x32x16_bf16 v[128:143], a[72:75], a[124:127], v[128:143]
    ds_read_b32 a124, v10 offset:5200
    v_max3_f32 v243, v110, v111, v243
    s_nop 2
    v_max3_f32 v242, v112, v113, v242
    s_waitcnt lgkmcnt(2)
    v_mfma_f32_32x32x16_bf16 v[144:159], a[8:11], a[112:115], 0
    v_max3_f32 v243, v114, v115, v243
    v_max3_f32 v242, v116, v117, v242
    v_max3_f32 v243, v118, v119, v243
    v_max3_f32 v242, v120, v121, v242
    v_max3_f32 v243, v122, v123, v243
    v_max3_f32 v242, v124, v125, v242
    v_mfma_f32_32x32x16_bf16 v[160:175], a[32:35], a[112:115], 0
    v_max3_f32 v243, v126, v127, v243
    v_max3_f32 v242, v128, v129, v242
    v_max3_f32 v243, v130, v131, v243
    v_max3_f32 v242, v132, v133, v242
    v_max3_f32 v243, v134, v135, v243
    v_max3_f32 v242, v136, v137, v242
    v_mfma_f32_32x32x16_bf16 v[144:159], a[72:75], a[120:123], v[144:159]
    v_max3_f32 v243, v138, v139, v243
    v_max3_f32 v242, v140, v141, v242
    v_max3_f32 v243, v142, v143, v243
    v_max_f32 v242, v242, v243
    v_mov_b32 v243, v242
    s_nop 1
    v_permlane32_swap_b32 v242, v243
    v_mfma_f32_32x32x16_bf16 v[160:175], a[96:99], a[120:123], v[160:175]
    v_max_f32 v242, v242, v243
    v_cvt_pk_bf16_f32 v244, v242, v242
    v_and_b32 v244, 0xffff0000, v244
    v_sub_f32 v243, v244, v242
    v_cvt_pk_bf16_f32 v224, -v244, v243
    v_cndmask_b32 v144, v144, v13, s[40:41]
    v_cndmask_b32 v145, v145, v13, s[42:43]
    v_mfma_f32_32x32x16_bf16 v[16:31], v[228:231], v[224:227], v[16:31]
    v_cndmask_b32 v146, v146, v13, s[44:45]
    v_cndmask_b32 v147, v147, v13, s[46:47]
    v_cndmask_b32 v148, v148, v13, s[48:49]
    v_cndmask_b32 v149, v149, v13, s[50:51]
    v_cndmask_b32 v150, v150, v13, s[52:53]
    v_cndmask_b32 v151, v151, v13, s[54:55]
    v_mfma_f32_32x32x16_bf16 v[32:47], v[228:231], v[224:227], v[32:47]
    v_max_f32 v240, v144, v145
    v_max_f32 v241, v146, v147
    v_cndmask_b32 v152, v152, v13, s[56:57]
    v_cndmask_b32 v153, v153, v13, s[58:59]
    v_cndmask_b32 v154, v154, v13, s[60:61]
    v_exp_f32 v16, v16
    v_mfma_f32_32x32x16_bf16 v[48:63], v[228:231], v[224:227], v[48:63]
    v_exp_f32 v17, v17
    v_exp_f32 v18, v18
    v_exp_f32 v19, v19
    v_mfma_f32_32x32x16_bf16 v[64:79], v[228:231], v[224:227], v[64:79]
    v_exp_f32 v20, v20
    v_exp_f32 v21, v21
    v_exp_f32 v22, v22
    v_mfma_f32_32x32x16_bf16 v[80:95], v[228:231], v[224:227], v[80:95]
    v_exp_f32 v23, v23
    v_cvt_pk_bf16_f32 v192, v16, v17
    v_cvt_pk_bf16_f32 v193, v18, v19
    v_cvt_pk_bf16_f32 v194, v20, v21
    v_cvt_pk_bf16_f32 v195, v22, v23
    v_mfma_f32_32x32x16_bf16 v[96:111], v[228:231], v[224:227], v[96:111]
    v_exp_f32 v24, v24
    v_exp_f32 v25, v25
    v_exp_f32 v26, v26
    s_waitcnt lgkmcnt(15)
    v_mfma_f32_32x32x16_bf16 v[176:191], a[184:187], v[192:195], 0
    v_exp_f32 v27, v27
    v_exp_f32 v28, v28
    v_exp_f32 v29, v29
    v_mfma_f32_32x32x16_bf16 v[112:127], v[228:231], v[224:227], v[112:127]
    v_exp_f32 v30, v30
    v_exp_f32 v31, v31
    v_cvt_pk_bf16_f32 v196, v24, v25
    v_cvt_pk_bf16_f32 v197, v26, v27
    v_mfma_f32_32x32x16_bf16 v[128:143], v[228:231], v[224:227], v[128:143]
    v_cvt_pk_bf16_f32 v198, v28, v29
    v_cvt_pk_bf16_f32 v199, v30, v31
    v_exp_f32 v32, v32
    v_exp_f32 v33, v33
    v_mfma_f32_32x32x16_bf16 v[176:191], a[188:191], v[196:199], v[176:191]
    v_exp_f32 v34, v34
    v_exp_f32 v35, v35
    v_exp_f32 v36, v36
    v_mfma_f32_32x32x16_bf16 v[16:31], a[36:39], a[112:115], 0
    v_exp_f32 v37, v37
    v_exp_f32 v38, v38
    v_exp_f32 v39, v39
    v_mfma_f32_32x32x16_bf16 v[16:31], a[100:103], a[120:123], v[16:31]
    v_cvt_pk_bf16_f32 v200, v32, v33
    v_cvt_pk_bf16_f32 v201, v34, v35
    v_cvt_pk_bf16_f32 v202, v36, v37
    v_cvt_pk_bf16_f32 v203, v38, v39
    v_exp_f32 v40, v40
    s_waitcnt lgkmcnt(4)
    v_mfma_f32_32x32x16_bf16 v[176:191], a[224:227], v[200:203], v[176:191]
    v_exp_f32 v41, v41
    v_exp_f32 v42, v42
    v_exp_f32 v43, v43
    v_exp_f32 v44, v44
    v_exp_f32 v45, v45
    v_exp_f32 v46, v46
    v_exp_f32 v47, v47
    v_cvt_pk_bf16_f32 v204, v40, v41
    v_cvt_pk_bf16_f32 v205, v42, v43
    v_cvt_pk_bf16_f32 v206, v44, v45
    v_cvt_pk_bf16_f32 v207, v46, v47
    v_mfma_f32_32x32x16_bf16 v[32:47], a[40:43], a[112:115], 0
    v_exp_f32 v48, v48
    v_exp_f32 v49, v49
    v_exp_f32 v50, v50
    v_mfma_f32_32x32x16_bf16 v[176:191], a[228:231], v[204:207], v[176:191]
    v_exp_f32 v51, v51
    v_exp_f32 v52, v52
    v_exp_f32 v53, v53
    v_mfma_f32_32x32x16_bf16 v[32:47], a[104:107], a[120:123], v[32:47]
    v_exp_f32 v54, v54
    v_exp_f32 v55, v55
    v_cvt_pk_bf16_f32 v208, v48, v49
    v_cvt_pk_bf16_f32 v209, v50, v51
    v_cvt_pk_bf16_f32 v210, v52, v53
    v_cvt_pk_bf16_f32 v211, v54, v55
    v_exp_f32 v56, v56
    s_waitcnt lgkmcnt(6)
    v_mfma_f32_32x32x16_bf16 v[176:191], a[232:235], v[208:211], v[176:191]
    v_exp_f32 v57, v57
    v_exp_f32 v58, v58
    v_exp_f32 v59, v59
    v_exp_f32 v60, v60
    v_exp_f32 v61, v61
    v_exp_f32 v62, v62
    v_exp_f32 v63, v63
    v_cvt_pk_bf16_f32 v212, v56, v57
    v_cvt_pk_bf16_f32 v213, v58, v59
    v_cvt_pk_bf16_f32 v214, v60, v61
    v_cvt_pk_bf16_f32 v215, v62, v63
    v_mfma_f32_32x32x16_bf16 v[48:63], a[44:47], a[112:115], 0
    v_exp_f32 v64, v64
    v_exp_f32 v65, v65
    v_exp_f32 v66, v66
    v_mfma_f32_32x32x16_bf16 v[176:191], a[236:239], v[212:215], v[176:191]
    v_exp_f32 v67, v67
    v_exp_f32 v68, v68
    v_exp_f32 v69, v69
    v_mfma_f32_32x32x16_bf16 v[48:63], a[108:111], a[120:123], v[48:63]
    v_exp_f32 v70, v70
    v_exp_f32 v71, v71
    v_cvt_pk_bf16_f32 v216, v64, v65
    v_cvt_pk_bf16_f32 v217, v66, v67
    v_cvt_pk_bf16_f32 v218, v68, v69
    v_cvt_pk_bf16_f32 v219, v70, v71
    v_exp_f32 v72, v72
    s_waitcnt lgkmcnt(8)
    v_mfma_f32_32x32x16_bf16 v[176:191], a[240:243], v[216:219], v[176:191]
    v_exp_f32 v73, v73
    v_exp_f32 v74, v74
    v_exp_f32 v75, v75
    v_exp_f32 v76, v76
    v_exp_f32 v77, v77
    v_exp_f32 v78, v78
    v_exp_f32 v79, v79
    v_cvt_pk_bf16_f32 v220, v72, v73
    v_cvt_pk_bf16_f32 v221, v74, v75
    v_cvt_pk_bf16_f32 v222, v76, v77
    v_cvt_pk_bf16_f32 v223, v78, v79
    v_mfma_f32_32x32x16_bf16 v[64:79], a[0:3], a[112:115], 0
    v_exp_f32 v80, v80
    v_exp_f32 v81, v81
    v_exp_f32 v82, v82
    v_mfma_f32_32x32x16_bf16 v[176:191], a[244:247], v[220:223], v[176:191]
    v_exp_f32 v83, v83
    v_exp_f32 v84, v84
    v_exp_f32 v85, v85
    v_mfma_f32_32x32x16_bf16 v[64:79], a[64:67], a[120:123], v[64:79]
    v_exp_f32 v86, v86
    v_exp_f32 v87, v87
    v_cvt_pk_bf16_f32 v192, v80, v81
    v_cvt_pk_bf16_f32 v193, v82, v83
    v_cvt_pk_bf16_f32 v194, v84, v85
    v_cvt_pk_bf16_f32 v195, v86, v87
    v_exp_f32 v88, v88
    s_waitcnt lgkmcnt(10)
    v_mfma_f32_32x32x16_bf16 v[176:191], a[248:251], v[192:195], v[176:191]
    v_exp_f32 v89, v89
    v_exp_f32 v90, v90
    v_exp_f32 v91, v91
    v_exp_f32 v92, v92
    v_exp_f32 v93, v93
    v_exp_f32 v94, v94
    v_exp_f32 v95, v95
    v_cvt_pk_bf16_f32 v196, v88, v89
    v_cvt_pk_bf16_f32 v197, v90, v91
    v_cvt_pk_bf16_f32 v198, v92, v93
    v_cvt_pk_bf16_f32 v199, v94, v95
    v_mfma_f32_32x32x16_bf16 v[80:95], a[4:7], a[112:115], 0
    ds_read_b128 a[112:115], v1 offset:4096
    v_exp_f32 v96, v96
    v_exp_f32 v97, v97
    v_exp_f32 v98, v98
    v_mfma_f32_32x32x16_bf16 v[176:191], a[252:255], v[196:199], v[176:191]
    v_exp_f32 v99, v99
    v_exp_f32 v100, v100
    v_exp_f32 v101, v101
    v_mfma_f32_32x32x16_bf16 v[80:95], a[68:71], a[120:123], v[80:95]
    ds_read_b32 a120, v10 offset:4160
    v_exp_f32 v102, v102
    v_exp_f32 v103, v103
    v_cvt_pk_bf16_f32 v200, v96, v97
    v_cvt_pk_bf16_f32 v201, v98, v99
    v_cvt_pk_bf16_f32 v202, v100, v101
    v_cvt_pk_bf16_f32 v203, v102, v103
    v_exp_f32 v104, v104
    s_waitcnt lgkmcnt(14)
    v_mfma_f32_32x32x16_bf16 v[176:191], a[160:163], v[200:203], v[176:191]
    v_exp_f32 v105, v105
    v_exp_f32 v106, v106
    v_exp_f32 v107, v107
    v_exp_f32 v108, v108
    v_exp_f32 v109, v109
    v_exp_f32 v110, v110
    v_exp_f32 v111, v111
    v_cndmask_b32 v155, v155, v13, s[62:63]
    v_max3_f32 v240, v148, v149, v240
    v_max3_f32 v241, v150, v151, v241
    v_cndmask_b32 v156, v156, v13, s[64:65]
    v_cndmask_b32 v157, v157, v13, s[66:67]
    v_cndmask_b32 v158, v158, v13, s[68:69]
    v_cndmask_b32 v159, v159, v13, s[70:71]
    v_max3_f32 v240, v152, v153, v240
    v_max3_f32 v241, v154, v155, v241
    v_max3_f32 v240, v156, v157, v240
    v_max3_f32 v241, v158, v159, v241
    v_cvt_pk_bf16_f32 v204, v104, v105
    v_cvt_pk_bf16_f32 v205, v106, v107
    v_cvt_pk_bf16_f32 v206, v108, v109
    v_cvt_pk_bf16_f32 v207, v110, v111
    s_waitcnt lgkmcnt(2)
    v_mfma_f32_32x32x16_bf16 v[96:111], a[4:7], a[116:119], 0
    v_max3_f32 v240, v160, v161, v240
    v_max3_f32 v241, v162, v163, v241
    v_max3_f32 v240, v164, v165, v240
    v_max3_f32 v241, v166, v167, v241
    v_max3_f32 v240, v168, v169, v240
    v_max3_f32 v241, v170, v171, v241
    v_mfma_f32_32x32x16_bf16 v[176:191], a[164:167], v[204:207], v[176:191]
    v_max3_f32 v240, v172, v173, v240
    v_max3_f32 v241, v174, v175, v241
    v_max3_f32 v240, v16, v17, v240
    v_max3_f32 v241, v18, v19, v241
    v_exp_f32 v112, v112
    v_mfma_f32_32x32x16_bf16 v[96:111], a[68:71], a[124:127], v[96:111]
    v_exp_f32 v113, v113
    v_exp_f32 v114, v114
    v_exp_f32 v115, v115
    v_exp_f32 v116, v116
    v_exp_f32 v117, v117
    v_exp_f32 v118, v118
    v_exp_f32 v119, v119
    v_max3_f32 v240, v20, v21, v240
    v_max3_f32 v241, v22, v23, v241
    v_max3_f32 v240, v24, v25, v240
    v_max3_f32 v241, v26, v27, v241
    v_max3_f32 v240, v28, v29, v240
    v_max3_f32 v241, v30, v31, v241
    v_cvt_pk_bf16_f32 v208, v112, v113
    v_cvt_pk_bf16_f32 v209, v114, v115
    v_cvt_pk_bf16_f32 v210, v116, v117
    v_cvt_pk_bf16_f32 v211, v118, v119
    v_max3_f32 v240, v32, v33, v240
    v_max3_f32 v241, v34, v35, v241
    s_waitcnt lgkmcnt(15)
    v_mfma_f32_32x32x16_bf16 v[176:191], a[168:171], v[208:211], v[176:191]
    v_max3_f32 v240, v36, v37, v240
    v_max3_f32 v241, v38, v39, v241
    v_max3_f32 v240, v40, v41, v240
    v_max3_f32 v241, v42, v43, v241
    v_max3_f32 v240, v44, v45, v240
    v_max3_f32 v241, v46, v47, v241
    v_max3_f32 v240, v48, v49, v240
    v_max3_f32 v241, v50, v51, v241
    v_exp_f32 v120, v120
    v_exp_f32 v121, v121
    v_exp_f32 v122, v122
    v_exp_f32 v123, v123
    v_exp_f32 v124, v124
    v_exp_f32 v125, v125
    v_exp_f32 v126, v126
    v_exp_f32 v127, v127
    v_max3_f32 v240, v52, v53, v240
    v_max3_f32 v241, v54, v55, v241
    v_max3_f32 v240, v56, v57, v240
    v_max3_f32 v241, v58, v59, v241
    v_max3_f32 v240, v60, v61, v240
    v_max3_f32 v241, v62, v63, v241
    v_cvt_pk_bf16_f32 v212, v120, v121
    v_cvt_pk_bf16_f32 v213, v122, v123
    v_cvt_pk_bf16_f32 v214, v124, v125
    v_cvt_pk_bf16_f32 v215, v126, v127
    v_mfma_f32_32x32x16_bf16 v[112:127], a[32:35], a[116:119], 0
    v_max3_f32 v240, v64, v65, v240
    v_max3_f32 v241, v66, v67, v241
    v_max3_f32 v240, v68, v69, v240
    v_max3_f32 v241, v70, v71, v241
    v_max3_f32 v240, v72, v73, v240
    v_max3_f32 v241, v74, v75, v241
    v_mfma_f32_32x32x16_bf16 v[176:191], a[172:175], v[212:215], v[176:191]
    v_max3_f32 v240, v76, v77, v240
    v_max3_f32 v241, v78, v79, v241
    v_max3_f32 v240, v80, v81, v240
    v_max3_f32 v241, v82, v83, v241
    v_exp_f32 v128, v128
    v_mfma_f32_32x32x16_bf16 v[112:127], a[96:99], a[124:127], v[112:127]
    v_exp_f32 v129, v129
    v_exp_f32 v130, v130
    v_exp_f32 v131, v131
    v_exp_f32 v132, v132
    v_exp_f32 v133, v133
    v_exp_f32 v134, v134
    v_exp_f32 v135, v135
    v_max3_f32 v240, v84, v85, v240
    v_max3_f32 v241, v86, v87, v241
    v_max3_f32 v240, v88, v89, v240
    v_max3_f32 v241, v90, v91, v241
    v_max3_f32 v240, v92, v93, v240
    v_max3_f32 v241, v94, v95, v241
    v_cvt_pk_bf16_f32 v216, v128, v129
    v_cvt_pk_bf16_f32 v217, v130, v131
    v_cvt_pk_bf16_f32 v218, v132, v133
    v_cvt_pk_bf16_f32 v219, v134, v135
    v_max_f32 v240, v240, v241
    v_mov_b32 v241, v240
    s_waitcnt lgkmcnt(15)
    v_mfma_f32_32x32x16_bf16 v[176:191], a[176:179], v[216:219], v[176:191]
    v_permlane32_swap_b32 v240, v241
    v_max_f32 v240, v240, v241
    v_cvt_pk_bf16_f32 v244, v240, v240
    v_exp_f32 v136, v136
    v_exp_f32 v137, v137
    v_exp_f32 v138, v138
    v_exp_f32 v139, v139
    v_exp_f32 v140, v140
    v_exp_f32 v141, v141
    v_exp_f32 v142, v142
    v_exp_f32 v143, v143
    v_and_b32 v244, 0xffff0000, v244
    v_sub_f32 v241, v244, v240
    v_cvt_pk_bf16_f32 v224, -v244, v241
    v_cvt_pk_bf16_f32 v220, v136, v137
    v_cvt_pk_bf16_f32 v221, v138, v139
    v_mfma_f32_32x32x16_bf16 v[144:159], v[228:231], v[224:227], v[144:159]
    v_cvt_pk_bf16_f32 v222, v140, v141
    v_cvt_pk_bf16_f32 v223, v142, v143
    v_cndmask_b32 v96, v96, v13, s[40:41]
    v_cndmask_b32 v97, v97, v13, s[42:43]
    v_cndmask_b32 v98, v98, v13, s[44:45]
    v_cndmask_b32 v99, v99, v13, s[46:47]
    v_mfma_f32_32x32x16_bf16 v[176:191], a[180:183], v[220:223], v[176:191]
    v_cndmask_b32 v100, v100, v13, s[48:49]
    v_cndmask_b32 v101, v101, v13, s[50:51]
    v_cndmask_b32 v102, v102, v13, s[52:53]
    v_cndmask_b32 v103, v103, v13, s[54:55]
    v_max_f32 v242, v96, v97
    v_exp_f32 v144, v144
    v_mfma_f32_32x32x16_bf16 v[160:175], v[228:231], v[224:227], v[160:175]
    v_exp_f32 v145, v145
    v_exp_f32 v146, v146
    v_exp_f32 v147, v147
    v_mfma_f32_32x32x16_bf16 v[16:31], v[228:231], v[224:227], v[16:31]
    v_exp_f32 v148, v148
    v_exp_f32 v149, v149
    v_exp_f32 v150, v150
    v_mfma_f32_32x32x16_bf16 v[32:47], v[228:231], v[224:227], v[32:47]
    v_exp_f32 v151, v151
    v_rcp_f32 v246, v186
    v_cvt_pk_bf16_f32 v192, v144, v145
    v_cvt_pk_bf16_f32 v193, v146, v147
    v_mfma_f32_32x32x16_bf16 v[48:63], v[228:231], v[224:227], v[48:63]
    v_cvt_pk_bf16_f32 v194, v148, v149
    v_cvt_pk_bf16_f32 v195, v150, v151
    v_mul_f32 v176, v176, v246
    v_mul_f32 v177, v177, v246
    v_mul_f32 v178, v178, v246
    v_mul_f32 v179, v179, v246
    v_mfma_f32_32x32x16_bf16 v[128:143], a[36:39], a[116:119], 0
    v_mul_f32 v180, v180, v246
    v_mul_f32 v181, v181, v246
    v_mul_f32 v182, v182, v246
    v_mul_f32 v183, v183, v246
    v_mul_f32 v184, v184, v246
    v_mul_f32 v185, v185, v246
    v_mfma_f32_32x32x16_bf16 v[64:79], v[228:231], v[224:227], v[64:79]
    v_cvt_pk_bf16_f32 v248, v176, v177
    v_cvt_pk_bf16_f32 v249, v178, v179
    v_cvt_pk_bf16_f32 v250, v180, v181
    v_cvt_pk_bf16_f32 v251, v182, v183
    v_cvt_pk_bf16_f32 v252, v184, v185
    v_exp_f32 v152, v152
    v_mfma_f32_32x32x16_bf16 v[176:191], a[176:179], v[192:195], 0
    buffer_store_dwordx4 v[248:251], v4, s[24:27], s16 offen sc0 sc1
    buffer_store_dword v252, v7, s[24:27], s17 offen sc0 sc1
    v_exp_f32 v153, v153
    s_add_u32 s16, s77, 405504
    s_add_u32 s17, s7, 405504
    v_mfma_f32_32x32x16_bf16 v[128:143], a[100:103], a[124:127], v[128:143]
    v_exp_f32 v154, v154
    v_exp_f32 v155, v155
    v_exp_f32 v156, v156
    v_mfma_f32_32x32x16_bf16 v[80:95], v[228:231], v[224:227], v[80:95]
    v_exp_f32 v157, v157
    v_exp_f32 v158, v158
    v_exp_f32 v159, v159
    v_cvt_pk_bf16_f32 v196, v152, v153
    v_cvt_pk_bf16_f32 v197, v154, v155
    v_cvt_pk_bf16_f32 v198, v156, v157
    v_cvt_pk_bf16_f32 v199, v158, v159
    v_mfma_f32_32x32x16_bf16 v[144:159], a[40:43], a[116:119], 0
    v_exp_f32 v160, v160
    v_exp_f32 v161, v161
    v_exp_f32 v162, v162
    v_mfma_f32_32x32x16_bf16 v[176:191], a[180:183], v[196:199], v[176:191]
    v_exp_f32 v163, v163
    v_exp_f32 v164, v164
    v_exp_f32 v165, v165
    v_mfma_f32_32x32x16_bf16 v[144:159], a[104:107], a[124:127], v[144:159]
    v_exp_f32 v166, v166
    v_exp_f32 v167, v167
    v_cvt_pk_bf16_f32 v200, v160, v161
    v_cvt_pk_bf16_f32 v201, v162, v163
    v_cvt_pk_bf16_f32 v202, v164, v165
    v_cvt_pk_bf16_f32 v203, v166, v167
    v_exp_f32 v168, v168
    s_nop 0
    v_mfma_f32_32x32x16_bf16 v[176:191], a[224:227], v[200:203], v[176:191]
    v_exp_f32 v169, v169
    v_exp_f32 v170, v170
    v_exp_f32 v171, v171
    v_exp_f32 v172, v172
    v_exp_f32 v173, v173
    v_exp_f32 v174, v174
    v_exp_f32 v175, v175
    v_cvt_pk_bf16_f32 v204, v168, v169
    v_cvt_pk_bf16_f32 v205, v170, v171
    v_cvt_pk_bf16_f32 v206, v172, v173
    v_cvt_pk_bf16_f32 v207, v174, v175
    v_mfma_f32_32x32x16_bf16 v[160:175], a[44:47], a[116:119], 0
    v_exp_f32 v16, v16
    v_exp_f32 v17, v17
    v_exp_f32 v18, v18
    v_mfma_f32_32x32x16_bf16 v[176:191], a[228:231], v[204:207], v[176:191]
    v_exp_f32 v19, v19
    v_exp_f32 v20, v20
    v_exp_f32 v21, v21
    v_mfma_f32_32x32x16_bf16 v[160:175], a[108:111], a[124:127], v[160:175]
    v_exp_f32 v22, v22
    v_exp_f32 v23, v23
    v_cvt_pk_bf16_f32 v208, v16, v17
    v_cvt_pk_bf16_f32 v209, v18, v19
    v_cvt_pk_bf16_f32 v210, v20, v21
    v_cvt_pk_bf16_f32 v211, v22, v23
    v_exp_f32 v24, v24
    s_nop 0
    v_mfma_f32_32x32x16_bf16 v[176:191], a[232:235], v[208:211], v[176:191]
    v_exp_f32 v25, v25
    v_exp_f32 v26, v26
    v_exp_f32 v27, v27
    v_exp_f32 v28, v28
    v_exp_f32 v29, v29
    v_exp_f32 v30, v30
    v_exp_f32 v31, v31
    v_cvt_pk_bf16_f32 v212, v24, v25
    v_cvt_pk_bf16_f32 v213, v26, v27
    v_cvt_pk_bf16_f32 v214, v28, v29
    v_cvt_pk_bf16_f32 v215, v30, v31
    v_mfma_f32_32x32x16_bf16 v[16:31], a[0:3], a[116:119], 0
    ds_read_b128 a[116:119], v1 offset:3072
    v_exp_f32 v32, v32
    v_exp_f32 v33, v33
    v_exp_f32 v34, v34
    v_mfma_f32_32x32x16_bf16 v[176:191], a[236:239], v[212:215], v[176:191]
    v_exp_f32 v35, v35
    v_exp_f32 v36, v36
    v_exp_f32 v37, v37
    v_mfma_f32_32x32x16_bf16 v[16:31], a[64:67], a[124:127], v[16:31]
    ds_read_b32 a124, v10 offset:3120
    v_exp_f32 v38, v38
    v_exp_f32 v39, v39
    v_cvt_pk_bf16_f32 v216, v32, v33
    v_cvt_pk_bf16_f32 v217, v34, v35
    v_cvt_pk_bf16_f32 v218, v36, v37
    v_cvt_pk_bf16_f32 v219, v38, v39
    v_exp_f32 v40, v40
    s_nop 0
    v_mfma_f32_32x32x16_bf16 v[176:191], a[240:243], v[216:219], v[176:191]
    v_exp_f32 v41, v41
    v_exp_f32 v42, v42
    v_exp_f32 v43, v43
    v_exp_f32 v44, v44
    v_exp_f32 v45, v45
    v_exp_f32 v46, v46
    v_exp_f32 v47, v47
    v_cvt_pk_bf16_f32 v220, v40, v41
    v_cvt_pk_bf16_f32 v221, v42, v43
    v_cvt_pk_bf16_f32 v222, v44, v45
    v_cvt_pk_bf16_f32 v223, v46, v47
    s_waitcnt lgkmcnt(2)
    v_mfma_f32_32x32x16_bf16 v[32:47], a[0:3], a[112:115], 0
    v_exp_f32 v48, v48
    v_exp_f32 v49, v49
    v_exp_f32 v50, v50
    v_mfma_f32_32x32x16_bf16 v[176:191], a[244:247], v[220:223], v[176:191]
    v_exp_f32 v51, v51
    v_exp_f32 v52, v52
    v_exp_f32 v53, v53
    v_mfma_f32_32x32x16_bf16 v[32:47], a[64:67], a[120:123], v[32:47]
    v_exp_f32 v54, v54
    v_exp_f32 v55, v55
    v_cvt_pk_bf16_f32 v192, v48, v49
    v_cvt_pk_bf16_f32 v193, v50, v51
    v_cvt_pk_bf16_f32 v194, v52, v53
    v_cvt_pk_bf16_f32 v195, v54, v55
    v_exp_f32 v56, v56
    s_nop 0
    v_mfma_f32_32x32x16_bf16 v[176:191], a[248:251], v[192:195], v[176:191]
    v_exp_f32 v57, v57
    v_exp_f32 v58, v58
    v_exp_f32 v59, v59
    v_exp_f32 v60, v60
    v_exp_f32 v61, v61
    v_exp_f32 v62, v62
    v_exp_f32 v63, v63
    v_cvt_pk_bf16_f32 v196, v56, v57
    v_cvt_pk_bf16_f32 v197, v58, v59
    v_cvt_pk_bf16_f32 v198, v60, v61
    v_cvt_pk_bf16_f32 v199, v62, v63
    v_mfma_f32_32x32x16_bf16 v[48:63], a[32:35], a[112:115], 0
    v_max_f32 v243, v98, v99
    v_cndmask_b32 v104, v104, v13, s[56:57]
    v_cndmask_b32 v105, v105, v13, s[58:59]
    v_cndmask_b32 v106, v106, v13, s[60:61]
    v_cndmask_b32 v107, v107, v13, s[62:63]
    v_max3_f32 v242, v100, v101, v242
    v_mfma_f32_32x32x16_bf16 v[176:191], a[252:255], v[196:199], v[176:191]
    v_max3_f32 v243, v102, v103, v243
    v_cndmask_b32 v108, v108, v13, s[64:65]
    v_cndmask_b32 v109, v109, v13, s[66:67]
    v_cndmask_b32 v110, v110, v13, s[68:69]
    v_cndmask_b32 v111, v111, v13, s[70:71]
    v_max3_f32 v242, v104, v105, v242
    v_mfma_f32_32x32x16_bf16 v[48:63], a[96:99], a[120:123], v[48:63]
    v_max3_f32 v243, v106, v107, v243
    v_max3_f32 v242, v108, v109, v242
    v_max3_f32 v243, v110, v111, v243
    v_max3_f32 v242, v112, v113, v242
    v_max3_f32 v243, v114, v115, v243
    v_exp_f32 v64, v64
    v_exp_f32 v65, v65
    v_exp_f32 v66, v66
    v_exp_f32 v67, v67
    v_exp_f32 v68, v68
    v_exp_f32 v69, v69
    v_exp_f32 v70, v70
    v_exp_f32 v71, v71
    v_max3_f32 v242, v116, v117, v242
    v_max3_f32 v243, v118, v119, v243
    v_max3_f32 v242, v120, v121, v242
    v_max3_f32 v243, v122, v123, v243
    v_max3_f32 v242, v124, v125, v242
    v_max3_f32 v243, v126, v127, v243
    v_cvt_pk_bf16_f32 v200, v64, v65
    v_cvt_pk_bf16_f32 v201, v66, v67
    v_cvt_pk_bf16_f32 v202, v68, v69
    v_cvt_pk_bf16_f32 v203, v70, v71
    v_max3_f32 v242, v128, v129, v242
    v_max3_f32 v243, v130, v131, v243
    v_mfma_f32_32x32x16_bf16 v[176:191], a[160:163], v[200:203], v[176:191]
    v_max3_f32 v242, v132, v133, v242
    v_max3_f32 v243, v134, v135, v243
    v_max3_f32 v242, v136, v137, v242
    v_max3_f32 v243, v138, v139, v243
    v_max3_f32 v242, v140, v141, v242
    v_max3_f32 v243, v142, v143, v243
    v_max3_f32 v242, v144, v145, v242
    v_max3_f32 v243, v146, v147, v243
    v_exp_f32 v72, v72
    v_exp_f32 v73, v73
    v_exp_f32 v74, v74
    v_exp_f32 v75, v75
    v_exp_f32 v76, v76
    v_exp_f32 v77, v77
    v_exp_f32 v78, v78
    v_exp_f32 v79, v79
    v_max3_f32 v242, v148, v149, v242
    v_max3_f32 v243, v150, v151, v243
    v_max3_f32 v242, v152, v153, v242
    v_max3_f32 v243, v154, v155, v243
    v_max3_f32 v242, v156, v157, v242
    v_max3_f32 v243, v158, v159, v243
    v_cvt_pk_bf16_f32 v204, v72, v73
    v_cvt_pk_bf16_f32 v205, v74, v75
    v_cvt_pk_bf16_f32 v206, v76, v77
    v_cvt_pk_bf16_f32 v207, v78, v79
    v_mfma_f32_32x32x16_bf16 v[64:79], a[36:39], a[112:115], 0
    v_max3_f32 v242, v160, v161, v242
    v_max3_f32 v243, v162, v163, v243
    v_max3_f32 v242, v164, v165, v242
    v_max3_f32 v243, v166, v167, v243
    v_max3_f32 v242, v168, v169, v242
    v_max3_f32 v243, v170, v171, v243
    v_mfma_f32_32x32x16_bf16 v[176:191], a[164:167], v[204:207], v[176:191]
    v_max3_f32 v242, v172, v173, v242
    v_max3_f32 v243, v174, v175, v243
    v_max3_f32 v242, v16, v17, v242
    v_max3_f32 v243, v18, v19, v243
    v_exp_f32 v80, v80
    v_mfma_f32_32x32x16_bf16 v[64:79], a[100:103], a[120:123], v[64:79]
    v_exp_f32 v81, v81
    v_exp_f32 v82, v82
    v_exp_f32 v83, v83
    v_exp_f32 v84, v84
    v_exp_f32 v85, v85
    v_exp_f32 v86, v86
    v_exp_f32 v87, v87
    v_max3_f32 v242, v20, v21, v242
    v_max3_f32 v243, v22, v23, v243
    v_max3_f32 v242, v24, v25, v242
    v_max3_f32 v243, v26, v27, v243
    v_max3_f32 v242, v28, v29, v242
    v_max3_f32 v243, v30, v31, v243
    v_cvt_pk_bf16_f32 v208, v80, v81
    v_cvt_pk_bf16_f32 v209, v82, v83
    v_cvt_pk_bf16_f32 v210, v84, v85
    v_cvt_pk_bf16_f32 v211, v86, v87
    v_max_f32 v242, v242, v243
    v_mov_b32 v243, v242
    v_mfma_f32_32x32x16_bf16 v[176:191], a[168:171], v[208:211], v[176:191]
    s_nop 0
    v_permlane32_swap_b32 v242, v243
    v_max_f32 v242, v242, v243
    v_cvt_pk_bf16_f32 v244, v242, v242
    v_exp_f32 v88, v88
    v_exp_f32 v89, v89
    v_exp_f32 v90, v90
    v_exp_f32 v91, v91
    v_exp_f32 v92, v92
    v_exp_f32 v93, v93
    v_exp_f32 v94, v94
    v_exp_f32 v95, v95
    v_and_b32 v244, 0xffff0000, v244
    v_sub_f32 v243, v244, v242
    v_cvt_pk_bf16_f32 v224, -v244, v243
    v_cvt_pk_bf16_f32 v212, v88, v89
    v_cvt_pk_bf16_f32 v213, v90, v91
    v_mfma_f32_32x32x16_bf16 v[96:111], v[228:231], v[224:227], v[96:111]
    v_cvt_pk_bf16_f32 v214, v92, v93
    v_cvt_pk_bf16_f32 v215, v94, v95
    v_cndmask_b32 v32, v32, v13, s[40:41]
    v_cndmask_b32 v33, v33, v13, s[42:43]
    v_cndmask_b32 v34, v34, v13, s[44:45]
    v_cndmask_b32 v35, v35, v13, s[46:47]
    v_mfma_f32_32x32x16_bf16 v[176:191], a[172:175], v[212:215], v[176:191]
    v_cndmask_b32 v36, v36, v13, s[48:49]
    v_cndmask_b32 v37, v37, v13, s[50:51]
    v_cndmask_b32 v38, v38, v13, s[52:53]
    v_cndmask_b32 v39, v39, v13, s[54:55]
    v_max_f32 v240, v32, v33
    v_exp_f32 v96, v96
    v_mfma_f32_32x32x16_bf16 v[112:127], v[228:231], v[224:227], v[112:127]
    v_exp_f32 v97, v97
    v_exp_f32 v98, v98
    v_exp_f32 v99, v99
    v_mfma_f32_32x32x16_bf16 v[128:143], v[228:231], v[224:227], v[128:143]
    v_exp_f32 v100, v100
    v_exp_f32 v101, v101
    v_exp_f32 v102, v102
    v_mfma_f32_32x32x16_bf16 v[144:159], v[228:231], v[224:227], v[144:159]
    v_exp_f32 v103, v103
    v_rcp_f32 v246, v186
    v_cvt_pk_bf16_f32 v216, v96, v97
    v_cvt_pk_bf16_f32 v217, v98, v99
    v_mfma_f32_32x32x16_bf16 v[160:175], v[228:231], v[224:227], v[160:175]
    v_cvt_pk_bf16_f32 v218, v100, v101
    v_cvt_pk_bf16_f32 v219, v102, v103
    v_mul_f32 v176, v176, v246
    v_mul_f32 v177, v177, v246
    v_mul_f32 v178, v178, v246
    v_mul_f32 v179, v179, v246
    v_mfma_f32_32x32x16_bf16 v[80:95], a[40:43], a[112:115], 0
    v_mul_f32 v180, v180, v246
    v_mul_f32 v181, v181, v246
    v_mul_f32 v182, v182, v246
    v_mul_f32 v183, v183, v246
    v_mul_f32 v184, v184, v246
    v_mul_f32 v185, v185, v246
    v_mfma_f32_32x32x16_bf16 v[80:95], a[104:107], a[120:123], v[80:95]
    v_cvt_pk_bf16_f32 v248, v176, v177
    v_cvt_pk_bf16_f32 v249, v178, v179
    v_cvt_pk_bf16_f32 v250, v180, v181
    v_cvt_pk_bf16_f32 v251, v182, v183
    v_cvt_pk_bf16_f32 v252, v184, v185
    v_exp_f32 v104, v104
    v_mfma_f32_32x32x16_bf16 v[176:191], a[168:171], v[216:219], 0
    buffer_store_dwordx4 v[248:251], v4, s[24:27], s18 offen sc0 sc1
    buffer_store_dword v252, v7, s[24:27], s19 offen sc0 sc1
    v_exp_f32 v105, v105
    s_add_u32 s18, s77, 368640
    s_add_u32 s19, s7, 368640
    v_mfma_f32_32x32x16_bf16 v[16:31], v[228:231], v[224:227], v[16:31]
    v_exp_f32 v106, v106
    v_exp_f32 v107, v107
    v_exp_f32 v108, v108
    v_exp_f32 v109, v109
    v_exp_f32 v110, v110
    v_exp_f32 v111, v111
    v_cvt_pk_bf16_f32 v220, v104, v105
    v_cvt_pk_bf16_f32 v221, v106, v107
    v_cvt_pk_bf16_f32 v222, v108, v109
    v_cvt_pk_bf16_f32 v223, v110, v111
    v_mfma_f32_32x32x16_bf16 v[96:111], a[44:47], a[112:115], 0
    ds_read_b128 a[112:115], v1 offset:2048
    v_exp_f32 v112, v112
    v_exp_f32 v113, v113
    v_exp_f32 v114, v114
    v_mfma_f32_32x32x16_bf16 v[176:191], a[172:175], v[220:223], v[176:191]
    v_exp_f32 v115, v115
    v_exp_f32 v116, v116
    v_exp_f32 v117, v117
    v_mfma_f32_32x32x16_bf16 v[96:111], a[108:111], a[120:123], v[96:111]
    ds_read_b32 a120, v10 offset:2080
    v_exp_f32 v118, v118
    v_exp_f32 v119, v119
    v_cvt_pk_bf16_f32 v192, v112, v113
    v_cvt_pk_bf16_f32 v193, v114, v115
    v_cvt_pk_bf16_f32 v194, v116, v117
    v_cvt_pk_bf16_f32 v195, v118, v119
    v_exp_f32 v120, v120
    s_nop 0
    v_mfma_f32_32x32x16_bf16 v[176:191], a[224:227], v[192:195], v[176:191]
    v_exp_f32 v121, v121
    v_exp_f32 v122, v122
    v_exp_f32 v123, v123
    v_exp_f32 v124, v124
    v_exp_f32 v125, v125
    v_exp_f32 v126, v126
    v_exp_f32 v127, v127
    v_cvt_pk_bf16_f32 v196, v120, v121
    v_cvt_pk_bf16_f32 v197, v122, v123
    v_cvt_pk_bf16_f32 v198, v124, v125
    v_cvt_pk_bf16_f32 v199, v126, v127
    s_waitcnt lgkmcnt(2)
    v_mfma_f32_32x32x16_bf16 v[112:127], a[44:47], a[116:119], 0
    v_exp_f32 v128, v128
    v_exp_f32 v129, v129
    v_exp_f32 v130, v130
    v_mfma_f32_32x32x16_bf16 v[176:191], a[228:231], v[196:199], v[176:191]
    v_exp_f32 v131, v131
    v_exp_f32 v132, v132
    v_exp_f32 v133, v133
    v_mfma_f32_32x32x16_bf16 v[112:127], a[108:111], a[124:127], v[112:127]
    v_exp_f32 v134, v134
    v_exp_f32 v135, v135
    v_cvt_pk_bf16_f32 v200, v128, v129
    v_cvt_pk_bf16_f32 v201, v130, v131
    v_cvt_pk_bf16_f32 v202, v132, v133
    v_cvt_pk_bf16_f32 v203, v134, v135
    v_exp_f32 v136, v136
    s_nop 0
    v_mfma_f32_32x32x16_bf16 v[176:191], a[232:235], v[200:203], v[176:191]
    v_exp_f32 v137, v137
    v_exp_f32 v138, v138
    v_exp_f32 v139, v139
    v_exp_f32 v140, v140
    v_exp_f32 v141, v141
    v_exp_f32 v142, v142
    v_exp_f32 v143, v143
    v_cvt_pk_bf16_f32 v204, v136, v137
    v_cvt_pk_bf16_f32 v205, v138, v139
    v_cvt_pk_bf16_f32 v206, v140, v141
    v_cvt_pk_bf16_f32 v207, v142, v143
    v_mfma_f32_32x32x16_bf16 v[128:143], a[32:35], a[116:119], 0
    v_exp_f32 v144, v144
    v_exp_f32 v145, v145
    v_exp_f32 v146, v146
    v_mfma_f32_32x32x16_bf16 v[176:191], a[236:239], v[204:207], v[176:191]
    v_exp_f32 v147, v147
    v_exp_f32 v148, v148
    v_exp_f32 v149, v149
    v_mfma_f32_32x32x16_bf16 v[128:143], a[96:99], a[124:127], v[128:143]
    v_exp_f32 v150, v150
    v_exp_f32 v151, v151
    v_cvt_pk_bf16_f32 v208, v144, v145
    v_cvt_pk_bf16_f32 v209, v146, v147
    v_cvt_pk_bf16_f32 v210, v148, v149
    v_cvt_pk_bf16_f32 v211, v150, v151
    v_exp_f32 v152, v152
    s_nop 0
    v_mfma_f32_32x32x16_bf16 v[176:191], a[240:243], v[208:211], v[176:191]
    v_exp_f32 v153, v153
    v_exp_f32 v154, v154
    v_exp_f32 v155, v155
    v_exp_f32 v156, v156
    v_exp_f32 v157, v157
    v_exp_f32 v158, v158
    v_exp_f32 v159, v159
    v_cvt_pk_bf16_f32 v212, v152, v153
    v_cvt_pk_bf16_f32 v213, v154, v155
    v_cvt_pk_bf16_f32 v214, v156, v157
    v_cvt_pk_bf16_f32 v215, v158, v159
    v_mfma_f32_32x32x16_bf16 v[144:159], a[36:39], a[116:119], 0
    v_max_f32 v241, v34, v35
    v_exp_f32 v160, v160
    v_exp_f32 v161, v161
    v_exp_f32 v162, v162
    v_mfma_f32_32x32x16_bf16 v[176:191], a[244:247], v[212:215], v[176:191]
    v_exp_f32 v163, v163
    v_exp_f32 v164, v164
    v_exp_f32 v165, v165
    v_mfma_f32_32x32x16_bf16 v[144:159], a[100:103], a[124:127], v[144:159]
    v_exp_f32 v166, v166
    v_exp_f32 v167, v167
    v_cndmask_b32 v40, v40, v13, s[56:57]
    v_cndmask_b32 v41, v41, v13, s[58:59]
    v_cndmask_b32 v42, v42, v13, s[60:61]
    v_cndmask_b32 v43, v43, v13, s[62:63]
    v_max3_f32 v240, v36, v37, v240
    v_max3_f32 v241, v38, v39, v241
    v_cndmask_b32 v44, v44, v13, s[64:65]
    v_cndmask_b32 v45, v45, v13, s[66:67]
    v_cndmask_b32 v46, v46, v13, s[68:69]
    v_cndmask_b32 v47, v47, v13, s[70:71]
    v_max3_f32 v240, v40, v41, v240
    v_max3_f32 v241, v42, v43, v241
    v_max3_f32 v240, v44, v45, v240
    v_max3_f32 v241, v46, v47, v241
    v_cvt_pk_bf16_f32 v216, v160, v161
    v_cvt_pk_bf16_f32 v217, v162, v163
    v_cvt_pk_bf16_f32 v218, v164, v165
    v_cvt_pk_bf16_f32 v219, v166, v167
    v_max3_f32 v240, v48, v49, v240
    v_max3_f32 v241, v50, v51, v241
    v_mfma_f32_32x32x16_bf16 v[176:191], a[248:251], v[216:219], v[176:191]
    v_max3_f32 v240, v52, v53, v240
    v_max3_f32 v241, v54, v55, v241
    v_max3_f32 v240, v56, v57, v240
    v_max3_f32 v241, v58, v59, v241
    v_max3_f32 v240, v60, v61, v240
    v_max3_f32 v241, v62, v63, v241
    v_max3_f32 v240, v64, v65, v240
    v_max3_f32 v241, v66, v67, v241
    v_exp_f32 v168, v168
    v_exp_f32 v169, v169
    v_exp_f32 v170, v170
    v_exp_f32 v171, v171
    v_exp_f32 v172, v172
    v_exp_f32 v173, v173
    v_exp_f32 v174, v174
    v_exp_f32 v175, v175
    v_max3_f32 v240, v68, v69, v240
    v_max3_f32 v241, v70, v71, v241
    v_max3_f32 v240, v72, v73, v240
    v_max3_f32 v241, v74, v75, v241
    v_max3_f32 v240, v76, v77, v240
    v_max3_f32 v241, v78, v79, v241
    v_cvt_pk_bf16_f32 v220, v168, v169
    v_cvt_pk_bf16_f32 v221, v170, v171
    v_cvt_pk_bf16_f32 v222, v172, v173
    v_cvt_pk_bf16_f32 v223, v174, v175
    v_mfma_f32_32x32x16_bf16 v[160:175], a[40:43], a[116:119], 0
    ds_read_b128 a[116:119], v1 offset:1024
    v_max3_f32 v240, v80, v81, v240
    v_max3_f32 v241, v82, v83, v241
    v_max3_f32 v240, v84, v85, v240
    v_max3_f32 v241, v86, v87, v241
    v_max3_f32 v240, v88, v89, v240
    v_mfma_f32_32x32x16_bf16 v[176:191], a[252:255], v[220:223], v[176:191]
    v_max3_f32 v241, v90, v91, v241
    v_max3_f32 v240, v92, v93, v240
    v_max3_f32 v241, v94, v95, v241
    v_max3_f32 v240, v96, v97, v240
    v_max3_f32 v241, v98, v99, v241
    v_exp_f32 v16, v16
    v_mfma_f32_32x32x16_bf16 v[160:175], a[104:107], a[124:127], v[160:175]
    ds_read_b32 a124, v10 offset:1040
    v_exp_f32 v17, v17
    v_exp_f32 v18, v18
    v_exp_f32 v19, v19
    v_exp_f32 v20, v20
    v_exp_f32 v21, v21
    v_exp_f32 v22, v22
    v_exp_f32 v23, v23
    v_max3_f32 v240, v100, v101, v240
    v_max3_f32 v241, v102, v103, v241
    v_max3_f32 v240, v104, v105, v240
    v_max3_f32 v241, v106, v107, v241
    v_max3_f32 v240, v108, v109, v240
    v_max3_f32 v241, v110, v111, v241
    v_cvt_pk_bf16_f32 v192, v16, v17
    v_cvt_pk_bf16_f32 v193, v18, v19
    v_cvt_pk_bf16_f32 v194, v20, v21
    v_cvt_pk_bf16_f32 v195, v22, v23
    v_max_f32 v240, v240, v241
    v_mov_b32 v241, v240
    v_mfma_f32_32x32x16_bf16 v[176:191], a[160:163], v[192:195], v[176:191]
    s_nop 0
    v_permlane32_swap_b32 v240, v241
    v_max_f32 v240, v240, v241
    v_cvt_pk_bf16_f32 v244, v240, v240
    v_exp_f32 v24, v24
    v_exp_f32 v25, v25
    v_exp_f32 v26, v26
    v_exp_f32 v27, v27
    v_exp_f32 v28, v28
    v_exp_f32 v29, v29
    v_exp_f32 v30, v30
    v_exp_f32 v31, v31
    v_and_b32 v244, 0xffff0000, v244
    v_sub_f32 v241, v244, v240
    v_cvt_pk_bf16_f32 v224, -v244, v241
    v_cvt_pk_bf16_f32 v196, v24, v25
    v_cvt_pk_bf16_f32 v197, v26, v27
    v_mfma_f32_32x32x16_bf16 v[32:47], v[228:231], v[224:227], v[32:47]
    v_cvt_pk_bf16_f32 v198, v28, v29
    v_cvt_pk_bf16_f32 v199, v30, v31
    v_cndmask_b32 v112, v112, v13, s[40:41]
    v_cndmask_b32 v113, v113, v13, s[42:43]
    v_cndmask_b32 v114, v114, v13, s[44:45]
    v_cndmask_b32 v115, v115, v13, s[46:47]
    v_mfma_f32_32x32x16_bf16 v[176:191], a[164:167], v[196:199], v[176:191]
    v_cndmask_b32 v116, v116, v13, s[48:49]
    v_cndmask_b32 v117, v117, v13, s[50:51]
    v_cndmask_b32 v118, v118, v13, s[52:53]
    v_cndmask_b32 v119, v119, v13, s[54:55]
    v_max_f32 v242, v112, v113
    v_exp_f32 v32, v32
    v_mfma_f32_32x32x16_bf16 v[48:63], v[228:231], v[224:227], v[48:63]
    v_exp_f32 v33, v33
    v_exp_f32 v34, v34
    v_exp_f32 v35, v35
    v_mfma_f32_32x32x16_bf16 v[64:79], v[228:231], v[224:227], v[64:79]
    v_exp_f32 v36, v36
    v_exp_f32 v37, v37
    v_exp_f32 v38, v38
    v_mfma_f32_32x32x16_bf16 v[80:95], v[228:231], v[224:227], v[80:95]
    v_exp_f32 v39, v39
    v_rcp_f32 v246, v186
    v_cvt_pk_bf16_f32 v200, v32, v33
    v_cvt_pk_bf16_f32 v201, v34, v35
    v_mfma_f32_32x32x16_bf16 v[96:111], v[228:231], v[224:227], v[96:111]
    v_cvt_pk_bf16_f32 v202, v36, v37
    v_cvt_pk_bf16_f32 v203, v38, v39
    v_mul_f32 v176, v176, v246
    v_mul_f32 v177, v177, v246
    v_mul_f32 v178, v178, v246
    v_mul_f32 v179, v179, v246
    s_waitcnt lgkmcnt(2)
    v_mfma_f32_32x32x16_bf16 v[16:31], a[40:43], a[112:115], 0
    v_mul_f32 v180, v180, v246
    v_mul_f32 v181, v181, v246
    v_mul_f32 v182, v182, v246
    v_mul_f32 v183, v183, v246
    v_mul_f32 v184, v184, v246
    v_mul_f32 v185, v185, v246
    v_mfma_f32_32x32x16_bf16 v[16:31], a[104:107], a[120:123], v[16:31]
    v_cvt_pk_bf16_f32 v248, v176, v177
    v_cvt_pk_bf16_f32 v249, v178, v179
    v_cvt_pk_bf16_f32 v250, v180, v181
    v_cvt_pk_bf16_f32 v251, v182, v183
    v_cvt_pk_bf16_f32 v252, v184, v185
    v_exp_f32 v40, v40
    v_mfma_f32_32x32x16_bf16 v[176:191], a[160:163], v[200:203], 0
    buffer_store_dwordx4 v[248:251], v4, s[24:27], s20 offen sc0 sc1
    buffer_store_dword v252, v7, s[24:27], s21 offen sc0 sc1
    v_exp_f32 v41, v41
    s_add_u32 s20, s77, 331776
    s_add_u32 s21, s7, 331776
    v_exp_f32 v42, v42
    v_exp_f32 v43, v43
    v_exp_f32 v44, v44
    v_exp_f32 v45, v45
    v_exp_f32 v46, v46
    v_exp_f32 v47, v47
    v_cvt_pk_bf16_f32 v204, v40, v41
    v_cvt_pk_bf16_f32 v205, v42, v43
    v_cvt_pk_bf16_f32 v206, v44, v45
    v_cvt_pk_bf16_f32 v207, v46, v47
    v_mfma_f32_32x32x16_bf16 v[32:47], a[32:35], a[112:115], 0
    v_exp_f32 v48, v48
    v_exp_f32 v49, v49
    v_exp_f32 v50, v50
    v_mfma_f32_32x32x16_bf16 v[176:191], a[164:167], v[204:207], v[176:191]
    v_exp_f32 v51, v51
    v_exp_f32 v52, v52
    v_exp_f32 v53, v53
    v_mfma_f32_32x32x16_bf16 v[32:47], a[96:99], a[120:123], v[32:47]
    v_exp_f32 v54, v54
    v_exp_f32 v55, v55
    v_cvt_pk_bf16_f32 v208, v48, v49
    v_cvt_pk_bf16_f32 v209, v50, v51
    v_cvt_pk_bf16_f32 v210, v52, v53
    v_cvt_pk_bf16_f32 v211, v54, v55
    v_exp_f32 v56, v56
    s_nop 0
    v_mfma_f32_32x32x16_bf16 v[176:191], a[224:227], v[208:211], v[176:191]
    v_exp_f32 v57, v57
    v_exp_f32 v58, v58
    v_exp_f32 v59, v59
    v_exp_f32 v60, v60
    v_exp_f32 v61, v61
    v_exp_f32 v62, v62
    v_exp_f32 v63, v63
    v_cvt_pk_bf16_f32 v212, v56, v57
    v_cvt_pk_bf16_f32 v213, v58, v59
    v_cvt_pk_bf16_f32 v214, v60, v61
    v_cvt_pk_bf16_f32 v215, v62, v63
    v_mfma_f32_32x32x16_bf16 v[48:63], a[36:39], a[112:115], 0
    ds_read_b128 a[112:115], v1 offset:0
    v_exp_f32 v64, v64
    v_exp_f32 v65, v65
    v_exp_f32 v66, v66
    v_mfma_f32_32x32x16_bf16 v[176:191], a[228:231], v[212:215], v[176:191]
    v_exp_f32 v67, v67
    v_exp_f32 v68, v68
    v_exp_f32 v69, v69
    v_mfma_f32_32x32x16_bf16 v[48:63], a[100:103], a[120:123], v[48:63]
    ds_read_b32 a120, v10 offset:0
    v_exp_f32 v70, v70
    v_exp_f32 v71, v71
    v_cvt_pk_bf16_f32 v216, v64, v65
    v_cvt_pk_bf16_f32 v217, v66, v67
    v_cvt_pk_bf16_f32 v218, v68, v69
    v_cvt_pk_bf16_f32 v219, v70, v71
    v_exp_f32 v72, v72
    s_nop 0
    v_mfma_f32_32x32x16_bf16 v[176:191], a[232:235], v[216:219], v[176:191]
    v_exp_f32 v73, v73
    v_exp_f32 v74, v74
    v_exp_f32 v75, v75
    v_exp_f32 v76, v76
    v_exp_f32 v77, v77
    v_exp_f32 v78, v78
    v_exp_f32 v79, v79
    v_cvt_pk_bf16_f32 v220, v72, v73
    v_cvt_pk_bf16_f32 v221, v74, v75
    v_cvt_pk_bf16_f32 v222, v76, v77
    v_cvt_pk_bf16_f32 v223, v78, v79
    s_waitcnt lgkmcnt(2)
    v_mfma_f32_32x32x16_bf16 v[64:79], a[36:39], a[116:119], 0
    v_exp_f32 v80, v80
    v_exp_f32 v81, v81
    v_exp_f32 v82, v82
    v_mfma_f32_32x32x16_bf16 v[176:191], a[236:239], v[220:223], v[176:191]
    v_exp_f32 v83, v83
    v_exp_f32 v84, v84
    v_exp_f32 v85, v85
    v_mfma_f32_32x32x16_bf16 v[64:79], a[100:103], a[124:127], v[64:79]
    v_exp_f32 v86, v86
    v_exp_f32 v87, v87
    v_cvt_pk_bf16_f32 v192, v80, v81
    v_cvt_pk_bf16_f32 v193, v82, v83
    v_cvt_pk_bf16_f32 v194, v84, v85
    v_cvt_pk_bf16_f32 v195, v86, v87
    v_max_f32 v243, v114, v115
    v_cndmask_b32 v120, v120, v13, s[56:57]
    v_mfma_f32_32x32x16_bf16 v[176:191], a[240:243], v[192:195], v[176:191]
    v_cndmask_b32 v121, v121, v13, s[58:59]
    v_cndmask_b32 v122, v122, v13, s[60:61]
    v_cndmask_b32 v123, v123, v13, s[62:63]
    v_max3_f32 v242, v116, v117, v242
    v_max3_f32 v243, v118, v119, v243
    v_cndmask_b32 v124, v124, v13, s[64:65]
    v_cndmask_b32 v125, v125, v13, s[66:67]
    v_cndmask_b32 v126, v126, v13, s[68:69]
    v_cndmask_b32 v127, v127, v13, s[70:71]
    v_max3_f32 v242, v120, v121, v242
    v_max3_f32 v243, v122, v123, v243
    v_max3_f32 v242, v124, v125, v242
    v_max3_f32 v243, v126, v127, v243
    v_max3_f32 v242, v128, v129, v242
    v_max3_f32 v243, v130, v131, v243
    v_exp_f32 v88, v88
    v_exp_f32 v89, v89
    v_exp_f32 v90, v90
    v_exp_f32 v91, v91
    v_exp_f32 v92, v92
    v_exp_f32 v93, v93
    v_exp_f32 v94, v94
    v_exp_f32 v95, v95
    v_max3_f32 v242, v132, v133, v242
    v_max3_f32 v243, v134, v135, v243
    v_max3_f32 v242, v136, v137, v242
    v_max3_f32 v243, v138, v139, v243
    v_max3_f32 v242, v140, v141, v242
    v_max3_f32 v243, v142, v143, v243
    v_cvt_pk_bf16_f32 v196, v88, v89
    v_cvt_pk_bf16_f32 v197, v90, v91
    v_cvt_pk_bf16_f32 v198, v92, v93
    v_cvt_pk_bf16_f32 v199, v94, v95
    v_mfma_f32_32x32x16_bf16 v[80:95], a[32:35], a[116:119], 0
    v_max3_f32 v242, v144, v145, v242
    v_max3_f32 v243, v146, v147, v243
    v_max3_f32 v242, v148, v149, v242
    v_max3_f32 v243, v150, v151, v243
    v_max3_f32 v242, v152, v153, v242
    v_max3_f32 v243, v154, v155, v243
    v_mfma_f32_32x32x16_bf16 v[176:191], a[244:247], v[196:199], v[176:191]
    v_max3_f32 v242, v156, v157, v242
    v_max3_f32 v243, v158, v159, v243
    v_max3_f32 v242, v160, v161, v242
    v_max3_f32 v243, v162, v163, v243
    v_exp_f32 v96, v96
    v_mfma_f32_32x32x16_bf16 v[80:95], a[96:99], a[124:127], v[80:95]
    v_exp_f32 v97, v97
    v_exp_f32 v98, v98
    v_exp_f32 v99, v99
    v_exp_f32 v100, v100
    v_exp_f32 v101, v101
    v_exp_f32 v102, v102
    v_exp_f32 v103, v103
    v_max3_f32 v242, v164, v165, v242
    v_max3_f32 v243, v166, v167, v243
    v_max3_f32 v242, v168, v169, v242
    v_max3_f32 v243, v170, v171, v243
    v_max3_f32 v242, v172, v173, v242
    v_max3_f32 v243, v174, v175, v243
    v_cvt_pk_bf16_f32 v200, v96, v97
    v_cvt_pk_bf16_f32 v201, v98, v99
    v_cvt_pk_bf16_f32 v202, v100, v101
    v_cvt_pk_bf16_f32 v203, v102, v103
    v_max_f32 v242, v242, v243
    v_mov_b32 v243, v242
    v_mfma_f32_32x32x16_bf16 v[176:191], a[248:251], v[200:203], v[176:191]
    s_nop 0
    v_permlane32_swap_b32 v242, v243
    v_max_f32 v242, v242, v243
    v_cvt_pk_bf16_f32 v244, v242, v242
    v_exp_f32 v104, v104
    v_exp_f32 v105, v105
    v_exp_f32 v106, v106
    v_exp_f32 v107, v107
    v_exp_f32 v108, v108
    v_exp_f32 v109, v109
    v_exp_f32 v110, v110
    v_exp_f32 v111, v111
    v_and_b32 v244, 0xffff0000, v244
    v_sub_f32 v243, v244, v242
    v_cvt_pk_bf16_f32 v224, -v244, v243
    v_cvt_pk_bf16_f32 v204, v104, v105
    v_cvt_pk_bf16_f32 v205, v106, v107
    v_mfma_f32_32x32x16_bf16 v[112:127], v[228:231], v[224:227], v[112:127]
    v_cvt_pk_bf16_f32 v206, v108, v109
    v_cvt_pk_bf16_f32 v207, v110, v111
    v_cndmask_b32 v16, v16, v13, s[40:41]
    v_cndmask_b32 v17, v17, v13, s[42:43]
    v_cndmask_b32 v18, v18, v13, s[44:45]
    v_cndmask_b32 v19, v19, v13, s[46:47]
    v_mfma_f32_32x32x16_bf16 v[176:191], a[252:255], v[204:207], v[176:191]
    v_cndmask_b32 v20, v20, v13, s[48:49]
    v_cndmask_b32 v21, v21, v13, s[50:51]
    v_cndmask_b32 v22, v22, v13, s[52:53]
    v_cndmask_b32 v23, v23, v13, s[54:55]
    v_max_f32 v240, v16, v17
    v_exp_f32 v112, v112
    v_mfma_f32_32x32x16_bf16 v[128:143], v[228:231], v[224:227], v[128:143]
    v_exp_f32 v113, v113
    v_exp_f32 v114, v114
    v_exp_f32 v115, v115
    v_mfma_f32_32x32x16_bf16 v[144:159], v[228:231], v[224:227], v[144:159]
    v_exp_f32 v116, v116
    v_exp_f32 v117, v117
    v_exp_f32 v118, v118
    v_mfma_f32_32x32x16_bf16 v[160:175], v[228:231], v[224:227], v[160:175]
    v_exp_f32 v119, v119
    v_rcp_f32 v246, v186
    v_cvt_pk_bf16_f32 v208, v112, v113
    v_cvt_pk_bf16_f32 v209, v114, v115
    s_waitcnt lgkmcnt(0)
    v_mfma_f32_32x32x16_bf16 v[96:111], a[32:35], a[112:115], 0
    v_cvt_pk_bf16_f32 v210, v116, v117
    v_cvt_pk_bf16_f32 v211, v118, v119
    v_mul_f32 v176, v176, v246
    v_mul_f32 v177, v177, v246
    v_mul_f32 v178, v178, v246
    v_mul_f32 v179, v179, v246
    v_mfma_f32_32x32x16_bf16 v[96:111], a[96:99], a[120:123], v[96:111]
    v_mul_f32 v180, v180, v246
    v_mul_f32 v181, v181, v246
    v_mul_f32 v182, v182, v246
    v_mul_f32 v183, v183, v246
    v_mul_f32 v184, v184, v246
    v_mul_f32 v185, v185, v246
    v_cvt_pk_bf16_f32 v248, v176, v177
    v_cvt_pk_bf16_f32 v249, v178, v179
    v_cvt_pk_bf16_f32 v250, v180, v181
    v_cvt_pk_bf16_f32 v251, v182, v183
    v_cvt_pk_bf16_f32 v252, v184, v185
    v_mfma_f32_32x32x16_bf16 v[176:191], a[248:251], v[208:211], 0
    buffer_store_dwordx4 v[248:251], v4, s[24:27], s22 offen sc0 sc1
    buffer_store_dword v252, v7, s[24:27], s23 offen sc0 sc1
    v_exp_f32 v120, v120
    s_add_u32 s22, s77, 294912
    s_add_u32 s23, s7, 294912
    v_exp_f32 v121, v121
    v_exp_f32 v122, v122
    v_exp_f32 v123, v123
    v_exp_f32 v124, v124
    v_exp_f32 v125, v125
    v_exp_f32 v126, v126
    v_exp_f32 v127, v127
    v_cvt_pk_bf16_f32 v212, v120, v121
    v_cvt_pk_bf16_f32 v213, v122, v123
    v_cvt_pk_bf16_f32 v214, v124, v125
    v_cvt_pk_bf16_f32 v215, v126, v127
    v_exp_f32 v128, v128
    s_nop 0
    v_mfma_f32_32x32x16_bf16 v[176:191], a[252:255], v[212:215], v[176:191]
    v_exp_f32 v129, v129
    v_exp_f32 v130, v130
    v_exp_f32 v131, v131
    v_exp_f32 v132, v132
    v_exp_f32 v133, v133
    v_exp_f32 v134, v134
    v_exp_f32 v135, v135
    v_cvt_pk_bf16_f32 v216, v128, v129
    v_cvt_pk_bf16_f32 v217, v130, v131
    v_cvt_pk_bf16_f32 v218, v132, v133
    v_cvt_pk_bf16_f32 v219, v134, v135
    v_exp_f32 v136, v136
    s_nop 0
    v_mfma_f32_32x32x16_bf16 v[176:191], a[224:227], v[216:219], v[176:191]
    v_exp_f32 v137, v137
    v_exp_f32 v138, v138
    v_exp_f32 v139, v139
    v_exp_f32 v140, v140
    v_exp_f32 v141, v141
    v_exp_f32 v142, v142
    v_exp_f32 v143, v143
    v_cvt_pk_bf16_f32 v220, v136, v137
    v_cvt_pk_bf16_f32 v221, v138, v139
    v_cvt_pk_bf16_f32 v222, v140, v141
    v_cvt_pk_bf16_f32 v223, v142, v143
    v_exp_f32 v144, v144
    s_nop 0
    v_mfma_f32_32x32x16_bf16 v[176:191], a[228:231], v[220:223], v[176:191]
    v_exp_f32 v145, v145
    v_exp_f32 v146, v146
    v_exp_f32 v147, v147
    v_exp_f32 v148, v148
    v_exp_f32 v149, v149
    v_exp_f32 v150, v150
    v_exp_f32 v151, v151
    v_cvt_pk_bf16_f32 v192, v144, v145
    v_cvt_pk_bf16_f32 v193, v146, v147
    v_cvt_pk_bf16_f32 v194, v148, v149
    v_cvt_pk_bf16_f32 v195, v150, v151
    v_max_f32 v241, v18, v19
    v_exp_f32 v152, v152
    v_mfma_f32_32x32x16_bf16 v[176:191], a[232:235], v[192:195], v[176:191]
    v_exp_f32 v153, v153
    v_exp_f32 v154, v154
    v_exp_f32 v155, v155
    v_exp_f32 v156, v156
    v_exp_f32 v157, v157
    v_exp_f32 v158, v158
    v_exp_f32 v159, v159
    v_cndmask_b32 v24, v24, v13, s[56:57]
    v_cndmask_b32 v25, v25, v13, s[58:59]
    v_cndmask_b32 v26, v26, v13, s[60:61]
    v_cndmask_b32 v27, v27, v13, s[62:63]
    v_max3_f32 v240, v20, v21, v240
    v_max3_f32 v241, v22, v23, v241
    v_cndmask_b32 v28, v28, v13, s[64:65]
    v_cndmask_b32 v29, v29, v13, s[66:67]
    v_cndmask_b32 v30, v30, v13, s[68:69]
    v_cndmask_b32 v31, v31, v13, s[70:71]
    v_max3_f32 v240, v24, v25, v240
    v_max3_f32 v241, v26, v27, v241
    v_max3_f32 v240, v28, v29, v240
    v_max3_f32 v241, v30, v31, v241
    v_cvt_pk_bf16_f32 v196, v152, v153
    v_cvt_pk_bf16_f32 v197, v154, v155
    v_cvt_pk_bf16_f32 v198, v156, v157
    v_cvt_pk_bf16_f32 v199, v158, v159
    v_max3_f32 v240, v32, v33, v240
    v_max3_f32 v241, v34, v35, v241
    v_mfma_f32_32x32x16_bf16 v[176:191], a[236:239], v[196:199], v[176:191]
    v_max3_f32 v240, v36, v37, v240
    v_max3_f32 v241, v38, v39, v241
    v_max3_f32 v240, v40, v41, v240
    v_max3_f32 v241, v42, v43, v241
    v_max3_f32 v240, v44, v45, v240
    v_max3_f32 v241, v46, v47, v241
    v_max3_f32 v240, v48, v49, v240
    v_max3_f32 v241, v50, v51, v241
    v_exp_f32 v160, v160
    v_exp_f32 v161, v161
    v_exp_f32 v162, v162
    v_exp_f32 v163, v163
    v_exp_f32 v164, v164
    v_exp_f32 v165, v165
    v_exp_f32 v166, v166
    v_exp_f32 v167, v167
    v_max3_f32 v240, v52, v53, v240
    v_max3_f32 v241, v54, v55, v241
    v_max3_f32 v240, v56, v57, v240
    v_max3_f32 v241, v58, v59, v241
    v_max3_f32 v240, v60, v61, v240
    v_max3_f32 v241, v62, v63, v241
    v_cvt_pk_bf16_f32 v200, v160, v161
    v_cvt_pk_bf16_f32 v201, v162, v163
    v_cvt_pk_bf16_f32 v202, v164, v165
    v_cvt_pk_bf16_f32 v203, v166, v167
    v_max_f32 v240, v240, v241
    v_mov_b32 v241, v240
    v_mfma_f32_32x32x16_bf16 v[176:191], a[240:243], v[200:203], v[176:191]
    s_nop 0
    v_permlane32_swap_b32 v240, v241
    v_max_f32 v240, v240, v241
    v_cvt_pk_bf16_f32 v244, v240, v240
    v_exp_f32 v168, v168
    v_exp_f32 v169, v169
    v_exp_f32 v170, v170
    v_exp_f32 v171, v171
    v_exp_f32 v172, v172
    v_exp_f32 v173, v173
    v_exp_f32 v174, v174
    v_exp_f32 v175, v175
    v_and_b32 v244, 0xffff0000, v244
    v_sub_f32 v241, v244, v240
    v_cvt_pk_bf16_f32 v224, -v244, v241
    v_cvt_pk_bf16_f32 v204, v168, v169
    v_cvt_pk_bf16_f32 v205, v170, v171
    v_mfma_f32_32x32x16_bf16 v[16:31], v[228:231], v[224:227], v[16:31]
    v_cvt_pk_bf16_f32 v206, v172, v173
    v_cvt_pk_bf16_f32 v207, v174, v175
    v_cndmask_b32 v64, v64, v13, s[40:41]
    v_cndmask_b32 v65, v65, v13, s[42:43]
    v_cndmask_b32 v66, v66, v13, s[44:45]
    v_cndmask_b32 v67, v67, v13, s[46:47]
    v_mfma_f32_32x32x16_bf16 v[176:191], a[244:247], v[204:207], v[176:191]
    v_cndmask_b32 v68, v68, v13, s[48:49]
    v_cndmask_b32 v69, v69, v13, s[50:51]
    v_cndmask_b32 v70, v70, v13, s[52:53]
    v_cndmask_b32 v71, v71, v13, s[54:55]
    v_max_f32 v242, v64, v65
    v_exp_f32 v16, v16
    v_mfma_f32_32x32x16_bf16 v[32:47], v[228:231], v[224:227], v[32:47]
    v_exp_f32 v17, v17
    v_exp_f32 v18, v18
    v_exp_f32 v19, v19
    v_mfma_f32_32x32x16_bf16 v[48:63], v[228:231], v[224:227], v[48:63]
    v_exp_f32 v20, v20
    v_exp_f32 v21, v21
    v_exp_f32 v22, v22
    v_exp_f32 v23, v23
    v_rcp_f32 v246, v186
    v_cvt_pk_bf16_f32 v208, v16, v17
    v_cvt_pk_bf16_f32 v209, v18, v19
    v_cvt_pk_bf16_f32 v210, v20, v21
    v_cvt_pk_bf16_f32 v211, v22, v23
    v_mul_f32 v176, v176, v246
    v_mul_f32 v177, v177, v246
    v_mul_f32 v178, v178, v246
    v_mul_f32 v179, v179, v246
    v_mul_f32 v180, v180, v246
    v_mul_f32 v181, v181, v246
    v_mul_f32 v182, v182, v246
    v_mul_f32 v183, v183, v246
    v_mul_f32 v184, v184, v246
    v_mul_f32 v185, v185, v246
    v_cvt_pk_bf16_f32 v248, v176, v177
    v_cvt_pk_bf16_f32 v249, v178, v179
    v_cvt_pk_bf16_f32 v250, v180, v181
    v_cvt_pk_bf16_f32 v251, v182, v183
    v_cvt_pk_bf16_f32 v252, v184, v185
    v_mfma_f32_32x32x16_bf16 v[176:191], a[240:243], v[208:211], 0
    buffer_store_dwordx4 v[248:251], v4, s[24:27], s16 offen sc0 sc1
    buffer_store_dword v252, v7, s[24:27], s17 offen sc0 sc1
    v_exp_f32 v24, v24
    v_exp_f32 v25, v25
    v_exp_f32 v26, v26
    v_exp_f32 v27, v27
    v_exp_f32 v28, v28
    v_exp_f32 v29, v29
    v_exp_f32 v30, v30
    v_exp_f32 v31, v31
    v_cvt_pk_bf16_f32 v212, v24, v25
    v_cvt_pk_bf16_f32 v213, v26, v27
    v_cvt_pk_bf16_f32 v214, v28, v29
    v_cvt_pk_bf16_f32 v215, v30, v31
    v_exp_f32 v32, v32
    s_nop 0
    v_mfma_f32_32x32x16_bf16 v[176:191], a[244:247], v[212:215], v[176:191]
    v_exp_f32 v33, v33
    v_exp_f32 v34, v34
    v_exp_f32 v35, v35
    v_exp_f32 v36, v36
    v_exp_f32 v37, v37
    v_exp_f32 v38, v38
    v_exp_f32 v39, v39
    v_cvt_pk_bf16_f32 v216, v32, v33
    v_cvt_pk_bf16_f32 v217, v34, v35
    v_cvt_pk_bf16_f32 v218, v36, v37
    v_cvt_pk_bf16_f32 v219, v38, v39
    v_exp_f32 v40, v40
    s_nop 0
    v_mfma_f32_32x32x16_bf16 v[176:191], a[224:227], v[216:219], v[176:191]
    v_exp_f32 v41, v41
    v_exp_f32 v42, v42
    v_exp_f32 v43, v43
    v_exp_f32 v44, v44
    v_exp_f32 v45, v45
    v_exp_f32 v46, v46
    v_exp_f32 v47, v47
    v_cvt_pk_bf16_f32 v220, v40, v41
    v_cvt_pk_bf16_f32 v221, v42, v43
    v_cvt_pk_bf16_f32 v222, v44, v45
    v_cvt_pk_bf16_f32 v223, v46, v47
    v_max_f32 v243, v66, v67
    v_cndmask_b32 v72, v72, v13, s[56:57]
    v_mfma_f32_32x32x16_bf16 v[176:191], a[228:231], v[220:223], v[176:191]
    v_cndmask_b32 v73, v73, v13, s[58:59]
    v_cndmask_b32 v74, v74, v13, s[60:61]
    v_cndmask_b32 v75, v75, v13, s[62:63]
    v_max3_f32 v242, v68, v69, v242
    v_max3_f32 v243, v70, v71, v243
    v_cndmask_b32 v76, v76, v13, s[64:65]
    v_cndmask_b32 v77, v77, v13, s[66:67]
    v_cndmask_b32 v78, v78, v13, s[68:69]
    v_cndmask_b32 v79, v79, v13, s[70:71]
    v_max3_f32 v242, v72, v73, v242
    v_max3_f32 v243, v74, v75, v243
    v_max3_f32 v242, v76, v77, v242
    v_max3_f32 v243, v78, v79, v243
    v_max3_f32 v242, v80, v81, v242
    v_max3_f32 v243, v82, v83, v243
    v_exp_f32 v48, v48
    v_exp_f32 v49, v49
    v_exp_f32 v50, v50
    v_exp_f32 v51, v51
    v_exp_f32 v52, v52
    v_exp_f32 v53, v53
    v_exp_f32 v54, v54
    v_exp_f32 v55, v55
    v_max3_f32 v242, v84, v85, v242
    v_max3_f32 v243, v86, v87, v243
    v_max3_f32 v242, v88, v89, v242
    v_max3_f32 v243, v90, v91, v243
    v_max3_f32 v242, v92, v93, v242
    v_max3_f32 v243, v94, v95, v243
    v_cvt_pk_bf16_f32 v192, v48, v49
    v_cvt_pk_bf16_f32 v193, v50, v51
    v_cvt_pk_bf16_f32 v194, v52, v53
    v_cvt_pk_bf16_f32 v195, v54, v55
    v_max_f32 v242, v242, v243
    v_mov_b32 v243, v242
    v_mfma_f32_32x32x16_bf16 v[176:191], a[232:235], v[192:195], v[176:191]
    s_nop 0
    v_permlane32_swap_b32 v242, v243
    v_max_f32 v242, v242, v243
    v_cvt_pk_bf16_f32 v244, v242, v242
    v_exp_f32 v56, v56
    v_exp_f32 v57, v57
    v_exp_f32 v58, v58
    v_exp_f32 v59, v59
    v_exp_f32 v60, v60
    v_exp_f32 v61, v61
    v_exp_f32 v62, v62
    v_exp_f32 v63, v63
    v_and_b32 v244, 0xffff0000, v244
    v_sub_f32 v243, v244, v242
    v_cvt_pk_bf16_f32 v224, -v244, v243
    v_cvt_pk_bf16_f32 v196, v56, v57
    v_cvt_pk_bf16_f32 v197, v58, v59
    v_mfma_f32_32x32x16_bf16 v[64:79], v[228:231], v[224:227], v[64:79]
    v_cvt_pk_bf16_f32 v198, v60, v61
    v_cvt_pk_bf16_f32 v199, v62, v63
    v_cndmask_b32 v96, v96, v13, s[40:41]
    v_cndmask_b32 v97, v97, v13, s[42:43]
    v_cndmask_b32 v98, v98, v13, s[44:45]
    v_cndmask_b32 v99, v99, v13, s[46:47]
    v_mfma_f32_32x32x16_bf16 v[176:191], a[236:239], v[196:199], v[176:191]
    v_cndmask_b32 v100, v100, v13, s[48:49]
    v_cndmask_b32 v101, v101, v13, s[50:51]
    v_cndmask_b32 v102, v102, v13, s[52:53]
    v_cndmask_b32 v103, v103, v13, s[54:55]
    v_max_f32 v240, v96, v97
    v_exp_f32 v64, v64
    v_mfma_f32_32x32x16_bf16 v[80:95], v[228:231], v[224:227], v[80:95]
    v_exp_f32 v65, v65
    v_exp_f32 v66, v66
    v_exp_f32 v67, v67
    v_exp_f32 v68, v68
    v_exp_f32 v69, v69
    v_exp_f32 v70, v70
    v_exp_f32 v71, v71
    v_rcp_f32 v246, v186
    v_cvt_pk_bf16_f32 v200, v64, v65
    v_cvt_pk_bf16_f32 v201, v66, v67
    v_cvt_pk_bf16_f32 v202, v68, v69
    v_cvt_pk_bf16_f32 v203, v70, v71
    v_mul_f32 v176, v176, v246
    v_mul_f32 v177, v177, v246
    v_mul_f32 v178, v178, v246
    v_mul_f32 v179, v179, v246
    v_mul_f32 v180, v180, v246
    v_mul_f32 v181, v181, v246
    v_mul_f32 v182, v182, v246
    v_mul_f32 v183, v183, v246
    v_mul_f32 v184, v184, v246
    v_mul_f32 v185, v185, v246
    v_cvt_pk_bf16_f32 v248, v176, v177
    v_cvt_pk_bf16_f32 v249, v178, v179
    v_cvt_pk_bf16_f32 v250, v180, v181
    v_cvt_pk_bf16_f32 v251, v182, v183
    v_cvt_pk_bf16_f32 v252, v184, v185
    v_mfma_f32_32x32x16_bf16 v[176:191], a[232:235], v[200:203], 0
    buffer_store_dwordx4 v[248:251], v4, s[24:27], s18 offen sc0 sc1
    buffer_store_dword v252, v7, s[24:27], s19 offen sc0 sc1
    v_exp_f32 v72, v72
    v_exp_f32 v73, v73
    v_exp_f32 v74, v74
    v_exp_f32 v75, v75
    v_exp_f32 v76, v76
    v_exp_f32 v77, v77
    v_exp_f32 v78, v78
    v_exp_f32 v79, v79
    v_cvt_pk_bf16_f32 v204, v72, v73
    v_cvt_pk_bf16_f32 v205, v74, v75
    v_cvt_pk_bf16_f32 v206, v76, v77
    v_cvt_pk_bf16_f32 v207, v78, v79
    v_max_f32 v241, v98, v99
    v_exp_f32 v80, v80
    v_mfma_f32_32x32x16_bf16 v[176:191], a[236:239], v[204:207], v[176:191]
    v_exp_f32 v81, v81
    v_exp_f32 v82, v82
    v_exp_f32 v83, v83
    v_exp_f32 v84, v84
    v_exp_f32 v85, v85
    v_exp_f32 v86, v86
    v_exp_f32 v87, v87
    v_cndmask_b32 v104, v104, v13, s[56:57]
    v_cndmask_b32 v105, v105, v13, s[58:59]
    v_cndmask_b32 v106, v106, v13, s[60:61]
    v_cndmask_b32 v107, v107, v13, s[62:63]
    v_max3_f32 v240, v100, v101, v240
    v_max3_f32 v241, v102, v103, v241
    v_cndmask_b32 v108, v108, v13, s[64:65]
    v_cndmask_b32 v109, v109, v13, s[66:67]
    v_cndmask_b32 v110, v110, v13, s[68:69]
    v_cndmask_b32 v111, v111, v13, s[70:71]
    v_max3_f32 v240, v104, v105, v240
    v_max3_f32 v241, v106, v107, v241
    v_max3_f32 v240, v108, v109, v240
    v_max3_f32 v241, v110, v111, v241
    v_cvt_pk_bf16_f32 v208, v80, v81
    v_cvt_pk_bf16_f32 v209, v82, v83
    v_cvt_pk_bf16_f32 v210, v84, v85
    v_cvt_pk_bf16_f32 v211, v86, v87
    v_max_f32 v240, v240, v241
    v_mov_b32 v241, v240
    v_mfma_f32_32x32x16_bf16 v[176:191], a[224:227], v[208:211], v[176:191]
    s_nop 0
    v_permlane32_swap_b32 v240, v241
    v_max_f32 v240, v240, v241
    v_cvt_pk_bf16_f32 v244, v240, v240
    v_exp_f32 v88, v88
    v_exp_f32 v89, v89
    v_exp_f32 v90, v90
    v_exp_f32 v91, v91
    v_exp_f32 v92, v92
    v_exp_f32 v93, v93
    v_exp_f32 v94, v94
    v_exp_f32 v95, v95
    v_and_b32 v244, 0xffff0000, v244
    v_sub_f32 v241, v244, v240
    v_cvt_pk_bf16_f32 v224, -v244, v241
    v_cvt_pk_bf16_f32 v212, v88, v89
    v_cvt_pk_bf16_f32 v213, v90, v91
    v_mfma_f32_32x32x16_bf16 v[96:111], v[228:231], v[224:227], v[96:111]
    v_cvt_pk_bf16_f32 v214, v92, v93
    v_cvt_pk_bf16_f32 v215, v94, v95
    s_nop 1
    v_mfma_f32_32x32x16_bf16 v[176:191], a[228:231], v[212:215], v[176:191]
    s_nop 6
    v_exp_f32 v96, v96
    v_exp_f32 v97, v97
    v_exp_f32 v98, v98
    v_exp_f32 v99, v99
    v_exp_f32 v100, v100
    v_exp_f32 v101, v101
    v_exp_f32 v102, v102
    v_exp_f32 v103, v103
    v_rcp_f32 v246, v186
    v_cvt_pk_bf16_f32 v216, v96, v97
    v_cvt_pk_bf16_f32 v217, v98, v99
    v_cvt_pk_bf16_f32 v218, v100, v101
    v_cvt_pk_bf16_f32 v219, v102, v103
    v_mul_f32 v176, v176, v246
    v_mul_f32 v177, v177, v246
    v_mul_f32 v178, v178, v246
    v_mul_f32 v179, v179, v246
    v_mul_f32 v180, v180, v246
    v_mul_f32 v181, v181, v246
    v_mul_f32 v182, v182, v246
    v_mul_f32 v183, v183, v246
    v_mul_f32 v184, v184, v246
    v_mul_f32 v185, v185, v246
    v_cvt_pk_bf16_f32 v248, v176, v177
    v_cvt_pk_bf16_f32 v249, v178, v179
    v_cvt_pk_bf16_f32 v250, v180, v181
    v_cvt_pk_bf16_f32 v251, v182, v183
    v_cvt_pk_bf16_f32 v252, v184, v185
    v_mfma_f32_32x32x16_bf16 v[176:191], a[224:227], v[216:219], 0
    buffer_store_dwordx4 v[248:251], v4, s[24:27], s20 offen sc0 sc1
    buffer_store_dword v252, v7, s[24:27], s21 offen sc0 sc1
    v_exp_f32 v104, v104
    v_exp_f32 v105, v105
    v_exp_f32 v106, v106
    v_exp_f32 v107, v107
    v_exp_f32 v108, v108
    v_exp_f32 v109, v109
    v_exp_f32 v110, v110
    v_exp_f32 v111, v111
    v_cvt_pk_bf16_f32 v220, v104, v105
    v_cvt_pk_bf16_f32 v221, v106, v107
    v_cvt_pk_bf16_f32 v222, v108, v109
    v_cvt_pk_bf16_f32 v223, v110, v111
    s_nop 1
    v_mfma_f32_32x32x16_bf16 v[176:191], a[228:231], v[220:223], v[176:191]
    s_nop 11
    v_rcp_f32 v246, v186
    s_nop 0
    v_mul_f32 v176, v176, v246
    v_mul_f32 v177, v177, v246
    v_mul_f32 v178, v178, v246
    v_mul_f32 v179, v179, v246
    v_mul_f32 v180, v180, v246
    v_mul_f32 v181, v181, v246
    v_mul_f32 v182, v182, v246
    v_mul_f32 v183, v183, v246
    v_mul_f32 v184, v184, v246
    v_mul_f32 v185, v185, v246
    v_cvt_pk_bf16_f32 v248, v176, v177
    v_cvt_pk_bf16_f32 v249, v178, v179
    v_cvt_pk_bf16_f32 v250, v180, v181
    v_cvt_pk_bf16_f32 v251, v182, v183
    v_cvt_pk_bf16_f32 v252, v184, v185
    buffer_store_dwordx4 v[248:251], v4, s[24:27], s22 offen sc0 sc1
    buffer_store_dword v252, v7, s[24:27], s23 offen sc0 sc1
    s_endpgm
TG_1:
    s_mov_b32 s101, 0
TG_1a:
    buffer_load_dword v246, v247, s[12:15], 0 offen sc0 sc1
    s_waitcnt vmcnt(0)
    v_readfirstlane_b32 s3, v246
    s_nop 1
    s_cmp_lg_u32 s3, 0
    s_cbranch_scc1 TGR_2
    s_sleep 2
    s_add_u32 s101, s101, 1
    s_cmp_lt_u32 s101, 20000
    s_cbranch_scc1 TG_1a
    s_branch TGR_2
PC_6:
    s_mov_b32 s100, 0
PC_6a:
    buffer_load_dword v11, v10, s[24:27], s44 offen sc0 sc1
    s_waitcnt vmcnt(0)
    v_readfirstlane_b32 s101, v11
    s_nop 1
    s_xor_b32 s101, s101, s43
    s_and_b32 s42, s101, 0xffffffe0
    s_cmp_eq_u32 s42, 0
    s_cbranch_scc1 PC_6b
    s_add_u32 s100, s100, 1
    s_cmp_lt_u32 s100, 20000
    s_cbranch_scc1 PC_6a
PC_6b:
    s_and_b32 s42, s101, 15
    s_cmp_eq_u32 s42, 0
    s_cbranch_scc1 PCR_7
    buffer_inv sc1
    s_waitcnt vmcnt(0)
    s_branch PCR_7
PC_8:
    s_mov_b32 s100, 0
PC_8a:
    buffer_load_dword v11, v10, s[24:27], s45 offen sc0 sc1
    s_waitcnt vmcnt(0)
    v_readfirstlane_b32 s101, v11
    s_nop 1
    s_xor_b32 s101, s101, s43
    s_and_b32 s42, s101, 0xffffffe0
    s_cmp_eq_u32 s42, 0
    s_cbranch_scc1 PC_8b
    s_add_u32 s100, s100, 1
    s_cmp_lt_u32 s100, 20000
    s_cbranch_scc1 PC_8a
PC_8b:
    s_and_b32 s42, s101, 15
    s_cmp_eq_u32 s42, 0
    s_cbranch_scc1 PCR_9
    buffer_inv sc1
    s_waitcnt vmcnt(0)
    s_branch PCR_9
AC_10:
    s_add_u32 s100, s100, 1
    s_cmp_lt_u32 s100, 20000
    s_cbranch_scc0 ACR_11
    s_sleep 8
    buffer_load_dword v247, v246, s[24:27], 0 offen sc0 sc1
    s_waitcnt vmcnt(0)
    s_branch AC_10t
TG_33:
    s_mov_b32 s101, 0
TG_33a:
    buffer_load_dword v14, v15, s[12:15], 0 offen sc0 sc1
    s_waitcnt vmcnt(0)
    v_readfirstlane_b32 s3, v14
    s_nop 1
    s_cmp_lg_u32 s3, 0
    s_cbranch_scc1 TGR_34
    s_sleep 2
    s_add_u32 s101, s101, 1
    s_cmp_lt_u32 s101, 20000
    s_cbranch_scc1 TG_33a
    s_branch TGR_34
F_QEPI_SC:
    s_nop 4
    v_mul_f32 v144, v144, v9
    v_mul_f32 v145, v145, v9
    v_mul_f32 v146, v146, v9
    v_mul_f32 v147, v147, v9
    v_mul_f32 v148, v148, v9
    v_mul_f32 v149, v149, v9
    v_mul_f32 v150, v150, v9
    v_mul_f32 v151, v151, v9
    v_cvt_pk_bf16_f32 v144, v144, v145
    v_cvt_pk_bf16_f32 v145, v146, v147
    v_cvt_pk_bf16_f32 v146, v148, v149
    v_cvt_pk_bf16_f32 v147, v150, v151
    v_cvt_pk_bf16_f32 v152, v152, v153
    v_cvt_pk_bf16_f32 v153, v154, v155
    v_cvt_pk_bf16_f32 v154, v156, v157
    v_cvt_pk_bf16_f32 v155, v158, v159
    v_mul_f32 v160, v160, v9
    v_mul_f32 v161, v161, v9
    v_mul_f32 v162, v162, v9
    v_mul_f32 v163, v163, v9
    v_mul_f32 v164, v164, v9
    v_mul_f32 v165, v165, v9
    v_mul_f32 v166, v166, v9
    v_mul_f32 v167, v167, v9
    v_cvt_pk_bf16_f32 v160, v160, v161
    v_cvt_pk_bf16_f32 v161, v162, v163
    v_cvt_pk_bf16_f32 v162, v164, v165
    v_cvt_pk_bf16_f32 v163, v166, v167
    v_cvt_pk_bf16_f32 v168, v168, v169
    v_cvt_pk_bf16_f32 v169, v170, v171
    v_cvt_pk_bf16_f32 v170, v172, v173
    v_cvt_pk_bf16_f32 v171, v174, v175
    ds_write_b16 v10, v152 offset:1024
    ds_write_b16_d16_hi v10, v152 offset:1040
    ds_write_b16 v10, v153 offset:1056
    ds_write_b16_d16_hi v10, v153 offset:1072
    ds_write_b16 v10, v154 offset:1088
    ds_write_b16_d16_hi v10, v154 offset:1104
    ds_write_b16 v10, v155 offset:1120
    ds_write_b16_d16_hi v10, v155 offset:1136
    s_add_u32 s46, s43, 0
    buffer_store_dwordx4 v[144:147], v1, s[24:27], s46 offen sc0 sc1
    ds_write_b128 v3, v[144:147] offset:0
    ds_write_b16 v10, v168 offset:5632
    ds_write_b16_d16_hi v10, v168 offset:5648
    ds_write_b16 v10, v169 offset:5664
    ds_write_b16_d16_hi v10, v169 offset:5680
    ds_write_b16 v10, v170 offset:5696
    ds_write_b16_d16_hi v10, v170 offset:5712
    ds_write_b16 v10, v171 offset:5728
    ds_write_b16_d16_hi v10, v171 offset:5744
    s_add_u32 s47, s43, 1024
    buffer_store_dwordx4 v[160:163], v1, s[24:27], s47 offen sc0 sc1
    ds_write_b128 v3, v[160:163] offset:1040
    ds_read_b128 v[240:243], v4 offset:1024
    v_cvt_pk_bf16_f32 v96, v96, v97
    v_cvt_pk_bf16_f32 v97, v98, v99
    v_cvt_pk_bf16_f32 v98, v100, v101
    v_cvt_pk_bf16_f32 v99, v102, v103
    v_cvt_pk_bf16_f32 v104, v104, v105
    v_cvt_pk_bf16_f32 v105, v106, v107
    v_cvt_pk_bf16_f32 v106, v108, v109
    v_cvt_pk_bf16_f32 v107, v110, v111
    v_cvt_pk_bf16_f32 v128, v128, v129
    v_cvt_pk_bf16_f32 v129, v130, v131
    v_cvt_pk_bf16_f32 v130, v132, v133
    v_cvt_pk_bf16_f32 v131, v134, v135
    v_cvt_pk_bf16_f32 v136, v136, v137
    v_cvt_pk_bf16_f32 v137, v138, v139
    v_cvt_pk_bf16_f32 v138, v140, v141
    v_cvt_pk_bf16_f32 v139, v142, v143
    s_add_u32 s48, s42, 1024
    buffer_store_dwordx4 v[96:99], v1, s[24:27], s48 offen sc0 sc1
    ds_write_b128 v2, v[96:99] offset:33792
    s_add_u32 s49, s42, 66560
    buffer_store_dwordx4 v[104:107], v1, s[24:27], s49 offen sc0 sc1
    ds_write_b128 v2, v[104:107] offset:41984
    s_add_u32 s50, s42, 132096
    buffer_store_dwordx4 v[128:131], v1, s[24:27], s50 offen sc0 sc1
    ds_write_b128 v2, v[128:131] offset:50176
    s_add_u32 s51, s42, 197632
    buffer_store_dwordx4 v[136:139], v1, s[24:27], s51 offen sc0 sc1
    ds_write_b128 v2, v[136:139] offset:58368
    v_cvt_pk_bf16_f32 v192, v192, v193
    v_cvt_pk_bf16_f32 v193, v194, v195
    v_cvt_pk_bf16_f32 v194, v196, v197
    v_cvt_pk_bf16_f32 v195, v198, v199
    v_cvt_pk_bf16_f32 v200, v200, v201
    v_cvt_pk_bf16_f32 v201, v202, v203
    v_cvt_pk_bf16_f32 v202, v204, v205
    v_cvt_pk_bf16_f32 v203, v206, v207
    v_cvt_pk_bf16_f32 v224, v224, v225
    v_cvt_pk_bf16_f32 v225, v226, v227
    v_cvt_pk_bf16_f32 v226, v228, v229
    v_cvt_pk_bf16_f32 v227, v230, v231
    v_cvt_pk_bf16_f32 v232, v232, v233
    v_cvt_pk_bf16_f32 v233, v234, v235
    v_cvt_pk_bf16_f32 v234, v236, v237
    v_cvt_pk_bf16_f32 v235, v238, v239
    s_add_u32 s52, s44, 36864
    buffer_store_dwordx4 v[192:195], v6, s[24:27], s52 offen sc0 sc1
    ds_write_b128 v5, v[192:195] offset:4608
    s_add_u32 s53, s44, 55296
    buffer_store_dwordx4 v[200:203], v6, s[24:27], s53 offen sc0 sc1
    ds_write_b128 v5, v[200:203] offset:6912
    s_add_u32 s46, s44, 37376
    buffer_store_dwordx4 v[224:227], v6, s[24:27], s46 offen sc0 sc1
    ds_write_b128 v5, v[224:227] offset:5120
    s_add_u32 s47, s44, 55808
    buffer_store_dwordx4 v[232:235], v6, s[24:27], s47 offen sc0 sc1
    ds_write_b128 v5, v[232:235] offset:7424
    s_waitcnt lgkmcnt(8)
    buffer_store_dwordx4 v[240:243], v11, s[24:27], s44 offen offset:1024 sc0 sc1
    v_cvt_pk_bf16_f32 v80, v80, v81
    v_cvt_pk_bf16_f32 v81, v82, v83
    v_cvt_pk_bf16_f32 v82, v84, v85
    v_cvt_pk_bf16_f32 v83, v86, v87
    v_cvt_pk_bf16_f32 v88, v88, v89
    v_cvt_pk_bf16_f32 v89, v90, v91
    v_cvt_pk_bf16_f32 v90, v92, v93
    v_cvt_pk_bf16_f32 v91, v94, v95
    v_cvt_pk_bf16_f32 v112, v112, v113
    v_cvt_pk_bf16_f32 v113, v114, v115
    v_cvt_pk_bf16_f32 v114, v116, v117
    v_cvt_pk_bf16_f32 v115, v118, v119
    v_cvt_pk_bf16_f32 v120, v120, v121
    v_cvt_pk_bf16_f32 v121, v122, v123
    v_cvt_pk_bf16_f32 v122, v124, v125
    v_cvt_pk_bf16_f32 v123, v126, v127
    s_add_u32 s48, s42, 0
    buffer_store_dwordx4 v[80:83], v1, s[24:27], s48 offen sc0 sc1
    ds_write_b128 v2, v[80:83] offset:32768
    s_add_u32 s49, s42, 65536
    buffer_store_dwordx4 v[88:91], v1, s[24:27], s49 offen sc0 sc1
    ds_write_b128 v2, v[88:91] offset:40960
    s_add_u32 s50, s42, 131072
    buffer_store_dwordx4 v[112:115], v1, s[24:27], s50 offen sc0 sc1
    ds_write_b128 v2, v[112:115] offset:49152
    s_add_u32 s51, s42, 196608
    buffer_store_dwordx4 v[120:123], v1, s[24:27], s51 offen sc0 sc1
    ds_write_b128 v2, v[120:123] offset:57344
    v_cvt_pk_bf16_f32 v176, v176, v177
    v_cvt_pk_bf16_f32 v177, v178, v179
    v_cvt_pk_bf16_f32 v178, v180, v181
    v_cvt_pk_bf16_f32 v179, v182, v183
    v_cvt_pk_bf16_f32 v184, v184, v185
    v_cvt_pk_bf16_f32 v185, v186, v187
    v_cvt_pk_bf16_f32 v186, v188, v189
    v_cvt_pk_bf16_f32 v187, v190, v191
    v_cvt_pk_bf16_f32 v208, v208, v209
    v_cvt_pk_bf16_f32 v209, v210, v211
    v_cvt_pk_bf16_f32 v210, v212, v213
    v_cvt_pk_bf16_f32 v211, v214, v215
    v_cvt_pk_bf16_f32 v216, v216, v217
    v_cvt_pk_bf16_f32 v217, v218, v219
    v_cvt_pk_bf16_f32 v218, v220, v221
    v_cvt_pk_bf16_f32 v219, v222, v223
    s_add_u32 s52, s44, 0
    buffer_store_dwordx4 v[176:179], v6, s[24:27], s52 offen sc0 sc1
    ds_write_b128 v5, v[176:179] offset:0
    s_add_u32 s53, s44, 18432
    buffer_store_dwordx4 v[184:187], v6, s[24:27], s53 offen sc0 sc1
    ds_write_b128 v5, v[184:187] offset:2304
    s_add_u32 s46, s44, 512
    buffer_store_dwordx4 v[208:211], v6, s[24:27], s46 offen sc0 sc1
    ds_write_b128 v5, v[208:211] offset:512
    s_add_u32 s47, s44, 18944
    buffer_store_dwordx4 v[216:219], v6, s[24:27], s47 offen sc0 sc1
    ds_write_b128 v5, v[216:219] offset:2816
    v_mul_f32 v16, v16, v8
    v_mul_f32 v17, v17, v8
    v_mul_f32 v18, v18, v8
    v_mul_f32 v19, v19, v8
    v_mul_f32 v20, v20, v8
    v_mul_f32 v21, v21, v8
    v_mul_f32 v22, v22, v8
    v_mul_f32 v23, v23, v8
    v_cvt_pk_bf16_f32 v16, v16, v17
    v_cvt_pk_bf16_f32 v17, v18, v19
    v_cvt_pk_bf16_f32 v18, v20, v21
    v_cvt_pk_bf16_f32 v19, v22, v23
    v_mul_f32 v24, v24, v8
    v_mul_f32 v25, v25, v8
    v_mul_f32 v26, v26, v8
    v_mul_f32 v27, v27, v8
    v_mul_f32 v28, v28, v8
    v_mul_f32 v29, v29, v8
    v_mul_f32 v30, v30, v8
    v_mul_f32 v31, v31, v8
    v_cvt_pk_bf16_f32 v24, v24, v25
    v_cvt_pk_bf16_f32 v25, v26, v27
    v_cvt_pk_bf16_f32 v26, v28, v29
    v_cvt_pk_bf16_f32 v27, v30, v31
    v_mul_f32 v48, v48, v8
    v_mul_f32 v49, v49, v8
    v_mul_f32 v50, v50, v8
    v_mul_f32 v51, v51, v8
    v_mul_f32 v52, v52, v8
    v_mul_f32 v53, v53, v8
    v_mul_f32 v54, v54, v8
    v_mul_f32 v55, v55, v8
    v_cvt_pk_bf16_f32 v48, v48, v49
    v_cvt_pk_bf16_f32 v49, v50, v51
    v_cvt_pk_bf16_f32 v50, v52, v53
    v_cvt_pk_bf16_f32 v51, v54, v55
    v_mul_f32 v56, v56, v8
    v_mul_f32 v57, v57, v8
    v_mul_f32 v58, v58, v8
    v_mul_f32 v59, v59, v8
    v_mul_f32 v60, v60, v8
    v_mul_f32 v61, v61, v8
    v_mul_f32 v62, v62, v8
    v_mul_f32 v63, v63, v8
    v_cvt_pk_bf16_f32 v56, v56, v57
    v_cvt_pk_bf16_f32 v57, v58, v59
    v_cvt_pk_bf16_f32 v58, v60, v61
    v_cvt_pk_bf16_f32 v59, v62, v63
    ds_write_b128 v2, v[16:19] offset:0
    ds_write_b128 v2, v[24:27] offset:8192
    ds_write_b128 v2, v[48:51] offset:16384
    ds_write_b128 v2, v[56:59] offset:24576
    v_mul_f32 v32, v32, v8
    v_mul_f32 v33, v33, v8
    v_mul_f32 v34, v34, v8
    v_mul_f32 v35, v35, v8
    v_mul_f32 v36, v36, v8
    v_mul_f32 v37, v37, v8
    v_mul_f32 v38, v38, v8
    v_mul_f32 v39, v39, v8
    v_cvt_pk_bf16_f32 v32, v32, v33
    v_cvt_pk_bf16_f32 v33, v34, v35
    v_cvt_pk_bf16_f32 v34, v36, v37
    v_cvt_pk_bf16_f32 v35, v38, v39
    v_mul_f32 v40, v40, v8
    v_mul_f32 v41, v41, v8
    v_mul_f32 v42, v42, v8
    v_mul_f32 v43, v43, v8
    v_mul_f32 v44, v44, v8
    v_mul_f32 v45, v45, v8
    v_mul_f32 v46, v46, v8
    v_mul_f32 v47, v47, v8
    v_cvt_pk_bf16_f32 v40, v40, v41
    v_cvt_pk_bf16_f32 v41, v42, v43
    v_cvt_pk_bf16_f32 v42, v44, v45
    v_cvt_pk_bf16_f32 v43, v46, v47
    v_mul_f32 v64, v64, v8
    v_mul_f32 v65, v65, v8
    v_mul_f32 v66, v66, v8
    v_mul_f32 v67, v67, v8
    v_mul_f32 v68, v68, v8
    v_mul_f32 v69, v69, v8
    v_mul_f32 v70, v70, v8
    v_mul_f32 v71, v71, v8
    v_cvt_pk_bf16_f32 v64, v64, v65
    v_cvt_pk_bf16_f32 v65, v66, v67
    v_cvt_pk_bf16_f32 v66, v68, v69
    v_cvt_pk_bf16_f32 v67, v70, v71
    v_mul_f32 v72, v72, v8
    v_mul_f32 v73, v73, v8
    v_mul_f32 v74, v74, v8
    v_mul_f32 v75, v75, v8
    v_mul_f32 v76, v76, v8
    v_mul_f32 v77, v77, v8
    v_mul_f32 v78, v78, v8
    v_mul_f32 v79, v79, v8
    v_cvt_pk_bf16_f32 v72, v72, v73
    v_cvt_pk_bf16_f32 v73, v74, v75
    v_cvt_pk_bf16_f32 v74, v76, v77
    v_cvt_pk_bf16_f32 v75, v78, v79
    ds_write_b128 v2, v[32:35] offset:1024
    ds_write_b128 v2, v[40:43] offset:9216
    ds_write_b128 v2, v[64:67] offset:17408
    ds_write_b128 v2, v[72:75] offset:25600
    v_mov_b32 v244, 0
    v_mov_b32 v245, 0
    v_mov_b32 v246, 0
    v_mov_b32 v247, 0
    ds_write_b128 v7, v[244:247] offset:1024
    ds_write_b128 v7, v[244:247] offset:2064
    s_branch F_QEPI_DONE
HC_38:
    s_mov_b32 s100, 0
HC_38a:
    buffer_load_dword v14, v15, s[24:27], s9 offen sc0 sc1
    s_waitcnt vmcnt(0)
    v_readfirstlane_b32 s101, v14
    s_nop 1
    s_xor_b32 s101, s101, s8
    s_and_b32 s5, s101, 0xffffffe0
    s_cmp_eq_u32 s5, 0
    s_cbranch_scc1 HC_38b
    s_add_u32 s100, s100, 1
    s_cmp_lt_u32 s100, 20000
    s_cbranch_scc1 HC_38a
HC_38b:
    s_and_b32 s5, s101, 15
    s_cmp_eq_u32 s5, 0
    s_cbranch_scc1 HCR_39
    buffer_inv sc1
    s_waitcnt vmcnt(0)
    s_branch HCR_39
F_DONE:
    s_endpgm
F_CODE_END:
.set CODE_SPAN, (F_CODE_END - gated_mix__sliding_block__mixer_channel_mlp__prompt_kernel - 4)
.section .rodata,"a"
.p2align 6
.amdhsa_kernel gated_mix__sliding_block__mixer_channel_mlp__prompt_kernel
  .amdhsa_next_free_vgpr 512
  .amdhsa_next_free_sgpr 102
  .amdhsa_accum_offset 256
  .amdhsa_group_segment_fixed_size 0
  .amdhsa_kernarg_size 96
  .amdhsa_user_sgpr_count 2
  .amdhsa_user_sgpr_kernarg_segment_ptr 1
  .amdhsa_system_sgpr_workgroup_id_x 1
.end_amdhsa_kernel
```
